```python
import torch

def _softmax(x, axis=-1):
    return torch.softmax(x, dim=axis)

def _gelu(x):
    return torch.nn.functional.gelu(x, approximate='tanh')

def _silu(x):
    return torch.nn.functional.silu(x)

def _sigmoid(x):
    return torch.sigmoid(x)

def _layernorm(x, axis=-1, eps=1e-05):
    m = x.mean(dim=axis, keepdim=True)
    v = x.var(dim=axis, keepdim=True, unbiased=False)
    return (x - m) / torch.sqrt(v + eps)

def _scatter_add(tgt, idx, src, axis=0):
    return tgt.clone().index_add_(axis, idx, src)

def _segment_sum(src, seg, n):
    out = torch.zeros((n,) + src.shape[1:], dtype=src.dtype)
    return out.index_add_(0, seg, src)

def _pad(x, pw):
    flat = tuple((v for pair in reversed(pw) for v in pair))
    return torch.nn.functional.pad(x, flat)
kernel_name = 'interleave_layers__memory_aug_recurrent_mem_tr__dense_activation_relu__prompt'

def setup_inputs():

    _w = lambda a: (lambda t: t.to(torch.bfloat16) if t.is_floating_point() else t)(torch.as_tensor(a))

    def _A_setup():
        B, S, Dm = (1, 2048, 640)
        H, Dh = (32, 128)
        M, seg = (8, 32)
        seg = min(seg, S)
        S = S // seg * seg
        return {'x': _w((lambda *s: torch.randn(*s, dtype=torch.bfloat16) * 0.05)(B, S, Dm)), 'mem0': _w((lambda *s: torch.randn(*s, dtype=torch.bfloat16) * 0.8)(B, M, Dm)), 'Wq': _w((lambda *s: torch.randn(*s, dtype=torch.bfloat16) * 0.8)(Dm, H, Dh) * Dm ** (-0.5)), 'Wk': _w((lambda *s: torch.randn(*s, dtype=torch.bfloat16) * 0.8)(Dm, H, Dh) * Dm ** (-0.5)), 'Wv': _w((lambda *s: torch.randn(*s, dtype=torch.bfloat16) * 0.8)(Dm, H, Dh) * Dm ** (-0.5)), 'Wo': _w((lambda *s: torch.randn(*s, dtype=torch.bfloat16) * 0.8)(H, Dh, Dm) * (H * Dh) ** (-0.5)), 'seg_len': seg}
    _A_in = _A_setup()

    def _B_setup():
        B, S, D, Dff = (1, 2048, 640, 1728)
        return {'x': _w((lambda *s: torch.randn(*s, dtype=torch.bfloat16) * 0.05)(B, S, D)), 'w1': _w((lambda *s: torch.randn(*s, dtype=torch.bfloat16) * 0.05)(D, Dff)), 'w2': _w((lambda *s: torch.randn(*s, dtype=torch.bfloat16) * 0.05)(Dff, D))}
    _B_in = _B_setup()
    return {'A_x': _A_in['x'], 'A_mem0': _A_in['mem0'], 'A_Wq': _A_in['Wq'], 'A_Wk': _A_in['Wk'], 'A_Wv': _A_in['Wv'], 'A_Wo': _A_in['Wo'], 'A_seg_len': _A_in['seg_len'], 'B_x': _B_in['x'], 'B_w1': _B_in['w1'], 'B_w2': _B_in['w2']}

def reference(A_x, A_mem0, A_Wq, A_Wk, A_Wv, A_Wo, A_seg_len, B_x, B_w1, B_w2):

    def _A_ref(x, mem0, Wq, Wk, Wv, Wo, seg_len):
        B, S, Dm = x.shape
        H, Dh = (Wq.shape[1], Wq.shape[2])
        M = mem0.shape[1]
        scale = Dh ** (-0.5)
        n_seg = S // seg_len
        L = M + seg_len
        idx = torch.arange(L)
        mask = (idx[:, None] < M) | (idx[:, None] >= idx[None, :])
        mem = mem0
        outs = []
        for s in range(n_seg):
            xs = x[:, s * seg_len:(s + 1) * seg_len, :].clone()
            h = torch.concatenate([mem, xs], axis=1)
            q = torch.einsum('btd,dhe->bhte', h, Wq)
            k = torch.einsum('btd,dhe->bhte', h, Wk)
            v = torch.einsum('btd,dhe->bhte', h, Wv)
            scores = torch.einsum('bhqe,bhke->bhqk', q, k) * scale
            scores = torch.where(mask[None, None], scores, -1000000000.0)
            p = _softmax(scores, axis=-1)
            o = torch.einsum('bhqk,bhke->bhqe', p, v)
            o = torch.einsum('bhte,hed->btd', o, Wo)
            mem = o[:, :M, :].clone()
            outs.append(o[:, M:, :])
        return torch.concatenate(outs, axis=1)

    def _B_ref(x, w1, w2):
        h = torch.einsum('bsd,df->bsf', x, w1)
        zero = torch.zeros_like(h)
        h = torch.maximum(h, zero)
        return torch.einsum('bsf,fd->bsd', h, w2)
    x = A_x
    x = x + _A_ref(_layernorm(x, axis=-1), A_mem0, A_Wq, A_Wk, A_Wv, A_Wo, A_seg_len)
    x = x + _B_ref(_layernorm(x, axis=-1), B_w1, B_w2)
    x = x + _A_ref(_layernorm(x, axis=-1), A_mem0, A_Wq, A_Wk, A_Wv, A_Wo, A_seg_len)
    x = x + _B_ref(_layernorm(x, axis=-1), B_w1, B_w2)
    return x
```

```asm
; @launch kernel=interleave_layers__memory_aug_recurrent_mem_tr__dense_activation_relu__prompt_kernel grid=(256,1,1) block=(256,1,1) lds=163840
.amdgcn_target "amdgcn-amd-amdhsa--gfx950"
.text
.globl interleave_layers__memory_aug_recurrent_mem_tr__dense_activation_relu__prompt_kernel
.p2align 8
.type interleave_layers__memory_aug_recurrent_mem_tr__dense_activation_relu__prompt_kernel,@function
interleave_layers__memory_aug_recurrent_mem_tr__dense_activation_relu__prompt_kernel:
    s_cmp_ge_u32 s2, 256
    s_cbranch_scc1 L_end
    s_load_dwordx16 s[64:79], s[0:1], 0
    s_load_dwordx8 s[80:87], s[0:1], 64
    s_load_dwordx2 s[88:89], s[0:1], 96
    s_waitcnt lgkmcnt(0)
    s_mov_b32 s8, s88
    s_mov_b32 s9, s89
    s_mov_b32 s10, 0x10000000
    s_mov_b32 s11, 0x20000
    s_mov_b32 s12, s68
    s_mov_b32 s13, s69
    s_mov_b32 s14, 0x500000
    s_mov_b32 s15, 0x20000
    s_mov_b32 s16, s70
    s_mov_b32 s17, s71
    s_mov_b32 s18, 0x500000
    s_mov_b32 s19, 0x20000
    s_mov_b32 s20, s72
    s_mov_b32 s21, s73
    s_mov_b32 s22, 0x500000
    s_mov_b32 s23, 0x20000
    s_mov_b32 s24, s74
    s_mov_b32 s25, s75
    s_mov_b32 s26, 0x500000
    s_mov_b32 s27, 0x20000
    s_mov_b32 s28, s64
    s_mov_b32 s29, s65
    s_mov_b32 s30, 0x280000
    s_mov_b32 s31, 0x20000
    s_mov_b32 s32, s66
    s_mov_b32 s33, s67
    s_mov_b32 s34, 0x2800
    s_mov_b32 s35, 0x20000
    s_mov_b32 s36, s80
    s_mov_b32 s37, s81
    s_mov_b32 s38, 0x21c000
    s_mov_b32 s39, 0x20000
    s_mov_b32 s40, s82
    s_mov_b32 s41, s83
    s_mov_b32 s42, 0x21c000
    s_mov_b32 s43, 0x20000
    s_mov_b32 s44, s84
    s_mov_b32 s45, s85
    s_mov_b32 s46, 0x280000
    s_mov_b32 s47, 0x20000
    s_mov_b32 s48, s86
    s_mov_b32 s49, s87
    s_mov_b32 s50, 0x100
    s_mov_b32 s51, 0x20000
    s_getreg_b32 s97, hwreg(HW_REG_XCC_ID)
    s_and_b32 s97, s97, 15
    v_lshrrev_b32 v1, 6, v0
    s_nop 0
    v_readfirstlane_b32 s52, v1
    s_mov_b32 s96, 0
    v_mbcnt_lo_u32_b32 v1, -1, 0
    v_mbcnt_hi_u32_b32 v1, -1, v1
    v_lshlrev_b32 v2, 4, v1
    s_cmp_lg_u32 s52, 0
    s_cbranch_scc1 L_w123a
    s_mov_b64 exec, 1
    v_mov_b32 v8, 1
    s_lshl_b32 s70, s97, 2
    s_add_u32 s70, s70, 128
    s_cmp_eq_u32 s97, 0
    s_cselect_b32 s70, 0, s70
    buffer_atomic_add v8, off, s[48:51], s70 sc0
    s_waitcnt vmcnt(0)
    v_mov_b32 v3, 0
    ds_write_b32 v3, v8
    s_mov_b64 exec, 0xffffffff
    v_mov_b32 v4, 0
    v_mov_b32 v5, 0
    v_mov_b32 v6, 0
    v_mov_b32 v7, 0
    s_lshl_b32 s70, s2, 9
    s_sub_u32 s71, s70, 32768
    s_cmp_lt_u32 s71, 1024
    s_cselect_b32 s70, 0x20000000, s70
    buffer_store_dwordx4 v[4:7], v2, s[8:11], s70 offen sc1
    s_mov_b64 exec, -1
    s_branch L_joina
L_w123a:
    v_mov_b32 v4, 0xff81ff81
    v_mov_b32 v5, 0xff81ff81
    v_mov_b32 v6, 0xff81ff81
    v_mov_b32 v7, 0xff81ff81
    s_mul_i32 s70, s2, 3072
    s_lshl_b32 s71, s52, 10
    s_add_u32 s70, s70, s71
    s_add_u32 s70, s70, 130048
    buffer_store_dwordx4 v[4:7], v2, s[8:11], s70 offen sc1
L_joina:
    s_waitcnt lgkmcnt(0)
    s_barrier
    v_mov_b32 v3, 0
    ds_read_b32 v9, v3
    s_waitcnt lgkmcnt(0)
    v_readfirstlane_b32 s98, v9
    s_min_u32 s70, s97, 8
    s_cmp_ge_u32 s97, 8
    s_cbranch_scc1 L_nomap
    s_lshl_b32 s70, s97, 2
    s_lshr_b32 s97, 0x76543210, s70
    s_and_b32 s97, s97, 15
L_nomap:
    s_lshl_b32 s99, s97, 5
    s_add_u32 s99, s99, s98
    s_sub_u32 s70, s98, 20
    s_cmp_lt_u32 s70, 8
    s_cbranch_scc0 L_noown
    s_lshl_b32 s70, s70, 7
    s_lshl_b32 s71, s52, 2
    s_add_u32 s70, s70, s71
    s_add_u32 s70, s70, 32768
    s_cmp_eq_u32 s97, 5
    s_cbranch_scc0 L_noown
L_own:
    buffer_store_dword v3, off, s[8:11], s70 sc1
L_noown:
    s_waitcnt vmcnt(0)
    s_barrier
    s_cmp_lg_u32 s52, 0
    s_cbranch_scc1 L_arr
    s_mov_b64 exec, 1
    v_mov_b32 v9, 1
    buffer_atomic_add v9, off, s[48:51], 0 offset:32
    s_mov_b64 exec, -1
L_arr:
    s_cmp_ge_u32 s98, 32
    s_cbranch_scc1 L_slow
    s_cmp_ge_u32 s97, 8
    s_cbranch_scc0 L_dispatch
L_slow:
    s_waitcnt vmcnt(0) lgkmcnt(0)
    s_barrier
    v_mbcnt_lo_u32_b32 v1, -1, 0
    v_mbcnt_hi_u32_b32 v1, -1, v1
    v_lshlrev_b32 v2, 4, v1
    s_cmp_lg_u32 s52, 0
    s_cbranch_scc1 L_w123b
    s_mov_b64 exec, 0xffffffff
    v_mov_b32 v4, 0
    v_mov_b32 v5, 0
    v_mov_b32 v6, 0
    v_mov_b32 v7, 0
    s_lshl_b32 s70, s2, 9
    buffer_store_dwordx4 v[4:7], v2, s[8:11], s70 offen sc1
    s_mov_b64 exec, -1
    s_branch L_joinb
L_w123b:
    v_mov_b32 v4, 0xff81ff81
    v_mov_b32 v5, 0xff81ff81
    v_mov_b32 v6, 0xff81ff81
    v_mov_b32 v7, 0xff81ff81
    s_mul_i32 s70, s2, 3072
    s_lshl_b32 s71, s52, 10
    s_add_u32 s70, s70, s71
    s_add_u32 s70, s70, 130048
    buffer_store_dwordx4 v[4:7], v2, s[8:11], s70 offen sc1
L_joinb:
    s_waitcnt vmcnt(0)
    s_barrier
    s_cmp_lg_u32 s52, 0
    s_cbranch_scc1 L_arr2
    s_mov_b64 exec, 1
    v_mov_b32 v9, 1
    buffer_atomic_add v9, off, s[48:51], 0 offset:36
    s_mov_b64 exec, -1
    s_mov_b32 s68, 0
L_poll2:
    buffer_load_dword v9, off, s[48:51], 0 offset:36 sc1
    s_waitcnt vmcnt(0)
    v_readfirstlane_b32 s70, v9
    s_nop 0
    s_cmp_ge_u32 s70, 256
    s_cbranch_scc1 L_arr2
    s_sleep 8
    s_add_u32 s68, s68, 1
    s_cmp_lt_u32 s68, 65536
    s_cbranch_scc1 L_poll2
L_arr2:
    s_barrier
    s_mov_b32 s96, 1
    s_mov_b32 s99, s2
    v_mov_b32 v0, v1
L_dispatch:
    s_lshr_b32 s97, s99, 5
    s_and_b32 s98, s99, 31
    s_cmp_ge_u32 s97, 2
    s_cbranch_scc1 L_bulk
    s_mov_b32 s53, s98
    s_mov_b32 s54, s97
    s_cmp_eq_u32 s52, 0
    s_cbranch_scc1 CH0_entry
    s_cmp_eq_u32 s52, 1
    s_cbranch_scc1 CH1_entry
    s_cmp_eq_u32 s52, 2
    s_cbranch_scc1 CH2_entry
    s_cmp_eq_u32 s52, 3
    s_cbranch_scc1 CH3_entry
L_bulk:
    s_cmp_ge_u32 s97, 5
    s_cselect_b32 s54, 1, 0
    s_mul_i32 s70, s54, 3
    s_sub_u32 s70, s97, s70
    s_sub_u32 s70, s70, 2
    s_mov_b32 s53, s98
    s_cmp_eq_u32 s70, 2
    s_cbranch_scc1 L_qkv
    s_cmp_eq_u32 s70, 1
    s_cbranch_scc1 L_t1
    s_cmp_lt_u32 s98, 20
    s_cbranch_scc1 G2op_entry
    s_sub_u32 s53, s98, 20
    s_cmp_ge_u32 s98, 28
    s_cbranch_scc1 L_natt
    s_cmp_eq_u32 s54, 0
    s_cbranch_scc1 ATT_entry
    s_branch LN0_entry
L_natt:
    s_sub_u32 s53, s98, 28
    s_cmp_lt_u32 s98, 30
    s_cbranch_scc1 LNA_entry
    s_mov_b32 s53, s54
    s_cmp_eq_u32 s98, 30
    s_cbranch_scc1 LN1_entry
    s_mov_b32 s53, 6
    s_branch G1f1_entry
L_t1:
    s_lshr_b32 s54, s98, 4
    s_and_b32 s71, s98, 15
    s_add_u32 s53, s71, 32
    s_cmp_eq_u32 s97, 6
    s_cbranch_scc1 L_qkv
    s_mov_b32 s53, s71
    s_cmp_lt_u32 s71, 10
    s_cbranch_scc1 G2f2_entry
    s_sub_u32 s53, s71, 10
    s_branch G1f1_entry
L_qkv:
    s_mul_i32 s70, s53, 43
    s_lshr_b32 s70, s70, 7
    s_mul_i32 s70, s70, 3
    s_sub_u32 s70, s53, s70
    s_cmp_eq_u32 s70, 2
    s_cbranch_scc1 G1v_entry
    s_branch G1qk_entry
L_end:
    s_endpgm
LN1_entry:
    v_and_b32 v0, 63, v0
    v_lshlrev_b32 v1, 4, v0
    v_min_u32 v2, 9, v0
    v_lshlrev_b32 v2, 7, v2
    s_mov_b32 s55, 0
    s_mov_b32 s60, 0
    s_mov_b32 s61, 0
    s_mov_b32 s69, 0
    v_lshrrev_b32 v8, 4, v0
    v_and_b32 v9, 15, v0
    v_lshlrev_b32 v10, 9, v8
    v_lshl_add_u32 v32, v9, 4, v10
    s_lshl_b32 s70, s52, 2
    v_add_u32 v34, s70, v1
    s_and_b32 s73, s53, 1
    s_lshl_b32 s73, s73, 8
    s_mul_i32 s72, s52, 10240
    s_add_u32 s72, s72, s73
    s_add_u32 s56, s72, 176029696
    s_add_u32 s57, s72, 170786816
    s_mov_b32 s58, 114688
    s_mov_b32 s54, 1
    s_mul_i32 s59, s54, 8192
    s_lshl_b32 s70, s53, 7
    s_add_u32 s59, s59, s70
    s_lshl_b32 s70, s52, 2
    s_add_u32 s59, s59, s70
    s_add_u32 s59, s59, 32768
    s_cmp_lg_u32 s96, 0
    s_cbranch_scc1 RDY_ok_1
    s_mov_b32 s68, 0
RDY_lp_2:
    buffer_load_dword v40, off, s[48:51], 0 offset:32 sc1
    s_waitcnt vmcnt(0)
    v_readfirstlane_b32 s70, v40
    s_nop 0
    s_cmp_ge_u32 s70, 256
    s_cbranch_scc1 RDY_all_3
    s_sleep 8
    s_add_u32 s68, s68, 1
    s_cmp_lt_u32 s68, 65536
    s_cbranch_scc1 RDY_lp_2
    s_branch RDY_ok_1
RDY_all_3:
    v_mbcnt_lo_u32_b32 v41, -1, 0
    v_and_b32 v41, 7, v41
    v_min_u32 v42, 1, v41
    v_lshlrev_b32 v41, 2, v41
    v_lshl_add_u32 v41, v42, 7, v41
    buffer_load_dword v40, v41, s[48:51], 0 offen sc1
    s_waitcnt vmcnt(0)
    v_cmp_ne_u32 vcc, 32, v40
    s_nop 0
    s_cbranch_vccnz L_slow
RDY_ok_1:
LN1_fetch:
    s_cmp_gt_u32 s60, s55
    s_cbranch_scc1 LN1_p_ok_4
    s_mov_b32 s68, 0
LN1_p_lp_5:
    buffer_load_dwordx4 v[4:7], v2, s[8:11], s58 offen sc1
    s_waitcnt vmcnt(0)
    v_min3_u32 v4, v4, v5, v6
    v_min_u32 v4, v4, v7
    s_nop 1
    v_min_u32_dpp v4, v4, v4 row_ror:1 row_mask:0xf bank_mask:0xf
    s_nop 1
    v_min_u32_dpp v4, v4, v4 row_ror:2 row_mask:0xf bank_mask:0xf
    s_nop 1
    v_min_u32_dpp v4, v4, v4 row_ror:4 row_mask:0xf bank_mask:0xf
    s_nop 1
    v_min_u32_dpp v4, v4, v4 row_ror:8 row_mask:0xf bank_mask:0xf
    s_nop 0
    v_readlane_b32 s70, v4, 0
    s_nop 0
    s_max_u32 s60, s60, s70
    s_cmp_gt_u32 s60, s55
    s_cbranch_scc1 LN1_p_ok_4
    s_cmp_lg_u32 s69, 0
    s_cbranch_scc1 LN1_p_ok_4
    s_sleep 2
    s_add_u32 s68, s68, 1
    s_cmp_lt_u32 s68, 65536
    s_cbranch_scc1 LN1_p_lp_5
    s_mov_b32 s69, 1
LN1_p_ok_4:
    s_add_u32 s73, s56, 0
    buffer_load_dwordx4 v[44:47], v32, s[8:11], s73 offen offset:0 sc1
    buffer_load_dwordx4 v[48:51], v32, s[8:11], s73 offen offset:2048 sc1
    s_add_u32 s73, s56, 4096
    buffer_load_dwordx4 v[52:55], v32, s[8:11], s73 offen offset:0 sc1
    buffer_load_dwordx4 v[56:59], v32, s[8:11], s73 offen offset:2048 sc1
    s_add_u32 s73, s56, 8192
    buffer_load_dwordx4 v[60:63], v32, s[8:11], s73 offen offset:0 sc1
    s_add_u32 s56, s56, 40960
LN1_top:
    s_waitcnt vmcnt(4)
    v_lshlrev_b32 v164, 16, v44
    v_and_b32 v165, 0xffff0000, v44
    v_lshlrev_b32 v166, 16, v45
    v_and_b32 v167, 0xffff0000, v45
    v_pk_add_f32 v[8:9], v[164:165], v[166:167]
    v_lshlrev_b32 v168, 16, v46
    v_and_b32 v169, 0xffff0000, v46
    v_pk_add_f32 v[8:9], v[8:9], v[168:169]
    v_lshlrev_b32 v170, 16, v47
    v_and_b32 v171, 0xffff0000, v47
    v_pk_add_f32 v[8:9], v[8:9], v[170:171]
    s_waitcnt vmcnt(3)
    v_lshlrev_b32 v172, 16, v48
    v_and_b32 v173, 0xffff0000, v48
    v_pk_add_f32 v[8:9], v[8:9], v[172:173]
    v_lshlrev_b32 v174, 16, v49
    v_and_b32 v175, 0xffff0000, v49
    v_pk_add_f32 v[8:9], v[8:9], v[174:175]
    v_lshlrev_b32 v176, 16, v50
    v_and_b32 v177, 0xffff0000, v50
    v_pk_add_f32 v[8:9], v[8:9], v[176:177]
    v_lshlrev_b32 v178, 16, v51
    v_and_b32 v179, 0xffff0000, v51
    v_pk_add_f32 v[8:9], v[8:9], v[178:179]
    s_waitcnt vmcnt(2)
    v_lshlrev_b32 v180, 16, v52
    v_and_b32 v181, 0xffff0000, v52
    v_pk_add_f32 v[8:9], v[8:9], v[180:181]
    v_lshlrev_b32 v182, 16, v53
    v_and_b32 v183, 0xffff0000, v53
    v_pk_add_f32 v[8:9], v[8:9], v[182:183]
    v_lshlrev_b32 v184, 16, v54
    v_and_b32 v185, 0xffff0000, v54
    v_pk_add_f32 v[8:9], v[8:9], v[184:185]
    v_lshlrev_b32 v186, 16, v55
    v_and_b32 v187, 0xffff0000, v55
    v_pk_add_f32 v[8:9], v[8:9], v[186:187]
    s_waitcnt vmcnt(1)
    v_lshlrev_b32 v188, 16, v56
    v_and_b32 v189, 0xffff0000, v56
    v_pk_add_f32 v[8:9], v[8:9], v[188:189]
    v_lshlrev_b32 v190, 16, v57
    v_and_b32 v191, 0xffff0000, v57
    v_pk_add_f32 v[8:9], v[8:9], v[190:191]
    v_lshlrev_b32 v192, 16, v58
    v_and_b32 v193, 0xffff0000, v58
    v_pk_add_f32 v[8:9], v[8:9], v[192:193]
    v_lshlrev_b32 v194, 16, v59
    v_and_b32 v195, 0xffff0000, v59
    v_pk_add_f32 v[8:9], v[8:9], v[194:195]
    s_waitcnt vmcnt(0)
    v_lshlrev_b32 v196, 16, v60
    v_and_b32 v197, 0xffff0000, v60
    v_pk_add_f32 v[8:9], v[8:9], v[196:197]
    v_lshlrev_b32 v198, 16, v61
    v_and_b32 v199, 0xffff0000, v61
    v_pk_add_f32 v[8:9], v[8:9], v[198:199]
    v_lshlrev_b32 v200, 16, v62
    v_and_b32 v201, 0xffff0000, v62
    v_pk_add_f32 v[8:9], v[8:9], v[200:201]
    v_lshlrev_b32 v202, 16, v63
    v_and_b32 v203, 0xffff0000, v63
    v_pk_add_f32 v[8:9], v[8:9], v[202:203]
    v_add_f32 v8, v8, v9
    v_mov_b32 v12, v8
    s_nop 1
    v_permlane16_swap_b32 v12, v8
    v_add_f32 v8, v8, v12
    v_mov_b32 v12, v8
    s_nop 1
    v_permlane32_swap_b32 v12, v8
    v_add_f32 v8, v8, v12
    ds_write_b32 v34, v8 offset:0
    s_add_u32 s55, s55, 1
    buffer_load_dwordx4 v[4:7], v2, s[8:11], s58 offen sc1
    s_waitcnt lgkmcnt(0)
    s_barrier
    ds_read_b128 v[8:11], v1 offset:0
    s_waitcnt lgkmcnt(0)
    v_pk_add_f32 v[8:9], v[8:9], v[10:11]
    v_add_f32 v8, v8, v9
    v_mul_f32 v8, 0xbacccccd, v8
    v_mov_b32 v9, v8
    v_mov_b32 v18, v8
    v_cvt_pk_bf16_f32 v18, v18, v18
    v_lshlrev_b32 v18, 16, v18
    v_sub_f32 v18, v18, v8
    v_pk_add_f32 v[164:165], v[164:165], v[8:9]
    v_pk_mul_f32 v[10:11], v[164:165], v[164:165]
    v_pk_add_f32 v[166:167], v[166:167], v[8:9]
    v_pk_fma_f32 v[10:11], v[166:167], v[166:167], v[10:11]
    v_pk_add_f32 v[168:169], v[168:169], v[8:9]
    v_pk_fma_f32 v[10:11], v[168:169], v[168:169], v[10:11]
    v_pk_add_f32 v[170:171], v[170:171], v[8:9]
    v_pk_fma_f32 v[10:11], v[170:171], v[170:171], v[10:11]
    v_pk_add_f32 v[172:173], v[172:173], v[8:9]
    v_pk_fma_f32 v[10:11], v[172:173], v[172:173], v[10:11]
    v_pk_add_f32 v[174:175], v[174:175], v[8:9]
    v_pk_fma_f32 v[10:11], v[174:175], v[174:175], v[10:11]
    v_pk_add_f32 v[176:177], v[176:177], v[8:9]
    v_pk_fma_f32 v[10:11], v[176:177], v[176:177], v[10:11]
    v_pk_add_f32 v[178:179], v[178:179], v[8:9]
    v_pk_fma_f32 v[10:11], v[178:179], v[178:179], v[10:11]
    v_pk_add_f32 v[180:181], v[180:181], v[8:9]
    v_pk_fma_f32 v[10:11], v[180:181], v[180:181], v[10:11]
    v_pk_add_f32 v[182:183], v[182:183], v[8:9]
    v_pk_fma_f32 v[10:11], v[182:183], v[182:183], v[10:11]
    v_pk_add_f32 v[184:185], v[184:185], v[8:9]
    v_pk_fma_f32 v[10:11], v[184:185], v[184:185], v[10:11]
    v_pk_add_f32 v[186:187], v[186:187], v[8:9]
    v_pk_fma_f32 v[10:11], v[186:187], v[186:187], v[10:11]
    v_pk_add_f32 v[188:189], v[188:189], v[8:9]
    v_pk_fma_f32 v[10:11], v[188:189], v[188:189], v[10:11]
    v_pk_add_f32 v[190:191], v[190:191], v[8:9]
    v_pk_fma_f32 v[10:11], v[190:191], v[190:191], v[10:11]
    v_pk_add_f32 v[192:193], v[192:193], v[8:9]
    v_pk_fma_f32 v[10:11], v[192:193], v[192:193], v[10:11]
    v_pk_add_f32 v[194:195], v[194:195], v[8:9]
    v_pk_fma_f32 v[10:11], v[194:195], v[194:195], v[10:11]
    v_pk_add_f32 v[196:197], v[196:197], v[8:9]
    v_pk_fma_f32 v[10:11], v[196:197], v[196:197], v[10:11]
    v_pk_add_f32 v[198:199], v[198:199], v[8:9]
    v_pk_fma_f32 v[10:11], v[198:199], v[198:199], v[10:11]
    v_pk_add_f32 v[200:201], v[200:201], v[8:9]
    v_pk_fma_f32 v[10:11], v[200:201], v[200:201], v[10:11]
    v_pk_add_f32 v[202:203], v[202:203], v[8:9]
    v_pk_fma_f32 v[10:11], v[202:203], v[202:203], v[10:11]
    v_add_f32 v8, v10, v11
    v_mov_b32 v12, v8
    s_nop 1
    v_permlane16_swap_b32 v12, v8
    v_add_f32 v8, v8, v12
    v_mov_b32 v12, v8
    s_nop 1
    v_permlane32_swap_b32 v12, v8
    v_add_f32 v8, v8, v12
    ds_write_b32 v34, v8 offset:1024
    s_waitcnt lgkmcnt(0)
    s_barrier
    ds_read_b128 v[8:11], v1 offset:1024
    s_waitcnt lgkmcnt(0)
    v_pk_add_f32 v[8:9], v[8:9], v[10:11]
    v_add_f32 v8, v8, v9
    v_mul_f32 v10, 0x3acccccd, v8
    v_cvt_pk_bf16_f32 v10, v10, v10
    v_lshlrev_b32 v10, 16, v10
    v_add_f32 v10, 0x3727c5ac, v10
    v_cvt_pk_bf16_f32 v10, v10, v10
    v_lshlrev_b32 v10, 16, v10
    v_sqrt_f32 v10, v10
    s_nop 0
    v_cvt_pk_bf16_f32 v10, v10, v10
    v_lshlrev_b32 v10, 16, v10
    v_rcp_f32 v8, v10
    s_nop 0
    v_mov_b32 v9, v8
    v_mul_f32 v18, v18, v8
    v_mov_b32 v19, v18
    v_pk_fma_f32 v[164:165], v[164:165], v[8:9], v[18:19]
    v_cvt_pk_bf16_f32 v204, v164, v165
    v_pk_fma_f32 v[166:167], v[166:167], v[8:9], v[18:19]
    v_cvt_pk_bf16_f32 v205, v166, v167
    v_pk_fma_f32 v[168:169], v[168:169], v[8:9], v[18:19]
    v_cvt_pk_bf16_f32 v206, v168, v169
    v_pk_fma_f32 v[170:171], v[170:171], v[8:9], v[18:19]
    v_cvt_pk_bf16_f32 v207, v170, v171
    s_add_u32 s73, s57, 0
    buffer_store_dwordx4 v[204:207], v32, s[8:11], s73 offen offset:0 sc1
    v_pk_fma_f32 v[172:173], v[172:173], v[8:9], v[18:19]
    v_cvt_pk_bf16_f32 v208, v172, v173
    v_pk_fma_f32 v[174:175], v[174:175], v[8:9], v[18:19]
    v_cvt_pk_bf16_f32 v209, v174, v175
    v_pk_fma_f32 v[176:177], v[176:177], v[8:9], v[18:19]
    v_cvt_pk_bf16_f32 v210, v176, v177
    v_pk_fma_f32 v[178:179], v[178:179], v[8:9], v[18:19]
    v_cvt_pk_bf16_f32 v211, v178, v179
    buffer_store_dwordx4 v[208:211], v32, s[8:11], s73 offen offset:2048 sc1
    v_pk_fma_f32 v[180:181], v[180:181], v[8:9], v[18:19]
    v_cvt_pk_bf16_f32 v212, v180, v181
    v_pk_fma_f32 v[182:183], v[182:183], v[8:9], v[18:19]
    v_cvt_pk_bf16_f32 v213, v182, v183
    v_pk_fma_f32 v[184:185], v[184:185], v[8:9], v[18:19]
    v_cvt_pk_bf16_f32 v214, v184, v185
    v_pk_fma_f32 v[186:187], v[186:187], v[8:9], v[18:19]
    v_cvt_pk_bf16_f32 v215, v186, v187
    s_add_u32 s73, s57, 4096
    buffer_store_dwordx4 v[212:215], v32, s[8:11], s73 offen offset:0 sc1
    v_pk_fma_f32 v[188:189], v[188:189], v[8:9], v[18:19]
    v_cvt_pk_bf16_f32 v216, v188, v189
    v_pk_fma_f32 v[190:191], v[190:191], v[8:9], v[18:19]
    v_cvt_pk_bf16_f32 v217, v190, v191
    v_pk_fma_f32 v[192:193], v[192:193], v[8:9], v[18:19]
    v_cvt_pk_bf16_f32 v218, v192, v193
    v_pk_fma_f32 v[194:195], v[194:195], v[8:9], v[18:19]
    v_cvt_pk_bf16_f32 v219, v194, v195
    buffer_store_dwordx4 v[216:219], v32, s[8:11], s73 offen offset:2048 sc1
    v_pk_fma_f32 v[196:197], v[196:197], v[8:9], v[18:19]
    v_cvt_pk_bf16_f32 v220, v196, v197
    v_pk_fma_f32 v[198:199], v[198:199], v[8:9], v[18:19]
    v_cvt_pk_bf16_f32 v221, v198, v199
    v_pk_fma_f32 v[200:201], v[200:201], v[8:9], v[18:19]
    v_cvt_pk_bf16_f32 v222, v200, v201
    v_pk_fma_f32 v[202:203], v[202:203], v[8:9], v[18:19]
    v_cvt_pk_bf16_f32 v223, v202, v203
    s_add_u32 s73, s57, 8192
    buffer_store_dwordx4 v[220:223], v32, s[8:11], s73 offen offset:0 sc1
    s_add_u32 s57, s57, 40960
    s_waitcnt vmcnt(5)
    v_min3_u32 v4, v4, v5, v6
    v_min_u32 v4, v4, v7
    s_nop 1
    v_min_u32_dpp v4, v4, v4 row_ror:1 row_mask:0xf bank_mask:0xf
    s_nop 1
    v_min_u32_dpp v4, v4, v4 row_ror:2 row_mask:0xf bank_mask:0xf
    s_nop 1
    v_min_u32_dpp v4, v4, v4 row_ror:4 row_mask:0xf bank_mask:0xf
    s_nop 1
    v_min_u32_dpp v4, v4, v4 row_ror:8 row_mask:0xf bank_mask:0xf
    s_nop 0
    v_readlane_b32 s70, v4, 0
    s_nop 0
    s_max_u32 s60, s60, s70
    s_cmp_gt_u32 s60, s55
    s_cbranch_scc0 LN1_idle
    s_add_u32 s73, s56, 0
    buffer_load_dwordx4 v[44:47], v32, s[8:11], s73 offen offset:0 sc1
    buffer_load_dwordx4 v[48:51], v32, s[8:11], s73 offen offset:2048 sc1
    s_add_u32 s73, s56, 4096
    buffer_load_dwordx4 v[52:55], v32, s[8:11], s73 offen offset:0 sc1
    buffer_load_dwordx4 v[56:59], v32, s[8:11], s73 offen offset:2048 sc1
    s_add_u32 s73, s56, 8192
    buffer_load_dwordx4 v[60:63], v32, s[8:11], s73 offen offset:0 sc1
    s_add_u32 s56, s56, 40960
    s_waitcnt vmcnt(5)
    s_barrier
    s_cmp_lg_u32 s52, 0
    s_cbranch_scc1 pwg_6
    v_mov_b32 v3, s55
    v_lshrrev_b32 v31, 2, v1
    s_mov_b64 exec, 15
    buffer_store_dword v3, v31, s[8:11], s59 offen sc1
    s_mov_b64 exec, 1
    s_mov_b64 exec, -1
pwg_6:
    s_branch LN1_top
LN1_idle:
    buffer_load_dwordx4 v[4:7], v2, s[8:11], s58 offen sc1
    s_waitcnt vmcnt(0)
    s_barrier
    s_cmp_lg_u32 s52, 0
    s_cbranch_scc1 pwg_7
    v_mov_b32 v3, s55
    v_lshrrev_b32 v31, 2, v1
    s_mov_b64 exec, 15
    buffer_store_dword v3, v31, s[8:11], s59 offen sc1
    s_mov_b64 exec, 1
    s_mov_b64 exec, -1
pwg_7:
    v_min3_u32 v4, v4, v5, v6
    v_min_u32 v4, v4, v7
    s_nop 1
    v_min_u32_dpp v4, v4, v4 row_ror:1 row_mask:0xf bank_mask:0xf
    s_nop 1
    v_min_u32_dpp v4, v4, v4 row_ror:2 row_mask:0xf bank_mask:0xf
    s_nop 1
    v_min_u32_dpp v4, v4, v4 row_ror:4 row_mask:0xf bank_mask:0xf
    s_nop 1
    v_min_u32_dpp v4, v4, v4 row_ror:8 row_mask:0xf bank_mask:0xf
    s_nop 0
    v_readlane_b32 s70, v4, 0
    s_nop 0
    s_max_u32 s60, s60, s70
    s_cmp_lt_u32 s55, 64
    s_cbranch_scc1 LN1_fetch
LN1_end:
    s_endpgm
LNA_entry:
    v_and_b32 v0, 63, v0
    v_lshlrev_b32 v1, 4, v0
    v_min_u32 v2, 19, v0
    v_lshlrev_b32 v2, 7, v2
    s_mov_b32 s55, 0
    s_mov_b32 s60, 0
    s_mov_b32 s61, 0
    s_mov_b32 s69, 0
    v_lshrrev_b32 v8, 4, v0
    v_and_b32 v9, 15, v0
    v_lshlrev_b32 v10, 9, v8
    v_lshl_add_u32 v32, v9, 4, v10
    s_lshl_b32 s70, s52, 2
    v_add_u32 v34, s70, v1
    s_and_b32 s73, s53, 1
    s_lshl_b32 s73, s73, 8
    s_mul_i32 s72, s52, 10240
    s_add_u32 s72, s72, s73
    s_mul_i32 s64, s54, 5242880
    s_add_u32 s64, s64, s72
    s_add_u32 s64, s64, 206438400
    s_mul_i32 s71, s54, 2621440
    s_add_u32 s72, s72, s71
    s_add_u32 s56, s72, 173408256
    s_add_u32 s57, s72, 183894016
    s_add_u32 s65, s72, 178651136
    s_mul_i32 s58, s54, 8192
    s_add_u32 s58, s58, 65536
    s_mul_i32 s59, s54, 8192
    s_lshl_b32 s70, s53, 7
    s_add_u32 s59, s59, s70
    s_lshl_b32 s70, s52, 2
    s_add_u32 s59, s59, s70
    s_add_u32 s59, s59, 81920
    s_cmp_lg_u32 s96, 0
    s_cbranch_scc1 RDY_ok_8
    s_mov_b32 s68, 0
RDY_lp_9:
    buffer_load_dword v40, off, s[48:51], 0 offset:32 sc1
    s_waitcnt vmcnt(0)
    v_readfirstlane_b32 s70, v40
    s_nop 0
    s_cmp_ge_u32 s70, 256
    s_cbranch_scc1 RDY_all_10
    s_sleep 8
    s_add_u32 s68, s68, 1
    s_cmp_lt_u32 s68, 65536
    s_cbranch_scc1 RDY_lp_9
    s_branch RDY_ok_8
RDY_all_10:
    v_mbcnt_lo_u32_b32 v41, -1, 0
    v_and_b32 v41, 7, v41
    v_min_u32 v42, 1, v41
    v_lshlrev_b32 v41, 2, v41
    v_lshl_add_u32 v41, v42, 7, v41
    buffer_load_dword v40, v41, s[48:51], 0 offen sc1
    s_waitcnt vmcnt(0)
    v_cmp_ne_u32 vcc, 32, v40
    s_nop 0
    s_cbranch_vccnz L_slow
RDY_ok_8:
LNA_fetch:
    s_cmp_gt_u32 s60, s55
    s_cbranch_scc1 LNA_p_ok_11
    s_mov_b32 s68, 0
LNA_p_lp_12:
    buffer_load_dwordx4 v[4:7], v2, s[8:11], s58 offen sc1
    s_waitcnt vmcnt(0)
    v_min3_u32 v4, v4, v5, v6
    v_min_u32 v4, v4, v7
    s_nop 1
    v_min_u32_dpp v4, v4, v4 row_ror:1 row_mask:0xf bank_mask:0xf
    s_nop 1
    v_min_u32_dpp v4, v4, v4 row_ror:2 row_mask:0xf bank_mask:0xf
    s_nop 1
    v_min_u32_dpp v4, v4, v4 row_ror:4 row_mask:0xf bank_mask:0xf
    s_nop 1
    v_min_u32_dpp v4, v4, v4 row_ror:8 row_mask:0xf bank_mask:0xf
    s_nop 0
    v_readlane_b32 s70, v4, 0
    v_readlane_b32 s71, v4, 16
    s_nop 0
    s_min_u32 s70, s70, s71
    s_max_u32 s60, s60, s70
    s_cmp_gt_u32 s60, s55
    s_cbranch_scc1 LNA_p_ok_11
    s_cmp_lg_u32 s69, 0
    s_cbranch_scc1 LNA_p_ok_11
    s_sleep 2
    s_add_u32 s68, s68, 1
    s_cmp_lt_u32 s68, 65536
    s_cbranch_scc1 LNA_p_lp_12
    s_mov_b32 s69, 1
LNA_p_ok_11:
    s_add_u32 s73, s56, 0
    buffer_load_dwordx4 v[44:47], v32, s[8:11], s73 offen offset:0 sc1
    buffer_load_dwordx4 v[48:51], v32, s[8:11], s73 offen offset:2048 sc1
    s_add_u32 s73, s56, 4096
    buffer_load_dwordx4 v[52:55], v32, s[8:11], s73 offen offset:0 sc1
    buffer_load_dwordx4 v[56:59], v32, s[8:11], s73 offen offset:2048 sc1
    s_add_u32 s73, s56, 8192
    buffer_load_dwordx4 v[60:63], v32, s[8:11], s73 offen offset:0 sc1
    s_add_u32 s73, s64, 0
    buffer_load_dwordx4 v[64:67], v32, s[8:11], s73 offen offset:0 sc1
    buffer_load_dwordx4 v[68:71], v32, s[8:11], s73 offen offset:2048 sc1
    s_add_u32 s73, s64, 4096
    buffer_load_dwordx4 v[72:75], v32, s[8:11], s73 offen offset:0 sc1
    buffer_load_dwordx4 v[76:79], v32, s[8:11], s73 offen offset:2048 sc1
    s_add_u32 s73, s64, 8192
    buffer_load_dwordx4 v[80:83], v32, s[8:11], s73 offen offset:0 sc1
    s_add_u32 s64, s64, 40960
    s_add_u32 s73, s64, 0
    buffer_load_dwordx4 v[104:107], v32, s[8:11], s73 offen offset:0 sc1
    buffer_load_dwordx4 v[108:111], v32, s[8:11], s73 offen offset:2048 sc1
    s_add_u32 s73, s64, 4096
    buffer_load_dwordx4 v[112:115], v32, s[8:11], s73 offen offset:0 sc1
    buffer_load_dwordx4 v[116:119], v32, s[8:11], s73 offen offset:2048 sc1
    s_add_u32 s73, s64, 8192
    buffer_load_dwordx4 v[120:123], v32, s[8:11], s73 offen offset:0 sc1
    s_add_u32 s64, s64, 40960
    s_add_u32 s56, s56, 40960
LNA_top:
    s_waitcnt vmcnt(5)
    v_lshlrev_b32 v164, 16, v44
    v_and_b32 v165, 0xffff0000, v44
    v_lshlrev_b32 v14, 16, v64
    v_and_b32 v15, 0xffff0000, v64
    v_pk_add_f32 v[164:165], v[164:165], v[14:15]
    v_lshlrev_b32 v166, 16, v45
    v_and_b32 v167, 0xffff0000, v45
    v_lshlrev_b32 v14, 16, v65
    v_and_b32 v15, 0xffff0000, v65
    v_pk_add_f32 v[166:167], v[166:167], v[14:15]
    v_lshlrev_b32 v168, 16, v46
    v_and_b32 v169, 0xffff0000, v46
    v_lshlrev_b32 v14, 16, v66
    v_and_b32 v15, 0xffff0000, v66
    v_pk_add_f32 v[168:169], v[168:169], v[14:15]
    v_lshlrev_b32 v170, 16, v47
    v_and_b32 v171, 0xffff0000, v47
    v_lshlrev_b32 v14, 16, v67
    v_and_b32 v15, 0xffff0000, v67
    v_pk_add_f32 v[170:171], v[170:171], v[14:15]
    v_lshlrev_b32 v172, 16, v48
    v_and_b32 v173, 0xffff0000, v48
    v_lshlrev_b32 v14, 16, v68
    v_and_b32 v15, 0xffff0000, v68
    v_pk_add_f32 v[172:173], v[172:173], v[14:15]
    v_lshlrev_b32 v174, 16, v49
    v_and_b32 v175, 0xffff0000, v49
    v_lshlrev_b32 v14, 16, v69
    v_and_b32 v15, 0xffff0000, v69
    v_pk_add_f32 v[174:175], v[174:175], v[14:15]
    v_lshlrev_b32 v176, 16, v50
    v_and_b32 v177, 0xffff0000, v50
    v_lshlrev_b32 v14, 16, v70
    v_and_b32 v15, 0xffff0000, v70
    v_pk_add_f32 v[176:177], v[176:177], v[14:15]
    v_lshlrev_b32 v178, 16, v51
    v_and_b32 v179, 0xffff0000, v51
    v_lshlrev_b32 v14, 16, v71
    v_and_b32 v15, 0xffff0000, v71
    v_pk_add_f32 v[178:179], v[178:179], v[14:15]
    v_lshlrev_b32 v180, 16, v52
    v_and_b32 v181, 0xffff0000, v52
    v_lshlrev_b32 v14, 16, v72
    v_and_b32 v15, 0xffff0000, v72
    v_pk_add_f32 v[180:181], v[180:181], v[14:15]
    v_lshlrev_b32 v182, 16, v53
    v_and_b32 v183, 0xffff0000, v53
    v_lshlrev_b32 v14, 16, v73
    v_and_b32 v15, 0xffff0000, v73
    v_pk_add_f32 v[182:183], v[182:183], v[14:15]
    v_lshlrev_b32 v184, 16, v54
    v_and_b32 v185, 0xffff0000, v54
    v_lshlrev_b32 v14, 16, v74
    v_and_b32 v15, 0xffff0000, v74
    v_pk_add_f32 v[184:185], v[184:185], v[14:15]
    v_lshlrev_b32 v186, 16, v55
    v_and_b32 v187, 0xffff0000, v55
    v_lshlrev_b32 v14, 16, v75
    v_and_b32 v15, 0xffff0000, v75
    v_pk_add_f32 v[186:187], v[186:187], v[14:15]
    v_lshlrev_b32 v188, 16, v56
    v_and_b32 v189, 0xffff0000, v56
    v_lshlrev_b32 v14, 16, v76
    v_and_b32 v15, 0xffff0000, v76
    v_pk_add_f32 v[188:189], v[188:189], v[14:15]
    v_lshlrev_b32 v190, 16, v57
    v_and_b32 v191, 0xffff0000, v57
    v_lshlrev_b32 v14, 16, v77
    v_and_b32 v15, 0xffff0000, v77
    v_pk_add_f32 v[190:191], v[190:191], v[14:15]
    v_lshlrev_b32 v192, 16, v58
    v_and_b32 v193, 0xffff0000, v58
    v_lshlrev_b32 v14, 16, v78
    v_and_b32 v15, 0xffff0000, v78
    v_pk_add_f32 v[192:193], v[192:193], v[14:15]
    v_lshlrev_b32 v194, 16, v59
    v_and_b32 v195, 0xffff0000, v59
    v_lshlrev_b32 v14, 16, v79
    v_and_b32 v15, 0xffff0000, v79
    v_pk_add_f32 v[194:195], v[194:195], v[14:15]
    v_lshlrev_b32 v196, 16, v60
    v_and_b32 v197, 0xffff0000, v60
    v_lshlrev_b32 v14, 16, v80
    v_and_b32 v15, 0xffff0000, v80
    v_pk_add_f32 v[196:197], v[196:197], v[14:15]
    v_lshlrev_b32 v198, 16, v61
    v_and_b32 v199, 0xffff0000, v61
    v_lshlrev_b32 v14, 16, v81
    v_and_b32 v15, 0xffff0000, v81
    v_pk_add_f32 v[198:199], v[198:199], v[14:15]
    v_lshlrev_b32 v200, 16, v62
    v_and_b32 v201, 0xffff0000, v62
    v_lshlrev_b32 v14, 16, v82
    v_and_b32 v15, 0xffff0000, v82
    v_pk_add_f32 v[200:201], v[200:201], v[14:15]
    v_lshlrev_b32 v202, 16, v63
    v_and_b32 v203, 0xffff0000, v63
    v_lshlrev_b32 v14, 16, v83
    v_and_b32 v15, 0xffff0000, v83
    v_pk_add_f32 v[202:203], v[202:203], v[14:15]
    s_waitcnt vmcnt(4)
    v_lshlrev_b32 v14, 16, v104
    v_and_b32 v15, 0xffff0000, v104
    v_pk_add_f32 v[164:165], v[164:165], v[14:15]
    v_cvt_pk_bf16_f32 v144, v164, v165
    v_lshlrev_b32 v164, 16, v144
    v_and_b32 v165, 0xffff0000, v144
    v_lshlrev_b32 v14, 16, v105
    v_and_b32 v15, 0xffff0000, v105
    v_pk_add_f32 v[166:167], v[166:167], v[14:15]
    v_cvt_pk_bf16_f32 v145, v166, v167
    v_lshlrev_b32 v166, 16, v145
    v_and_b32 v167, 0xffff0000, v145
    v_pk_add_f32 v[8:9], v[164:165], v[166:167]
    v_lshlrev_b32 v14, 16, v106
    v_and_b32 v15, 0xffff0000, v106
    v_pk_add_f32 v[168:169], v[168:169], v[14:15]
    v_cvt_pk_bf16_f32 v146, v168, v169
    v_lshlrev_b32 v168, 16, v146
    v_and_b32 v169, 0xffff0000, v146
    v_pk_add_f32 v[8:9], v[8:9], v[168:169]
    v_lshlrev_b32 v14, 16, v107
    v_and_b32 v15, 0xffff0000, v107
    v_pk_add_f32 v[170:171], v[170:171], v[14:15]
    v_cvt_pk_bf16_f32 v147, v170, v171
    v_lshlrev_b32 v170, 16, v147
    v_and_b32 v171, 0xffff0000, v147
    v_pk_add_f32 v[8:9], v[8:9], v[170:171]
    s_waitcnt vmcnt(3)
    v_lshlrev_b32 v14, 16, v108
    v_and_b32 v15, 0xffff0000, v108
    v_pk_add_f32 v[172:173], v[172:173], v[14:15]
    v_cvt_pk_bf16_f32 v148, v172, v173
    v_lshlrev_b32 v172, 16, v148
    v_and_b32 v173, 0xffff0000, v148
    v_pk_add_f32 v[8:9], v[8:9], v[172:173]
    v_lshlrev_b32 v14, 16, v109
    v_and_b32 v15, 0xffff0000, v109
    v_pk_add_f32 v[174:175], v[174:175], v[14:15]
    v_cvt_pk_bf16_f32 v149, v174, v175
    v_lshlrev_b32 v174, 16, v149
    v_and_b32 v175, 0xffff0000, v149
    v_pk_add_f32 v[8:9], v[8:9], v[174:175]
    v_lshlrev_b32 v14, 16, v110
    v_and_b32 v15, 0xffff0000, v110
    v_pk_add_f32 v[176:177], v[176:177], v[14:15]
    v_cvt_pk_bf16_f32 v150, v176, v177
    v_lshlrev_b32 v176, 16, v150
    v_and_b32 v177, 0xffff0000, v150
    v_pk_add_f32 v[8:9], v[8:9], v[176:177]
    v_lshlrev_b32 v14, 16, v111
    v_and_b32 v15, 0xffff0000, v111
    v_pk_add_f32 v[178:179], v[178:179], v[14:15]
    v_cvt_pk_bf16_f32 v151, v178, v179
    v_lshlrev_b32 v178, 16, v151
    v_and_b32 v179, 0xffff0000, v151
    v_pk_add_f32 v[8:9], v[8:9], v[178:179]
    s_waitcnt vmcnt(2)
    v_lshlrev_b32 v14, 16, v112
    v_and_b32 v15, 0xffff0000, v112
    v_pk_add_f32 v[180:181], v[180:181], v[14:15]
    v_cvt_pk_bf16_f32 v152, v180, v181
    v_lshlrev_b32 v180, 16, v152
    v_and_b32 v181, 0xffff0000, v152
    v_pk_add_f32 v[8:9], v[8:9], v[180:181]
    v_lshlrev_b32 v14, 16, v113
    v_and_b32 v15, 0xffff0000, v113
    v_pk_add_f32 v[182:183], v[182:183], v[14:15]
    v_cvt_pk_bf16_f32 v153, v182, v183
    v_lshlrev_b32 v182, 16, v153
    v_and_b32 v183, 0xffff0000, v153
    v_pk_add_f32 v[8:9], v[8:9], v[182:183]
    v_lshlrev_b32 v14, 16, v114
    v_and_b32 v15, 0xffff0000, v114
    v_pk_add_f32 v[184:185], v[184:185], v[14:15]
    v_cvt_pk_bf16_f32 v154, v184, v185
    v_lshlrev_b32 v184, 16, v154
    v_and_b32 v185, 0xffff0000, v154
    v_pk_add_f32 v[8:9], v[8:9], v[184:185]
    v_lshlrev_b32 v14, 16, v115
    v_and_b32 v15, 0xffff0000, v115
    v_pk_add_f32 v[186:187], v[186:187], v[14:15]
    v_cvt_pk_bf16_f32 v155, v186, v187
    v_lshlrev_b32 v186, 16, v155
    v_and_b32 v187, 0xffff0000, v155
    v_pk_add_f32 v[8:9], v[8:9], v[186:187]
    s_waitcnt vmcnt(1)
    v_lshlrev_b32 v14, 16, v116
    v_and_b32 v15, 0xffff0000, v116
    v_pk_add_f32 v[188:189], v[188:189], v[14:15]
    v_cvt_pk_bf16_f32 v156, v188, v189
    v_lshlrev_b32 v188, 16, v156
    v_and_b32 v189, 0xffff0000, v156
    v_pk_add_f32 v[8:9], v[8:9], v[188:189]
    v_lshlrev_b32 v14, 16, v117
    v_and_b32 v15, 0xffff0000, v117
    v_pk_add_f32 v[190:191], v[190:191], v[14:15]
    v_cvt_pk_bf16_f32 v157, v190, v191
    v_lshlrev_b32 v190, 16, v157
    v_and_b32 v191, 0xffff0000, v157
    v_pk_add_f32 v[8:9], v[8:9], v[190:191]
    v_lshlrev_b32 v14, 16, v118
    v_and_b32 v15, 0xffff0000, v118
    v_pk_add_f32 v[192:193], v[192:193], v[14:15]
    v_cvt_pk_bf16_f32 v158, v192, v193
    v_lshlrev_b32 v192, 16, v158
    v_and_b32 v193, 0xffff0000, v158
    v_pk_add_f32 v[8:9], v[8:9], v[192:193]
    v_lshlrev_b32 v14, 16, v119
    v_and_b32 v15, 0xffff0000, v119
    v_pk_add_f32 v[194:195], v[194:195], v[14:15]
    v_cvt_pk_bf16_f32 v159, v194, v195
    v_lshlrev_b32 v194, 16, v159
    v_and_b32 v195, 0xffff0000, v159
    v_pk_add_f32 v[8:9], v[8:9], v[194:195]
    s_waitcnt vmcnt(0)
    v_lshlrev_b32 v14, 16, v120
    v_and_b32 v15, 0xffff0000, v120
    v_pk_add_f32 v[196:197], v[196:197], v[14:15]
    v_cvt_pk_bf16_f32 v160, v196, v197
    v_lshlrev_b32 v196, 16, v160
    v_and_b32 v197, 0xffff0000, v160
    v_pk_add_f32 v[8:9], v[8:9], v[196:197]
    v_lshlrev_b32 v14, 16, v121
    v_and_b32 v15, 0xffff0000, v121
    v_pk_add_f32 v[198:199], v[198:199], v[14:15]
    v_cvt_pk_bf16_f32 v161, v198, v199
    v_lshlrev_b32 v198, 16, v161
    v_and_b32 v199, 0xffff0000, v161
    v_pk_add_f32 v[8:9], v[8:9], v[198:199]
    v_lshlrev_b32 v14, 16, v122
    v_and_b32 v15, 0xffff0000, v122
    v_pk_add_f32 v[200:201], v[200:201], v[14:15]
    v_cvt_pk_bf16_f32 v162, v200, v201
    v_lshlrev_b32 v200, 16, v162
    v_and_b32 v201, 0xffff0000, v162
    v_pk_add_f32 v[8:9], v[8:9], v[200:201]
    v_lshlrev_b32 v14, 16, v123
    v_and_b32 v15, 0xffff0000, v123
    v_pk_add_f32 v[202:203], v[202:203], v[14:15]
    v_cvt_pk_bf16_f32 v163, v202, v203
    v_lshlrev_b32 v202, 16, v163
    v_and_b32 v203, 0xffff0000, v163
    v_pk_add_f32 v[8:9], v[8:9], v[202:203]
    v_add_f32 v8, v8, v9
    v_mov_b32 v12, v8
    s_nop 1
    v_permlane16_swap_b32 v12, v8
    v_add_f32 v8, v8, v12
    v_mov_b32 v12, v8
    s_nop 1
    v_permlane32_swap_b32 v12, v8
    v_add_f32 v8, v8, v12
    ds_write_b32 v34, v8 offset:0
    s_add_u32 s55, s55, 1
    buffer_load_dwordx4 v[4:7], v2, s[8:11], s58 offen sc1
    s_waitcnt lgkmcnt(0)
    s_barrier
    ds_read_b128 v[8:11], v1 offset:0
    s_waitcnt lgkmcnt(0)
    v_pk_add_f32 v[8:9], v[8:9], v[10:11]
    v_add_f32 v8, v8, v9
    v_mul_f32 v8, 0xbacccccd, v8
    v_mov_b32 v9, v8
    v_mov_b32 v18, v8
    v_cvt_pk_bf16_f32 v18, v18, v18
    v_lshlrev_b32 v18, 16, v18
    v_sub_f32 v18, v18, v8
    v_pk_add_f32 v[164:165], v[164:165], v[8:9]
    v_pk_mul_f32 v[10:11], v[164:165], v[164:165]
    v_pk_add_f32 v[166:167], v[166:167], v[8:9]
    v_pk_fma_f32 v[10:11], v[166:167], v[166:167], v[10:11]
    v_pk_add_f32 v[168:169], v[168:169], v[8:9]
    v_pk_fma_f32 v[10:11], v[168:169], v[168:169], v[10:11]
    v_pk_add_f32 v[170:171], v[170:171], v[8:9]
    v_pk_fma_f32 v[10:11], v[170:171], v[170:171], v[10:11]
    v_pk_add_f32 v[172:173], v[172:173], v[8:9]
    v_pk_fma_f32 v[10:11], v[172:173], v[172:173], v[10:11]
    v_pk_add_f32 v[174:175], v[174:175], v[8:9]
    v_pk_fma_f32 v[10:11], v[174:175], v[174:175], v[10:11]
    v_pk_add_f32 v[176:177], v[176:177], v[8:9]
    v_pk_fma_f32 v[10:11], v[176:177], v[176:177], v[10:11]
    v_pk_add_f32 v[178:179], v[178:179], v[8:9]
    v_pk_fma_f32 v[10:11], v[178:179], v[178:179], v[10:11]
    v_pk_add_f32 v[180:181], v[180:181], v[8:9]
    v_pk_fma_f32 v[10:11], v[180:181], v[180:181], v[10:11]
    v_pk_add_f32 v[182:183], v[182:183], v[8:9]
    v_pk_fma_f32 v[10:11], v[182:183], v[182:183], v[10:11]
    v_pk_add_f32 v[184:185], v[184:185], v[8:9]
    v_pk_fma_f32 v[10:11], v[184:185], v[184:185], v[10:11]
    v_pk_add_f32 v[186:187], v[186:187], v[8:9]
    v_pk_fma_f32 v[10:11], v[186:187], v[186:187], v[10:11]
    v_pk_add_f32 v[188:189], v[188:189], v[8:9]
    v_pk_fma_f32 v[10:11], v[188:189], v[188:189], v[10:11]
    v_pk_add_f32 v[190:191], v[190:191], v[8:9]
    v_pk_fma_f32 v[10:11], v[190:191], v[190:191], v[10:11]
    v_pk_add_f32 v[192:193], v[192:193], v[8:9]
    v_pk_fma_f32 v[10:11], v[192:193], v[192:193], v[10:11]
    v_pk_add_f32 v[194:195], v[194:195], v[8:9]
    v_pk_fma_f32 v[10:11], v[194:195], v[194:195], v[10:11]
    v_pk_add_f32 v[196:197], v[196:197], v[8:9]
    v_pk_fma_f32 v[10:11], v[196:197], v[196:197], v[10:11]
    v_pk_add_f32 v[198:199], v[198:199], v[8:9]
    v_pk_fma_f32 v[10:11], v[198:199], v[198:199], v[10:11]
    v_pk_add_f32 v[200:201], v[200:201], v[8:9]
    v_pk_fma_f32 v[10:11], v[200:201], v[200:201], v[10:11]
    v_pk_add_f32 v[202:203], v[202:203], v[8:9]
    v_pk_fma_f32 v[10:11], v[202:203], v[202:203], v[10:11]
    v_add_f32 v8, v10, v11
    v_mov_b32 v12, v8
    s_nop 1
    v_permlane16_swap_b32 v12, v8
    v_add_f32 v8, v8, v12
    v_mov_b32 v12, v8
    s_nop 1
    v_permlane32_swap_b32 v12, v8
    v_add_f32 v8, v8, v12
    ds_write_b32 v34, v8 offset:1024
    s_waitcnt lgkmcnt(0)
    s_barrier
    ds_read_b128 v[8:11], v1 offset:1024
    s_waitcnt lgkmcnt(0)
    v_pk_add_f32 v[8:9], v[8:9], v[10:11]
    v_add_f32 v8, v8, v9
    v_mul_f32 v10, 0x3acccccd, v8
    v_cvt_pk_bf16_f32 v10, v10, v10
    v_lshlrev_b32 v10, 16, v10
    v_add_f32 v10, 0x3727c5ac, v10
    v_cvt_pk_bf16_f32 v10, v10, v10
    v_lshlrev_b32 v10, 16, v10
    v_sqrt_f32 v10, v10
    s_nop 0
    v_cvt_pk_bf16_f32 v10, v10, v10
    v_lshlrev_b32 v10, 16, v10
    v_rcp_f32 v8, v10
    s_nop 0
    v_mov_b32 v9, v8
    v_mul_f32 v18, v18, v8
    v_mov_b32 v19, v18
    v_pk_fma_f32 v[164:165], v[164:165], v[8:9], v[18:19]
    v_cvt_pk_bf16_f32 v204, v164, v165
    v_pk_fma_f32 v[166:167], v[166:167], v[8:9], v[18:19]
    v_cvt_pk_bf16_f32 v205, v166, v167
    v_pk_fma_f32 v[168:169], v[168:169], v[8:9], v[18:19]
    v_cvt_pk_bf16_f32 v206, v168, v169
    v_pk_fma_f32 v[170:171], v[170:171], v[8:9], v[18:19]
    v_cvt_pk_bf16_f32 v207, v170, v171
    s_add_u32 s73, s57, 0
    buffer_store_dwordx4 v[204:207], v32, s[8:11], s73 offen offset:0 sc1
    v_pk_fma_f32 v[172:173], v[172:173], v[8:9], v[18:19]
    v_cvt_pk_bf16_f32 v208, v172, v173
    v_pk_fma_f32 v[174:175], v[174:175], v[8:9], v[18:19]
    v_cvt_pk_bf16_f32 v209, v174, v175
    v_pk_fma_f32 v[176:177], v[176:177], v[8:9], v[18:19]
    v_cvt_pk_bf16_f32 v210, v176, v177
    v_pk_fma_f32 v[178:179], v[178:179], v[8:9], v[18:19]
    v_cvt_pk_bf16_f32 v211, v178, v179
    buffer_store_dwordx4 v[208:211], v32, s[8:11], s73 offen offset:2048 sc1
    v_pk_fma_f32 v[180:181], v[180:181], v[8:9], v[18:19]
    v_cvt_pk_bf16_f32 v212, v180, v181
    v_pk_fma_f32 v[182:183], v[182:183], v[8:9], v[18:19]
    v_cvt_pk_bf16_f32 v213, v182, v183
    v_pk_fma_f32 v[184:185], v[184:185], v[8:9], v[18:19]
    v_cvt_pk_bf16_f32 v214, v184, v185
    v_pk_fma_f32 v[186:187], v[186:187], v[8:9], v[18:19]
    v_cvt_pk_bf16_f32 v215, v186, v187
    s_add_u32 s73, s57, 4096
    buffer_store_dwordx4 v[212:215], v32, s[8:11], s73 offen offset:0 sc1
    v_pk_fma_f32 v[188:189], v[188:189], v[8:9], v[18:19]
    v_cvt_pk_bf16_f32 v216, v188, v189
    v_pk_fma_f32 v[190:191], v[190:191], v[8:9], v[18:19]
    v_cvt_pk_bf16_f32 v217, v190, v191
    v_pk_fma_f32 v[192:193], v[192:193], v[8:9], v[18:19]
    v_cvt_pk_bf16_f32 v218, v192, v193
    v_pk_fma_f32 v[194:195], v[194:195], v[8:9], v[18:19]
    v_cvt_pk_bf16_f32 v219, v194, v195
    buffer_store_dwordx4 v[216:219], v32, s[8:11], s73 offen offset:2048 sc1
    v_pk_fma_f32 v[196:197], v[196:197], v[8:9], v[18:19]
    v_cvt_pk_bf16_f32 v220, v196, v197
    v_pk_fma_f32 v[198:199], v[198:199], v[8:9], v[18:19]
    v_cvt_pk_bf16_f32 v221, v198, v199
    v_pk_fma_f32 v[200:201], v[200:201], v[8:9], v[18:19]
    v_cvt_pk_bf16_f32 v222, v200, v201
    v_pk_fma_f32 v[202:203], v[202:203], v[8:9], v[18:19]
    v_cvt_pk_bf16_f32 v223, v202, v203
    s_add_u32 s73, s57, 8192
    buffer_store_dwordx4 v[220:223], v32, s[8:11], s73 offen offset:0 sc1
    s_add_u32 s57, s57, 40960
    s_waitcnt vmcnt(5)
    v_min3_u32 v4, v4, v5, v6
    v_min_u32 v4, v4, v7
    s_nop 1
    v_min_u32_dpp v4, v4, v4 row_ror:1 row_mask:0xf bank_mask:0xf
    s_nop 1
    v_min_u32_dpp v4, v4, v4 row_ror:2 row_mask:0xf bank_mask:0xf
    s_nop 1
    v_min_u32_dpp v4, v4, v4 row_ror:4 row_mask:0xf bank_mask:0xf
    s_nop 1
    v_min_u32_dpp v4, v4, v4 row_ror:8 row_mask:0xf bank_mask:0xf
    s_nop 0
    v_readlane_b32 s70, v4, 0
    v_readlane_b32 s71, v4, 16
    s_nop 0
    s_min_u32 s70, s70, s71
    s_max_u32 s60, s60, s70
    s_cmp_gt_u32 s60, s55
    s_cbranch_scc0 LNA_idle
    s_add_u32 s73, s56, 0
    buffer_load_dwordx4 v[44:47], v32, s[8:11], s73 offen offset:0 sc1
    buffer_load_dwordx4 v[48:51], v32, s[8:11], s73 offen offset:2048 sc1
    s_add_u32 s73, s56, 4096
    buffer_load_dwordx4 v[52:55], v32, s[8:11], s73 offen offset:0 sc1
    buffer_load_dwordx4 v[56:59], v32, s[8:11], s73 offen offset:2048 sc1
    s_add_u32 s73, s56, 8192
    buffer_load_dwordx4 v[60:63], v32, s[8:11], s73 offen offset:0 sc1
    s_add_u32 s73, s64, 0
    buffer_load_dwordx4 v[64:67], v32, s[8:11], s73 offen offset:0 sc1
    buffer_load_dwordx4 v[68:71], v32, s[8:11], s73 offen offset:2048 sc1
    s_add_u32 s73, s64, 4096
    buffer_load_dwordx4 v[72:75], v32, s[8:11], s73 offen offset:0 sc1
    buffer_load_dwordx4 v[76:79], v32, s[8:11], s73 offen offset:2048 sc1
    s_add_u32 s73, s64, 8192
    buffer_load_dwordx4 v[80:83], v32, s[8:11], s73 offen offset:0 sc1
    s_add_u32 s64, s64, 40960
    s_add_u32 s73, s64, 0
    buffer_load_dwordx4 v[104:107], v32, s[8:11], s73 offen offset:0 sc1
    buffer_load_dwordx4 v[108:111], v32, s[8:11], s73 offen offset:2048 sc1
    s_add_u32 s73, s64, 4096
    buffer_load_dwordx4 v[112:115], v32, s[8:11], s73 offen offset:0 sc1
    buffer_load_dwordx4 v[116:119], v32, s[8:11], s73 offen offset:2048 sc1
    s_add_u32 s73, s64, 8192
    buffer_load_dwordx4 v[120:123], v32, s[8:11], s73 offen offset:0 sc1
    s_add_u32 s64, s64, 40960
    s_add_u32 s56, s56, 40960
    s_waitcnt vmcnt(15)
    s_barrier
    s_cmp_lg_u32 s52, 0
    s_cbranch_scc1 pwg_13
    v_mov_b32 v3, s55
    v_lshrrev_b32 v31, 2, v1
    s_mov_b64 exec, 15
    buffer_store_dword v3, v31, s[8:11], s59 offen sc1
    s_mov_b64 exec, 1
    s_mov_b64 exec, -1
pwg_13:
    s_branch LNA_top
LNA_idle:
    buffer_load_dwordx4 v[4:7], v2, s[8:11], s58 offen sc1
    s_waitcnt vmcnt(0)
    s_barrier
    s_cmp_lg_u32 s52, 0
    s_cbranch_scc1 pwg_14
    v_mov_b32 v3, s55
    v_lshrrev_b32 v31, 2, v1
    s_mov_b64 exec, 15
    buffer_store_dword v3, v31, s[8:11], s59 offen sc1
    s_mov_b64 exec, 1
    s_mov_b64 exec, -1
pwg_14:
    v_min3_u32 v4, v4, v5, v6
    v_min_u32 v4, v4, v7
    s_nop 1
    v_min_u32_dpp v4, v4, v4 row_ror:1 row_mask:0xf bank_mask:0xf
    s_nop 1
    v_min_u32_dpp v4, v4, v4 row_ror:2 row_mask:0xf bank_mask:0xf
    s_nop 1
    v_min_u32_dpp v4, v4, v4 row_ror:4 row_mask:0xf bank_mask:0xf
    s_nop 1
    v_min_u32_dpp v4, v4, v4 row_ror:8 row_mask:0xf bank_mask:0xf
    s_nop 0
    v_readlane_b32 s70, v4, 0
    v_readlane_b32 s71, v4, 16
    s_nop 0
    s_min_u32 s70, s70, s71
    s_max_u32 s60, s60, s70
    s_cmp_lt_u32 s55, 64
    s_cbranch_scc1 LNA_fetch
LNA_end:
    s_endpgm
LN0_entry:
    v_and_b32 v0, 63, v0
    v_lshlrev_b32 v1, 4, v0
    v_min_u32 v2, 0, v0
    v_lshlrev_b32 v2, 7, v2
    s_mov_b32 s55, 0
    s_mov_b32 s60, 0
    s_mov_b32 s61, 0
    s_mov_b32 s69, 0
    v_lshrrev_b32 v8, 4, v0
    v_and_b32 v9, 15, v0
    v_lshlrev_b32 v10, 9, v8
    v_lshl_add_u32 v32, v9, 4, v10
    s_lshl_b32 s70, s52, 2
    v_add_u32 v34, s70, v1
    s_and_b32 s73, s53, 1
    s_lshl_b32 s73, s73, 8
    s_mul_i32 s72, s52, 10240
    s_add_u32 s72, s72, s73
    v_mul_u32_u24 v10, 1280, v9
    v_lshl_add_u32 v33, v8, 4, v10
    s_lshr_b32 s55, s53, 1
    s_mul_i32 s71, s55, 40960
    s_add_u32 s72, s72, s71
    s_add_u32 s65, s72, 173408256
    s_add_u32 s57, s72, 168165376
    s_mul_i32 s64, s73, 80
    s_add_u32 s64, s64, s71
    s_mul_i32 s71, s52, 320
    s_add_u32 s64, s64, s71
    s_mov_b32 s60, 64
    s_mov_b32 s78, s54
    s_mov_b32 s54, 0
    s_mul_i32 s59, s54, 8192
    s_lshl_b32 s70, s53, 7
    s_add_u32 s59, s59, s70
    s_lshl_b32 s70, s52, 2
    s_add_u32 s59, s59, s70
    s_add_u32 s59, s59, 32768
    s_mov_b32 s54, s78
LN0_fetch:
    buffer_load_dwordx4 v[44:47], v33, s[28:31], s64 offen offset:0
    buffer_load_dwordx4 v[48:51], v33, s[28:31], s64 offen offset:64
    buffer_load_dwordx4 v[52:55], v33, s[28:31], s64 offen offset:128
    buffer_load_dwordx4 v[56:59], v33, s[28:31], s64 offen offset:192
    buffer_load_dwordx4 v[60:63], v33, s[28:31], s64 offen offset:256
    s_add_u32 s64, s64, 163840
LN0_top:
    s_waitcnt vmcnt(4)
    v_lshlrev_b32 v164, 16, v44
    v_and_b32 v165, 0xffff0000, v44
    v_mov_b32 v144, v44
    v_lshlrev_b32 v166, 16, v45
    v_and_b32 v167, 0xffff0000, v45
    v_mov_b32 v145, v45
    v_pk_add_f32 v[8:9], v[164:165], v[166:167]
    v_lshlrev_b32 v168, 16, v46
    v_and_b32 v169, 0xffff0000, v46
    v_mov_b32 v146, v46
    v_pk_add_f32 v[8:9], v[8:9], v[168:169]
    v_lshlrev_b32 v170, 16, v47
    v_and_b32 v171, 0xffff0000, v47
    v_mov_b32 v147, v47
    v_pk_add_f32 v[8:9], v[8:9], v[170:171]
    s_waitcnt vmcnt(3)
    v_lshlrev_b32 v172, 16, v48
    v_and_b32 v173, 0xffff0000, v48
    v_mov_b32 v148, v48
    v_pk_add_f32 v[8:9], v[8:9], v[172:173]
    v_lshlrev_b32 v174, 16, v49
    v_and_b32 v175, 0xffff0000, v49
    v_mov_b32 v149, v49
    v_pk_add_f32 v[8:9], v[8:9], v[174:175]
    v_lshlrev_b32 v176, 16, v50
    v_and_b32 v177, 0xffff0000, v50
    v_mov_b32 v150, v50
    v_pk_add_f32 v[8:9], v[8:9], v[176:177]
    v_lshlrev_b32 v178, 16, v51
    v_and_b32 v179, 0xffff0000, v51
    v_mov_b32 v151, v51
    v_pk_add_f32 v[8:9], v[8:9], v[178:179]
    s_waitcnt vmcnt(2)
    v_lshlrev_b32 v180, 16, v52
    v_and_b32 v181, 0xffff0000, v52
    v_mov_b32 v152, v52
    v_pk_add_f32 v[8:9], v[8:9], v[180:181]
    v_lshlrev_b32 v182, 16, v53
    v_and_b32 v183, 0xffff0000, v53
    v_mov_b32 v153, v53
    v_pk_add_f32 v[8:9], v[8:9], v[182:183]
    v_lshlrev_b32 v184, 16, v54
    v_and_b32 v185, 0xffff0000, v54
    v_mov_b32 v154, v54
    v_pk_add_f32 v[8:9], v[8:9], v[184:185]
    v_lshlrev_b32 v186, 16, v55
    v_and_b32 v187, 0xffff0000, v55
    v_mov_b32 v155, v55
    v_pk_add_f32 v[8:9], v[8:9], v[186:187]
    s_waitcnt vmcnt(1)
    v_lshlrev_b32 v188, 16, v56
    v_and_b32 v189, 0xffff0000, v56
    v_mov_b32 v156, v56
    v_pk_add_f32 v[8:9], v[8:9], v[188:189]
    v_lshlrev_b32 v190, 16, v57
    v_and_b32 v191, 0xffff0000, v57
    v_mov_b32 v157, v57
    v_pk_add_f32 v[8:9], v[8:9], v[190:191]
    v_lshlrev_b32 v192, 16, v58
    v_and_b32 v193, 0xffff0000, v58
    v_mov_b32 v158, v58
    v_pk_add_f32 v[8:9], v[8:9], v[192:193]
    v_lshlrev_b32 v194, 16, v59
    v_and_b32 v195, 0xffff0000, v59
    v_mov_b32 v159, v59
    v_pk_add_f32 v[8:9], v[8:9], v[194:195]
    s_waitcnt vmcnt(0)
    v_lshlrev_b32 v196, 16, v60
    v_and_b32 v197, 0xffff0000, v60
    v_mov_b32 v160, v60
    v_pk_add_f32 v[8:9], v[8:9], v[196:197]
    v_lshlrev_b32 v198, 16, v61
    v_and_b32 v199, 0xffff0000, v61
    v_mov_b32 v161, v61
    v_pk_add_f32 v[8:9], v[8:9], v[198:199]
    v_lshlrev_b32 v200, 16, v62
    v_and_b32 v201, 0xffff0000, v62
    v_mov_b32 v162, v62
    v_pk_add_f32 v[8:9], v[8:9], v[200:201]
    v_lshlrev_b32 v202, 16, v63
    v_and_b32 v203, 0xffff0000, v63
    v_mov_b32 v163, v63
    v_pk_add_f32 v[8:9], v[8:9], v[202:203]
    v_add_f32 v8, v8, v9
    v_mov_b32 v12, v8
    s_nop 1
    v_permlane16_swap_b32 v12, v8
    v_add_f32 v8, v8, v12
    v_mov_b32 v12, v8
    s_nop 1
    v_permlane32_swap_b32 v12, v8
    v_add_f32 v8, v8, v12
    ds_write_b32 v34, v8 offset:0
    s_add_u32 s55, s55, 4
    s_cmp_lt_u32 s55, 64
    s_cselect_b32 s75, s64, 0x20000000
    s_add_u32 s64, s64, 163840
    s_waitcnt lgkmcnt(0)
    s_barrier
    ds_read_b128 v[8:11], v1 offset:0
    s_waitcnt lgkmcnt(0)
    v_pk_add_f32 v[8:9], v[8:9], v[10:11]
    v_add_f32 v8, v8, v9
    v_mul_f32 v8, 0xbacccccd, v8
    v_mov_b32 v9, v8
    v_mov_b32 v18, v8
    v_cvt_pk_bf16_f32 v18, v18, v18
    v_lshlrev_b32 v18, 16, v18
    v_sub_f32 v18, v18, v8
    v_pk_add_f32 v[164:165], v[164:165], v[8:9]
    v_pk_mul_f32 v[10:11], v[164:165], v[164:165]
    v_pk_add_f32 v[166:167], v[166:167], v[8:9]
    v_pk_fma_f32 v[10:11], v[166:167], v[166:167], v[10:11]
    v_pk_add_f32 v[168:169], v[168:169], v[8:9]
    v_pk_fma_f32 v[10:11], v[168:169], v[168:169], v[10:11]
    v_pk_add_f32 v[170:171], v[170:171], v[8:9]
    v_pk_fma_f32 v[10:11], v[170:171], v[170:171], v[10:11]
    buffer_load_dwordx4 v[44:47], v33, s[28:31], s75 offen offset:0
    v_pk_add_f32 v[172:173], v[172:173], v[8:9]
    v_pk_fma_f32 v[10:11], v[172:173], v[172:173], v[10:11]
    v_pk_add_f32 v[174:175], v[174:175], v[8:9]
    v_pk_fma_f32 v[10:11], v[174:175], v[174:175], v[10:11]
    v_pk_add_f32 v[176:177], v[176:177], v[8:9]
    v_pk_fma_f32 v[10:11], v[176:177], v[176:177], v[10:11]
    v_pk_add_f32 v[178:179], v[178:179], v[8:9]
    v_pk_fma_f32 v[10:11], v[178:179], v[178:179], v[10:11]
    buffer_load_dwordx4 v[48:51], v33, s[28:31], s75 offen offset:64
    v_pk_add_f32 v[180:181], v[180:181], v[8:9]
    v_pk_fma_f32 v[10:11], v[180:181], v[180:181], v[10:11]
    v_pk_add_f32 v[182:183], v[182:183], v[8:9]
    v_pk_fma_f32 v[10:11], v[182:183], v[182:183], v[10:11]
    v_pk_add_f32 v[184:185], v[184:185], v[8:9]
    v_pk_fma_f32 v[10:11], v[184:185], v[184:185], v[10:11]
    v_pk_add_f32 v[186:187], v[186:187], v[8:9]
    v_pk_fma_f32 v[10:11], v[186:187], v[186:187], v[10:11]
    buffer_load_dwordx4 v[52:55], v33, s[28:31], s75 offen offset:128
    v_pk_add_f32 v[188:189], v[188:189], v[8:9]
    v_pk_fma_f32 v[10:11], v[188:189], v[188:189], v[10:11]
    v_pk_add_f32 v[190:191], v[190:191], v[8:9]
    v_pk_fma_f32 v[10:11], v[190:191], v[190:191], v[10:11]
    v_pk_add_f32 v[192:193], v[192:193], v[8:9]
    v_pk_fma_f32 v[10:11], v[192:193], v[192:193], v[10:11]
    v_pk_add_f32 v[194:195], v[194:195], v[8:9]
    v_pk_fma_f32 v[10:11], v[194:195], v[194:195], v[10:11]
    buffer_load_dwordx4 v[56:59], v33, s[28:31], s75 offen offset:192
    v_pk_add_f32 v[196:197], v[196:197], v[8:9]
    v_pk_fma_f32 v[10:11], v[196:197], v[196:197], v[10:11]
    v_pk_add_f32 v[198:199], v[198:199], v[8:9]
    v_pk_fma_f32 v[10:11], v[198:199], v[198:199], v[10:11]
    v_pk_add_f32 v[200:201], v[200:201], v[8:9]
    v_pk_fma_f32 v[10:11], v[200:201], v[200:201], v[10:11]
    v_pk_add_f32 v[202:203], v[202:203], v[8:9]
    v_pk_fma_f32 v[10:11], v[202:203], v[202:203], v[10:11]
    buffer_load_dwordx4 v[60:63], v33, s[28:31], s75 offen offset:256
    v_add_f32 v8, v10, v11
    v_mov_b32 v12, v8
    s_nop 1
    v_permlane16_swap_b32 v12, v8
    v_add_f32 v8, v8, v12
    v_mov_b32 v12, v8
    s_nop 1
    v_permlane32_swap_b32 v12, v8
    v_add_f32 v8, v8, v12
    ds_write_b32 v34, v8 offset:1024
    s_add_u32 s73, s65, 0
    buffer_store_dwordx4 v[144:147], v32, s[8:11], s73 offen offset:0 sc1
    buffer_store_dwordx4 v[148:151], v32, s[8:11], s73 offen offset:2048 sc1
    s_add_u32 s73, s65, 4096
    buffer_store_dwordx4 v[152:155], v32, s[8:11], s73 offen offset:0 sc1
    buffer_store_dwordx4 v[156:159], v32, s[8:11], s73 offen offset:2048 sc1
    s_add_u32 s73, s65, 8192
    buffer_store_dwordx4 v[160:163], v32, s[8:11], s73 offen offset:0 sc1
    s_add_u32 s65, s65, 163840
    s_waitcnt lgkmcnt(0)
    s_barrier
    ds_read_b128 v[8:11], v1 offset:1024
    s_waitcnt lgkmcnt(0)
    v_pk_add_f32 v[8:9], v[8:9], v[10:11]
    v_add_f32 v8, v8, v9
    v_mul_f32 v10, 0x3acccccd, v8
    v_cvt_pk_bf16_f32 v10, v10, v10
    v_lshlrev_b32 v10, 16, v10
    v_add_f32 v10, 0x3727c5ac, v10
    v_cvt_pk_bf16_f32 v10, v10, v10
    v_lshlrev_b32 v10, 16, v10
    v_sqrt_f32 v10, v10
    s_nop 0
    v_cvt_pk_bf16_f32 v10, v10, v10
    v_lshlrev_b32 v10, 16, v10
    v_rcp_f32 v8, v10
    s_nop 0
    v_mov_b32 v9, v8
    v_mul_f32 v18, v18, v8
    v_mov_b32 v19, v18
    v_pk_fma_f32 v[164:165], v[164:165], v[8:9], v[18:19]
    v_cvt_pk_bf16_f32 v204, v164, v165
    v_pk_fma_f32 v[166:167], v[166:167], v[8:9], v[18:19]
    v_cvt_pk_bf16_f32 v205, v166, v167
    v_pk_fma_f32 v[168:169], v[168:169], v[8:9], v[18:19]
    v_cvt_pk_bf16_f32 v206, v168, v169
    v_pk_fma_f32 v[170:171], v[170:171], v[8:9], v[18:19]
    v_cvt_pk_bf16_f32 v207, v170, v171
    s_add_u32 s73, s57, 0
    buffer_store_dwordx4 v[204:207], v32, s[8:11], s73 offen offset:0 sc1
    v_pk_fma_f32 v[172:173], v[172:173], v[8:9], v[18:19]
    v_cvt_pk_bf16_f32 v208, v172, v173
    v_pk_fma_f32 v[174:175], v[174:175], v[8:9], v[18:19]
    v_cvt_pk_bf16_f32 v209, v174, v175
    v_pk_fma_f32 v[176:177], v[176:177], v[8:9], v[18:19]
    v_cvt_pk_bf16_f32 v210, v176, v177
    v_pk_fma_f32 v[178:179], v[178:179], v[8:9], v[18:19]
    v_cvt_pk_bf16_f32 v211, v178, v179
    buffer_store_dwordx4 v[208:211], v32, s[8:11], s73 offen offset:2048 sc1
    v_pk_fma_f32 v[180:181], v[180:181], v[8:9], v[18:19]
    v_cvt_pk_bf16_f32 v212, v180, v181
    v_pk_fma_f32 v[182:183], v[182:183], v[8:9], v[18:19]
    v_cvt_pk_bf16_f32 v213, v182, v183
    v_pk_fma_f32 v[184:185], v[184:185], v[8:9], v[18:19]
    v_cvt_pk_bf16_f32 v214, v184, v185
    v_pk_fma_f32 v[186:187], v[186:187], v[8:9], v[18:19]
    v_cvt_pk_bf16_f32 v215, v186, v187
    s_add_u32 s73, s57, 4096
    buffer_store_dwordx4 v[212:215], v32, s[8:11], s73 offen offset:0 sc1
    v_pk_fma_f32 v[188:189], v[188:189], v[8:9], v[18:19]
    v_cvt_pk_bf16_f32 v216, v188, v189
    v_pk_fma_f32 v[190:191], v[190:191], v[8:9], v[18:19]
    v_cvt_pk_bf16_f32 v217, v190, v191
    v_pk_fma_f32 v[192:193], v[192:193], v[8:9], v[18:19]
    v_cvt_pk_bf16_f32 v218, v192, v193
    v_pk_fma_f32 v[194:195], v[194:195], v[8:9], v[18:19]
    v_cvt_pk_bf16_f32 v219, v194, v195
    buffer_store_dwordx4 v[216:219], v32, s[8:11], s73 offen offset:2048 sc1
    v_pk_fma_f32 v[196:197], v[196:197], v[8:9], v[18:19]
    v_cvt_pk_bf16_f32 v220, v196, v197
    v_pk_fma_f32 v[198:199], v[198:199], v[8:9], v[18:19]
    v_cvt_pk_bf16_f32 v221, v198, v199
    v_pk_fma_f32 v[200:201], v[200:201], v[8:9], v[18:19]
    v_cvt_pk_bf16_f32 v222, v200, v201
    v_pk_fma_f32 v[202:203], v[202:203], v[8:9], v[18:19]
    v_cvt_pk_bf16_f32 v223, v202, v203
    s_add_u32 s73, s57, 8192
    buffer_store_dwordx4 v[220:223], v32, s[8:11], s73 offen offset:0 sc1
    s_add_u32 s57, s57, 163840
    s_waitcnt vmcnt(0)
    s_barrier
    s_cmp_lg_u32 s52, 0
    s_cbranch_scc1 pwg_15
    v_mov_b32 v3, s55
    v_lshrrev_b32 v31, 2, v1
    s_mov_b64 exec, 15
    buffer_store_dword v3, v31, s[8:11], s59 offen sc1
    s_mov_b64 exec, 1
    s_mov_b64 exec, -1
pwg_15:
    s_cmp_lt_u32 s55, 64
    s_cbranch_scc1 LN0_top
LN0_end:
ATT_entry:
    v_and_b32 v0, 63, v0
    v_lshlrev_b32 v1, 4, v0
    v_min_u32 v2, 2, v0
    v_lshlrev_b32 v2, 7, v2
    s_mov_b32 s55, 0
    s_mov_b32 s60, 0
    s_mov_b32 s61, 0
    s_mov_b32 s69, 0
    v_lshrrev_b32 v8, 4, v0
    v_and_b32 v9, 15, v0
    v_and_b32 v10, 13, v9
    v_and_b32 v11, 1, v8
    v_lshl_or_b32 v10, v11, 1, v10
    v_lshlrev_b32 v10, 4, v10
    v_lshrrev_b32 v11, 1, v8
    v_lshl_add_u32 v32, v11, 8, v10
    v_lshlrev_b32 v33, 3, v0
    v_and_b32 v37, 31, v0
    v_lshlrev_b32 v37, 7, v37
    v_lshlrev_b32 v10, 9, v8
    v_lshl_add_u32 v34, v9, 4, v10
    v_lshl_add_u32 v10, v8, 2, 0
    v_cmp_le_u32 s[80:81], v10, v9
    v_lshl_add_u32 v10, v8, 2, 1
    v_cmp_le_u32 s[82:83], v10, v9
    v_lshl_add_u32 v10, v8, 2, 2
    v_cmp_le_u32 s[84:85], v10, v9
    v_lshl_add_u32 v10, v8, 2, 3
    v_cmp_le_u32 s[86:87], v10, v9
    v_mov_b32 v35, 0xd028965f
    v_mov_b32 v36, 0
    s_lshl_b32 s72, s53, 2
    s_add_u32 s72, s72, s52
    s_mul_i32 s73, s54, 16777216
    s_lshl_b32 s71, s72, 13
    s_add_u32 s73, s73, s71
    s_add_u32 s56, s73, 16777216
    s_add_u32 s57, s73, 117440512
    s_mul_i32 s76, s54, 8519680
    s_lshl_b32 s71, s72, 12
    s_add_u32 s76, s76, s71
    s_add_u32 s76, s76, 151126016
    s_mul_i32 s73, s54, 8192
    s_lshr_b32 s71, s72, 1
    s_mul_i32 s71, s71, 384
    s_add_u32 s58, s73, s71
    s_and_b32 s71, s72, 1
    s_lshl_b32 s71, s71, 3
    s_add_u32 s58, s58, s71
    s_add_u32 s58, s58, 0
    s_lshl_b32 s71, s72, 7
    s_add_u32 s75, s73, s71
    s_add_u32 s75, s75, 16384
    s_mov_b32 s74, 0
    s_mov_b32 s77, 0x3e0293ee
    s_mul_i32 s59, s54, 8192
    s_lshl_b32 s70, s53, 7
    s_add_u32 s59, s59, s70
    s_lshl_b32 s70, s52, 2
    s_add_u32 s59, s59, s70
    s_add_u32 s59, s59, 49152
    s_cmp_lg_u32 s96, 0
    s_cbranch_scc1 RDY_ok_16
    s_mov_b32 s68, 0
RDY_lp_17:
    buffer_load_dword v40, off, s[48:51], 0 offset:32 sc1
    s_waitcnt vmcnt(0)
    v_readfirstlane_b32 s70, v40
    s_nop 0
    s_cmp_ge_u32 s70, 256
    s_cbranch_scc1 RDY_all_18
    s_sleep 8
    s_add_u32 s68, s68, 1
    s_cmp_lt_u32 s68, 65536
    s_cbranch_scc1 RDY_lp_17
    s_branch RDY_ok_16
RDY_all_18:
    v_mbcnt_lo_u32_b32 v41, -1, 0
    v_and_b32 v41, 7, v41
    v_min_u32 v42, 1, v41
    v_lshlrev_b32 v41, 2, v41
    v_lshl_add_u32 v41, v42, 7, v41
    buffer_load_dword v40, v41, s[48:51], 0 offen sc1
    s_waitcnt vmcnt(0)
    v_cmp_ne_u32 vcc, 32, v40
    s_nop 0
    s_cbranch_vccnz L_slow
RDY_ok_16:
ATT_fetch:
    s_cmp_gt_u32 s60, s55
    s_cbranch_scc1 ATT_p_ok_19
    s_mov_b32 s68, 0
ATT_p_lp_20:
    buffer_load_dwordx2 v[4:5], v2, s[8:11], s58 offen sc1
    s_waitcnt vmcnt(0)
    v_min_u32 v4, v4, v5
    s_nop 1
    v_min_u32_dpp v4, v4, v4 row_ror:1 row_mask:0xf bank_mask:0xf
    s_nop 1
    v_min_u32_dpp v4, v4, v4 row_ror:2 row_mask:0xf bank_mask:0xf
    s_nop 1
    v_min_u32_dpp v4, v4, v4 row_ror:4 row_mask:0xf bank_mask:0xf
    s_nop 1
    v_min_u32_dpp v4, v4, v4 row_ror:8 row_mask:0xf bank_mask:0xf
    s_nop 0
    v_readlane_b32 s70, v4, 0
    s_nop 0
    s_max_u32 s60, s60, s70
    s_cmp_gt_u32 s60, s55
    s_cbranch_scc1 ATT_p_ok_19
    s_cmp_lg_u32 s69, 0
    s_cbranch_scc1 ATT_p_ok_19
    s_sleep 2
    s_add_u32 s68, s68, 1
    s_cmp_lt_u32 s68, 65536
    s_cbranch_scc1 ATT_p_lp_20
    s_mov_b32 s69, 1
ATT_p_ok_19:
    s_add_u32 s73, s56, 67108864
    buffer_load_dwordx4 v[64:67], v1, s[8:11], s73 offen offset:0 sc1
    buffer_load_dwordx4 v[68:71], v1, s[8:11], s73 offen offset:1024 sc1
    buffer_load_dwordx4 v[72:75], v1, s[8:11], s73 offen offset:2048 sc1
    buffer_load_dwordx4 v[76:79], v1, s[8:11], s73 offen offset:3072 sc1
    s_add_u32 s73, s56, 67112960
    buffer_load_dwordx4 v[80:83], v1, s[8:11], s73 offen offset:0 sc1
    buffer_load_dwordx4 v[84:87], v1, s[8:11], s73 offen offset:1024 sc1
    buffer_load_dwordx4 v[88:91], v1, s[8:11], s73 offen offset:2048 sc1
    buffer_load_dwordx4 v[92:95], v1, s[8:11], s73 offen offset:3072 sc1
    s_add_u32 s73, s56, 0
    buffer_load_dwordx4 v[96:99], v1, s[8:11], s73 offen offset:0 sc1
    buffer_load_dwordx4 v[100:103], v1, s[8:11], s73 offen offset:1024 sc1
    buffer_load_dwordx4 v[104:107], v1, s[8:11], s73 offen offset:2048 sc1
    buffer_load_dwordx4 v[108:111], v1, s[8:11], s73 offen offset:3072 sc1
    s_add_u32 s73, s56, 4096
    buffer_load_dwordx4 v[112:115], v1, s[8:11], s73 offen offset:0 sc1
    buffer_load_dwordx4 v[116:119], v1, s[8:11], s73 offen offset:1024 sc1
    buffer_load_dwordx4 v[120:123], v1, s[8:11], s73 offen offset:2048 sc1
    buffer_load_dwordx4 v[124:127], v1, s[8:11], s73 offen offset:3072 sc1
    s_add_u32 s73, s56, 33554432
    buffer_load_dwordx4 v[128:131], v1, s[8:11], s73 offen offset:0 sc1
    buffer_load_dwordx4 v[132:135], v1, s[8:11], s73 offen offset:1024 sc1
    buffer_load_dwordx4 v[136:139], v1, s[8:11], s73 offen offset:2048 sc1
    buffer_load_dwordx4 v[140:143], v1, s[8:11], s73 offen offset:3072 sc1
    s_add_u32 s73, s56, 33558528
    buffer_load_dwordx4 v[144:147], v1, s[8:11], s73 offen offset:0 sc1
    buffer_load_dwordx4 v[148:151], v1, s[8:11], s73 offen offset:1024 sc1
    buffer_load_dwordx4 v[152:155], v1, s[8:11], s73 offen offset:2048 sc1
    buffer_load_dwordx4 v[156:159], v1, s[8:11], s73 offen offset:3072 sc1
ATT_top:
    s_waitcnt vmcnt(8)
    v_mfma_f32_16x16x32_bf16 v[188:191], v[96:99], v[64:67], 0
    v_mfma_f32_16x16x32_bf16 v[196:199], v[96:99], v[80:83], 0
    v_mfma_f32_16x16x32_bf16 v[200:203], v[112:115], v[80:83], 0
    v_mfma_f32_16x16x32_bf16 v[188:191], v[100:103], v[68:71], v[188:191]
    v_mfma_f32_16x16x32_bf16 v[196:199], v[100:103], v[84:87], v[196:199]
    v_mfma_f32_16x16x32_bf16 v[200:203], v[116:119], v[84:87], v[200:203]
    v_mfma_f32_16x16x32_bf16 v[188:191], v[104:107], v[72:75], v[188:191]
    v_mfma_f32_16x16x32_bf16 v[196:199], v[104:107], v[88:91], v[196:199]
    v_mfma_f32_16x16x32_bf16 v[200:203], v[120:123], v[88:91], v[200:203]
    v_mfma_f32_16x16x32_bf16 v[188:191], v[108:111], v[76:79], v[188:191]
    v_mfma_f32_16x16x32_bf16 v[196:199], v[108:111], v[92:95], v[196:199]
    v_mfma_f32_16x16x32_bf16 v[200:203], v[124:127], v[92:95], v[200:203]
    s_nop 5
    v_cndmask_b32 v188, v35, v188, s[80:81]
    v_cndmask_b32 v189, v35, v189, s[82:83]
    v_cndmask_b32 v190, v35, v190, s[84:85]
    v_cndmask_b32 v191, v35, v191, s[86:87]
    v_cndmask_b32 v200, v35, v200, s[80:81]
    v_cndmask_b32 v201, v35, v201, s[82:83]
    v_cndmask_b32 v202, v35, v202, s[84:85]
    v_cndmask_b32 v203, v35, v203, s[86:87]
    s_mov_b32 s68, 0
ATT_km:
    buffer_load_dwordx4 v[160:163], v32, s[8:11], s76 offen offset:0 sc1
    buffer_load_dwordx4 v[164:167], v32, s[8:11], s76 offen offset:1024 sc1
    buffer_load_dwordx4 v[168:171], v32, s[8:11], s76 offen offset:2048 sc1
    buffer_load_dwordx4 v[172:175], v32, s[8:11], s76 offen offset:3072 sc1
    buffer_load_dwordx2 v[176:177], v33, s[8:11], s76 offen offset:512 sc1
    buffer_load_dwordx2 v[178:179], v33, s[8:11], s76 offen offset:1536 sc1
    buffer_load_dwordx2 v[180:181], v33, s[8:11], s76 offen offset:2560 sc1
    buffer_load_dwordx2 v[182:183], v33, s[8:11], s76 offen offset:3584 sc1
    buffer_load_dwordx2 v[4:5], v2, s[8:11], s58 offen sc1
    s_waitcnt vmcnt(8)
    v_mfma_f32_16x16x32_bf16 v[184:187], v[160:163], v[64:67], 0
    v_pk_max_u16 v16, v160, v160
    v_pk_max_u16 v16, v161, v16
    v_mfma_f32_16x16x32_bf16 v[192:195], v[160:163], v[80:83], 0
    v_pk_max_u16 v16, v162, v16
    v_pk_max_u16 v16, v163, v16
    s_waitcnt vmcnt(7)
    v_mfma_f32_16x16x32_bf16 v[184:187], v[164:167], v[68:71], v[184:187]
    v_pk_max_u16 v16, v164, v16
    v_pk_max_u16 v16, v165, v16
    v_mfma_f32_16x16x32_bf16 v[192:195], v[164:167], v[84:87], v[192:195]
    v_pk_max_u16 v16, v166, v16
    v_pk_max_u16 v16, v167, v16
    s_waitcnt vmcnt(6)
    v_mfma_f32_16x16x32_bf16 v[184:187], v[168:171], v[72:75], v[184:187]
    v_pk_max_u16 v16, v168, v16
    v_pk_max_u16 v16, v169, v16
    v_mfma_f32_16x16x32_bf16 v[192:195], v[168:171], v[88:91], v[192:195]
    v_pk_max_u16 v16, v170, v16
    v_pk_max_u16 v16, v171, v16
    s_waitcnt vmcnt(5)
    v_mfma_f32_16x16x32_bf16 v[184:187], v[172:175], v[76:79], v[184:187]
    v_pk_max_u16 v16, v172, v16
    v_pk_max_u16 v16, v173, v16
    v_mfma_f32_16x16x32_bf16 v[192:195], v[172:175], v[92:95], v[192:195]
    v_pk_max_u16 v16, v174, v16
    v_pk_max_u16 v16, v175, v16
    s_waitcnt vmcnt(0)
    v_pk_max_u16 v16, v176, v16
    v_pk_max_u16 v16, v177, v16
    v_pk_max_u16 v16, v178, v16
    v_pk_max_u16 v16, v179, v16
    v_pk_max_u16 v16, v180, v16
    v_pk_max_u16 v16, v181, v16
    v_pk_max_u16 v16, v182, v16
    v_pk_max_u16 v16, v183, v16
    v_pk_max_u16 v16, v16, v16 op_sel:[0,1] op_sel_hi:[1,0]
    s_nop 0
    v_cmp_le_u32 vcc, 0xff810000, v16
    s_nop 0
    s_cbranch_vccz ATT_kmok
    s_cmp_lg_u32 s69, 0
    s_cbranch_scc1 ATT_kmok
    s_cmp_lg_u32 s68, 0
    s_cbranch_scc1 ATT_kmx
ATT_kmw:
    s_sleep 1
    buffer_load_dword v16, v37, s[8:11], s76 offen sc1
    s_waitcnt vmcnt(0)
    s_add_u32 s68, s68, 1
    v_cmp_eq_u32 vcc, 0xff81ff81, v16
    s_nop 0
    s_cbranch_vccz ATT_km
    s_cmp_lt_u32 s68, 262144
    s_cbranch_scc1 ATT_kmw
ATT_kmx:
    v_mov_b32 v16, -1
    v_xor_b32 v17, 0xff81ff81, v160
    v_pk_min_u16 v16, v16, v17
    v_xor_b32 v17, 0xff81ff81, v161
    v_pk_min_u16 v16, v16, v17
    v_xor_b32 v17, 0xff81ff81, v162
    v_pk_min_u16 v16, v16, v17
    v_xor_b32 v17, 0xff81ff81, v163
    v_pk_min_u16 v16, v16, v17
    v_xor_b32 v17, 0xff81ff81, v164
    v_pk_min_u16 v16, v16, v17
    v_xor_b32 v17, 0xff81ff81, v165
    v_pk_min_u16 v16, v16, v17
    v_xor_b32 v17, 0xff81ff81, v166
    v_pk_min_u16 v16, v16, v17
    v_xor_b32 v17, 0xff81ff81, v167
    v_pk_min_u16 v16, v16, v17
    v_xor_b32 v17, 0xff81ff81, v168
    v_pk_min_u16 v16, v16, v17
    v_xor_b32 v17, 0xff81ff81, v169
    v_pk_min_u16 v16, v16, v17
    v_xor_b32 v17, 0xff81ff81, v170
    v_pk_min_u16 v16, v16, v17
    v_xor_b32 v17, 0xff81ff81, v171
    v_pk_min_u16 v16, v16, v17
    v_xor_b32 v17, 0xff81ff81, v172
    v_pk_min_u16 v16, v16, v17
    v_xor_b32 v17, 0xff81ff81, v173
    v_pk_min_u16 v16, v16, v17
    v_xor_b32 v17, 0xff81ff81, v174
    v_pk_min_u16 v16, v16, v17
    v_xor_b32 v17, 0xff81ff81, v175
    v_pk_min_u16 v16, v16, v17
    v_xor_b32 v17, 0xff81ff81, v176
    v_pk_min_u16 v16, v16, v17
    v_xor_b32 v17, 0xff81ff81, v177
    v_pk_min_u16 v16, v16, v17
    v_xor_b32 v17, 0xff81ff81, v178
    v_pk_min_u16 v16, v16, v17
    v_xor_b32 v17, 0xff81ff81, v179
    v_pk_min_u16 v16, v16, v17
    v_xor_b32 v17, 0xff81ff81, v180
    v_pk_min_u16 v16, v16, v17
    v_xor_b32 v17, 0xff81ff81, v181
    v_pk_min_u16 v16, v16, v17
    v_xor_b32 v17, 0xff81ff81, v182
    v_pk_min_u16 v16, v16, v17
    v_xor_b32 v17, 0xff81ff81, v183
    v_pk_min_u16 v16, v16, v17
    v_pk_min_u16 v16, v16, v16 op_sel:[0,1] op_sel_hi:[1,0]
    s_nop 0
    v_cmp_eq_u32 vcc, 0, v16
    s_nop 0
    s_cbranch_vccz ATT_kmok
    s_add_u32 s68, s68, 1
    s_cmp_lt_u32 s68, 262144
    s_cbranch_scc1 ATT_km
    s_mov_b32 s69, 1
ATT_kmok:
    s_add_u32 s76, s76, 131072
    v_min_u32 v4, v4, v5
    s_nop 1
    v_min_u32_dpp v4, v4, v4 row_ror:1 row_mask:0xf bank_mask:0xf
    s_nop 1
    v_min_u32_dpp v4, v4, v4 row_ror:2 row_mask:0xf bank_mask:0xf
    s_nop 1
    v_min_u32_dpp v4, v4, v4 row_ror:4 row_mask:0xf bank_mask:0xf
    s_nop 1
    v_min_u32_dpp v4, v4, v4 row_ror:8 row_mask:0xf bank_mask:0xf
    s_nop 0
    v_readlane_b32 s70, v4, 0
    s_nop 0
    s_max_u32 s60, s60, s70
    s_add_u32 s72, s55, 1
    s_cmp_gt_u32 s60, s72
    s_cselect_b32 s63, 1, 0
    s_add_u32 s56, s56, 262144
    s_cmp_eq_u32 s63, 0
    s_cbranch_scc1 ATT_nq
    s_add_u32 s73, s56, 67108864
    buffer_load_dwordx4 v[64:67], v1, s[8:11], s73 offen offset:0 sc1
    buffer_load_dwordx4 v[68:71], v1, s[8:11], s73 offen offset:1024 sc1
    buffer_load_dwordx4 v[72:75], v1, s[8:11], s73 offen offset:2048 sc1
    buffer_load_dwordx4 v[76:79], v1, s[8:11], s73 offen offset:3072 sc1
    s_add_u32 s73, s56, 67112960
    buffer_load_dwordx4 v[80:83], v1, s[8:11], s73 offen offset:0 sc1
    buffer_load_dwordx4 v[84:87], v1, s[8:11], s73 offen offset:1024 sc1
    buffer_load_dwordx4 v[88:91], v1, s[8:11], s73 offen offset:2048 sc1
    buffer_load_dwordx4 v[92:95], v1, s[8:11], s73 offen offset:3072 sc1
    s_add_u32 s73, s56, 0
    buffer_load_dwordx4 v[96:99], v1, s[8:11], s73 offen offset:0 sc1
    buffer_load_dwordx4 v[100:103], v1, s[8:11], s73 offen offset:1024 sc1
    buffer_load_dwordx4 v[104:107], v1, s[8:11], s73 offen offset:2048 sc1
    buffer_load_dwordx4 v[108:111], v1, s[8:11], s73 offen offset:3072 sc1
    s_add_u32 s73, s56, 4096
    buffer_load_dwordx4 v[112:115], v1, s[8:11], s73 offen offset:0 sc1
    buffer_load_dwordx4 v[116:119], v1, s[8:11], s73 offen offset:1024 sc1
    buffer_load_dwordx4 v[120:123], v1, s[8:11], s73 offen offset:2048 sc1
    buffer_load_dwordx4 v[124:127], v1, s[8:11], s73 offen offset:3072 sc1
ATT_nq:
    v_max3_f32 v8, v184, v185, v188
    v_max3_f32 v9, v189, v190, v191
    v_max_f32 v8, v8, v9
    v_mov_b32 v9, v8
    s_nop 1
    v_permlane32_swap_b32 v9, v8
    v_max_f32 v8, v8, v9
    v_mov_b32 v9, v8
    s_nop 1
    v_permlane16_swap_b32 v9, v8
    v_max_f32 v8, v8, v9
    v_sub_f32 v184, v184, v8
    v_sub_f32 v185, v185, v8
    v_sub_f32 v188, v188, v8
    v_sub_f32 v189, v189, v8
    v_sub_f32 v190, v190, v8
    v_sub_f32 v191, v191, v8
    v_mul_f32 v184, s77, v184
    v_mul_f32 v185, s77, v185
    v_mul_f32 v188, s77, v188
    v_mul_f32 v189, s77, v189
    v_mul_f32 v190, s77, v190
    v_mul_f32 v191, s77, v191
    v_exp_f32 v184, v184
    v_exp_f32 v185, v185
    v_exp_f32 v188, v188
    v_exp_f32 v189, v189
    v_exp_f32 v190, v190
    v_exp_f32 v191, v191
    v_cvt_pk_bf16_f32 v208, v188, v189
    v_cvt_pk_bf16_f32 v209, v190, v191
    v_mov_b64 v[210:211], 0
    v_cvt_pk_bf16_f32 v212, v184, v185
    v_mov_b32 v213, 0
    v_mov_b32 v214, 0
    v_mov_b32 v215, v212
    v_add_f32 v10, v184, v185
    v_add_f32 v10, v10, v188
    v_add_f32 v10, v10, v189
    v_add_f32 v10, v10, v190
    v_add_f32 v10, v10, v191
    v_mov_b32 v9, v10
    s_nop 1
    v_permlane16_swap_b32 v9, v10
    v_add_f32 v10, v10, v9
    v_mov_b32 v9, v10
    s_nop 1
    v_permlane32_swap_b32 v9, v10
    v_add_f32 v10, v10, v9
    v_rcp_f32 v10, v10
    v_max3_f32 v8, v192, v193, v196
    v_max3_f32 v9, v197, v198, v199
    v_max3_f32 v8, v8, v200, v201
    v_max3_f32 v9, v9, v202, v203
    v_max_f32 v8, v8, v9
    v_mov_b32 v9, v8
    s_nop 1
    v_permlane32_swap_b32 v9, v8
    v_max_f32 v8, v8, v9
    v_mov_b32 v9, v8
    s_nop 1
    v_permlane16_swap_b32 v9, v8
    v_max_f32 v8, v8, v9
    v_sub_f32 v192, v192, v8
    v_sub_f32 v193, v193, v8
    v_sub_f32 v196, v196, v8
    v_sub_f32 v197, v197, v8
    v_sub_f32 v198, v198, v8
    v_sub_f32 v199, v199, v8
    v_sub_f32 v200, v200, v8
    v_sub_f32 v201, v201, v8
    v_sub_f32 v202, v202, v8
    v_sub_f32 v203, v203, v8
    v_mul_f32 v192, s77, v192
    v_mul_f32 v193, s77, v193
    v_mul_f32 v196, s77, v196
    v_mul_f32 v197, s77, v197
    v_mul_f32 v198, s77, v198
    v_mul_f32 v199, s77, v199
    v_mul_f32 v200, s77, v200
    v_mul_f32 v201, s77, v201
    v_mul_f32 v202, s77, v202
    v_mul_f32 v203, s77, v203
    v_exp_f32 v192, v192
    v_exp_f32 v193, v193
    v_exp_f32 v196, v196
    v_exp_f32 v197, v197
    v_exp_f32 v198, v198
    v_exp_f32 v199, v199
    v_exp_f32 v200, v200
    v_exp_f32 v201, v201
    v_exp_f32 v202, v202
    v_exp_f32 v203, v203
    v_cvt_pk_bf16_f32 v216, v196, v197
    v_cvt_pk_bf16_f32 v217, v198, v199
    v_cvt_pk_bf16_f32 v218, v200, v201
    v_cvt_pk_bf16_f32 v219, v202, v203
    v_cvt_pk_bf16_f32 v220, v192, v193
    v_mov_b32 v221, 0
    v_mov_b32 v222, 0
    v_mov_b32 v223, v220
    v_add_f32 v11, v192, v193
    v_add_f32 v11, v11, v196
    v_add_f32 v11, v11, v197
    v_add_f32 v11, v11, v198
    v_add_f32 v11, v11, v199
    v_add_f32 v11, v11, v200
    v_add_f32 v11, v11, v201
    v_add_f32 v11, v11, v202
    v_add_f32 v11, v11, v203
    v_mov_b32 v9, v11
    s_nop 1
    v_permlane16_swap_b32 v9, v11
    v_add_f32 v11, v11, v9
    v_mov_b32 v9, v11
    s_nop 1
    v_permlane32_swap_b32 v9, v11
    v_add_f32 v11, v11, v9
    v_rcp_f32 v11, v11
    v_mfma_f32_16x16x32_bf16 v[224:227], v[128:131], v[208:211], 0
    v_mfma_f32_16x16x32_bf16 v[228:231], v[132:135], v[208:211], 0
    v_mfma_f32_16x16x32_bf16 v[232:235], v[136:139], v[208:211], 0
    v_mfma_f32_16x16x32_bf16 v[236:239], v[140:143], v[208:211], 0
    v_mfma_f32_16x16x32_bf16 v[240:243], v[144:147], v[208:211], 0
    v_mfma_f32_16x16x32_bf16 v[244:247], v[148:151], v[208:211], 0
    v_mfma_f32_16x16x32_bf16 v[248:251], v[152:155], v[208:211], 0
    v_mfma_f32_16x16x32_bf16 v[252:255], v[156:159], v[208:211], 0
    v_mfma_f32_16x16x16_bf16 v[224:227], v[176:177], v[212:213], v[224:227]
    v_mfma_f32_16x16x16_bf16 v[228:231], v[176:177], v[214:215], v[228:231]
    v_mfma_f32_16x16x16_bf16 v[232:235], v[178:179], v[212:213], v[232:235]
    v_mfma_f32_16x16x16_bf16 v[236:239], v[178:179], v[214:215], v[236:239]
    v_mfma_f32_16x16x16_bf16 v[240:243], v[180:181], v[212:213], v[240:243]
    v_mfma_f32_16x16x16_bf16 v[244:247], v[180:181], v[214:215], v[244:247]
    v_mfma_f32_16x16x16_bf16 v[248:251], v[182:183], v[212:213], v[248:251]
    v_mfma_f32_16x16x16_bf16 v[252:255], v[182:183], v[214:215], v[252:255]
    s_nop 0
    v_mul_f32 v224, v224, v10
    v_mul_f32 v225, v225, v10
    v_mul_f32 v226, v226, v10
    v_mul_f32 v227, v227, v10
    v_mul_f32 v228, v228, v10
    v_mul_f32 v229, v229, v10
    v_mul_f32 v230, v230, v10
    v_mul_f32 v231, v231, v10
    v_cvt_pk_bf16_f32 v160, v224, v225
    v_cvt_pk_bf16_f32 v161, v226, v227
    v_cvt_pk_bf16_f32 v162, v228, v229
    v_cvt_pk_bf16_f32 v163, v230, v231
    s_add_u32 s73, s57, 0
    buffer_store_dwordx4 v[160:163], v34, s[8:11], s73 offen offset:0 sc1
    v_mul_f32 v232, v232, v10
    v_mul_f32 v233, v233, v10
    v_mul_f32 v234, v234, v10
    v_mul_f32 v235, v235, v10
    v_mul_f32 v236, v236, v10
    v_mul_f32 v237, v237, v10
    v_mul_f32 v238, v238, v10
    v_mul_f32 v239, v239, v10
    v_cvt_pk_bf16_f32 v164, v232, v233
    v_cvt_pk_bf16_f32 v165, v234, v235
    v_cvt_pk_bf16_f32 v166, v236, v237
    v_cvt_pk_bf16_f32 v167, v238, v239
    buffer_store_dwordx4 v[164:167], v34, s[8:11], s73 offen offset:2048 sc1
    v_mul_f32 v240, v240, v10
    v_mul_f32 v241, v241, v10
    v_mul_f32 v242, v242, v10
    v_mul_f32 v243, v243, v10
    v_mul_f32 v244, v244, v10
    v_mul_f32 v245, v245, v10
    v_mul_f32 v246, v246, v10
    v_mul_f32 v247, v247, v10
    v_cvt_pk_bf16_f32 v168, v240, v241
    v_cvt_pk_bf16_f32 v169, v242, v243
    v_cvt_pk_bf16_f32 v170, v244, v245
    v_cvt_pk_bf16_f32 v171, v246, v247
    s_add_u32 s73, s57, 4096
    buffer_store_dwordx4 v[168:171], v34, s[8:11], s73 offen offset:0 sc1
    v_mul_f32 v248, v248, v10
    v_mul_f32 v249, v249, v10
    v_mul_f32 v250, v250, v10
    v_mul_f32 v251, v251, v10
    v_mul_f32 v252, v252, v10
    v_mul_f32 v253, v253, v10
    v_mul_f32 v254, v254, v10
    v_mul_f32 v255, v255, v10
    v_cvt_pk_bf16_f32 v172, v248, v249
    v_cvt_pk_bf16_f32 v173, v250, v251
    v_cvt_pk_bf16_f32 v174, v252, v253
    v_cvt_pk_bf16_f32 v175, v254, v255
    buffer_store_dwordx4 v[172:175], v34, s[8:11], s73 offen offset:2048 sc1
    v_mfma_f32_16x16x32_bf16 v[224:227], v[128:131], v[216:219], 0
    v_mfma_f32_16x16x32_bf16 v[228:231], v[132:135], v[216:219], 0
    v_mfma_f32_16x16x32_bf16 v[232:235], v[136:139], v[216:219], 0
    v_mfma_f32_16x16x32_bf16 v[236:239], v[140:143], v[216:219], 0
    v_mfma_f32_16x16x32_bf16 v[240:243], v[144:147], v[216:219], 0
    v_mfma_f32_16x16x32_bf16 v[244:247], v[148:151], v[216:219], 0
    v_mfma_f32_16x16x32_bf16 v[248:251], v[152:155], v[216:219], 0
    v_mfma_f32_16x16x32_bf16 v[252:255], v[156:159], v[216:219], 0
    v_mfma_f32_16x16x16_bf16 v[224:227], v[176:177], v[220:221], v[224:227]
    v_mfma_f32_16x16x16_bf16 v[228:231], v[176:177], v[222:223], v[228:231]
    v_mfma_f32_16x16x16_bf16 v[232:235], v[178:179], v[220:221], v[232:235]
    v_mfma_f32_16x16x16_bf16 v[236:239], v[178:179], v[222:223], v[236:239]
    v_mfma_f32_16x16x16_bf16 v[240:243], v[180:181], v[220:221], v[240:243]
    v_mfma_f32_16x16x16_bf16 v[244:247], v[180:181], v[222:223], v[244:247]
    v_mfma_f32_16x16x16_bf16 v[248:251], v[182:183], v[220:221], v[248:251]
    v_mfma_f32_16x16x16_bf16 v[252:255], v[182:183], v[222:223], v[252:255]
    s_nop 0
    v_mul_f32 v224, v224, v11
    v_mul_f32 v225, v225, v11
    v_mul_f32 v226, v226, v11
    v_mul_f32 v227, v227, v11
    v_mul_f32 v228, v228, v11
    v_mul_f32 v229, v229, v11
    v_mul_f32 v230, v230, v11
    v_mul_f32 v231, v231, v11
    v_cvt_pk_bf16_f32 v160, v224, v225
    v_cvt_pk_bf16_f32 v161, v226, v227
    v_cvt_pk_bf16_f32 v162, v228, v229
    v_cvt_pk_bf16_f32 v163, v230, v231
    s_add_u32 s73, s57, 0
    buffer_store_dwordx4 v[160:163], v34, s[8:11], s73 offen offset:256 sc1
    v_mul_f32 v232, v232, v11
    v_mul_f32 v233, v233, v11
    v_mul_f32 v234, v234, v11
    v_mul_f32 v235, v235, v11
    v_mul_f32 v236, v236, v11
    v_mul_f32 v237, v237, v11
    v_mul_f32 v238, v238, v11
    v_mul_f32 v239, v239, v11
    v_cvt_pk_bf16_f32 v164, v232, v233
    v_cvt_pk_bf16_f32 v165, v234, v235
    v_cvt_pk_bf16_f32 v166, v236, v237
    v_cvt_pk_bf16_f32 v167, v238, v239
    buffer_store_dwordx4 v[164:167], v34, s[8:11], s73 offen offset:2304 sc1
    v_mul_f32 v240, v240, v11
    v_mul_f32 v241, v241, v11
    v_mul_f32 v242, v242, v11
    v_mul_f32 v243, v243, v11
    v_mul_f32 v244, v244, v11
    v_mul_f32 v245, v245, v11
    v_mul_f32 v246, v246, v11
    v_mul_f32 v247, v247, v11
    v_cvt_pk_bf16_f32 v168, v240, v241
    v_cvt_pk_bf16_f32 v169, v242, v243
    v_cvt_pk_bf16_f32 v170, v244, v245
    v_cvt_pk_bf16_f32 v171, v246, v247
    s_add_u32 s73, s57, 4096
    buffer_store_dwordx4 v[168:171], v34, s[8:11], s73 offen offset:256 sc1
    v_mul_f32 v248, v248, v11
    v_mul_f32 v249, v249, v11
    v_mul_f32 v250, v250, v11
    v_mul_f32 v251, v251, v11
    v_mul_f32 v252, v252, v11
    v_mul_f32 v253, v253, v11
    v_mul_f32 v254, v254, v11
    v_mul_f32 v255, v255, v11
    v_cvt_pk_bf16_f32 v172, v248, v249
    v_cvt_pk_bf16_f32 v173, v250, v251
    v_cvt_pk_bf16_f32 v174, v252, v253
    v_cvt_pk_bf16_f32 v175, v254, v255
    buffer_store_dwordx4 v[172:175], v34, s[8:11], s73 offen offset:2304 sc1
    s_add_u32 s57, s57, 262144
    s_add_u32 s55, s55, 1
    s_cmp_eq_u32 s63, 0
    s_cbranch_scc1 ATT_nv
    s_add_u32 s73, s56, 33554432
    buffer_load_dwordx4 v[128:131], v1, s[8:11], s73 offen offset:0 sc1
    buffer_load_dwordx4 v[132:135], v1, s[8:11], s73 offen offset:1024 sc1
    buffer_load_dwordx4 v[136:139], v1, s[8:11], s73 offen offset:2048 sc1
    buffer_load_dwordx4 v[140:143], v1, s[8:11], s73 offen offset:3072 sc1
    s_add_u32 s73, s56, 33558528
    buffer_load_dwordx4 v[144:147], v1, s[8:11], s73 offen offset:0 sc1
    buffer_load_dwordx4 v[148:151], v1, s[8:11], s73 offen offset:1024 sc1
    buffer_load_dwordx4 v[152:155], v1, s[8:11], s73 offen offset:2048 sc1
    buffer_load_dwordx4 v[156:159], v1, s[8:11], s73 offen offset:3072 sc1
    s_waitcnt vmcnt(8)
    v_mov_b32 v3, s55
    s_mov_b64 exec, 1
    s_cmp_lg_u32 s96, 0
    s_cbranch_scc1 loc_s_21
    buffer_store_dword v3, off, s[8:11], s59
    s_branch loc_e_22
loc_s_21:
    buffer_store_dword v3, off, s[8:11], s59 sc1
loc_e_22:
    s_mov_b64 exec, -1
    s_branch ATT_top
ATT_nv:
    s_waitcnt vmcnt(0)
    v_mov_b32 v3, s55
    s_mov_b64 exec, 1
    s_cmp_lg_u32 s96, 0
    s_cbranch_scc1 loc_s_23
    buffer_store_dword v3, off, s[8:11], s59
    s_branch loc_e_24
loc_s_23:
    buffer_store_dword v3, off, s[8:11], s59 sc1
loc_e_24:
    s_mov_b64 exec, -1
    s_cmp_lt_u32 s55, 64
    s_cbranch_scc1 ATT_fetch
    s_endpgm
G1qk_entry:
    v_and_b32 v0, 63, v0
    v_lshlrev_b32 v1, 4, v0
    v_min_u32 v2, 1, v0
    v_lshlrev_b32 v2, 7, v2
    s_mov_b32 s55, 0
    s_mov_b32 s60, 0
    s_mov_b32 s61, 0
    s_mov_b32 s69, 0
    v_mov_b32 v34, 0
    s_cmp_eq_u32 s54, 0
    s_cselect_b32 s70, 7, 1
    v_min_u32 v2, s70, v0
    v_lshrrev_b32 v34, 1, v2
    v_lshlrev_b32 v2, 7, v2
    s_mul_i32 s71, s53, 43
    s_lshr_b32 s65, s71, 7
    s_mul_i32 s71, s65, 3
    s_sub_u32 s66, s53, s71
    s_lshl_b32 s64, s65, 9
    s_lshl_b32 s71, s52, 7
    s_add_u32 s64, s64, s71
    s_cmp_eq_u32 s66, 0
    s_cselect_b32 s76, s12, s16
    s_cselect_b32 s77, s13, s17
    s_mov_b32 s78, 0x500000
    s_mov_b32 s79, 0x20000
    v_lshrrev_b32 v11, 5, v0
    v_mul_u32_u24 v11, 4, v11
    v_bfe_u32 v12, v0, 3, 2
    v_add_u32 v11, v11, v12
    s_mov_b32 s70, 8192
    v_mul_lo_u32 v11, v11, s70
    v_bfe_u32 v12, v0, 4, 1
    v_lshlrev_b32 v12, 2, v12
    v_and_b32 v13, 7, v0
    v_xor_b32 v12, v12, v13
    v_lshl_add_u32 v11, v12, 4, v11
    v_add_u32 v8, s64, v11
    s_mul_i32 s62, s52, 40960
    v_lshrrev_b32 v11, 5, v0
    v_lshlrev_b32 v11, 10, v11
    v_bfe_u32 v12, v0, 2, 2
    v_lshl_add_u32 v11, v12, 7, v11
    v_bfe_u32 v12, v0, 3, 1
    v_lshl_add_u32 v11, v12, 6, v11
    v_bfe_u32 v12, v0, 4, 1
    v_lshl_add_u32 v11, v12, 5, v11
    v_and_b32 v12, 3, v0
    v_lshl_add_u32 v11, v12, 3, v11
    v_add_u32 v9, s62, v11
    v_xor_b32 v10, 64, v9
    s_add_u32 m0, s62, 0
    s_mov_b32 s70, 0
    buffer_load_dwordx4 v8, s[76:79], s70 offen lds
    s_add_u32 m0, s62, 1024
    s_mov_b32 s70, 65536
    buffer_load_dwordx4 v8, s[76:79], s70 offen lds
    s_add_u32 m0, s62, 2048
    s_mov_b32 s70, 131072
    buffer_load_dwordx4 v8, s[76:79], s70 offen lds
    s_add_u32 m0, s62, 3072
    s_mov_b32 s70, 196608
    buffer_load_dwordx4 v8, s[76:79], s70 offen lds
    s_add_u32 m0, s62, 4096
    s_mov_b32 s70, 262144
    buffer_load_dwordx4 v8, s[76:79], s70 offen lds
    s_add_u32 m0, s62, 5120
    s_mov_b32 s70, 327680
    buffer_load_dwordx4 v8, s[76:79], s70 offen lds
    s_add_u32 m0, s62, 6144
    s_mov_b32 s70, 393216
    buffer_load_dwordx4 v8, s[76:79], s70 offen lds
    s_add_u32 m0, s62, 7168
    s_mov_b32 s70, 458752
    buffer_load_dwordx4 v8, s[76:79], s70 offen lds
    s_add_u32 m0, s62, 8192
    s_mov_b32 s70, 524288
    buffer_load_dwordx4 v8, s[76:79], s70 offen lds
    s_add_u32 m0, s62, 9216
    s_mov_b32 s70, 589824
    buffer_load_dwordx4 v8, s[76:79], s70 offen lds
    s_add_u32 m0, s62, 10240
    s_mov_b32 s70, 655360
    buffer_load_dwordx4 v8, s[76:79], s70 offen lds
    s_add_u32 m0, s62, 11264
    s_mov_b32 s70, 720896
    buffer_load_dwordx4 v8, s[76:79], s70 offen lds
    s_add_u32 m0, s62, 12288
    s_mov_b32 s70, 786432
    buffer_load_dwordx4 v8, s[76:79], s70 offen lds
    s_add_u32 m0, s62, 13312
    s_mov_b32 s70, 851968
    buffer_load_dwordx4 v8, s[76:79], s70 offen lds
    s_add_u32 m0, s62, 14336
    s_mov_b32 s70, 917504
    buffer_load_dwordx4 v8, s[76:79], s70 offen lds
    s_add_u32 m0, s62, 15360
    s_mov_b32 s70, 983040
    buffer_load_dwordx4 v8, s[76:79], s70 offen lds
    s_add_u32 m0, s62, 16384
    s_mov_b32 s70, 1048576
    buffer_load_dwordx4 v8, s[76:79], s70 offen lds
    s_add_u32 m0, s62, 17408
    s_mov_b32 s70, 1114112
    buffer_load_dwordx4 v8, s[76:79], s70 offen lds
    s_add_u32 m0, s62, 18432
    s_mov_b32 s70, 1179648
    buffer_load_dwordx4 v8, s[76:79], s70 offen lds
    s_add_u32 m0, s62, 19456
    s_mov_b32 s70, 1245184
    buffer_load_dwordx4 v8, s[76:79], s70 offen lds
    s_add_u32 m0, s62, 20480
    s_mov_b32 s70, 1310720
    buffer_load_dwordx4 v8, s[76:79], s70 offen lds
    s_add_u32 m0, s62, 21504
    s_mov_b32 s70, 1376256
    buffer_load_dwordx4 v8, s[76:79], s70 offen lds
    s_add_u32 m0, s62, 22528
    s_mov_b32 s70, 1441792
    buffer_load_dwordx4 v8, s[76:79], s70 offen lds
    s_add_u32 m0, s62, 23552
    s_mov_b32 s70, 1507328
    buffer_load_dwordx4 v8, s[76:79], s70 offen lds
    s_add_u32 m0, s62, 24576
    s_mov_b32 s70, 1572864
    buffer_load_dwordx4 v8, s[76:79], s70 offen lds
    s_add_u32 m0, s62, 25600
    s_mov_b32 s70, 1638400
    buffer_load_dwordx4 v8, s[76:79], s70 offen lds
    s_add_u32 m0, s62, 26624
    s_mov_b32 s70, 1703936
    buffer_load_dwordx4 v8, s[76:79], s70 offen lds
    s_add_u32 m0, s62, 27648
    s_mov_b32 s70, 1769472
    buffer_load_dwordx4 v8, s[76:79], s70 offen lds
    s_add_u32 m0, s62, 28672
    s_mov_b32 s70, 1835008
    buffer_load_dwordx4 v8, s[76:79], s70 offen lds
    s_add_u32 m0, s62, 29696
    s_mov_b32 s70, 1900544
    buffer_load_dwordx4 v8, s[76:79], s70 offen lds
    s_add_u32 m0, s62, 30720
    s_mov_b32 s70, 1966080
    buffer_load_dwordx4 v8, s[76:79], s70 offen lds
    s_add_u32 m0, s62, 31744
    s_mov_b32 s70, 2031616
    buffer_load_dwordx4 v8, s[76:79], s70 offen lds
    s_add_u32 m0, s62, 32768
    s_mov_b32 s70, 2097152
    buffer_load_dwordx4 v8, s[76:79], s70 offen lds
    s_add_u32 m0, s62, 33792
    s_mov_b32 s70, 2162688
    buffer_load_dwordx4 v8, s[76:79], s70 offen lds
    s_add_u32 m0, s62, 34816
    s_mov_b32 s70, 2228224
    buffer_load_dwordx4 v8, s[76:79], s70 offen lds
    s_add_u32 m0, s62, 35840
    s_mov_b32 s70, 2293760
    buffer_load_dwordx4 v8, s[76:79], s70 offen lds
    s_add_u32 m0, s62, 36864
    s_mov_b32 s70, 2359296
    buffer_load_dwordx4 v8, s[76:79], s70 offen lds
    s_add_u32 m0, s62, 37888
    s_mov_b32 s70, 2424832
    buffer_load_dwordx4 v8, s[76:79], s70 offen lds
    s_add_u32 m0, s62, 38912
    s_mov_b32 s70, 2490368
    buffer_load_dwordx4 v8, s[76:79], s70 offen lds
    s_add_u32 m0, s62, 39936
    s_mov_b32 s70, 2555904
    buffer_load_dwordx4 v8, s[76:79], s70 offen lds
    s_waitcnt vmcnt(38)
    ds_read_b64_tr_b16 v[192:193], v9 offset:0
    ds_read_b64_tr_b16 v[194:195], v9 offset:512
    ds_read_b64_tr_b16 v[196:197], v10 offset:0
    ds_read_b64_tr_b16 v[198:199], v10 offset:512
    s_waitcnt vmcnt(36)
    ds_read_b64_tr_b16 v[200:201], v9 offset:2048
    ds_read_b64_tr_b16 v[202:203], v9 offset:2560
    ds_read_b64_tr_b16 v[204:205], v10 offset:2048
    ds_read_b64_tr_b16 v[206:207], v10 offset:2560
    s_waitcnt lgkmcnt(4)
    s_add_u32 m0, s62, 0
    s_mov_b32 s70, 2621440
    buffer_load_dwordx4 v8, s[76:79], s70 offen lds
    s_add_u32 m0, s62, 1024
    s_mov_b32 s70, 2686976
    buffer_load_dwordx4 v8, s[76:79], s70 offen lds
    s_waitcnt vmcnt(36)
    ds_read_b64_tr_b16 v[208:209], v9 offset:4096
    ds_read_b64_tr_b16 v[210:211], v9 offset:4608
    ds_read_b64_tr_b16 v[212:213], v10 offset:4096
    ds_read_b64_tr_b16 v[214:215], v10 offset:4608
    s_waitcnt lgkmcnt(4)
    s_add_u32 m0, s62, 2048
    s_mov_b32 s70, 2752512
    buffer_load_dwordx4 v8, s[76:79], s70 offen lds
    s_add_u32 m0, s62, 3072
    s_mov_b32 s70, 2818048
    buffer_load_dwordx4 v8, s[76:79], s70 offen lds
    s_waitcnt vmcnt(36)
    ds_read_b64_tr_b16 v[216:217], v9 offset:6144
    ds_read_b64_tr_b16 v[218:219], v9 offset:6656
    ds_read_b64_tr_b16 v[220:221], v10 offset:6144
    ds_read_b64_tr_b16 v[222:223], v10 offset:6656
    s_waitcnt lgkmcnt(4)
    s_add_u32 m0, s62, 4096
    s_mov_b32 s70, 2883584
    buffer_load_dwordx4 v8, s[76:79], s70 offen lds
    s_add_u32 m0, s62, 5120
    s_mov_b32 s70, 2949120
    buffer_load_dwordx4 v8, s[76:79], s70 offen lds
    s_waitcnt vmcnt(36)
    ds_read_b64_tr_b16 v[224:225], v9 offset:8192
    ds_read_b64_tr_b16 v[226:227], v9 offset:8704
    ds_read_b64_tr_b16 v[228:229], v10 offset:8192
    ds_read_b64_tr_b16 v[230:231], v10 offset:8704
    s_waitcnt lgkmcnt(4)
    s_add_u32 m0, s62, 6144
    s_mov_b32 s70, 3014656
    buffer_load_dwordx4 v8, s[76:79], s70 offen lds
    s_add_u32 m0, s62, 7168
    s_mov_b32 s70, 3080192
    buffer_load_dwordx4 v8, s[76:79], s70 offen lds
    s_waitcnt vmcnt(36)
    ds_read_b64_tr_b16 v[232:233], v9 offset:10240
    ds_read_b64_tr_b16 v[234:235], v9 offset:10752
    ds_read_b64_tr_b16 v[236:237], v10 offset:10240
    ds_read_b64_tr_b16 v[238:239], v10 offset:10752
    s_waitcnt lgkmcnt(4)
    s_add_u32 m0, s62, 8192
    s_mov_b32 s70, 3145728
    buffer_load_dwordx4 v8, s[76:79], s70 offen lds
    s_add_u32 m0, s62, 9216
    s_mov_b32 s70, 3211264
    buffer_load_dwordx4 v8, s[76:79], s70 offen lds
    s_waitcnt vmcnt(36)
    ds_read_b64_tr_b16 v[240:241], v9 offset:12288
    ds_read_b64_tr_b16 v[242:243], v9 offset:12800
    ds_read_b64_tr_b16 v[244:245], v10 offset:12288
    ds_read_b64_tr_b16 v[246:247], v10 offset:12800
    s_waitcnt lgkmcnt(4)
    s_add_u32 m0, s62, 10240
    s_mov_b32 s70, 3276800
    buffer_load_dwordx4 v8, s[76:79], s70 offen lds
    s_add_u32 m0, s62, 11264
    s_mov_b32 s70, 3342336
    buffer_load_dwordx4 v8, s[76:79], s70 offen lds
    s_waitcnt vmcnt(36)
    ds_read_b64_tr_b16 v[248:249], v9 offset:14336
    ds_read_b64_tr_b16 v[250:251], v9 offset:14848
    ds_read_b64_tr_b16 v[252:253], v10 offset:14336
    ds_read_b64_tr_b16 v[254:255], v10 offset:14848
    s_waitcnt lgkmcnt(4)
    s_add_u32 m0, s62, 12288
    s_mov_b32 s70, 3407872
    buffer_load_dwordx4 v8, s[76:79], s70 offen lds
    s_add_u32 m0, s62, 13312
    s_mov_b32 s70, 3473408
    buffer_load_dwordx4 v8, s[76:79], s70 offen lds
    s_waitcnt vmcnt(36)
    ds_read_b64_tr_b16 a[0:1], v9 offset:16384
    ds_read_b64_tr_b16 a[2:3], v9 offset:16896
    ds_read_b64_tr_b16 a[4:5], v10 offset:16384
    ds_read_b64_tr_b16 a[6:7], v10 offset:16896
    s_waitcnt lgkmcnt(4)
    s_add_u32 m0, s62, 14336
    s_mov_b32 s70, 3538944
    buffer_load_dwordx4 v8, s[76:79], s70 offen lds
    s_add_u32 m0, s62, 15360
    s_mov_b32 s70, 3604480
    buffer_load_dwordx4 v8, s[76:79], s70 offen lds
    s_waitcnt vmcnt(36)
    ds_read_b64_tr_b16 a[8:9], v9 offset:18432
    ds_read_b64_tr_b16 a[10:11], v9 offset:18944
    ds_read_b64_tr_b16 a[12:13], v10 offset:18432
    ds_read_b64_tr_b16 a[14:15], v10 offset:18944
    s_waitcnt lgkmcnt(4)
    s_add_u32 m0, s62, 16384
    s_mov_b32 s70, 3670016
    buffer_load_dwordx4 v8, s[76:79], s70 offen lds
    s_add_u32 m0, s62, 17408
    s_mov_b32 s70, 3735552
    buffer_load_dwordx4 v8, s[76:79], s70 offen lds
    s_waitcnt vmcnt(36)
    ds_read_b64_tr_b16 a[16:17], v9 offset:20480
    ds_read_b64_tr_b16 a[18:19], v9 offset:20992
    ds_read_b64_tr_b16 a[20:21], v10 offset:20480
    ds_read_b64_tr_b16 a[22:23], v10 offset:20992
    s_waitcnt lgkmcnt(4)
    s_add_u32 m0, s62, 18432
    s_mov_b32 s70, 3801088
    buffer_load_dwordx4 v8, s[76:79], s70 offen lds
    s_add_u32 m0, s62, 19456
    s_mov_b32 s70, 3866624
    buffer_load_dwordx4 v8, s[76:79], s70 offen lds
    s_waitcnt vmcnt(36)
    ds_read_b64_tr_b16 a[24:25], v9 offset:22528
    ds_read_b64_tr_b16 a[26:27], v9 offset:23040
    ds_read_b64_tr_b16 a[28:29], v10 offset:22528
    ds_read_b64_tr_b16 a[30:31], v10 offset:23040
    s_waitcnt lgkmcnt(4)
    s_add_u32 m0, s62, 20480
    s_mov_b32 s70, 3932160
    buffer_load_dwordx4 v8, s[76:79], s70 offen lds
    s_add_u32 m0, s62, 21504
    s_mov_b32 s70, 3997696
    buffer_load_dwordx4 v8, s[76:79], s70 offen lds
    s_waitcnt vmcnt(36)
    ds_read_b64_tr_b16 a[32:33], v9 offset:24576
    ds_read_b64_tr_b16 a[34:35], v9 offset:25088
    ds_read_b64_tr_b16 a[36:37], v10 offset:24576
    ds_read_b64_tr_b16 a[38:39], v10 offset:25088
    s_waitcnt lgkmcnt(4)
    s_add_u32 m0, s62, 22528
    s_mov_b32 s70, 4063232
    buffer_load_dwordx4 v8, s[76:79], s70 offen lds
    s_add_u32 m0, s62, 23552
    s_mov_b32 s70, 4128768
    buffer_load_dwordx4 v8, s[76:79], s70 offen lds
    s_waitcnt vmcnt(36)
    ds_read_b64_tr_b16 a[40:41], v9 offset:26624
    ds_read_b64_tr_b16 a[42:43], v9 offset:27136
    ds_read_b64_tr_b16 a[44:45], v10 offset:26624
    ds_read_b64_tr_b16 a[46:47], v10 offset:27136
    s_waitcnt lgkmcnt(4)
    s_add_u32 m0, s62, 24576
    s_mov_b32 s70, 4194304
    buffer_load_dwordx4 v8, s[76:79], s70 offen lds
    s_add_u32 m0, s62, 25600
    s_mov_b32 s70, 4259840
    buffer_load_dwordx4 v8, s[76:79], s70 offen lds
    s_waitcnt vmcnt(36)
    ds_read_b64_tr_b16 a[48:49], v9 offset:28672
    ds_read_b64_tr_b16 a[50:51], v9 offset:29184
    ds_read_b64_tr_b16 a[52:53], v10 offset:28672
    ds_read_b64_tr_b16 a[54:55], v10 offset:29184
    s_waitcnt lgkmcnt(4)
    s_add_u32 m0, s62, 26624
    s_mov_b32 s70, 4325376
    buffer_load_dwordx4 v8, s[76:79], s70 offen lds
    s_add_u32 m0, s62, 27648
    s_mov_b32 s70, 4390912
    buffer_load_dwordx4 v8, s[76:79], s70 offen lds
    s_waitcnt vmcnt(36)
    ds_read_b64_tr_b16 a[56:57], v9 offset:30720
    ds_read_b64_tr_b16 a[58:59], v9 offset:31232
    ds_read_b64_tr_b16 a[60:61], v10 offset:30720
    ds_read_b64_tr_b16 a[62:63], v10 offset:31232
    s_waitcnt lgkmcnt(4)
    s_add_u32 m0, s62, 28672
    s_mov_b32 s70, 4456448
    buffer_load_dwordx4 v8, s[76:79], s70 offen lds
    s_add_u32 m0, s62, 29696
    s_mov_b32 s70, 4521984
    buffer_load_dwordx4 v8, s[76:79], s70 offen lds
    s_waitcnt vmcnt(36)
    ds_read_b64_tr_b16 a[64:65], v9 offset:32768
    ds_read_b64_tr_b16 a[66:67], v9 offset:33280
    ds_read_b64_tr_b16 a[68:69], v10 offset:32768
    ds_read_b64_tr_b16 a[70:71], v10 offset:33280
    s_waitcnt lgkmcnt(4)
    s_add_u32 m0, s62, 30720
    s_mov_b32 s70, 4587520
    buffer_load_dwordx4 v8, s[76:79], s70 offen lds
    s_add_u32 m0, s62, 31744
    s_mov_b32 s70, 4653056
    buffer_load_dwordx4 v8, s[76:79], s70 offen lds
    s_waitcnt vmcnt(36)
    ds_read_b64_tr_b16 a[72:73], v9 offset:34816
    ds_read_b64_tr_b16 a[74:75], v9 offset:35328
    ds_read_b64_tr_b16 a[76:77], v10 offset:34816
    ds_read_b64_tr_b16 a[78:79], v10 offset:35328
    s_waitcnt lgkmcnt(4)
    s_add_u32 m0, s62, 32768
    s_mov_b32 s70, 4718592
    buffer_load_dwordx4 v8, s[76:79], s70 offen lds
    s_add_u32 m0, s62, 33792
    s_mov_b32 s70, 4784128
    buffer_load_dwordx4 v8, s[76:79], s70 offen lds
    s_waitcnt vmcnt(36)
    ds_read_b64_tr_b16 a[80:81], v9 offset:36864
    ds_read_b64_tr_b16 a[82:83], v9 offset:37376
    ds_read_b64_tr_b16 a[84:85], v10 offset:36864
    ds_read_b64_tr_b16 a[86:87], v10 offset:37376
    s_waitcnt lgkmcnt(4)
    s_add_u32 m0, s62, 34816
    s_mov_b32 s70, 4849664
    buffer_load_dwordx4 v8, s[76:79], s70 offen lds
    s_add_u32 m0, s62, 35840
    s_mov_b32 s70, 4915200
    buffer_load_dwordx4 v8, s[76:79], s70 offen lds
    s_waitcnt vmcnt(36)
    ds_read_b64_tr_b16 a[88:89], v9 offset:38912
    ds_read_b64_tr_b16 a[90:91], v9 offset:39424
    ds_read_b64_tr_b16 a[92:93], v10 offset:38912
    ds_read_b64_tr_b16 a[94:95], v10 offset:39424
    s_waitcnt lgkmcnt(4)
    s_add_u32 m0, s62, 36864
    s_mov_b32 s70, 4980736
    buffer_load_dwordx4 v8, s[76:79], s70 offen lds
    s_add_u32 m0, s62, 37888
    s_mov_b32 s70, 5046272
    buffer_load_dwordx4 v8, s[76:79], s70 offen lds
    s_waitcnt vmcnt(36)
    ds_read_b64_tr_b16 a[96:97], v9 offset:0
    ds_read_b64_tr_b16 a[98:99], v9 offset:512
    ds_read_b64_tr_b16 a[100:101], v10 offset:0
    ds_read_b64_tr_b16 a[102:103], v10 offset:512
    s_waitcnt lgkmcnt(4)
    s_add_u32 m0, s62, 38912
    s_mov_b32 s70, 5111808
    buffer_load_dwordx4 v8, s[76:79], s70 offen lds
    s_add_u32 m0, s62, 39936
    s_mov_b32 s70, 5177344
    buffer_load_dwordx4 v8, s[76:79], s70 offen lds
    s_waitcnt vmcnt(36)
    ds_read_b64_tr_b16 a[104:105], v9 offset:2048
    ds_read_b64_tr_b16 a[106:107], v9 offset:2560
    ds_read_b64_tr_b16 a[108:109], v10 offset:2048
    ds_read_b64_tr_b16 a[110:111], v10 offset:2560
    s_waitcnt vmcnt(34)
    ds_read_b64_tr_b16 a[112:113], v9 offset:4096
    ds_read_b64_tr_b16 a[114:115], v9 offset:4608
    ds_read_b64_tr_b16 a[116:117], v10 offset:4096
    ds_read_b64_tr_b16 a[118:119], v10 offset:4608
    s_waitcnt vmcnt(32)
    ds_read_b64_tr_b16 a[120:121], v9 offset:6144
    ds_read_b64_tr_b16 a[122:123], v9 offset:6656
    ds_read_b64_tr_b16 a[124:125], v10 offset:6144
    ds_read_b64_tr_b16 a[126:127], v10 offset:6656
    s_waitcnt vmcnt(30)
    ds_read_b64_tr_b16 a[128:129], v9 offset:8192
    ds_read_b64_tr_b16 a[130:131], v9 offset:8704
    ds_read_b64_tr_b16 a[132:133], v10 offset:8192
    ds_read_b64_tr_b16 a[134:135], v10 offset:8704
    s_waitcnt vmcnt(28)
    ds_read_b64_tr_b16 a[136:137], v9 offset:10240
    ds_read_b64_tr_b16 a[138:139], v9 offset:10752
    ds_read_b64_tr_b16 a[140:141], v10 offset:10240
    ds_read_b64_tr_b16 a[142:143], v10 offset:10752
    s_waitcnt vmcnt(26)
    ds_read_b64_tr_b16 a[144:145], v9 offset:12288
    ds_read_b64_tr_b16 a[146:147], v9 offset:12800
    ds_read_b64_tr_b16 a[148:149], v10 offset:12288
    ds_read_b64_tr_b16 a[150:151], v10 offset:12800
    s_waitcnt vmcnt(24)
    ds_read_b64_tr_b16 a[152:153], v9 offset:14336
    ds_read_b64_tr_b16 a[154:155], v9 offset:14848
    ds_read_b64_tr_b16 a[156:157], v10 offset:14336
    ds_read_b64_tr_b16 a[158:159], v10 offset:14848
    s_waitcnt vmcnt(22)
    ds_read_b64_tr_b16 a[160:161], v9 offset:16384
    ds_read_b64_tr_b16 a[162:163], v9 offset:16896
    ds_read_b64_tr_b16 a[164:165], v10 offset:16384
    ds_read_b64_tr_b16 a[166:167], v10 offset:16896
    s_waitcnt vmcnt(20)
    ds_read_b64_tr_b16 a[168:169], v9 offset:18432
    ds_read_b64_tr_b16 a[170:171], v9 offset:18944
    ds_read_b64_tr_b16 a[172:173], v10 offset:18432
    ds_read_b64_tr_b16 a[174:175], v10 offset:18944
    s_waitcnt vmcnt(18)
    ds_read_b64_tr_b16 a[176:177], v9 offset:20480
    ds_read_b64_tr_b16 a[178:179], v9 offset:20992
    ds_read_b64_tr_b16 a[180:181], v10 offset:20480
    ds_read_b64_tr_b16 a[182:183], v10 offset:20992
    s_waitcnt vmcnt(16)
    ds_read_b64_tr_b16 a[184:185], v9 offset:22528
    ds_read_b64_tr_b16 a[186:187], v9 offset:23040
    ds_read_b64_tr_b16 a[188:189], v10 offset:22528
    ds_read_b64_tr_b16 a[190:191], v10 offset:23040
    s_waitcnt vmcnt(14)
    ds_read_b64_tr_b16 a[192:193], v9 offset:24576
    ds_read_b64_tr_b16 a[194:195], v9 offset:25088
    ds_read_b64_tr_b16 a[196:197], v10 offset:24576
    ds_read_b64_tr_b16 a[198:199], v10 offset:25088
    s_waitcnt vmcnt(12)
    ds_read_b64_tr_b16 a[200:201], v9 offset:26624
    ds_read_b64_tr_b16 a[202:203], v9 offset:27136
    ds_read_b64_tr_b16 a[204:205], v10 offset:26624
    ds_read_b64_tr_b16 a[206:207], v10 offset:27136
    s_waitcnt vmcnt(10)
    ds_read_b64_tr_b16 a[208:209], v9 offset:28672
    ds_read_b64_tr_b16 a[210:211], v9 offset:29184
    ds_read_b64_tr_b16 a[212:213], v10 offset:28672
    ds_read_b64_tr_b16 a[214:215], v10 offset:29184
    s_waitcnt vmcnt(8)
    ds_read_b64_tr_b16 a[216:217], v9 offset:30720
    ds_read_b64_tr_b16 a[218:219], v9 offset:31232
    ds_read_b64_tr_b16 a[220:221], v10 offset:30720
    ds_read_b64_tr_b16 a[222:223], v10 offset:31232
    s_waitcnt vmcnt(6)
    ds_read_b64_tr_b16 a[224:225], v9 offset:32768
    ds_read_b64_tr_b16 a[226:227], v9 offset:33280
    ds_read_b64_tr_b16 a[228:229], v10 offset:32768
    ds_read_b64_tr_b16 a[230:231], v10 offset:33280
    s_waitcnt vmcnt(4)
    ds_read_b64_tr_b16 a[232:233], v9 offset:34816
    ds_read_b64_tr_b16 a[234:235], v9 offset:35328
    ds_read_b64_tr_b16 a[236:237], v10 offset:34816
    ds_read_b64_tr_b16 a[238:239], v10 offset:35328
    s_waitcnt vmcnt(2)
    ds_read_b64_tr_b16 a[240:241], v9 offset:36864
    ds_read_b64_tr_b16 a[242:243], v9 offset:37376
    ds_read_b64_tr_b16 a[244:245], v10 offset:36864
    ds_read_b64_tr_b16 a[246:247], v10 offset:37376
    s_waitcnt vmcnt(0)
    ds_read_b64_tr_b16 a[248:249], v9 offset:38912
    ds_read_b64_tr_b16 a[250:251], v9 offset:39424
    ds_read_b64_tr_b16 a[252:253], v10 offset:38912
    ds_read_b64_tr_b16 a[254:255], v10 offset:39424
    s_waitcnt vmcnt(0) lgkmcnt(0)
    s_mul_i32 s57, s54, 16777216
    s_lshl_b32 s71, s65, 14
    s_add_u32 s57, s57, s71
    s_lshr_b32 s71, s52, 1
    s_lshl_b32 s71, s71, 13
    s_add_u32 s57, s57, s71
    s_and_b32 s71, s52, 1
    s_lshl_b32 s71, s71, 11
    s_add_u32 s57, s57, s71
    s_cmp_eq_u32 s66, 0
    s_cselect_b32 s71, 67108864, 0
    s_add_u32 s57, s57, s71
    s_add_u32 s57, s57, 16777216
    s_mul_i32 s56, s54, 2621440
    s_add_u32 s56, s56, 168165376
    s_mul_i32 s58, s54, 8192
    s_add_u32 s58, s58, 32768
    s_mul_i32 s59, s54, 8192
    s_lshl_b32 s70, s53, 7
    s_add_u32 s59, s59, s70
    s_lshl_b32 s70, s52, 2
    s_add_u32 s59, s59, s70
    s_add_u32 s59, s59, 0
    v_bfe_u32 v8, v0, 4, 1
    v_lshlrev_b32 v8, 12, v8
    v_lshrrev_b32 v9, 5, v0
    v_lshl_add_u32 v8, v9, 8, v8
    v_and_b32 v9, 15, v0
    v_lshl_add_u32 v33, v9, 4, v8
    s_lshl_b32 s70, s52, 10
    s_add_u32 s56, s56, s70
    s_mov_b32 s62, s70
    s_mov_b32 s67, 0
    s_cmp_lg_u32 s96, 0
    s_cbranch_scc1 RDY_ok_25
    s_mov_b32 s68, 0
RDY_lp_26:
    buffer_load_dword v40, off, s[48:51], 0 offset:32 sc1
    s_waitcnt vmcnt(0)
    v_readfirstlane_b32 s70, v40
    s_nop 0
    s_cmp_ge_u32 s70, 256
    s_cbranch_scc1 RDY_all_27
    s_sleep 8
    s_add_u32 s68, s68, 1
    s_cmp_lt_u32 s68, 65536
    s_cbranch_scc1 RDY_lp_26
    s_branch RDY_ok_25
RDY_all_27:
    v_mbcnt_lo_u32_b32 v41, -1, 0
    v_and_b32 v41, 7, v41
    v_min_u32 v42, 1, v41
    v_lshlrev_b32 v41, 2, v41
    v_lshl_add_u32 v41, v42, 7, v41
    buffer_load_dword v40, v41, s[48:51], 0 offen sc1
    s_waitcnt vmcnt(0)
    v_cmp_ne_u32 vcc, 32, v40
    s_nop 0
    s_cbranch_vccnz L_slow
RDY_ok_25:
    s_barrier
    v_mov_b32 v35, 81920
    v_mov_b32 v3, 0
    ds_write_b32 v35, v3
    s_waitcnt lgkmcnt(0)
    s_barrier
    s_mov_b32 s78, 1
G1qk_fetch:
    s_cmp_gt_u32 s60, s55
    s_cbranch_scc1 G1qk_p_ok_28
    s_mov_b32 s68, 0
G1qk_p_lp_29:
    buffer_load_dwordx4 v[4:7], v2, s[8:11], s58 offen sc1
    s_waitcnt vmcnt(0)
    v_min3_u32 v4, v4, v5, v6
    v_min_u32 v4, v4, v7
    v_max_u32 v4, v4, v34
    s_nop 1
    v_min_u32_dpp v4, v4, v4 row_ror:1 row_mask:0xf bank_mask:0xf
    s_nop 1
    v_min_u32_dpp v4, v4, v4 row_ror:2 row_mask:0xf bank_mask:0xf
    s_nop 1
    v_min_u32_dpp v4, v4, v4 row_ror:4 row_mask:0xf bank_mask:0xf
    s_nop 1
    v_min_u32_dpp v4, v4, v4 row_ror:8 row_mask:0xf bank_mask:0xf
    s_nop 0
    v_readlane_b32 s70, v4, 0
    s_nop 0
    s_max_u32 s60, s60, s70
    s_cmp_gt_u32 s60, s55
    s_cbranch_scc1 G1qk_p_ok_28
    s_cmp_lg_u32 s69, 0
    s_cbranch_scc1 G1qk_p_ok_28
    s_sleep 2
    s_add_u32 s68, s68, 1
    s_cmp_lt_u32 s68, 65536
    s_cbranch_scc1 G1qk_p_lp_29
    s_mov_b32 s69, 1
G1qk_p_ok_28:
    s_add_u32 m0, s62, 0
    s_add_u32 s70, s56, 0
    buffer_load_dwordx4 v1, s[8:11], s70 offen sc1 lds
    s_add_u32 m0, s62, 4096
    s_add_u32 s70, s56, 4096
    buffer_load_dwordx4 v1, s[8:11], s70 offen sc1 lds
    s_add_u32 m0, s62, 8192
    s_add_u32 s70, s56, 8192
    buffer_load_dwordx4 v1, s[8:11], s70 offen sc1 lds
    s_add_u32 m0, s62, 12288
    s_add_u32 s70, s56, 12288
    buffer_load_dwordx4 v1, s[8:11], s70 offen sc1 lds
    s_add_u32 m0, s62, 16384
    s_add_u32 s70, s56, 16384
    buffer_load_dwordx4 v1, s[8:11], s70 offen sc1 lds
    s_add_u32 m0, s62, 20480
    s_add_u32 s70, s56, 20480
    buffer_load_dwordx4 v1, s[8:11], s70 offen sc1 lds
    s_add_u32 m0, s62, 24576
    s_add_u32 s70, s56, 24576
    buffer_load_dwordx4 v1, s[8:11], s70 offen sc1 lds
    s_add_u32 m0, s62, 28672
    s_add_u32 s70, s56, 28672
    buffer_load_dwordx4 v1, s[8:11], s70 offen sc1 lds
    s_add_u32 m0, s62, 32768
    s_add_u32 s70, s56, 32768
    buffer_load_dwordx4 v1, s[8:11], s70 offen sc1 lds
    s_add_u32 m0, s62, 36864
    s_add_u32 s70, s56, 36864
    buffer_load_dwordx4 v1, s[8:11], s70 offen sc1 lds
    s_add_u32 s56, s56, 40960
    s_mov_b32 s63, 1
    s_add_u32 s70, s62, 40960
    s_sub_u32 s71, s62, 40960
    s_cmp_ge_u32 s62, 40960
    s_cselect_b32 s62, s71, s70
    buffer_load_dwordx4 v[4:7], v2, s[8:11], s58 offen sc1
G1qk_top:
    s_waitcnt vmcnt(7)
    s_barrier
    v_add_u32 v32, s67, v1
    s_xor_b32 s67, s67, 40960
    ds_read_b128 v[64:67], v32 offset:0
    ds_read_b128 v[68:71], v32 offset:1024
    ds_read_b128 v[72:75], v32 offset:2048
    ds_read_b128 v[76:79], v32 offset:3072
    ds_read_b128 v[80:83], v32 offset:4096
    ds_read_b128 v[84:87], v32 offset:5120
    ds_read_b128 v[88:91], v32 offset:6144
    ds_read_b128 v[92:95], v32 offset:7168
    ds_read_b128 v[96:99], v32 offset:8192
    ds_read_b128 v[100:103], v32 offset:9216
    ds_read_b128 v[104:107], v32 offset:10240
    ds_read_b128 v[108:111], v32 offset:11264
    s_mov_b32 s63, 0
    s_add_u32 s72, s55, 1
    s_cmp_lt_u32 s72, 64
    s_cselect_b32 s77, s72, 0x7fffffff
    s_waitcnt lgkmcnt(10)
    v_mfma_f32_32x32x16_bf16 v[128:143], v[192:195], v[64:67], 0
    ds_read_b128 v[112:115], v32 offset:12288
    v_mfma_f32_32x32x16_bf16 v[128:143], v[200:203], v[68:71], v[128:143]
    ds_read_b128 v[116:119], v32 offset:13312
    s_waitcnt lgkmcnt(10)
    v_mfma_f32_32x32x16_bf16 v[128:143], v[208:211], v[72:75], v[128:143]
    ds_read_b128 v[120:123], v32 offset:14336
    v_mfma_f32_32x32x16_bf16 v[128:143], v[216:219], v[76:79], v[128:143]
    ds_read_b128 v[124:127], v32 offset:15360
    s_waitcnt vmcnt(5) lgkmcnt(10)
    s_barrier
    v_mfma_f32_32x32x16_bf16 v[128:143], v[224:227], v[80:83], v[128:143]
    ds_read_b128 v[64:67], v32 offset:16384
    v_mfma_f32_32x32x16_bf16 v[128:143], v[232:235], v[84:87], v[128:143]
    ds_read_b128 v[68:71], v32 offset:17408
    s_waitcnt lgkmcnt(10)
    v_mfma_f32_32x32x16_bf16 v[128:143], v[240:243], v[88:91], v[128:143]
    ds_read_b128 v[72:75], v32 offset:18432
    v_mfma_f32_32x32x16_bf16 v[128:143], v[248:251], v[92:95], v[128:143]
    ds_read_b128 v[76:79], v32 offset:19456
    s_waitcnt lgkmcnt(10)
    v_mfma_f32_32x32x16_bf16 v[128:143], a[0:3], v[96:99], v[128:143]
    ds_read_b128 v[80:83], v32 offset:20480
    v_mfma_f32_32x32x16_bf16 v[128:143], a[8:11], v[100:103], v[128:143]
    ds_read_b128 v[84:87], v32 offset:21504
    s_waitcnt lgkmcnt(10)
    v_mfma_f32_32x32x16_bf16 v[128:143], a[16:19], v[104:107], v[128:143]
    ds_read_b128 v[88:91], v32 offset:22528
    v_mfma_f32_32x32x16_bf16 v[128:143], a[24:27], v[108:111], v[128:143]
    ds_read_b128 v[92:95], v32 offset:23552
    s_waitcnt vmcnt(3) lgkmcnt(10)
    s_barrier
    v_mfma_f32_32x32x16_bf16 v[128:143], a[32:35], v[112:115], v[128:143]
    ds_read_b128 v[96:99], v32 offset:24576
    v_mfma_f32_32x32x16_bf16 v[128:143], a[40:43], v[116:119], v[128:143]
    ds_read_b128 v[100:103], v32 offset:25600
    s_waitcnt lgkmcnt(10)
    v_mfma_f32_32x32x16_bf16 v[128:143], a[48:51], v[120:123], v[128:143]
    ds_read_b128 v[104:107], v32 offset:26624
    v_mfma_f32_32x32x16_bf16 v[128:143], a[56:59], v[124:127], v[128:143]
    ds_read_b128 v[108:111], v32 offset:27648
    s_waitcnt lgkmcnt(10)
    v_mfma_f32_32x32x16_bf16 v[128:143], a[64:67], v[64:67], v[128:143]
    ds_read_b128 v[112:115], v32 offset:28672
    v_mfma_f32_32x32x16_bf16 v[128:143], a[72:75], v[68:71], v[128:143]
    ds_read_b128 v[116:119], v32 offset:29696
    s_waitcnt lgkmcnt(10)
    v_mfma_f32_32x32x16_bf16 v[128:143], a[80:83], v[72:75], v[128:143]
    ds_read_b128 v[120:123], v32 offset:30720
    s_waitcnt vmcnt(0)
    v_min3_u32 v4, v4, v5, v6
    v_min_u32 v4, v4, v7
    v_max_u32 v4, v4, v34
    v_cmp_ge_u32 vcc, s77, v4
    v_mfma_f32_32x32x16_bf16 v[128:143], a[88:91], v[76:79], v[128:143]
    ds_read_b128 v[124:127], v32 offset:31744
    s_cmp_eq_u32 s61, 0
    s_cbranch_scc1 G1qk_nop_30
    v_mov_b32 v3, s55
    s_mov_b64 exec, 1
    buffer_store_dword v3, off, s[8:11], s59 sc1
    s_mov_b64 exec, -1
    s_mov_b32 s61, 0
G1qk_nop_30:
    s_cbranch_vccz G1qk_dma9
    buffer_load_dwordx4 v[4:7], v2, s[8:11], s58 offen sc1
    s_barrier
    s_waitcnt lgkmcnt(10)
    v_mfma_f32_32x32x16_bf16 v[128:143], a[96:99], v[80:83], v[128:143]
    ds_read_b128 v[64:67], v32 offset:32768
    v_mfma_f32_32x32x16_bf16 v[128:143], a[104:107], v[84:87], v[128:143]
    ds_read_b128 v[68:71], v32 offset:33792
    s_waitcnt lgkmcnt(10)
    v_mfma_f32_32x32x16_bf16 v[128:143], a[112:115], v[88:91], v[128:143]
    ds_read_b128 v[72:75], v32 offset:34816
    v_mfma_f32_32x32x16_bf16 v[128:143], a[120:123], v[92:95], v[128:143]
    ds_read_b128 v[76:79], v32 offset:35840
    s_waitcnt lgkmcnt(10)
    v_mfma_f32_32x32x16_bf16 v[128:143], a[128:131], v[96:99], v[128:143]
    ds_read_b128 v[80:83], v32 offset:36864
    v_mfma_f32_32x32x16_bf16 v[128:143], a[136:139], v[100:103], v[128:143]
    ds_read_b128 v[84:87], v32 offset:37888
    s_waitcnt lgkmcnt(10)
    v_mfma_f32_32x32x16_bf16 v[128:143], a[144:147], v[104:107], v[128:143]
    ds_read_b128 v[88:91], v32 offset:38912
    v_mfma_f32_32x32x16_bf16 v[128:143], a[152:155], v[108:111], v[128:143]
    ds_read_b128 v[92:95], v32 offset:39936
    s_waitcnt lgkmcnt(10)
    v_mfma_f32_32x32x16_bf16 v[128:143], a[160:163], v[112:115], v[128:143]
    ds_read_b128 v[96:99], v32 offset:0
    v_mfma_f32_32x32x16_bf16 v[128:143], a[168:171], v[116:119], v[128:143]
    ds_read_b128 v[100:103], v32 offset:1024
    s_waitcnt lgkmcnt(10)
    v_mfma_f32_32x32x16_bf16 v[128:143], a[176:179], v[120:123], v[128:143]
    ds_read_b128 v[104:107], v32 offset:2048
    v_mfma_f32_32x32x16_bf16 v[128:143], a[184:187], v[124:127], v[128:143]
    ds_read_b128 v[108:111], v32 offset:3072
    s_waitcnt lgkmcnt(10)
    v_mfma_f32_32x32x16_bf16 v[128:143], a[192:195], v[64:67], v[128:143]
    ds_read_b128 v[112:115], v32 offset:4096
    v_mfma_f32_32x32x16_bf16 v[128:143], a[200:203], v[68:71], v[128:143]
    ds_read_b128 v[116:119], v32 offset:5120
    s_waitcnt lgkmcnt(10)
    v_mfma_f32_32x32x16_bf16 v[128:143], a[208:211], v[72:75], v[128:143]
    ds_read_b128 v[120:123], v32 offset:6144
    v_mfma_f32_32x32x16_bf16 v[128:143], a[216:219], v[76:79], v[128:143]
    ds_read_b128 v[124:127], v32 offset:7168
    s_waitcnt lgkmcnt(10)
    v_mfma_f32_32x32x16_bf16 v[128:143], a[224:227], v[80:83], v[128:143]
    ds_read_b128 v[64:67], v32 offset:8192
    v_mfma_f32_32x32x16_bf16 v[128:143], a[232:235], v[84:87], v[128:143]
    ds_read_b128 v[68:71], v32 offset:9216
    s_waitcnt lgkmcnt(10)
    v_mfma_f32_32x32x16_bf16 v[128:143], a[240:243], v[88:91], v[128:143]
    ds_read_b128 v[72:75], v32 offset:10240
    s_waitcnt vmcnt(0)
    v_min3_u32 v4, v4, v5, v6
    v_min_u32 v4, v4, v7
    v_max_u32 v4, v4, v34
    v_cmp_ge_u32 vcc, s77, v4
    v_mfma_f32_32x32x16_bf16 v[128:143], a[248:251], v[92:95], v[128:143]
    ds_read_b128 v[76:79], v32 offset:11264
    s_cbranch_vccz G1qk_dma19
    buffer_load_dwordx4 v[4:7], v2, s[8:11], s58 offen sc1
    s_waitcnt lgkmcnt(10)
    v_mfma_f32_32x32x16_bf16 v[144:159], v[196:199], v[96:99], 0
    ds_read_b128 v[80:83], v32 offset:12288
    v_mfma_f32_32x32x16_bf16 v[144:159], v[204:207], v[100:103], v[144:159]
    ds_read_b128 v[84:87], v32 offset:13312
    s_waitcnt lgkmcnt(10)
    v_mfma_f32_32x32x16_bf16 v[144:159], v[212:215], v[104:107], v[144:159]
    ds_read_b128 v[88:91], v32 offset:14336
    v_mfma_f32_32x32x16_bf16 v[144:159], v[220:223], v[108:111], v[144:159]
    ds_read_b128 v[92:95], v32 offset:15360
    s_waitcnt lgkmcnt(10)
    v_mfma_f32_32x32x16_bf16 v[144:159], v[228:231], v[112:115], v[144:159]
    ds_read_b128 v[96:99], v32 offset:16384
    v_mfma_f32_32x32x16_bf16 v[144:159], v[236:239], v[116:119], v[144:159]
    ds_read_b128 v[100:103], v32 offset:17408
    v_cvt_pk_bf16_f32 v160, v128, v136
    v_cvt_pk_bf16_f32 v161, v129, v137
    v_cvt_pk_bf16_f32 v162, v130, v138
    v_cvt_pk_bf16_f32 v163, v131, v139
    buffer_store_dwordx4 v[160:163], v33, s[8:11], s57 offen offset:0 sc1
    s_waitcnt lgkmcnt(10)
    v_mfma_f32_32x32x16_bf16 v[144:159], v[244:247], v[120:123], v[144:159]
    ds_read_b128 v[104:107], v32 offset:18432
    v_mfma_f32_32x32x16_bf16 v[144:159], v[252:255], v[124:127], v[144:159]
    ds_read_b128 v[108:111], v32 offset:19456
    s_waitcnt lgkmcnt(10)
    v_mfma_f32_32x32x16_bf16 v[144:159], a[4:7], v[64:67], v[144:159]
    ds_read_b128 v[112:115], v32 offset:20480
    v_mfma_f32_32x32x16_bf16 v[144:159], a[12:15], v[68:71], v[144:159]
    ds_read_b128 v[116:119], v32 offset:21504
    v_cvt_pk_bf16_f32 v164, v132, v140
    v_cvt_pk_bf16_f32 v165, v133, v141
    v_cvt_pk_bf16_f32 v166, v134, v142
    v_cvt_pk_bf16_f32 v167, v135, v143
    buffer_store_dwordx4 v[164:167], v33, s[8:11], s57 offen offset:512 sc1
    s_waitcnt lgkmcnt(10)
    v_mfma_f32_32x32x16_bf16 v[144:159], a[20:23], v[72:75], v[144:159]
    ds_read_b128 v[120:123], v32 offset:22528
    v_mfma_f32_32x32x16_bf16 v[144:159], a[28:31], v[76:79], v[144:159]
    ds_read_b128 v[124:127], v32 offset:23552
    s_waitcnt lgkmcnt(10)
    v_mfma_f32_32x32x16_bf16 v[144:159], a[36:39], v[80:83], v[144:159]
    ds_read_b128 v[64:67], v32 offset:24576
    v_mfma_f32_32x32x16_bf16 v[144:159], a[44:47], v[84:87], v[144:159]
    ds_read_b128 v[68:71], v32 offset:25600
    s_waitcnt lgkmcnt(10)
    v_mfma_f32_32x32x16_bf16 v[144:159], a[52:55], v[88:91], v[144:159]
    ds_read_b128 v[72:75], v32 offset:26624
    v_mfma_f32_32x32x16_bf16 v[144:159], a[60:63], v[92:95], v[144:159]
    ds_read_b128 v[76:79], v32 offset:27648
    s_waitcnt lgkmcnt(10)
    v_mfma_f32_32x32x16_bf16 v[144:159], a[68:71], v[96:99], v[144:159]
    ds_read_b128 v[80:83], v32 offset:28672
    v_mfma_f32_32x32x16_bf16 v[144:159], a[76:79], v[100:103], v[144:159]
    ds_read_b128 v[84:87], v32 offset:29696
    s_waitcnt lgkmcnt(10)
    v_mfma_f32_32x32x16_bf16 v[144:159], a[84:87], v[104:107], v[144:159]
    ds_read_b128 v[88:91], v32 offset:30720
    s_waitcnt vmcnt(2)
    v_min3_u32 v4, v4, v5, v6
    v_min_u32 v4, v4, v7
    v_max_u32 v4, v4, v34
    v_cmp_ge_u32 vcc, s77, v4
    v_mfma_f32_32x32x16_bf16 v[144:159], a[92:95], v[108:111], v[144:159]
    ds_read_b128 v[92:95], v32 offset:31744
    s_cbranch_vccz G1qk_dma29
    buffer_load_dwordx4 v[4:7], v2, s[8:11], s58 offen sc1
    s_waitcnt lgkmcnt(10)
    v_mfma_f32_32x32x16_bf16 v[144:159], a[100:103], v[112:115], v[144:159]
    ds_read_b128 v[96:99], v32 offset:32768
    v_mfma_f32_32x32x16_bf16 v[144:159], a[108:111], v[116:119], v[144:159]
    ds_read_b128 v[100:103], v32 offset:33792
    s_waitcnt lgkmcnt(10)
    v_mfma_f32_32x32x16_bf16 v[144:159], a[116:119], v[120:123], v[144:159]
    ds_read_b128 v[104:107], v32 offset:34816
    v_mfma_f32_32x32x16_bf16 v[144:159], a[124:127], v[124:127], v[144:159]
    ds_read_b128 v[108:111], v32 offset:35840
    s_waitcnt lgkmcnt(10)
    v_mfma_f32_32x32x16_bf16 v[144:159], a[132:135], v[64:67], v[144:159]
    ds_read_b128 v[112:115], v32 offset:36864
    v_mfma_f32_32x32x16_bf16 v[144:159], a[140:143], v[68:71], v[144:159]
    ds_read_b128 v[116:119], v32 offset:37888
    s_waitcnt lgkmcnt(10)
    v_mfma_f32_32x32x16_bf16 v[144:159], a[148:151], v[72:75], v[144:159]
    ds_read_b128 v[120:123], v32 offset:38912
    v_mfma_f32_32x32x16_bf16 v[144:159], a[156:159], v[76:79], v[144:159]
    ds_read_b128 v[124:127], v32 offset:39936
    s_waitcnt lgkmcnt(10)
    v_mfma_f32_32x32x16_bf16 v[144:159], a[164:167], v[80:83], v[144:159]
    v_mfma_f32_32x32x16_bf16 v[144:159], a[172:175], v[84:87], v[144:159]
    s_waitcnt lgkmcnt(8)
    v_mfma_f32_32x32x16_bf16 v[144:159], a[180:183], v[88:91], v[144:159]
    v_mfma_f32_32x32x16_bf16 v[144:159], a[188:191], v[92:95], v[144:159]
    s_waitcnt lgkmcnt(6)
    v_mfma_f32_32x32x16_bf16 v[144:159], a[196:199], v[96:99], v[144:159]
    v_mfma_f32_32x32x16_bf16 v[144:159], a[204:207], v[100:103], v[144:159]
    s_waitcnt lgkmcnt(4)
    v_mfma_f32_32x32x16_bf16 v[144:159], a[212:215], v[104:107], v[144:159]
    v_mfma_f32_32x32x16_bf16 v[144:159], a[220:223], v[108:111], v[144:159]
    s_waitcnt lgkmcnt(2)
    v_mfma_f32_32x32x16_bf16 v[144:159], a[228:231], v[112:115], v[144:159]
    v_mfma_f32_32x32x16_bf16 v[144:159], a[236:239], v[116:119], v[144:159]
    s_waitcnt lgkmcnt(0)
    v_mfma_f32_32x32x16_bf16 v[144:159], a[244:247], v[120:123], v[144:159]
    v_mfma_f32_32x32x16_bf16 v[144:159], a[252:255], v[124:127], v[144:159]
    s_branch G1qk_epi
G1qk_dma19:
    s_waitcnt lgkmcnt(10)
    v_mfma_f32_32x32x16_bf16 v[144:159], v[196:199], v[96:99], 0
    ds_read_b128 v[80:83], v32 offset:12288
    s_add_u32 m0, s62, 0
    s_add_u32 s70, s56, 0
    buffer_load_dwordx4 v1, s[8:11], s70 offen sc1 lds
    v_mfma_f32_32x32x16_bf16 v[144:159], v[204:207], v[100:103], v[144:159]
    ds_read_b128 v[84:87], v32 offset:13312
    s_waitcnt lgkmcnt(10)
    v_mfma_f32_32x32x16_bf16 v[144:159], v[212:215], v[104:107], v[144:159]
    ds_read_b128 v[88:91], v32 offset:14336
    s_add_u32 m0, s62, 4096
    s_add_u32 s70, s56, 4096
    buffer_load_dwordx4 v1, s[8:11], s70 offen sc1 lds
    v_mfma_f32_32x32x16_bf16 v[144:159], v[220:223], v[108:111], v[144:159]
    ds_read_b128 v[92:95], v32 offset:15360
    s_waitcnt lgkmcnt(10)
    v_mfma_f32_32x32x16_bf16 v[144:159], v[228:231], v[112:115], v[144:159]
    ds_read_b128 v[96:99], v32 offset:16384
    s_add_u32 m0, s62, 8192
    s_add_u32 s70, s56, 8192
    buffer_load_dwordx4 v1, s[8:11], s70 offen sc1 lds
    v_mfma_f32_32x32x16_bf16 v[144:159], v[236:239], v[116:119], v[144:159]
    ds_read_b128 v[100:103], v32 offset:17408
    v_cvt_pk_bf16_f32 v160, v128, v136
    v_cvt_pk_bf16_f32 v161, v129, v137
    v_cvt_pk_bf16_f32 v162, v130, v138
    v_cvt_pk_bf16_f32 v163, v131, v139
    buffer_store_dwordx4 v[160:163], v33, s[8:11], s57 offen offset:0 sc1
    s_waitcnt lgkmcnt(10)
    v_mfma_f32_32x32x16_bf16 v[144:159], v[244:247], v[120:123], v[144:159]
    ds_read_b128 v[104:107], v32 offset:18432
    s_add_u32 m0, s62, 12288
    s_add_u32 s70, s56, 12288
    buffer_load_dwordx4 v1, s[8:11], s70 offen sc1 lds
    v_mfma_f32_32x32x16_bf16 v[144:159], v[252:255], v[124:127], v[144:159]
    ds_read_b128 v[108:111], v32 offset:19456
    s_waitcnt lgkmcnt(10)
    v_mfma_f32_32x32x16_bf16 v[144:159], a[4:7], v[64:67], v[144:159]
    ds_read_b128 v[112:115], v32 offset:20480
    s_add_u32 m0, s62, 16384
    s_add_u32 s70, s56, 16384
    buffer_load_dwordx4 v1, s[8:11], s70 offen sc1 lds
    v_mfma_f32_32x32x16_bf16 v[144:159], a[12:15], v[68:71], v[144:159]
    ds_read_b128 v[116:119], v32 offset:21504
    v_cvt_pk_bf16_f32 v164, v132, v140
    v_cvt_pk_bf16_f32 v165, v133, v141
    v_cvt_pk_bf16_f32 v166, v134, v142
    v_cvt_pk_bf16_f32 v167, v135, v143
    buffer_store_dwordx4 v[164:167], v33, s[8:11], s57 offen offset:512 sc1
    s_waitcnt lgkmcnt(10)
    v_mfma_f32_32x32x16_bf16 v[144:159], a[20:23], v[72:75], v[144:159]
    ds_read_b128 v[120:123], v32 offset:22528
    s_add_u32 m0, s62, 20480
    s_add_u32 s70, s56, 20480
    buffer_load_dwordx4 v1, s[8:11], s70 offen sc1 lds
    v_mfma_f32_32x32x16_bf16 v[144:159], a[28:31], v[76:79], v[144:159]
    ds_read_b128 v[124:127], v32 offset:23552
    s_waitcnt lgkmcnt(10)
    v_mfma_f32_32x32x16_bf16 v[144:159], a[36:39], v[80:83], v[144:159]
    ds_read_b128 v[64:67], v32 offset:24576
    s_add_u32 m0, s62, 24576
    s_add_u32 s70, s56, 24576
    buffer_load_dwordx4 v1, s[8:11], s70 offen sc1 lds
    v_mfma_f32_32x32x16_bf16 v[144:159], a[44:47], v[84:87], v[144:159]
    ds_read_b128 v[68:71], v32 offset:25600
    s_waitcnt lgkmcnt(10)
    v_mfma_f32_32x32x16_bf16 v[144:159], a[52:55], v[88:91], v[144:159]
    ds_read_b128 v[72:75], v32 offset:26624
    s_add_u32 m0, s62, 28672
    s_add_u32 s70, s56, 28672
    buffer_load_dwordx4 v1, s[8:11], s70 offen sc1 lds
    v_mfma_f32_32x32x16_bf16 v[144:159], a[60:63], v[92:95], v[144:159]
    ds_read_b128 v[76:79], v32 offset:27648
    s_waitcnt lgkmcnt(10)
    v_mfma_f32_32x32x16_bf16 v[144:159], a[68:71], v[96:99], v[144:159]
    ds_read_b128 v[80:83], v32 offset:28672
    s_add_u32 m0, s62, 32768
    s_add_u32 s70, s56, 32768
    buffer_load_dwordx4 v1, s[8:11], s70 offen sc1 lds
    v_mfma_f32_32x32x16_bf16 v[144:159], a[76:79], v[100:103], v[144:159]
    ds_read_b128 v[84:87], v32 offset:29696
    s_waitcnt lgkmcnt(10)
    v_mfma_f32_32x32x16_bf16 v[144:159], a[84:87], v[104:107], v[144:159]
    ds_read_b128 v[88:91], v32 offset:30720
    s_add_u32 m0, s62, 36864
    s_add_u32 s70, s56, 36864
    buffer_load_dwordx4 v1, s[8:11], s70 offen sc1 lds
    s_add_u32 s56, s56, 40960
    s_mov_b32 s63, 1
    s_add_u32 s70, s62, 40960
    s_sub_u32 s71, s62, 40960
    s_cmp_ge_u32 s62, 40960
    s_cselect_b32 s62, s71, s70
    v_mfma_f32_32x32x16_bf16 v[144:159], a[92:95], v[108:111], v[144:159]
    ds_read_b128 v[92:95], v32 offset:31744
    s_branch G1qk_rest30
G1qk_dma29:
    s_waitcnt lgkmcnt(10)
    v_mfma_f32_32x32x16_bf16 v[144:159], a[100:103], v[112:115], v[144:159]
    ds_read_b128 v[96:99], v32 offset:32768
    s_add_u32 m0, s62, 0
    s_add_u32 s70, s56, 0
    buffer_load_dwordx4 v1, s[8:11], s70 offen sc1 lds
    v_mfma_f32_32x32x16_bf16 v[144:159], a[108:111], v[116:119], v[144:159]
    ds_read_b128 v[100:103], v32 offset:33792
    s_waitcnt lgkmcnt(10)
    v_mfma_f32_32x32x16_bf16 v[144:159], a[116:119], v[120:123], v[144:159]
    ds_read_b128 v[104:107], v32 offset:34816
    s_add_u32 m0, s62, 4096
    s_add_u32 s70, s56, 4096
    buffer_load_dwordx4 v1, s[8:11], s70 offen sc1 lds
    v_mfma_f32_32x32x16_bf16 v[144:159], a[124:127], v[124:127], v[144:159]
    ds_read_b128 v[108:111], v32 offset:35840
    s_waitcnt lgkmcnt(10)
    v_mfma_f32_32x32x16_bf16 v[144:159], a[132:135], v[64:67], v[144:159]
    ds_read_b128 v[112:115], v32 offset:36864
    s_add_u32 m0, s62, 8192
    s_add_u32 s70, s56, 8192
    buffer_load_dwordx4 v1, s[8:11], s70 offen sc1 lds
    v_mfma_f32_32x32x16_bf16 v[144:159], a[140:143], v[68:71], v[144:159]
    ds_read_b128 v[116:119], v32 offset:37888
    s_waitcnt lgkmcnt(10)
    v_mfma_f32_32x32x16_bf16 v[144:159], a[148:151], v[72:75], v[144:159]
    ds_read_b128 v[120:123], v32 offset:38912
    s_add_u32 m0, s62, 12288
    s_add_u32 s70, s56, 12288
    buffer_load_dwordx4 v1, s[8:11], s70 offen sc1 lds
    v_mfma_f32_32x32x16_bf16 v[144:159], a[156:159], v[76:79], v[144:159]
    ds_read_b128 v[124:127], v32 offset:39936
    s_waitcnt lgkmcnt(10)
    v_mfma_f32_32x32x16_bf16 v[144:159], a[164:167], v[80:83], v[144:159]
    s_add_u32 m0, s62, 16384
    s_add_u32 s70, s56, 16384
    buffer_load_dwordx4 v1, s[8:11], s70 offen sc1 lds
    v_mfma_f32_32x32x16_bf16 v[144:159], a[172:175], v[84:87], v[144:159]
    s_waitcnt lgkmcnt(8)
    v_mfma_f32_32x32x16_bf16 v[144:159], a[180:183], v[88:91], v[144:159]
    s_add_u32 m0, s62, 20480
    s_add_u32 s70, s56, 20480
    buffer_load_dwordx4 v1, s[8:11], s70 offen sc1 lds
    v_mfma_f32_32x32x16_bf16 v[144:159], a[188:191], v[92:95], v[144:159]
    s_waitcnt lgkmcnt(6)
    v_mfma_f32_32x32x16_bf16 v[144:159], a[196:199], v[96:99], v[144:159]
    s_add_u32 m0, s62, 24576
    s_add_u32 s70, s56, 24576
    buffer_load_dwordx4 v1, s[8:11], s70 offen sc1 lds
    v_mfma_f32_32x32x16_bf16 v[144:159], a[204:207], v[100:103], v[144:159]
    s_waitcnt lgkmcnt(4)
    v_mfma_f32_32x32x16_bf16 v[144:159], a[212:215], v[104:107], v[144:159]
    s_add_u32 m0, s62, 28672
    s_add_u32 s70, s56, 28672
    buffer_load_dwordx4 v1, s[8:11], s70 offen sc1 lds
    v_mfma_f32_32x32x16_bf16 v[144:159], a[220:223], v[108:111], v[144:159]
    s_waitcnt lgkmcnt(2)
    v_mfma_f32_32x32x16_bf16 v[144:159], a[228:231], v[112:115], v[144:159]
    s_add_u32 m0, s62, 32768
    s_add_u32 s70, s56, 32768
    buffer_load_dwordx4 v1, s[8:11], s70 offen sc1 lds
    v_mfma_f32_32x32x16_bf16 v[144:159], a[236:239], v[116:119], v[144:159]
    s_waitcnt lgkmcnt(0)
    v_mfma_f32_32x32x16_bf16 v[144:159], a[244:247], v[120:123], v[144:159]
    s_add_u32 m0, s62, 36864
    s_add_u32 s70, s56, 36864
    buffer_load_dwordx4 v1, s[8:11], s70 offen sc1 lds
    s_add_u32 s56, s56, 40960
    s_mov_b32 s63, 1
    s_add_u32 s70, s62, 40960
    s_sub_u32 s71, s62, 40960
    s_cmp_ge_u32 s62, 40960
    s_cselect_b32 s62, s71, s70
    v_mfma_f32_32x32x16_bf16 v[144:159], a[252:255], v[124:127], v[144:159]
    s_branch G1qk_epi
G1qk_dma9:
    s_barrier
    s_waitcnt lgkmcnt(10)
    v_mfma_f32_32x32x16_bf16 v[128:143], a[96:99], v[80:83], v[128:143]
    ds_read_b128 v[64:67], v32 offset:32768
    s_add_u32 m0, s62, 0
    s_add_u32 s70, s56, 0
    buffer_load_dwordx4 v1, s[8:11], s70 offen sc1 lds
    v_mfma_f32_32x32x16_bf16 v[128:143], a[104:107], v[84:87], v[128:143]
    ds_read_b128 v[68:71], v32 offset:33792
    s_waitcnt lgkmcnt(10)
    v_mfma_f32_32x32x16_bf16 v[128:143], a[112:115], v[88:91], v[128:143]
    ds_read_b128 v[72:75], v32 offset:34816
    s_add_u32 m0, s62, 4096
    s_add_u32 s70, s56, 4096
    buffer_load_dwordx4 v1, s[8:11], s70 offen sc1 lds
    v_mfma_f32_32x32x16_bf16 v[128:143], a[120:123], v[92:95], v[128:143]
    ds_read_b128 v[76:79], v32 offset:35840
    s_waitcnt lgkmcnt(10)
    v_mfma_f32_32x32x16_bf16 v[128:143], a[128:131], v[96:99], v[128:143]
    ds_read_b128 v[80:83], v32 offset:36864
    s_add_u32 m0, s62, 8192
    s_add_u32 s70, s56, 8192
    buffer_load_dwordx4 v1, s[8:11], s70 offen sc1 lds
    v_mfma_f32_32x32x16_bf16 v[128:143], a[136:139], v[100:103], v[128:143]
    ds_read_b128 v[84:87], v32 offset:37888
    s_waitcnt lgkmcnt(10)
    v_mfma_f32_32x32x16_bf16 v[128:143], a[144:147], v[104:107], v[128:143]
    ds_read_b128 v[88:91], v32 offset:38912
    s_add_u32 m0, s62, 12288
    s_add_u32 s70, s56, 12288
    buffer_load_dwordx4 v1, s[8:11], s70 offen sc1 lds
    v_mfma_f32_32x32x16_bf16 v[128:143], a[152:155], v[108:111], v[128:143]
    ds_read_b128 v[92:95], v32 offset:39936
    s_waitcnt lgkmcnt(10)
    v_mfma_f32_32x32x16_bf16 v[128:143], a[160:163], v[112:115], v[128:143]
    ds_read_b128 v[96:99], v32 offset:0
    s_add_u32 m0, s62, 16384
    s_add_u32 s70, s56, 16384
    buffer_load_dwordx4 v1, s[8:11], s70 offen sc1 lds
    v_mfma_f32_32x32x16_bf16 v[128:143], a[168:171], v[116:119], v[128:143]
    ds_read_b128 v[100:103], v32 offset:1024
    s_waitcnt lgkmcnt(10)
    v_mfma_f32_32x32x16_bf16 v[128:143], a[176:179], v[120:123], v[128:143]
    ds_read_b128 v[104:107], v32 offset:2048
    s_add_u32 m0, s62, 20480
    s_add_u32 s70, s56, 20480
    buffer_load_dwordx4 v1, s[8:11], s70 offen sc1 lds
    v_mfma_f32_32x32x16_bf16 v[128:143], a[184:187], v[124:127], v[128:143]
    ds_read_b128 v[108:111], v32 offset:3072
    s_waitcnt lgkmcnt(10)
    v_mfma_f32_32x32x16_bf16 v[128:143], a[192:195], v[64:67], v[128:143]
    ds_read_b128 v[112:115], v32 offset:4096
    s_add_u32 m0, s62, 24576
    s_add_u32 s70, s56, 24576
    buffer_load_dwordx4 v1, s[8:11], s70 offen sc1 lds
    v_mfma_f32_32x32x16_bf16 v[128:143], a[200:203], v[68:71], v[128:143]
    ds_read_b128 v[116:119], v32 offset:5120
    s_waitcnt lgkmcnt(10)
    v_mfma_f32_32x32x16_bf16 v[128:143], a[208:211], v[72:75], v[128:143]
    ds_read_b128 v[120:123], v32 offset:6144
    s_add_u32 m0, s62, 28672
    s_add_u32 s70, s56, 28672
    buffer_load_dwordx4 v1, s[8:11], s70 offen sc1 lds
    v_mfma_f32_32x32x16_bf16 v[128:143], a[216:219], v[76:79], v[128:143]
    ds_read_b128 v[124:127], v32 offset:7168
    s_waitcnt lgkmcnt(10)
    v_mfma_f32_32x32x16_bf16 v[128:143], a[224:227], v[80:83], v[128:143]
    ds_read_b128 v[64:67], v32 offset:8192
    s_add_u32 m0, s62, 32768
    s_add_u32 s70, s56, 32768
    buffer_load_dwordx4 v1, s[8:11], s70 offen sc1 lds
    v_mfma_f32_32x32x16_bf16 v[128:143], a[232:235], v[84:87], v[128:143]
    ds_read_b128 v[68:71], v32 offset:9216
    s_waitcnt lgkmcnt(10)
    v_mfma_f32_32x32x16_bf16 v[128:143], a[240:243], v[88:91], v[128:143]
    ds_read_b128 v[72:75], v32 offset:10240
    s_add_u32 m0, s62, 36864
    s_add_u32 s70, s56, 36864
    buffer_load_dwordx4 v1, s[8:11], s70 offen sc1 lds
    s_add_u32 s56, s56, 40960
    s_mov_b32 s63, 1
    s_add_u32 s70, s62, 40960
    s_sub_u32 s71, s62, 40960
    s_cmp_ge_u32 s62, 40960
    s_cselect_b32 s62, s71, s70
    v_mfma_f32_32x32x16_bf16 v[128:143], a[248:251], v[92:95], v[128:143]
    ds_read_b128 v[76:79], v32 offset:11264
G1qk_rest20:
    s_waitcnt lgkmcnt(10)
    v_mfma_f32_32x32x16_bf16 v[144:159], v[196:199], v[96:99], 0
    ds_read_b128 v[80:83], v32 offset:12288
    v_mfma_f32_32x32x16_bf16 v[144:159], v[204:207], v[100:103], v[144:159]
    ds_read_b128 v[84:87], v32 offset:13312
    s_waitcnt lgkmcnt(10)
    v_mfma_f32_32x32x16_bf16 v[144:159], v[212:215], v[104:107], v[144:159]
    ds_read_b128 v[88:91], v32 offset:14336
    v_mfma_f32_32x32x16_bf16 v[144:159], v[220:223], v[108:111], v[144:159]
    ds_read_b128 v[92:95], v32 offset:15360
    s_waitcnt lgkmcnt(10)
    v_mfma_f32_32x32x16_bf16 v[144:159], v[228:231], v[112:115], v[144:159]
    ds_read_b128 v[96:99], v32 offset:16384
    v_mfma_f32_32x32x16_bf16 v[144:159], v[236:239], v[116:119], v[144:159]
    ds_read_b128 v[100:103], v32 offset:17408
    v_cvt_pk_bf16_f32 v160, v128, v136
    v_cvt_pk_bf16_f32 v161, v129, v137
    v_cvt_pk_bf16_f32 v162, v130, v138
    v_cvt_pk_bf16_f32 v163, v131, v139
    buffer_store_dwordx4 v[160:163], v33, s[8:11], s57 offen offset:0 sc1
    s_waitcnt lgkmcnt(10)
    v_mfma_f32_32x32x16_bf16 v[144:159], v[244:247], v[120:123], v[144:159]
    ds_read_b128 v[104:107], v32 offset:18432
    v_mfma_f32_32x32x16_bf16 v[144:159], v[252:255], v[124:127], v[144:159]
    ds_read_b128 v[108:111], v32 offset:19456
    s_waitcnt lgkmcnt(10)
    v_mfma_f32_32x32x16_bf16 v[144:159], a[4:7], v[64:67], v[144:159]
    ds_read_b128 v[112:115], v32 offset:20480
    v_mfma_f32_32x32x16_bf16 v[144:159], a[12:15], v[68:71], v[144:159]
    ds_read_b128 v[116:119], v32 offset:21504
    v_cvt_pk_bf16_f32 v164, v132, v140
    v_cvt_pk_bf16_f32 v165, v133, v141
    v_cvt_pk_bf16_f32 v166, v134, v142
    v_cvt_pk_bf16_f32 v167, v135, v143
    buffer_store_dwordx4 v[164:167], v33, s[8:11], s57 offen offset:512 sc1
    s_waitcnt lgkmcnt(10)
    v_mfma_f32_32x32x16_bf16 v[144:159], a[20:23], v[72:75], v[144:159]
    ds_read_b128 v[120:123], v32 offset:22528
    v_mfma_f32_32x32x16_bf16 v[144:159], a[28:31], v[76:79], v[144:159]
    ds_read_b128 v[124:127], v32 offset:23552
    s_waitcnt lgkmcnt(10)
    v_mfma_f32_32x32x16_bf16 v[144:159], a[36:39], v[80:83], v[144:159]
    ds_read_b128 v[64:67], v32 offset:24576
    v_mfma_f32_32x32x16_bf16 v[144:159], a[44:47], v[84:87], v[144:159]
    ds_read_b128 v[68:71], v32 offset:25600
    s_waitcnt lgkmcnt(10)
    v_mfma_f32_32x32x16_bf16 v[144:159], a[52:55], v[88:91], v[144:159]
    ds_read_b128 v[72:75], v32 offset:26624
    v_mfma_f32_32x32x16_bf16 v[144:159], a[60:63], v[92:95], v[144:159]
    ds_read_b128 v[76:79], v32 offset:27648
    s_waitcnt lgkmcnt(10)
    v_mfma_f32_32x32x16_bf16 v[144:159], a[68:71], v[96:99], v[144:159]
    ds_read_b128 v[80:83], v32 offset:28672
    v_mfma_f32_32x32x16_bf16 v[144:159], a[76:79], v[100:103], v[144:159]
    ds_read_b128 v[84:87], v32 offset:29696
    s_waitcnt lgkmcnt(10)
    v_mfma_f32_32x32x16_bf16 v[144:159], a[84:87], v[104:107], v[144:159]
    ds_read_b128 v[88:91], v32 offset:30720
    v_mfma_f32_32x32x16_bf16 v[144:159], a[92:95], v[108:111], v[144:159]
    ds_read_b128 v[92:95], v32 offset:31744
G1qk_rest30:
    s_waitcnt lgkmcnt(10)
    v_mfma_f32_32x32x16_bf16 v[144:159], a[100:103], v[112:115], v[144:159]
    ds_read_b128 v[96:99], v32 offset:32768
    v_mfma_f32_32x32x16_bf16 v[144:159], a[108:111], v[116:119], v[144:159]
    ds_read_b128 v[100:103], v32 offset:33792
    s_waitcnt lgkmcnt(10)
    v_mfma_f32_32x32x16_bf16 v[144:159], a[116:119], v[120:123], v[144:159]
    ds_read_b128 v[104:107], v32 offset:34816
    v_mfma_f32_32x32x16_bf16 v[144:159], a[124:127], v[124:127], v[144:159]
    ds_read_b128 v[108:111], v32 offset:35840
    s_waitcnt lgkmcnt(10)
    v_mfma_f32_32x32x16_bf16 v[144:159], a[132:135], v[64:67], v[144:159]
    ds_read_b128 v[112:115], v32 offset:36864
    v_mfma_f32_32x32x16_bf16 v[144:159], a[140:143], v[68:71], v[144:159]
    ds_read_b128 v[116:119], v32 offset:37888
    s_waitcnt lgkmcnt(10)
    v_mfma_f32_32x32x16_bf16 v[144:159], a[148:151], v[72:75], v[144:159]
    ds_read_b128 v[120:123], v32 offset:38912
    v_mfma_f32_32x32x16_bf16 v[144:159], a[156:159], v[76:79], v[144:159]
    ds_read_b128 v[124:127], v32 offset:39936
    s_waitcnt lgkmcnt(10)
    v_mfma_f32_32x32x16_bf16 v[144:159], a[164:167], v[80:83], v[144:159]
    v_mfma_f32_32x32x16_bf16 v[144:159], a[172:175], v[84:87], v[144:159]
    s_waitcnt lgkmcnt(8)
    v_mfma_f32_32x32x16_bf16 v[144:159], a[180:183], v[88:91], v[144:159]
    v_mfma_f32_32x32x16_bf16 v[144:159], a[188:191], v[92:95], v[144:159]
    s_waitcnt lgkmcnt(6)
    v_mfma_f32_32x32x16_bf16 v[144:159], a[196:199], v[96:99], v[144:159]
    v_mfma_f32_32x32x16_bf16 v[144:159], a[204:207], v[100:103], v[144:159]
    s_waitcnt lgkmcnt(4)
    v_mfma_f32_32x32x16_bf16 v[144:159], a[212:215], v[104:107], v[144:159]
    v_mfma_f32_32x32x16_bf16 v[144:159], a[220:223], v[108:111], v[144:159]
    s_waitcnt lgkmcnt(2)
    v_mfma_f32_32x32x16_bf16 v[144:159], a[228:231], v[112:115], v[144:159]
    v_mfma_f32_32x32x16_bf16 v[144:159], a[236:239], v[116:119], v[144:159]
    s_waitcnt lgkmcnt(0)
    v_mfma_f32_32x32x16_bf16 v[144:159], a[244:247], v[120:123], v[144:159]
    v_mfma_f32_32x32x16_bf16 v[144:159], a[252:255], v[124:127], v[144:159]
G1qk_epi:
    s_nop 11
    v_cvt_pk_bf16_f32 v168, v144, v152
    v_cvt_pk_bf16_f32 v169, v145, v153
    v_cvt_pk_bf16_f32 v170, v146, v154
    v_cvt_pk_bf16_f32 v171, v147, v155
    buffer_store_dwordx4 v[168:171], v33, s[8:11], s57 offen offset:1024 sc1
    v_cvt_pk_bf16_f32 v172, v148, v156
    v_cvt_pk_bf16_f32 v173, v149, v157
    v_cvt_pk_bf16_f32 v174, v150, v158
    v_cvt_pk_bf16_f32 v175, v151, v159
    buffer_store_dwordx4 v[172:175], v33, s[8:11], s57 offen offset:1536 sc1
    s_add_u32 s57, s57, 262144
    s_add_u32 s55, s55, 1
    s_mov_b32 s61, 1
    s_cmp_eq_u32 s63, 0
    s_cbranch_scc1 G1qk_late
    buffer_load_dwordx4 v[4:7], v2, s[8:11], s58 offen sc1
    s_branch G1qk_top
G1qk_late:
    s_mov_b32 s61, 0
    s_waitcnt vmcnt(2)
    v_min3_u32 v4, v4, v5, v6
    v_min_u32 v4, v4, v7
    v_max_u32 v4, v4, v34
    s_nop 1
    v_min_u32_dpp v4, v4, v4 row_ror:1 row_mask:0xf bank_mask:0xf
    s_nop 1
    v_min_u32_dpp v4, v4, v4 row_ror:2 row_mask:0xf bank_mask:0xf
    s_nop 1
    v_min_u32_dpp v4, v4, v4 row_ror:4 row_mask:0xf bank_mask:0xf
    s_nop 1
    v_min_u32_dpp v4, v4, v4 row_ror:8 row_mask:0xf bank_mask:0xf
    s_nop 0
    v_readlane_b32 s70, v4, 0
    s_nop 0
    s_max_u32 s60, s60, s70
    s_min_u32 s60, s60, 64
    s_cmp_gt_u32 s60, s55
    s_cbranch_scc0 G1qk_idle
    s_add_u32 m0, s62, 0
    s_add_u32 s70, s56, 0
    buffer_load_dwordx4 v1, s[8:11], s70 offen sc1 lds
    s_add_u32 m0, s62, 4096
    s_add_u32 s70, s56, 4096
    buffer_load_dwordx4 v1, s[8:11], s70 offen sc1 lds
    s_add_u32 m0, s62, 8192
    s_add_u32 s70, s56, 8192
    buffer_load_dwordx4 v1, s[8:11], s70 offen sc1 lds
    s_add_u32 m0, s62, 12288
    s_add_u32 s70, s56, 12288
    buffer_load_dwordx4 v1, s[8:11], s70 offen sc1 lds
    s_add_u32 m0, s62, 16384
    s_add_u32 s70, s56, 16384
    buffer_load_dwordx4 v1, s[8:11], s70 offen sc1 lds
    s_add_u32 m0, s62, 20480
    s_add_u32 s70, s56, 20480
    buffer_load_dwordx4 v1, s[8:11], s70 offen sc1 lds
    s_add_u32 m0, s62, 24576
    s_add_u32 s70, s56, 24576
    buffer_load_dwordx4 v1, s[8:11], s70 offen sc1 lds
    s_add_u32 m0, s62, 28672
    s_add_u32 s70, s56, 28672
    buffer_load_dwordx4 v1, s[8:11], s70 offen sc1 lds
    s_add_u32 m0, s62, 32768
    s_add_u32 s70, s56, 32768
    buffer_load_dwordx4 v1, s[8:11], s70 offen sc1 lds
    s_add_u32 m0, s62, 36864
    s_add_u32 s70, s56, 36864
    buffer_load_dwordx4 v1, s[8:11], s70 offen sc1 lds
    s_add_u32 s56, s56, 40960
    s_mov_b32 s63, 1
    s_add_u32 s70, s62, 40960
    s_sub_u32 s71, s62, 40960
    s_cmp_ge_u32 s62, 40960
    s_cselect_b32 s62, s71, s70
    s_waitcnt vmcnt(10)
    v_mov_b32 v3, s55
    s_mov_b64 exec, 1
    buffer_store_dword v3, off, s[8:11], s59 sc1
    s_mov_b64 exec, -1
    buffer_load_dwordx4 v[4:7], v2, s[8:11], s58 offen sc1
    s_branch G1qk_top
G1qk_idle:
    buffer_load_dwordx4 v[4:7], v2, s[8:11], s58 offen sc1
    s_waitcnt vmcnt(0)
    v_mov_b32 v3, s55
    s_mov_b64 exec, 1
    buffer_store_dword v3, off, s[8:11], s59 sc1
    s_mov_b64 exec, -1
    v_min3_u32 v4, v4, v5, v6
    v_min_u32 v4, v4, v7
    v_max_u32 v4, v4, v34
    s_nop 1
    v_min_u32_dpp v4, v4, v4 row_ror:1 row_mask:0xf bank_mask:0xf
    s_nop 1
    v_min_u32_dpp v4, v4, v4 row_ror:2 row_mask:0xf bank_mask:0xf
    s_nop 1
    v_min_u32_dpp v4, v4, v4 row_ror:4 row_mask:0xf bank_mask:0xf
    s_nop 1
    v_min_u32_dpp v4, v4, v4 row_ror:8 row_mask:0xf bank_mask:0xf
    s_nop 0
    v_readlane_b32 s70, v4, 0
    s_nop 0
    s_max_u32 s60, s60, s70
    s_cmp_lt_u32 s55, 64
    s_cbranch_scc1 G1qk_fetch
    s_endpgm
G1v_entry:
    v_and_b32 v0, 63, v0
    v_lshlrev_b32 v1, 4, v0
    v_min_u32 v2, 1, v0
    v_lshlrev_b32 v2, 7, v2
    s_mov_b32 s55, 0
    s_mov_b32 s60, 0
    s_mov_b32 s61, 0
    s_mov_b32 s69, 0
    v_mov_b32 v34, 0
    s_cmp_eq_u32 s54, 0
    s_cselect_b32 s70, 7, 1
    v_min_u32 v2, s70, v0
    v_lshrrev_b32 v34, 1, v2
    v_lshlrev_b32 v2, 7, v2
    s_mul_i32 s71, s53, 43
    s_lshr_b32 s65, s71, 7
    s_mul_i32 s71, s65, 3
    s_sub_u32 s66, s53, s71
    s_lshl_b32 s64, s65, 9
    s_lshl_b32 s71, s52, 7
    s_add_u32 s64, s64, s71
    v_lshrrev_b32 v11, 5, v0
    v_mul_u32_u24 v11, 4, v11
    v_bfe_u32 v12, v0, 3, 2
    v_add_u32 v11, v11, v12
    s_mov_b32 s70, 8192
    v_mul_lo_u32 v11, v11, s70
    v_bfe_u32 v12, v0, 4, 1
    v_lshlrev_b32 v12, 2, v12
    v_and_b32 v13, 7, v0
    v_xor_b32 v12, v12, v13
    v_lshl_add_u32 v11, v12, 4, v11
    v_add_u32 v8, s64, v11
    s_mul_i32 s62, s52, 40960
    v_lshrrev_b32 v11, 5, v0
    v_lshlrev_b32 v11, 10, v11
    v_bfe_u32 v12, v0, 2, 2
    v_lshl_add_u32 v11, v12, 7, v11
    v_bfe_u32 v12, v0, 3, 1
    v_lshl_add_u32 v11, v12, 6, v11
    v_bfe_u32 v12, v0, 4, 1
    v_lshl_add_u32 v11, v12, 5, v11
    v_and_b32 v12, 3, v0
    v_lshl_add_u32 v11, v12, 3, v11
    v_add_u32 v9, s62, v11
    v_xor_b32 v10, 64, v9
    s_add_u32 m0, s62, 0
    s_mov_b32 s70, 0
    buffer_load_dwordx4 v8, s[20:23], s70 offen lds
    s_add_u32 m0, s62, 1024
    s_mov_b32 s70, 65536
    buffer_load_dwordx4 v8, s[20:23], s70 offen lds
    s_add_u32 m0, s62, 2048
    s_mov_b32 s70, 131072
    buffer_load_dwordx4 v8, s[20:23], s70 offen lds
    s_add_u32 m0, s62, 3072
    s_mov_b32 s70, 196608
    buffer_load_dwordx4 v8, s[20:23], s70 offen lds
    s_add_u32 m0, s62, 4096
    s_mov_b32 s70, 262144
    buffer_load_dwordx4 v8, s[20:23], s70 offen lds
    s_add_u32 m0, s62, 5120
    s_mov_b32 s70, 327680
    buffer_load_dwordx4 v8, s[20:23], s70 offen lds
    s_add_u32 m0, s62, 6144
    s_mov_b32 s70, 393216
    buffer_load_dwordx4 v8, s[20:23], s70 offen lds
    s_add_u32 m0, s62, 7168
    s_mov_b32 s70, 458752
    buffer_load_dwordx4 v8, s[20:23], s70 offen lds
    s_add_u32 m0, s62, 8192
    s_mov_b32 s70, 524288
    buffer_load_dwordx4 v8, s[20:23], s70 offen lds
    s_add_u32 m0, s62, 9216
    s_mov_b32 s70, 589824
    buffer_load_dwordx4 v8, s[20:23], s70 offen lds
    s_add_u32 m0, s62, 10240
    s_mov_b32 s70, 655360
    buffer_load_dwordx4 v8, s[20:23], s70 offen lds
    s_add_u32 m0, s62, 11264
    s_mov_b32 s70, 720896
    buffer_load_dwordx4 v8, s[20:23], s70 offen lds
    s_add_u32 m0, s62, 12288
    s_mov_b32 s70, 786432
    buffer_load_dwordx4 v8, s[20:23], s70 offen lds
    s_add_u32 m0, s62, 13312
    s_mov_b32 s70, 851968
    buffer_load_dwordx4 v8, s[20:23], s70 offen lds
    s_add_u32 m0, s62, 14336
    s_mov_b32 s70, 917504
    buffer_load_dwordx4 v8, s[20:23], s70 offen lds
    s_add_u32 m0, s62, 15360
    s_mov_b32 s70, 983040
    buffer_load_dwordx4 v8, s[20:23], s70 offen lds
    s_add_u32 m0, s62, 16384
    s_mov_b32 s70, 1048576
    buffer_load_dwordx4 v8, s[20:23], s70 offen lds
    s_add_u32 m0, s62, 17408
    s_mov_b32 s70, 1114112
    buffer_load_dwordx4 v8, s[20:23], s70 offen lds
    s_add_u32 m0, s62, 18432
    s_mov_b32 s70, 1179648
    buffer_load_dwordx4 v8, s[20:23], s70 offen lds
    s_add_u32 m0, s62, 19456
    s_mov_b32 s70, 1245184
    buffer_load_dwordx4 v8, s[20:23], s70 offen lds
    s_add_u32 m0, s62, 20480
    s_mov_b32 s70, 1310720
    buffer_load_dwordx4 v8, s[20:23], s70 offen lds
    s_add_u32 m0, s62, 21504
    s_mov_b32 s70, 1376256
    buffer_load_dwordx4 v8, s[20:23], s70 offen lds
    s_add_u32 m0, s62, 22528
    s_mov_b32 s70, 1441792
    buffer_load_dwordx4 v8, s[20:23], s70 offen lds
    s_add_u32 m0, s62, 23552
    s_mov_b32 s70, 1507328
    buffer_load_dwordx4 v8, s[20:23], s70 offen lds
    s_add_u32 m0, s62, 24576
    s_mov_b32 s70, 1572864
    buffer_load_dwordx4 v8, s[20:23], s70 offen lds
    s_add_u32 m0, s62, 25600
    s_mov_b32 s70, 1638400
    buffer_load_dwordx4 v8, s[20:23], s70 offen lds
    s_add_u32 m0, s62, 26624
    s_mov_b32 s70, 1703936
    buffer_load_dwordx4 v8, s[20:23], s70 offen lds
    s_add_u32 m0, s62, 27648
    s_mov_b32 s70, 1769472
    buffer_load_dwordx4 v8, s[20:23], s70 offen lds
    s_add_u32 m0, s62, 28672
    s_mov_b32 s70, 1835008
    buffer_load_dwordx4 v8, s[20:23], s70 offen lds
    s_add_u32 m0, s62, 29696
    s_mov_b32 s70, 1900544
    buffer_load_dwordx4 v8, s[20:23], s70 offen lds
    s_add_u32 m0, s62, 30720
    s_mov_b32 s70, 1966080
    buffer_load_dwordx4 v8, s[20:23], s70 offen lds
    s_add_u32 m0, s62, 31744
    s_mov_b32 s70, 2031616
    buffer_load_dwordx4 v8, s[20:23], s70 offen lds
    s_add_u32 m0, s62, 32768
    s_mov_b32 s70, 2097152
    buffer_load_dwordx4 v8, s[20:23], s70 offen lds
    s_add_u32 m0, s62, 33792
    s_mov_b32 s70, 2162688
    buffer_load_dwordx4 v8, s[20:23], s70 offen lds
    s_add_u32 m0, s62, 34816
    s_mov_b32 s70, 2228224
    buffer_load_dwordx4 v8, s[20:23], s70 offen lds
    s_add_u32 m0, s62, 35840
    s_mov_b32 s70, 2293760
    buffer_load_dwordx4 v8, s[20:23], s70 offen lds
    s_add_u32 m0, s62, 36864
    s_mov_b32 s70, 2359296
    buffer_load_dwordx4 v8, s[20:23], s70 offen lds
    s_add_u32 m0, s62, 37888
    s_mov_b32 s70, 2424832
    buffer_load_dwordx4 v8, s[20:23], s70 offen lds
    s_add_u32 m0, s62, 38912
    s_mov_b32 s70, 2490368
    buffer_load_dwordx4 v8, s[20:23], s70 offen lds
    s_add_u32 m0, s62, 39936
    s_mov_b32 s70, 2555904
    buffer_load_dwordx4 v8, s[20:23], s70 offen lds
    s_waitcnt vmcnt(38)
    ds_read_b64_tr_b16 v[192:193], v9 offset:0
    ds_read_b64_tr_b16 v[194:195], v9 offset:512
    ds_read_b64_tr_b16 v[196:197], v10 offset:0
    ds_read_b64_tr_b16 v[198:199], v10 offset:512
    s_waitcnt vmcnt(36)
    ds_read_b64_tr_b16 v[200:201], v9 offset:2048
    ds_read_b64_tr_b16 v[202:203], v9 offset:2560
    ds_read_b64_tr_b16 v[204:205], v10 offset:2048
    ds_read_b64_tr_b16 v[206:207], v10 offset:2560
    s_waitcnt lgkmcnt(4)
    s_add_u32 m0, s62, 0
    s_mov_b32 s70, 2621440
    buffer_load_dwordx4 v8, s[20:23], s70 offen lds
    s_add_u32 m0, s62, 1024
    s_mov_b32 s70, 2686976
    buffer_load_dwordx4 v8, s[20:23], s70 offen lds
    s_waitcnt vmcnt(36)
    ds_read_b64_tr_b16 v[208:209], v9 offset:4096
    ds_read_b64_tr_b16 v[210:211], v9 offset:4608
    ds_read_b64_tr_b16 v[212:213], v10 offset:4096
    ds_read_b64_tr_b16 v[214:215], v10 offset:4608
    s_waitcnt lgkmcnt(4)
    s_add_u32 m0, s62, 2048
    s_mov_b32 s70, 2752512
    buffer_load_dwordx4 v8, s[20:23], s70 offen lds
    s_add_u32 m0, s62, 3072
    s_mov_b32 s70, 2818048
    buffer_load_dwordx4 v8, s[20:23], s70 offen lds
    s_waitcnt vmcnt(36)
    ds_read_b64_tr_b16 v[216:217], v9 offset:6144
    ds_read_b64_tr_b16 v[218:219], v9 offset:6656
    ds_read_b64_tr_b16 v[220:221], v10 offset:6144
    ds_read_b64_tr_b16 v[222:223], v10 offset:6656
    s_waitcnt lgkmcnt(4)
    s_add_u32 m0, s62, 4096
    s_mov_b32 s70, 2883584
    buffer_load_dwordx4 v8, s[20:23], s70 offen lds
    s_add_u32 m0, s62, 5120
    s_mov_b32 s70, 2949120
    buffer_load_dwordx4 v8, s[20:23], s70 offen lds
    s_waitcnt vmcnt(36)
    ds_read_b64_tr_b16 v[224:225], v9 offset:8192
    ds_read_b64_tr_b16 v[226:227], v9 offset:8704
    ds_read_b64_tr_b16 v[228:229], v10 offset:8192
    ds_read_b64_tr_b16 v[230:231], v10 offset:8704
    s_waitcnt lgkmcnt(4)
    s_add_u32 m0, s62, 6144
    s_mov_b32 s70, 3014656
    buffer_load_dwordx4 v8, s[20:23], s70 offen lds
    s_add_u32 m0, s62, 7168
    s_mov_b32 s70, 3080192
    buffer_load_dwordx4 v8, s[20:23], s70 offen lds
    s_waitcnt vmcnt(36)
    ds_read_b64_tr_b16 v[232:233], v9 offset:10240
    ds_read_b64_tr_b16 v[234:235], v9 offset:10752
    ds_read_b64_tr_b16 v[236:237], v10 offset:10240
    ds_read_b64_tr_b16 v[238:239], v10 offset:10752
    s_waitcnt lgkmcnt(4)
    s_add_u32 m0, s62, 8192
    s_mov_b32 s70, 3145728
    buffer_load_dwordx4 v8, s[20:23], s70 offen lds
    s_add_u32 m0, s62, 9216
    s_mov_b32 s70, 3211264
    buffer_load_dwordx4 v8, s[20:23], s70 offen lds
    s_waitcnt vmcnt(36)
    ds_read_b64_tr_b16 v[240:241], v9 offset:12288
    ds_read_b64_tr_b16 v[242:243], v9 offset:12800
    ds_read_b64_tr_b16 v[244:245], v10 offset:12288
    ds_read_b64_tr_b16 v[246:247], v10 offset:12800
    s_waitcnt lgkmcnt(4)
    s_add_u32 m0, s62, 10240
    s_mov_b32 s70, 3276800
    buffer_load_dwordx4 v8, s[20:23], s70 offen lds
    s_add_u32 m0, s62, 11264
    s_mov_b32 s70, 3342336
    buffer_load_dwordx4 v8, s[20:23], s70 offen lds
    s_waitcnt vmcnt(36)
    ds_read_b64_tr_b16 v[248:249], v9 offset:14336
    ds_read_b64_tr_b16 v[250:251], v9 offset:14848
    ds_read_b64_tr_b16 v[252:253], v10 offset:14336
    ds_read_b64_tr_b16 v[254:255], v10 offset:14848
    s_waitcnt lgkmcnt(4)
    s_add_u32 m0, s62, 12288
    s_mov_b32 s70, 3407872
    buffer_load_dwordx4 v8, s[20:23], s70 offen lds
    s_add_u32 m0, s62, 13312
    s_mov_b32 s70, 3473408
    buffer_load_dwordx4 v8, s[20:23], s70 offen lds
    s_waitcnt vmcnt(36)
    ds_read_b64_tr_b16 a[0:1], v9 offset:16384
    ds_read_b64_tr_b16 a[2:3], v9 offset:16896
    ds_read_b64_tr_b16 a[4:5], v10 offset:16384
    ds_read_b64_tr_b16 a[6:7], v10 offset:16896
    s_waitcnt lgkmcnt(4)
    s_add_u32 m0, s62, 14336
    s_mov_b32 s70, 3538944
    buffer_load_dwordx4 v8, s[20:23], s70 offen lds
    s_add_u32 m0, s62, 15360
    s_mov_b32 s70, 3604480
    buffer_load_dwordx4 v8, s[20:23], s70 offen lds
    s_waitcnt vmcnt(36)
    ds_read_b64_tr_b16 a[8:9], v9 offset:18432
    ds_read_b64_tr_b16 a[10:11], v9 offset:18944
    ds_read_b64_tr_b16 a[12:13], v10 offset:18432
    ds_read_b64_tr_b16 a[14:15], v10 offset:18944
    s_waitcnt lgkmcnt(4)
    s_add_u32 m0, s62, 16384
    s_mov_b32 s70, 3670016
    buffer_load_dwordx4 v8, s[20:23], s70 offen lds
    s_add_u32 m0, s62, 17408
    s_mov_b32 s70, 3735552
    buffer_load_dwordx4 v8, s[20:23], s70 offen lds
    s_waitcnt vmcnt(36)
    ds_read_b64_tr_b16 a[16:17], v9 offset:20480
    ds_read_b64_tr_b16 a[18:19], v9 offset:20992
    ds_read_b64_tr_b16 a[20:21], v10 offset:20480
    ds_read_b64_tr_b16 a[22:23], v10 offset:20992
    s_waitcnt lgkmcnt(4)
    s_add_u32 m0, s62, 18432
    s_mov_b32 s70, 3801088
    buffer_load_dwordx4 v8, s[20:23], s70 offen lds
    s_add_u32 m0, s62, 19456
    s_mov_b32 s70, 3866624
    buffer_load_dwordx4 v8, s[20:23], s70 offen lds
    s_waitcnt vmcnt(36)
    ds_read_b64_tr_b16 a[24:25], v9 offset:22528
    ds_read_b64_tr_b16 a[26:27], v9 offset:23040
    ds_read_b64_tr_b16 a[28:29], v10 offset:22528
    ds_read_b64_tr_b16 a[30:31], v10 offset:23040
    s_waitcnt lgkmcnt(4)
    s_add_u32 m0, s62, 20480
    s_mov_b32 s70, 3932160
    buffer_load_dwordx4 v8, s[20:23], s70 offen lds
    s_add_u32 m0, s62, 21504
    s_mov_b32 s70, 3997696
    buffer_load_dwordx4 v8, s[20:23], s70 offen lds
    s_waitcnt vmcnt(36)
    ds_read_b64_tr_b16 a[32:33], v9 offset:24576
    ds_read_b64_tr_b16 a[34:35], v9 offset:25088
    ds_read_b64_tr_b16 a[36:37], v10 offset:24576
    ds_read_b64_tr_b16 a[38:39], v10 offset:25088
    s_waitcnt lgkmcnt(4)
    s_add_u32 m0, s62, 22528
    s_mov_b32 s70, 4063232
    buffer_load_dwordx4 v8, s[20:23], s70 offen lds
    s_add_u32 m0, s62, 23552
    s_mov_b32 s70, 4128768
    buffer_load_dwordx4 v8, s[20:23], s70 offen lds
    s_waitcnt vmcnt(36)
    ds_read_b64_tr_b16 a[40:41], v9 offset:26624
    ds_read_b64_tr_b16 a[42:43], v9 offset:27136
    ds_read_b64_tr_b16 a[44:45], v10 offset:26624
    ds_read_b64_tr_b16 a[46:47], v10 offset:27136
    s_waitcnt lgkmcnt(4)
    s_add_u32 m0, s62, 24576
    s_mov_b32 s70, 4194304
    buffer_load_dwordx4 v8, s[20:23], s70 offen lds
    s_add_u32 m0, s62, 25600
    s_mov_b32 s70, 4259840
    buffer_load_dwordx4 v8, s[20:23], s70 offen lds
    s_waitcnt vmcnt(36)
    ds_read_b64_tr_b16 a[48:49], v9 offset:28672
    ds_read_b64_tr_b16 a[50:51], v9 offset:29184
    ds_read_b64_tr_b16 a[52:53], v10 offset:28672
    ds_read_b64_tr_b16 a[54:55], v10 offset:29184
    s_waitcnt lgkmcnt(4)
    s_add_u32 m0, s62, 26624
    s_mov_b32 s70, 4325376
    buffer_load_dwordx4 v8, s[20:23], s70 offen lds
    s_add_u32 m0, s62, 27648
    s_mov_b32 s70, 4390912
    buffer_load_dwordx4 v8, s[20:23], s70 offen lds
    s_waitcnt vmcnt(36)
    ds_read_b64_tr_b16 a[56:57], v9 offset:30720
    ds_read_b64_tr_b16 a[58:59], v9 offset:31232
    ds_read_b64_tr_b16 a[60:61], v10 offset:30720
    ds_read_b64_tr_b16 a[62:63], v10 offset:31232
    s_waitcnt lgkmcnt(4)
    s_add_u32 m0, s62, 28672
    s_mov_b32 s70, 4456448
    buffer_load_dwordx4 v8, s[20:23], s70 offen lds
    s_add_u32 m0, s62, 29696
    s_mov_b32 s70, 4521984
    buffer_load_dwordx4 v8, s[20:23], s70 offen lds
    s_waitcnt vmcnt(36)
    ds_read_b64_tr_b16 a[64:65], v9 offset:32768
    ds_read_b64_tr_b16 a[66:67], v9 offset:33280
    ds_read_b64_tr_b16 a[68:69], v10 offset:32768
    ds_read_b64_tr_b16 a[70:71], v10 offset:33280
    s_waitcnt lgkmcnt(4)
    s_add_u32 m0, s62, 30720
    s_mov_b32 s70, 4587520
    buffer_load_dwordx4 v8, s[20:23], s70 offen lds
    s_add_u32 m0, s62, 31744
    s_mov_b32 s70, 4653056
    buffer_load_dwordx4 v8, s[20:23], s70 offen lds
    s_waitcnt vmcnt(36)
    ds_read_b64_tr_b16 a[72:73], v9 offset:34816
    ds_read_b64_tr_b16 a[74:75], v9 offset:35328
    ds_read_b64_tr_b16 a[76:77], v10 offset:34816
    ds_read_b64_tr_b16 a[78:79], v10 offset:35328
    s_waitcnt lgkmcnt(4)
    s_add_u32 m0, s62, 32768
    s_mov_b32 s70, 4718592
    buffer_load_dwordx4 v8, s[20:23], s70 offen lds
    s_add_u32 m0, s62, 33792
    s_mov_b32 s70, 4784128
    buffer_load_dwordx4 v8, s[20:23], s70 offen lds
    s_waitcnt vmcnt(36)
    ds_read_b64_tr_b16 a[80:81], v9 offset:36864
    ds_read_b64_tr_b16 a[82:83], v9 offset:37376
    ds_read_b64_tr_b16 a[84:85], v10 offset:36864
    ds_read_b64_tr_b16 a[86:87], v10 offset:37376
    s_waitcnt lgkmcnt(4)
    s_add_u32 m0, s62, 34816
    s_mov_b32 s70, 4849664
    buffer_load_dwordx4 v8, s[20:23], s70 offen lds
    s_add_u32 m0, s62, 35840
    s_mov_b32 s70, 4915200
    buffer_load_dwordx4 v8, s[20:23], s70 offen lds
    s_waitcnt vmcnt(36)
    ds_read_b64_tr_b16 a[88:89], v9 offset:38912
    ds_read_b64_tr_b16 a[90:91], v9 offset:39424
    ds_read_b64_tr_b16 a[92:93], v10 offset:38912
    ds_read_b64_tr_b16 a[94:95], v10 offset:39424
    s_waitcnt lgkmcnt(4)
    s_add_u32 m0, s62, 36864
    s_mov_b32 s70, 4980736
    buffer_load_dwordx4 v8, s[20:23], s70 offen lds
    s_add_u32 m0, s62, 37888
    s_mov_b32 s70, 5046272
    buffer_load_dwordx4 v8, s[20:23], s70 offen lds
    s_waitcnt vmcnt(36)
    ds_read_b64_tr_b16 a[96:97], v9 offset:0
    ds_read_b64_tr_b16 a[98:99], v9 offset:512
    ds_read_b64_tr_b16 a[100:101], v10 offset:0
    ds_read_b64_tr_b16 a[102:103], v10 offset:512
    s_waitcnt lgkmcnt(4)
    s_add_u32 m0, s62, 38912
    s_mov_b32 s70, 5111808
    buffer_load_dwordx4 v8, s[20:23], s70 offen lds
    s_add_u32 m0, s62, 39936
    s_mov_b32 s70, 5177344
    buffer_load_dwordx4 v8, s[20:23], s70 offen lds
    s_waitcnt vmcnt(36)
    ds_read_b64_tr_b16 a[104:105], v9 offset:2048
    ds_read_b64_tr_b16 a[106:107], v9 offset:2560
    ds_read_b64_tr_b16 a[108:109], v10 offset:2048
    ds_read_b64_tr_b16 a[110:111], v10 offset:2560
    s_waitcnt vmcnt(34)
    ds_read_b64_tr_b16 a[112:113], v9 offset:4096
    ds_read_b64_tr_b16 a[114:115], v9 offset:4608
    ds_read_b64_tr_b16 a[116:117], v10 offset:4096
    ds_read_b64_tr_b16 a[118:119], v10 offset:4608
    s_waitcnt vmcnt(32)
    ds_read_b64_tr_b16 a[120:121], v9 offset:6144
    ds_read_b64_tr_b16 a[122:123], v9 offset:6656
    ds_read_b64_tr_b16 a[124:125], v10 offset:6144
    ds_read_b64_tr_b16 a[126:127], v10 offset:6656
    s_waitcnt vmcnt(30)
    ds_read_b64_tr_b16 a[128:129], v9 offset:8192
    ds_read_b64_tr_b16 a[130:131], v9 offset:8704
    ds_read_b64_tr_b16 a[132:133], v10 offset:8192
    ds_read_b64_tr_b16 a[134:135], v10 offset:8704
    s_waitcnt vmcnt(28)
    ds_read_b64_tr_b16 a[136:137], v9 offset:10240
    ds_read_b64_tr_b16 a[138:139], v9 offset:10752
    ds_read_b64_tr_b16 a[140:141], v10 offset:10240
    ds_read_b64_tr_b16 a[142:143], v10 offset:10752
    s_waitcnt vmcnt(26)
    ds_read_b64_tr_b16 a[144:145], v9 offset:12288
    ds_read_b64_tr_b16 a[146:147], v9 offset:12800
    ds_read_b64_tr_b16 a[148:149], v10 offset:12288
    ds_read_b64_tr_b16 a[150:151], v10 offset:12800
    s_waitcnt vmcnt(24)
    ds_read_b64_tr_b16 a[152:153], v9 offset:14336
    ds_read_b64_tr_b16 a[154:155], v9 offset:14848
    ds_read_b64_tr_b16 a[156:157], v10 offset:14336
    ds_read_b64_tr_b16 a[158:159], v10 offset:14848
    s_waitcnt vmcnt(22)
    ds_read_b64_tr_b16 a[160:161], v9 offset:16384
    ds_read_b64_tr_b16 a[162:163], v9 offset:16896
    ds_read_b64_tr_b16 a[164:165], v10 offset:16384
    ds_read_b64_tr_b16 a[166:167], v10 offset:16896
    s_waitcnt vmcnt(20)
    ds_read_b64_tr_b16 a[168:169], v9 offset:18432
    ds_read_b64_tr_b16 a[170:171], v9 offset:18944
    ds_read_b64_tr_b16 a[172:173], v10 offset:18432
    ds_read_b64_tr_b16 a[174:175], v10 offset:18944
    s_waitcnt vmcnt(18)
    ds_read_b64_tr_b16 a[176:177], v9 offset:20480
    ds_read_b64_tr_b16 a[178:179], v9 offset:20992
    ds_read_b64_tr_b16 a[180:181], v10 offset:20480
    ds_read_b64_tr_b16 a[182:183], v10 offset:20992
    s_waitcnt vmcnt(16)
    ds_read_b64_tr_b16 a[184:185], v9 offset:22528
    ds_read_b64_tr_b16 a[186:187], v9 offset:23040
    ds_read_b64_tr_b16 a[188:189], v10 offset:22528
    ds_read_b64_tr_b16 a[190:191], v10 offset:23040
    s_waitcnt vmcnt(14)
    ds_read_b64_tr_b16 a[192:193], v9 offset:24576
    ds_read_b64_tr_b16 a[194:195], v9 offset:25088
    ds_read_b64_tr_b16 a[196:197], v10 offset:24576
    ds_read_b64_tr_b16 a[198:199], v10 offset:25088
    s_waitcnt vmcnt(12)
    ds_read_b64_tr_b16 a[200:201], v9 offset:26624
    ds_read_b64_tr_b16 a[202:203], v9 offset:27136
    ds_read_b64_tr_b16 a[204:205], v10 offset:26624
    ds_read_b64_tr_b16 a[206:207], v10 offset:27136
    s_waitcnt vmcnt(10)
    ds_read_b64_tr_b16 a[208:209], v9 offset:28672
    ds_read_b64_tr_b16 a[210:211], v9 offset:29184
    ds_read_b64_tr_b16 a[212:213], v10 offset:28672
    ds_read_b64_tr_b16 a[214:215], v10 offset:29184
    s_waitcnt vmcnt(8)
    ds_read_b64_tr_b16 a[216:217], v9 offset:30720
    ds_read_b64_tr_b16 a[218:219], v9 offset:31232
    ds_read_b64_tr_b16 a[220:221], v10 offset:30720
    ds_read_b64_tr_b16 a[222:223], v10 offset:31232
    s_waitcnt vmcnt(6)
    ds_read_b64_tr_b16 a[224:225], v9 offset:32768
    ds_read_b64_tr_b16 a[226:227], v9 offset:33280
    ds_read_b64_tr_b16 a[228:229], v10 offset:32768
    ds_read_b64_tr_b16 a[230:231], v10 offset:33280
    s_waitcnt vmcnt(4)
    ds_read_b64_tr_b16 a[232:233], v9 offset:34816
    ds_read_b64_tr_b16 a[234:235], v9 offset:35328
    ds_read_b64_tr_b16 a[236:237], v10 offset:34816
    ds_read_b64_tr_b16 a[238:239], v10 offset:35328
    s_waitcnt vmcnt(2)
    ds_read_b64_tr_b16 a[240:241], v9 offset:36864
    ds_read_b64_tr_b16 a[242:243], v9 offset:37376
    ds_read_b64_tr_b16 a[244:245], v10 offset:36864
    ds_read_b64_tr_b16 a[246:247], v10 offset:37376
    s_waitcnt vmcnt(0)
    ds_read_b64_tr_b16 a[248:249], v9 offset:38912
    ds_read_b64_tr_b16 a[250:251], v9 offset:39424
    ds_read_b64_tr_b16 a[252:253], v10 offset:38912
    ds_read_b64_tr_b16 a[254:255], v10 offset:39424
    s_waitcnt vmcnt(0) lgkmcnt(0)
    s_mul_i32 s57, s54, 16777216
    s_lshl_b32 s71, s65, 14
    s_add_u32 s57, s57, s71
    s_lshr_b32 s71, s52, 1
    s_lshl_b32 s71, s71, 13
    s_add_u32 s57, s57, s71
    s_and_b32 s71, s52, 1
    s_lshl_b32 s71, s71, 12
    s_add_u32 s57, s57, s71
    s_add_u32 s57, s57, 50331648
    s_mul_i32 s74, s54, 8519680
    s_lshl_b32 s71, s65, 13
    s_add_u32 s74, s74, s71
    s_lshl_b32 s71, s52, 11
    s_add_u32 s74, s74, s71
    s_add_u32 s74, s74, 151126016
    v_mov_b32 v36, 0xff81ff81
    v_mov_b32 v37, 0xff81ff81
    v_mov_b32 v38, 0xff81ff81
    v_mov_b32 v39, 0xff81ff81
    s_mul_i32 s56, s54, 2621440
    s_add_u32 s56, s56, 168165376
    s_mul_i32 s58, s54, 8192
    s_add_u32 s58, s58, 32768
    s_mul_i32 s59, s54, 8192
    s_lshl_b32 s70, s53, 7
    s_add_u32 s59, s59, s70
    s_lshl_b32 s70, s52, 2
    s_add_u32 s59, s59, s70
    s_add_u32 s59, s59, 0
    v_bfe_u32 v8, v0, 4, 1
    v_lshlrev_b32 v8, 10, v8
    v_lshrrev_b32 v9, 5, v0
    v_lshl_add_u32 v8, v9, 8, v8
    v_and_b32 v9, 15, v0
    v_lshl_add_u32 v33, v9, 4, v8
    s_lshl_b32 s70, s52, 10
    s_add_u32 s56, s56, s70
    s_mov_b32 s62, s70
    s_mov_b32 s67, 0
    s_cmp_lg_u32 s96, 0
    s_cbranch_scc1 RDY_ok_31
    s_mov_b32 s68, 0
RDY_lp_32:
    buffer_load_dword v40, off, s[48:51], 0 offset:32 sc1
    s_waitcnt vmcnt(0)
    v_readfirstlane_b32 s70, v40
    s_nop 0
    s_cmp_ge_u32 s70, 256
    s_cbranch_scc1 RDY_all_33
    s_sleep 8
    s_add_u32 s68, s68, 1
    s_cmp_lt_u32 s68, 65536
    s_cbranch_scc1 RDY_lp_32
    s_branch RDY_ok_31
RDY_all_33:
    v_mbcnt_lo_u32_b32 v41, -1, 0
    v_and_b32 v41, 7, v41
    v_min_u32 v42, 1, v41
    v_lshlrev_b32 v41, 2, v41
    v_lshl_add_u32 v41, v42, 7, v41
    buffer_load_dword v40, v41, s[48:51], 0 offen sc1
    s_waitcnt vmcnt(0)
    v_cmp_ne_u32 vcc, 32, v40
    s_nop 0
    s_cbranch_vccnz L_slow
RDY_ok_31:
    s_barrier
    v_mov_b32 v35, 81920
    v_mov_b32 v3, 0
    ds_write_b32 v35, v3
    s_waitcnt lgkmcnt(0)
    s_barrier
    s_mov_b32 s78, 1
G1v_fetch:
    s_cmp_gt_u32 s60, s55
    s_cbranch_scc1 G1v_p_ok_34
    s_mov_b32 s68, 0
G1v_p_lp_35:
    buffer_load_dwordx4 v[4:7], v2, s[8:11], s58 offen sc1
    s_waitcnt vmcnt(0)
    v_min3_u32 v4, v4, v5, v6
    v_min_u32 v4, v4, v7
    v_max_u32 v4, v4, v34
    s_nop 1
    v_min_u32_dpp v4, v4, v4 row_ror:1 row_mask:0xf bank_mask:0xf
    s_nop 1
    v_min_u32_dpp v4, v4, v4 row_ror:2 row_mask:0xf bank_mask:0xf
    s_nop 1
    v_min_u32_dpp v4, v4, v4 row_ror:4 row_mask:0xf bank_mask:0xf
    s_nop 1
    v_min_u32_dpp v4, v4, v4 row_ror:8 row_mask:0xf bank_mask:0xf
    s_nop 0
    v_readlane_b32 s70, v4, 0
    s_nop 0
    s_max_u32 s60, s60, s70
    s_cmp_gt_u32 s60, s55
    s_cbranch_scc1 G1v_p_ok_34
    s_cmp_lg_u32 s69, 0
    s_cbranch_scc1 G1v_p_ok_34
    s_sleep 2
    s_add_u32 s68, s68, 1
    s_cmp_lt_u32 s68, 65536
    s_cbranch_scc1 G1v_p_lp_35
    s_mov_b32 s69, 1
G1v_p_ok_34:
    s_add_u32 m0, s62, 0
    s_add_u32 s70, s56, 0
    buffer_load_dwordx4 v1, s[8:11], s70 offen sc1 lds
    s_add_u32 m0, s62, 4096
    s_add_u32 s70, s56, 4096
    buffer_load_dwordx4 v1, s[8:11], s70 offen sc1 lds
    s_add_u32 m0, s62, 8192
    s_add_u32 s70, s56, 8192
    buffer_load_dwordx4 v1, s[8:11], s70 offen sc1 lds
    s_add_u32 m0, s62, 12288
    s_add_u32 s70, s56, 12288
    buffer_load_dwordx4 v1, s[8:11], s70 offen sc1 lds
    s_add_u32 m0, s62, 16384
    s_add_u32 s70, s56, 16384
    buffer_load_dwordx4 v1, s[8:11], s70 offen sc1 lds
    s_add_u32 m0, s62, 20480
    s_add_u32 s70, s56, 20480
    buffer_load_dwordx4 v1, s[8:11], s70 offen sc1 lds
    s_add_u32 m0, s62, 24576
    s_add_u32 s70, s56, 24576
    buffer_load_dwordx4 v1, s[8:11], s70 offen sc1 lds
    s_add_u32 m0, s62, 28672
    s_add_u32 s70, s56, 28672
    buffer_load_dwordx4 v1, s[8:11], s70 offen sc1 lds
    s_add_u32 m0, s62, 32768
    s_add_u32 s70, s56, 32768
    buffer_load_dwordx4 v1, s[8:11], s70 offen sc1 lds
    s_add_u32 m0, s62, 36864
    s_add_u32 s70, s56, 36864
    buffer_load_dwordx4 v1, s[8:11], s70 offen sc1 lds
    s_add_u32 s56, s56, 40960
    s_mov_b32 s63, 1
    s_add_u32 s70, s62, 40960
    s_sub_u32 s71, s62, 40960
    s_cmp_ge_u32 s62, 40960
    s_cselect_b32 s62, s71, s70
    buffer_load_dwordx4 v[4:7], v2, s[8:11], s58 offen sc1
G1v_top:
    s_waitcnt vmcnt(7)
    s_barrier
    v_add_u32 v32, s67, v1
    s_xor_b32 s67, s67, 40960
    ds_read_b128 v[64:67], v32 offset:0
    ds_read_b128 v[68:71], v32 offset:1024
    ds_read_b128 v[72:75], v32 offset:2048
    ds_read_b128 v[76:79], v32 offset:3072
    ds_read_b128 v[80:83], v32 offset:4096
    ds_read_b128 v[84:87], v32 offset:5120
    ds_read_b128 v[88:91], v32 offset:6144
    ds_read_b128 v[92:95], v32 offset:7168
    ds_read_b128 v[96:99], v32 offset:8192
    ds_read_b128 v[100:103], v32 offset:9216
    ds_read_b128 v[104:107], v32 offset:10240
    ds_read_b128 v[108:111], v32 offset:11264
    s_mov_b32 s63, 0
    s_add_u32 s72, s55, 1
    s_cmp_lt_u32 s72, 64
    s_cselect_b32 s77, s72, 0x7fffffff
    s_waitcnt lgkmcnt(10)
    v_mfma_f32_32x32x16_bf16 v[128:143], v[64:67], v[192:195], 0
    ds_read_b128 v[112:115], v32 offset:12288
    v_mfma_f32_32x32x16_bf16 v[128:143], v[68:71], v[200:203], v[128:143]
    ds_read_b128 v[116:119], v32 offset:13312
    s_waitcnt lgkmcnt(10)
    v_mfma_f32_32x32x16_bf16 v[128:143], v[72:75], v[208:211], v[128:143]
    ds_read_b128 v[120:123], v32 offset:14336
    v_mfma_f32_32x32x16_bf16 v[128:143], v[76:79], v[216:219], v[128:143]
    ds_read_b128 v[124:127], v32 offset:15360
    s_waitcnt vmcnt(5) lgkmcnt(10)
    s_barrier
    v_mfma_f32_32x32x16_bf16 v[128:143], v[80:83], v[224:227], v[128:143]
    ds_read_b128 v[64:67], v32 offset:16384
    v_mfma_f32_32x32x16_bf16 v[128:143], v[84:87], v[232:235], v[128:143]
    ds_read_b128 v[68:71], v32 offset:17408
    s_waitcnt lgkmcnt(10)
    v_mfma_f32_32x32x16_bf16 v[128:143], v[88:91], v[240:243], v[128:143]
    ds_read_b128 v[72:75], v32 offset:18432
    v_mfma_f32_32x32x16_bf16 v[128:143], v[92:95], v[248:251], v[128:143]
    ds_read_b128 v[76:79], v32 offset:19456
    s_waitcnt lgkmcnt(10)
    v_mfma_f32_32x32x16_bf16 v[128:143], v[96:99], a[0:3], v[128:143]
    ds_read_b128 v[80:83], v32 offset:20480
    v_mfma_f32_32x32x16_bf16 v[128:143], v[100:103], a[8:11], v[128:143]
    ds_read_b128 v[84:87], v32 offset:21504
    s_waitcnt lgkmcnt(10)
    v_mfma_f32_32x32x16_bf16 v[128:143], v[104:107], a[16:19], v[128:143]
    ds_read_b128 v[88:91], v32 offset:22528
    v_mfma_f32_32x32x16_bf16 v[128:143], v[108:111], a[24:27], v[128:143]
    ds_read_b128 v[92:95], v32 offset:23552
    s_waitcnt vmcnt(3) lgkmcnt(10)
    s_barrier
    v_mfma_f32_32x32x16_bf16 v[128:143], v[112:115], a[32:35], v[128:143]
    ds_read_b128 v[96:99], v32 offset:24576
    v_mfma_f32_32x32x16_bf16 v[128:143], v[116:119], a[40:43], v[128:143]
    ds_read_b128 v[100:103], v32 offset:25600
    s_waitcnt lgkmcnt(10)
    v_mfma_f32_32x32x16_bf16 v[128:143], v[120:123], a[48:51], v[128:143]
    ds_read_b128 v[104:107], v32 offset:26624
    v_mfma_f32_32x32x16_bf16 v[128:143], v[124:127], a[56:59], v[128:143]
    ds_read_b128 v[108:111], v32 offset:27648
    s_waitcnt lgkmcnt(10)
    v_mfma_f32_32x32x16_bf16 v[128:143], v[64:67], a[64:67], v[128:143]
    ds_read_b128 v[112:115], v32 offset:28672
    v_mfma_f32_32x32x16_bf16 v[128:143], v[68:71], a[72:75], v[128:143]
    ds_read_b128 v[116:119], v32 offset:29696
    s_waitcnt lgkmcnt(10)
    v_mfma_f32_32x32x16_bf16 v[128:143], v[72:75], a[80:83], v[128:143]
    ds_read_b128 v[120:123], v32 offset:30720
    s_waitcnt vmcnt(0)
    v_min3_u32 v4, v4, v5, v6
    v_min_u32 v4, v4, v7
    v_max_u32 v4, v4, v34
    v_cmp_ge_u32 vcc, s77, v4
    v_mfma_f32_32x32x16_bf16 v[128:143], v[76:79], a[88:91], v[128:143]
    ds_read_b128 v[124:127], v32 offset:31744
    s_cmp_eq_u32 s61, 0
    s_cbranch_scc1 G1v_nop_36
    v_mov_b32 v3, s55
    s_mov_b64 exec, 1
    buffer_store_dword v3, off, s[8:11], s59 sc1
    s_mov_b64 exec, -1
    s_mov_b32 s61, 0
G1v_nop_36:
    s_cbranch_vccz G1v_dma9
    buffer_load_dwordx4 v[4:7], v2, s[8:11], s58 offen sc1
    s_barrier
    s_waitcnt lgkmcnt(10)
    v_mfma_f32_32x32x16_bf16 v[128:143], v[80:83], a[96:99], v[128:143]
    ds_read_b128 v[64:67], v32 offset:32768
    v_mfma_f32_32x32x16_bf16 v[128:143], v[84:87], a[104:107], v[128:143]
    ds_read_b128 v[68:71], v32 offset:33792
    s_waitcnt lgkmcnt(10)
    v_mfma_f32_32x32x16_bf16 v[128:143], v[88:91], a[112:115], v[128:143]
    ds_read_b128 v[72:75], v32 offset:34816
    v_mfma_f32_32x32x16_bf16 v[128:143], v[92:95], a[120:123], v[128:143]
    ds_read_b128 v[76:79], v32 offset:35840
    s_waitcnt lgkmcnt(10)
    v_mfma_f32_32x32x16_bf16 v[128:143], v[96:99], a[128:131], v[128:143]
    ds_read_b128 v[80:83], v32 offset:36864
    v_mfma_f32_32x32x16_bf16 v[128:143], v[100:103], a[136:139], v[128:143]
    ds_read_b128 v[84:87], v32 offset:37888
    s_waitcnt lgkmcnt(10)
    v_mfma_f32_32x32x16_bf16 v[128:143], v[104:107], a[144:147], v[128:143]
    ds_read_b128 v[88:91], v32 offset:38912
    v_mfma_f32_32x32x16_bf16 v[128:143], v[108:111], a[152:155], v[128:143]
    ds_read_b128 v[92:95], v32 offset:39936
    s_waitcnt lgkmcnt(10)
    v_mfma_f32_32x32x16_bf16 v[128:143], v[112:115], a[160:163], v[128:143]
    ds_read_b128 v[96:99], v32 offset:0
    v_mfma_f32_32x32x16_bf16 v[128:143], v[116:119], a[168:171], v[128:143]
    ds_read_b128 v[100:103], v32 offset:1024
    s_waitcnt lgkmcnt(10)
    v_mfma_f32_32x32x16_bf16 v[128:143], v[120:123], a[176:179], v[128:143]
    ds_read_b128 v[104:107], v32 offset:2048
    v_mfma_f32_32x32x16_bf16 v[128:143], v[124:127], a[184:187], v[128:143]
    ds_read_b128 v[108:111], v32 offset:3072
    s_waitcnt lgkmcnt(10)
    v_mfma_f32_32x32x16_bf16 v[128:143], v[64:67], a[192:195], v[128:143]
    ds_read_b128 v[112:115], v32 offset:4096
    v_mfma_f32_32x32x16_bf16 v[128:143], v[68:71], a[200:203], v[128:143]
    ds_read_b128 v[116:119], v32 offset:5120
    s_waitcnt lgkmcnt(10)
    v_mfma_f32_32x32x16_bf16 v[128:143], v[72:75], a[208:211], v[128:143]
    ds_read_b128 v[120:123], v32 offset:6144
    v_mfma_f32_32x32x16_bf16 v[128:143], v[76:79], a[216:219], v[128:143]
    ds_read_b128 v[124:127], v32 offset:7168
    s_waitcnt lgkmcnt(10)
    v_mfma_f32_32x32x16_bf16 v[128:143], v[80:83], a[224:227], v[128:143]
    ds_read_b128 v[64:67], v32 offset:8192
    v_mfma_f32_32x32x16_bf16 v[128:143], v[84:87], a[232:235], v[128:143]
    ds_read_b128 v[68:71], v32 offset:9216
    s_waitcnt lgkmcnt(10)
    v_mfma_f32_32x32x16_bf16 v[128:143], v[88:91], a[240:243], v[128:143]
    ds_read_b128 v[72:75], v32 offset:10240
    s_waitcnt vmcnt(0)
    v_min3_u32 v4, v4, v5, v6
    v_min_u32 v4, v4, v7
    v_max_u32 v4, v4, v34
    v_cmp_ge_u32 vcc, s77, v4
    v_mfma_f32_32x32x16_bf16 v[128:143], v[92:95], a[248:251], v[128:143]
    ds_read_b128 v[76:79], v32 offset:11264
    s_cbranch_vccz G1v_dma19
    buffer_load_dwordx4 v[4:7], v2, s[8:11], s58 offen sc1
    s_waitcnt lgkmcnt(10)
    v_mfma_f32_32x32x16_bf16 v[144:159], v[96:99], v[196:199], 0
    ds_read_b128 v[80:83], v32 offset:12288
    v_mfma_f32_32x32x16_bf16 v[144:159], v[100:103], v[204:207], v[144:159]
    ds_read_b128 v[84:87], v32 offset:13312
    s_waitcnt lgkmcnt(10)
    v_mfma_f32_32x32x16_bf16 v[144:159], v[104:107], v[212:215], v[144:159]
    ds_read_b128 v[88:91], v32 offset:14336
    v_mfma_f32_32x32x16_bf16 v[144:159], v[108:111], v[220:223], v[144:159]
    ds_read_b128 v[92:95], v32 offset:15360
    s_waitcnt lgkmcnt(10)
    v_mfma_f32_32x32x16_bf16 v[144:159], v[112:115], v[228:231], v[144:159]
    ds_read_b128 v[96:99], v32 offset:16384
    v_mfma_f32_32x32x16_bf16 v[144:159], v[116:119], v[236:239], v[144:159]
    ds_read_b128 v[100:103], v32 offset:17408
    v_cvt_pk_bf16_f32 v160, v128, v129
    v_cvt_pk_bf16_f32 v161, v130, v131
    v_cvt_pk_bf16_f32 v162, v136, v137
    v_cvt_pk_bf16_f32 v163, v138, v139
    buffer_store_dwordx4 v[160:163], v33, s[8:11], s57 offen offset:0 sc1
    s_waitcnt lgkmcnt(10)
    v_mfma_f32_32x32x16_bf16 v[144:159], v[120:123], v[244:247], v[144:159]
    ds_read_b128 v[104:107], v32 offset:18432
    v_mfma_f32_32x32x16_bf16 v[144:159], v[124:127], v[252:255], v[144:159]
    ds_read_b128 v[108:111], v32 offset:19456
    s_waitcnt lgkmcnt(10)
    v_mfma_f32_32x32x16_bf16 v[144:159], v[64:67], a[4:7], v[144:159]
    ds_read_b128 v[112:115], v32 offset:20480
    v_mfma_f32_32x32x16_bf16 v[144:159], v[68:71], a[12:15], v[144:159]
    ds_read_b128 v[116:119], v32 offset:21504
    v_cvt_pk_bf16_f32 v164, v132, v133
    v_cvt_pk_bf16_f32 v165, v134, v135
    v_cvt_pk_bf16_f32 v166, v140, v141
    v_cvt_pk_bf16_f32 v167, v142, v143
    buffer_store_dwordx4 v[164:167], v33, s[8:11], s57 offen offset:512 sc1
    s_waitcnt lgkmcnt(10)
    v_mfma_f32_32x32x16_bf16 v[144:159], v[72:75], a[20:23], v[144:159]
    ds_read_b128 v[120:123], v32 offset:22528
    v_mfma_f32_32x32x16_bf16 v[144:159], v[76:79], a[28:31], v[144:159]
    ds_read_b128 v[124:127], v32 offset:23552
    s_waitcnt lgkmcnt(10)
    v_mfma_f32_32x32x16_bf16 v[144:159], v[80:83], a[36:39], v[144:159]
    ds_read_b128 v[64:67], v32 offset:24576
    v_mfma_f32_32x32x16_bf16 v[144:159], v[84:87], a[44:47], v[144:159]
    ds_read_b128 v[68:71], v32 offset:25600
    buffer_store_dwordx4 v[36:39], v1, s[8:11], s74 offen offset:0 sc1
    s_waitcnt lgkmcnt(10)
    v_mfma_f32_32x32x16_bf16 v[144:159], v[88:91], a[52:55], v[144:159]
    ds_read_b128 v[72:75], v32 offset:26624
    v_mfma_f32_32x32x16_bf16 v[144:159], v[92:95], a[60:63], v[144:159]
    ds_read_b128 v[76:79], v32 offset:27648
    buffer_store_dwordx4 v[36:39], v1, s[8:11], s74 offen offset:1024 sc1
    s_add_u32 s74, s74, 131072
    s_waitcnt lgkmcnt(10)
    v_mfma_f32_32x32x16_bf16 v[144:159], v[96:99], a[68:71], v[144:159]
    ds_read_b128 v[80:83], v32 offset:28672
    v_mfma_f32_32x32x16_bf16 v[144:159], v[100:103], a[76:79], v[144:159]
    ds_read_b128 v[84:87], v32 offset:29696
    s_waitcnt lgkmcnt(10)
    v_mfma_f32_32x32x16_bf16 v[144:159], v[104:107], a[84:87], v[144:159]
    ds_read_b128 v[88:91], v32 offset:30720
    s_waitcnt vmcnt(4)
    v_min3_u32 v4, v4, v5, v6
    v_min_u32 v4, v4, v7
    v_max_u32 v4, v4, v34
    v_cmp_ge_u32 vcc, s77, v4
    v_mfma_f32_32x32x16_bf16 v[144:159], v[108:111], a[92:95], v[144:159]
    ds_read_b128 v[92:95], v32 offset:31744
    s_cbranch_vccz G1v_dma29
    buffer_load_dwordx4 v[4:7], v2, s[8:11], s58 offen sc1
    s_waitcnt lgkmcnt(10)
    v_mfma_f32_32x32x16_bf16 v[144:159], v[112:115], a[100:103], v[144:159]
    ds_read_b128 v[96:99], v32 offset:32768
    v_mfma_f32_32x32x16_bf16 v[144:159], v[116:119], a[108:111], v[144:159]
    ds_read_b128 v[100:103], v32 offset:33792
    s_waitcnt lgkmcnt(10)
    v_mfma_f32_32x32x16_bf16 v[144:159], v[120:123], a[116:119], v[144:159]
    ds_read_b128 v[104:107], v32 offset:34816
    v_mfma_f32_32x32x16_bf16 v[144:159], v[124:127], a[124:127], v[144:159]
    ds_read_b128 v[108:111], v32 offset:35840
    s_waitcnt lgkmcnt(10)
    v_mfma_f32_32x32x16_bf16 v[144:159], v[64:67], a[132:135], v[144:159]
    ds_read_b128 v[112:115], v32 offset:36864
    v_mfma_f32_32x32x16_bf16 v[144:159], v[68:71], a[140:143], v[144:159]
    ds_read_b128 v[116:119], v32 offset:37888
    s_waitcnt lgkmcnt(10)
    v_mfma_f32_32x32x16_bf16 v[144:159], v[72:75], a[148:151], v[144:159]
    ds_read_b128 v[120:123], v32 offset:38912
    v_mfma_f32_32x32x16_bf16 v[144:159], v[76:79], a[156:159], v[144:159]
    ds_read_b128 v[124:127], v32 offset:39936
    s_waitcnt lgkmcnt(10)
    v_mfma_f32_32x32x16_bf16 v[144:159], v[80:83], a[164:167], v[144:159]
    v_mfma_f32_32x32x16_bf16 v[144:159], v[84:87], a[172:175], v[144:159]
    s_waitcnt lgkmcnt(8)
    v_mfma_f32_32x32x16_bf16 v[144:159], v[88:91], a[180:183], v[144:159]
    v_mfma_f32_32x32x16_bf16 v[144:159], v[92:95], a[188:191], v[144:159]
    s_waitcnt lgkmcnt(6)
    v_mfma_f32_32x32x16_bf16 v[144:159], v[96:99], a[196:199], v[144:159]
    v_mfma_f32_32x32x16_bf16 v[144:159], v[100:103], a[204:207], v[144:159]
    s_waitcnt lgkmcnt(4)
    v_mfma_f32_32x32x16_bf16 v[144:159], v[104:107], a[212:215], v[144:159]
    v_mfma_f32_32x32x16_bf16 v[144:159], v[108:111], a[220:223], v[144:159]
    s_waitcnt lgkmcnt(2)
    v_mfma_f32_32x32x16_bf16 v[144:159], v[112:115], a[228:231], v[144:159]
    v_mfma_f32_32x32x16_bf16 v[144:159], v[116:119], a[236:239], v[144:159]
    s_waitcnt lgkmcnt(0)
    v_mfma_f32_32x32x16_bf16 v[144:159], v[120:123], a[244:247], v[144:159]
    v_mfma_f32_32x32x16_bf16 v[144:159], v[124:127], a[252:255], v[144:159]
    s_branch G1v_epi
G1v_dma19:
    s_waitcnt lgkmcnt(10)
    v_mfma_f32_32x32x16_bf16 v[144:159], v[96:99], v[196:199], 0
    ds_read_b128 v[80:83], v32 offset:12288
    s_add_u32 m0, s62, 0
    s_add_u32 s70, s56, 0
    buffer_load_dwordx4 v1, s[8:11], s70 offen sc1 lds
    v_mfma_f32_32x32x16_bf16 v[144:159], v[100:103], v[204:207], v[144:159]
    ds_read_b128 v[84:87], v32 offset:13312
    s_waitcnt lgkmcnt(10)
    v_mfma_f32_32x32x16_bf16 v[144:159], v[104:107], v[212:215], v[144:159]
    ds_read_b128 v[88:91], v32 offset:14336
    s_add_u32 m0, s62, 4096
    s_add_u32 s70, s56, 4096
    buffer_load_dwordx4 v1, s[8:11], s70 offen sc1 lds
    v_mfma_f32_32x32x16_bf16 v[144:159], v[108:111], v[220:223], v[144:159]
    ds_read_b128 v[92:95], v32 offset:15360
    s_waitcnt lgkmcnt(10)
    v_mfma_f32_32x32x16_bf16 v[144:159], v[112:115], v[228:231], v[144:159]
    ds_read_b128 v[96:99], v32 offset:16384
    s_add_u32 m0, s62, 8192
    s_add_u32 s70, s56, 8192
    buffer_load_dwordx4 v1, s[8:11], s70 offen sc1 lds
    v_mfma_f32_32x32x16_bf16 v[144:159], v[116:119], v[236:239], v[144:159]
    ds_read_b128 v[100:103], v32 offset:17408
    v_cvt_pk_bf16_f32 v160, v128, v129
    v_cvt_pk_bf16_f32 v161, v130, v131
    v_cvt_pk_bf16_f32 v162, v136, v137
    v_cvt_pk_bf16_f32 v163, v138, v139
    buffer_store_dwordx4 v[160:163], v33, s[8:11], s57 offen offset:0 sc1
    s_waitcnt lgkmcnt(10)
    v_mfma_f32_32x32x16_bf16 v[144:159], v[120:123], v[244:247], v[144:159]
    ds_read_b128 v[104:107], v32 offset:18432
    s_add_u32 m0, s62, 12288
    s_add_u32 s70, s56, 12288
    buffer_load_dwordx4 v1, s[8:11], s70 offen sc1 lds
    v_mfma_f32_32x32x16_bf16 v[144:159], v[124:127], v[252:255], v[144:159]
    ds_read_b128 v[108:111], v32 offset:19456
    s_waitcnt lgkmcnt(10)
    v_mfma_f32_32x32x16_bf16 v[144:159], v[64:67], a[4:7], v[144:159]
    ds_read_b128 v[112:115], v32 offset:20480
    s_add_u32 m0, s62, 16384
    s_add_u32 s70, s56, 16384
    buffer_load_dwordx4 v1, s[8:11], s70 offen sc1 lds
    v_mfma_f32_32x32x16_bf16 v[144:159], v[68:71], a[12:15], v[144:159]
    ds_read_b128 v[116:119], v32 offset:21504
    v_cvt_pk_bf16_f32 v164, v132, v133
    v_cvt_pk_bf16_f32 v165, v134, v135
    v_cvt_pk_bf16_f32 v166, v140, v141
    v_cvt_pk_bf16_f32 v167, v142, v143
    buffer_store_dwordx4 v[164:167], v33, s[8:11], s57 offen offset:512 sc1
    s_waitcnt lgkmcnt(10)
    v_mfma_f32_32x32x16_bf16 v[144:159], v[72:75], a[20:23], v[144:159]
    ds_read_b128 v[120:123], v32 offset:22528
    s_add_u32 m0, s62, 20480
    s_add_u32 s70, s56, 20480
    buffer_load_dwordx4 v1, s[8:11], s70 offen sc1 lds
    v_mfma_f32_32x32x16_bf16 v[144:159], v[76:79], a[28:31], v[144:159]
    ds_read_b128 v[124:127], v32 offset:23552
    s_waitcnt lgkmcnt(10)
    v_mfma_f32_32x32x16_bf16 v[144:159], v[80:83], a[36:39], v[144:159]
    ds_read_b128 v[64:67], v32 offset:24576
    s_add_u32 m0, s62, 24576
    s_add_u32 s70, s56, 24576
    buffer_load_dwordx4 v1, s[8:11], s70 offen sc1 lds
    v_mfma_f32_32x32x16_bf16 v[144:159], v[84:87], a[44:47], v[144:159]
    ds_read_b128 v[68:71], v32 offset:25600
    buffer_store_dwordx4 v[36:39], v1, s[8:11], s74 offen offset:0 sc1
    s_waitcnt lgkmcnt(10)
    v_mfma_f32_32x32x16_bf16 v[144:159], v[88:91], a[52:55], v[144:159]
    ds_read_b128 v[72:75], v32 offset:26624
    s_add_u32 m0, s62, 28672
    s_add_u32 s70, s56, 28672
    buffer_load_dwordx4 v1, s[8:11], s70 offen sc1 lds
    v_mfma_f32_32x32x16_bf16 v[144:159], v[92:95], a[60:63], v[144:159]
    ds_read_b128 v[76:79], v32 offset:27648
    buffer_store_dwordx4 v[36:39], v1, s[8:11], s74 offen offset:1024 sc1
    s_add_u32 s74, s74, 131072
    s_waitcnt lgkmcnt(10)
    v_mfma_f32_32x32x16_bf16 v[144:159], v[96:99], a[68:71], v[144:159]
    ds_read_b128 v[80:83], v32 offset:28672
    s_add_u32 m0, s62, 32768
    s_add_u32 s70, s56, 32768
    buffer_load_dwordx4 v1, s[8:11], s70 offen sc1 lds
    v_mfma_f32_32x32x16_bf16 v[144:159], v[100:103], a[76:79], v[144:159]
    ds_read_b128 v[84:87], v32 offset:29696
    s_waitcnt lgkmcnt(10)
    v_mfma_f32_32x32x16_bf16 v[144:159], v[104:107], a[84:87], v[144:159]
    ds_read_b128 v[88:91], v32 offset:30720
    s_add_u32 m0, s62, 36864
    s_add_u32 s70, s56, 36864
    buffer_load_dwordx4 v1, s[8:11], s70 offen sc1 lds
    s_add_u32 s56, s56, 40960
    s_mov_b32 s63, 1
    s_add_u32 s70, s62, 40960
    s_sub_u32 s71, s62, 40960
    s_cmp_ge_u32 s62, 40960
    s_cselect_b32 s62, s71, s70
    v_mfma_f32_32x32x16_bf16 v[144:159], v[108:111], a[92:95], v[144:159]
    ds_read_b128 v[92:95], v32 offset:31744
    s_branch G1v_rest30
G1v_dma29:
    s_waitcnt lgkmcnt(10)
    v_mfma_f32_32x32x16_bf16 v[144:159], v[112:115], a[100:103], v[144:159]
    ds_read_b128 v[96:99], v32 offset:32768
    s_add_u32 m0, s62, 0
    s_add_u32 s70, s56, 0
    buffer_load_dwordx4 v1, s[8:11], s70 offen sc1 lds
    v_mfma_f32_32x32x16_bf16 v[144:159], v[116:119], a[108:111], v[144:159]
    ds_read_b128 v[100:103], v32 offset:33792
    s_waitcnt lgkmcnt(10)
    v_mfma_f32_32x32x16_bf16 v[144:159], v[120:123], a[116:119], v[144:159]
    ds_read_b128 v[104:107], v32 offset:34816
    s_add_u32 m0, s62, 4096
    s_add_u32 s70, s56, 4096
    buffer_load_dwordx4 v1, s[8:11], s70 offen sc1 lds
    v_mfma_f32_32x32x16_bf16 v[144:159], v[124:127], a[124:127], v[144:159]
    ds_read_b128 v[108:111], v32 offset:35840
    s_waitcnt lgkmcnt(10)
    v_mfma_f32_32x32x16_bf16 v[144:159], v[64:67], a[132:135], v[144:159]
    ds_read_b128 v[112:115], v32 offset:36864
    s_add_u32 m0, s62, 8192
    s_add_u32 s70, s56, 8192
    buffer_load_dwordx4 v1, s[8:11], s70 offen sc1 lds
    v_mfma_f32_32x32x16_bf16 v[144:159], v[68:71], a[140:143], v[144:159]
    ds_read_b128 v[116:119], v32 offset:37888
    s_waitcnt lgkmcnt(10)
    v_mfma_f32_32x32x16_bf16 v[144:159], v[72:75], a[148:151], v[144:159]
    ds_read_b128 v[120:123], v32 offset:38912
    s_add_u32 m0, s62, 12288
    s_add_u32 s70, s56, 12288
    buffer_load_dwordx4 v1, s[8:11], s70 offen sc1 lds
    v_mfma_f32_32x32x16_bf16 v[144:159], v[76:79], a[156:159], v[144:159]
    ds_read_b128 v[124:127], v32 offset:39936
    s_waitcnt lgkmcnt(10)
    v_mfma_f32_32x32x16_bf16 v[144:159], v[80:83], a[164:167], v[144:159]
    s_add_u32 m0, s62, 16384
    s_add_u32 s70, s56, 16384
    buffer_load_dwordx4 v1, s[8:11], s70 offen sc1 lds
    v_mfma_f32_32x32x16_bf16 v[144:159], v[84:87], a[172:175], v[144:159]
    s_waitcnt lgkmcnt(8)
    v_mfma_f32_32x32x16_bf16 v[144:159], v[88:91], a[180:183], v[144:159]
    s_add_u32 m0, s62, 20480
    s_add_u32 s70, s56, 20480
    buffer_load_dwordx4 v1, s[8:11], s70 offen sc1 lds
    v_mfma_f32_32x32x16_bf16 v[144:159], v[92:95], a[188:191], v[144:159]
    s_waitcnt lgkmcnt(6)
    v_mfma_f32_32x32x16_bf16 v[144:159], v[96:99], a[196:199], v[144:159]
    s_add_u32 m0, s62, 24576
    s_add_u32 s70, s56, 24576
    buffer_load_dwordx4 v1, s[8:11], s70 offen sc1 lds
    v_mfma_f32_32x32x16_bf16 v[144:159], v[100:103], a[204:207], v[144:159]
    s_waitcnt lgkmcnt(4)
    v_mfma_f32_32x32x16_bf16 v[144:159], v[104:107], a[212:215], v[144:159]
    s_add_u32 m0, s62, 28672
    s_add_u32 s70, s56, 28672
    buffer_load_dwordx4 v1, s[8:11], s70 offen sc1 lds
    v_mfma_f32_32x32x16_bf16 v[144:159], v[108:111], a[220:223], v[144:159]
    s_waitcnt lgkmcnt(2)
    v_mfma_f32_32x32x16_bf16 v[144:159], v[112:115], a[228:231], v[144:159]
    s_add_u32 m0, s62, 32768
    s_add_u32 s70, s56, 32768
    buffer_load_dwordx4 v1, s[8:11], s70 offen sc1 lds
    v_mfma_f32_32x32x16_bf16 v[144:159], v[116:119], a[236:239], v[144:159]
    s_waitcnt lgkmcnt(0)
    v_mfma_f32_32x32x16_bf16 v[144:159], v[120:123], a[244:247], v[144:159]
    s_add_u32 m0, s62, 36864
    s_add_u32 s70, s56, 36864
    buffer_load_dwordx4 v1, s[8:11], s70 offen sc1 lds
    s_add_u32 s56, s56, 40960
    s_mov_b32 s63, 1
    s_add_u32 s70, s62, 40960
    s_sub_u32 s71, s62, 40960
    s_cmp_ge_u32 s62, 40960
    s_cselect_b32 s62, s71, s70
    v_mfma_f32_32x32x16_bf16 v[144:159], v[124:127], a[252:255], v[144:159]
    s_branch G1v_epi
G1v_dma9:
    s_barrier
    s_waitcnt lgkmcnt(10)
    v_mfma_f32_32x32x16_bf16 v[128:143], v[80:83], a[96:99], v[128:143]
    ds_read_b128 v[64:67], v32 offset:32768
    s_add_u32 m0, s62, 0
    s_add_u32 s70, s56, 0
    buffer_load_dwordx4 v1, s[8:11], s70 offen sc1 lds
    v_mfma_f32_32x32x16_bf16 v[128:143], v[84:87], a[104:107], v[128:143]
    ds_read_b128 v[68:71], v32 offset:33792
    s_waitcnt lgkmcnt(10)
    v_mfma_f32_32x32x16_bf16 v[128:143], v[88:91], a[112:115], v[128:143]
    ds_read_b128 v[72:75], v32 offset:34816
    s_add_u32 m0, s62, 4096
    s_add_u32 s70, s56, 4096
    buffer_load_dwordx4 v1, s[8:11], s70 offen sc1 lds
    v_mfma_f32_32x32x16_bf16 v[128:143], v[92:95], a[120:123], v[128:143]
    ds_read_b128 v[76:79], v32 offset:35840
    s_waitcnt lgkmcnt(10)
    v_mfma_f32_32x32x16_bf16 v[128:143], v[96:99], a[128:131], v[128:143]
    ds_read_b128 v[80:83], v32 offset:36864
    s_add_u32 m0, s62, 8192
    s_add_u32 s70, s56, 8192
    buffer_load_dwordx4 v1, s[8:11], s70 offen sc1 lds
    v_mfma_f32_32x32x16_bf16 v[128:143], v[100:103], a[136:139], v[128:143]
    ds_read_b128 v[84:87], v32 offset:37888
    s_waitcnt lgkmcnt(10)
    v_mfma_f32_32x32x16_bf16 v[128:143], v[104:107], a[144:147], v[128:143]
    ds_read_b128 v[88:91], v32 offset:38912
    s_add_u32 m0, s62, 12288
    s_add_u32 s70, s56, 12288
    buffer_load_dwordx4 v1, s[8:11], s70 offen sc1 lds
    v_mfma_f32_32x32x16_bf16 v[128:143], v[108:111], a[152:155], v[128:143]
    ds_read_b128 v[92:95], v32 offset:39936
    s_waitcnt lgkmcnt(10)
    v_mfma_f32_32x32x16_bf16 v[128:143], v[112:115], a[160:163], v[128:143]
    ds_read_b128 v[96:99], v32 offset:0
    s_add_u32 m0, s62, 16384
    s_add_u32 s70, s56, 16384
    buffer_load_dwordx4 v1, s[8:11], s70 offen sc1 lds
    v_mfma_f32_32x32x16_bf16 v[128:143], v[116:119], a[168:171], v[128:143]
    ds_read_b128 v[100:103], v32 offset:1024
    s_waitcnt lgkmcnt(10)
    v_mfma_f32_32x32x16_bf16 v[128:143], v[120:123], a[176:179], v[128:143]
    ds_read_b128 v[104:107], v32 offset:2048
    s_add_u32 m0, s62, 20480
    s_add_u32 s70, s56, 20480
    buffer_load_dwordx4 v1, s[8:11], s70 offen sc1 lds
    v_mfma_f32_32x32x16_bf16 v[128:143], v[124:127], a[184:187], v[128:143]
    ds_read_b128 v[108:111], v32 offset:3072
    s_waitcnt lgkmcnt(10)
    v_mfma_f32_32x32x16_bf16 v[128:143], v[64:67], a[192:195], v[128:143]
    ds_read_b128 v[112:115], v32 offset:4096
    s_add_u32 m0, s62, 24576
    s_add_u32 s70, s56, 24576
    buffer_load_dwordx4 v1, s[8:11], s70 offen sc1 lds
    v_mfma_f32_32x32x16_bf16 v[128:143], v[68:71], a[200:203], v[128:143]
    ds_read_b128 v[116:119], v32 offset:5120
    s_waitcnt lgkmcnt(10)
    v_mfma_f32_32x32x16_bf16 v[128:143], v[72:75], a[208:211], v[128:143]
    ds_read_b128 v[120:123], v32 offset:6144
    s_add_u32 m0, s62, 28672
    s_add_u32 s70, s56, 28672
    buffer_load_dwordx4 v1, s[8:11], s70 offen sc1 lds
    v_mfma_f32_32x32x16_bf16 v[128:143], v[76:79], a[216:219], v[128:143]
    ds_read_b128 v[124:127], v32 offset:7168
    s_waitcnt lgkmcnt(10)
    v_mfma_f32_32x32x16_bf16 v[128:143], v[80:83], a[224:227], v[128:143]
    ds_read_b128 v[64:67], v32 offset:8192
    s_add_u32 m0, s62, 32768
    s_add_u32 s70, s56, 32768
    buffer_load_dwordx4 v1, s[8:11], s70 offen sc1 lds
    v_mfma_f32_32x32x16_bf16 v[128:143], v[84:87], a[232:235], v[128:143]
    ds_read_b128 v[68:71], v32 offset:9216
    s_waitcnt lgkmcnt(10)
    v_mfma_f32_32x32x16_bf16 v[128:143], v[88:91], a[240:243], v[128:143]
    ds_read_b128 v[72:75], v32 offset:10240
    s_add_u32 m0, s62, 36864
    s_add_u32 s70, s56, 36864
    buffer_load_dwordx4 v1, s[8:11], s70 offen sc1 lds
    s_add_u32 s56, s56, 40960
    s_mov_b32 s63, 1
    s_add_u32 s70, s62, 40960
    s_sub_u32 s71, s62, 40960
    s_cmp_ge_u32 s62, 40960
    s_cselect_b32 s62, s71, s70
    v_mfma_f32_32x32x16_bf16 v[128:143], v[92:95], a[248:251], v[128:143]
    ds_read_b128 v[76:79], v32 offset:11264
G1v_rest20:
    s_waitcnt lgkmcnt(10)
    v_mfma_f32_32x32x16_bf16 v[144:159], v[96:99], v[196:199], 0
    ds_read_b128 v[80:83], v32 offset:12288
    v_mfma_f32_32x32x16_bf16 v[144:159], v[100:103], v[204:207], v[144:159]
    ds_read_b128 v[84:87], v32 offset:13312
    s_waitcnt lgkmcnt(10)
    v_mfma_f32_32x32x16_bf16 v[144:159], v[104:107], v[212:215], v[144:159]
    ds_read_b128 v[88:91], v32 offset:14336
    v_mfma_f32_32x32x16_bf16 v[144:159], v[108:111], v[220:223], v[144:159]
    ds_read_b128 v[92:95], v32 offset:15360
    s_waitcnt lgkmcnt(10)
    v_mfma_f32_32x32x16_bf16 v[144:159], v[112:115], v[228:231], v[144:159]
    ds_read_b128 v[96:99], v32 offset:16384
    v_mfma_f32_32x32x16_bf16 v[144:159], v[116:119], v[236:239], v[144:159]
    ds_read_b128 v[100:103], v32 offset:17408
    v_cvt_pk_bf16_f32 v160, v128, v129
    v_cvt_pk_bf16_f32 v161, v130, v131
    v_cvt_pk_bf16_f32 v162, v136, v137
    v_cvt_pk_bf16_f32 v163, v138, v139
    buffer_store_dwordx4 v[160:163], v33, s[8:11], s57 offen offset:0 sc1
    s_waitcnt lgkmcnt(10)
    v_mfma_f32_32x32x16_bf16 v[144:159], v[120:123], v[244:247], v[144:159]
    ds_read_b128 v[104:107], v32 offset:18432
    v_mfma_f32_32x32x16_bf16 v[144:159], v[124:127], v[252:255], v[144:159]
    ds_read_b128 v[108:111], v32 offset:19456
    s_waitcnt lgkmcnt(10)
    v_mfma_f32_32x32x16_bf16 v[144:159], v[64:67], a[4:7], v[144:159]
    ds_read_b128 v[112:115], v32 offset:20480
    v_mfma_f32_32x32x16_bf16 v[144:159], v[68:71], a[12:15], v[144:159]
    ds_read_b128 v[116:119], v32 offset:21504
    v_cvt_pk_bf16_f32 v164, v132, v133
    v_cvt_pk_bf16_f32 v165, v134, v135
    v_cvt_pk_bf16_f32 v166, v140, v141
    v_cvt_pk_bf16_f32 v167, v142, v143
    buffer_store_dwordx4 v[164:167], v33, s[8:11], s57 offen offset:512 sc1
    s_waitcnt lgkmcnt(10)
    v_mfma_f32_32x32x16_bf16 v[144:159], v[72:75], a[20:23], v[144:159]
    ds_read_b128 v[120:123], v32 offset:22528
    v_mfma_f32_32x32x16_bf16 v[144:159], v[76:79], a[28:31], v[144:159]
    ds_read_b128 v[124:127], v32 offset:23552
    s_waitcnt lgkmcnt(10)
    v_mfma_f32_32x32x16_bf16 v[144:159], v[80:83], a[36:39], v[144:159]
    ds_read_b128 v[64:67], v32 offset:24576
    v_mfma_f32_32x32x16_bf16 v[144:159], v[84:87], a[44:47], v[144:159]
    ds_read_b128 v[68:71], v32 offset:25600
    buffer_store_dwordx4 v[36:39], v1, s[8:11], s74 offen offset:0 sc1
    s_waitcnt lgkmcnt(10)
    v_mfma_f32_32x32x16_bf16 v[144:159], v[88:91], a[52:55], v[144:159]
    ds_read_b128 v[72:75], v32 offset:26624
    v_mfma_f32_32x32x16_bf16 v[144:159], v[92:95], a[60:63], v[144:159]
    ds_read_b128 v[76:79], v32 offset:27648
    buffer_store_dwordx4 v[36:39], v1, s[8:11], s74 offen offset:1024 sc1
    s_add_u32 s74, s74, 131072
    s_waitcnt lgkmcnt(10)
    v_mfma_f32_32x32x16_bf16 v[144:159], v[96:99], a[68:71], v[144:159]
    ds_read_b128 v[80:83], v32 offset:28672
    v_mfma_f32_32x32x16_bf16 v[144:159], v[100:103], a[76:79], v[144:159]
    ds_read_b128 v[84:87], v32 offset:29696
    s_waitcnt lgkmcnt(10)
    v_mfma_f32_32x32x16_bf16 v[144:159], v[104:107], a[84:87], v[144:159]
    ds_read_b128 v[88:91], v32 offset:30720
    v_mfma_f32_32x32x16_bf16 v[144:159], v[108:111], a[92:95], v[144:159]
    ds_read_b128 v[92:95], v32 offset:31744
G1v_rest30:
    s_waitcnt lgkmcnt(10)
    v_mfma_f32_32x32x16_bf16 v[144:159], v[112:115], a[100:103], v[144:159]
    ds_read_b128 v[96:99], v32 offset:32768
    v_mfma_f32_32x32x16_bf16 v[144:159], v[116:119], a[108:111], v[144:159]
    ds_read_b128 v[100:103], v32 offset:33792
    s_waitcnt lgkmcnt(10)
    v_mfma_f32_32x32x16_bf16 v[144:159], v[120:123], a[116:119], v[144:159]
    ds_read_b128 v[104:107], v32 offset:34816
    v_mfma_f32_32x32x16_bf16 v[144:159], v[124:127], a[124:127], v[144:159]
    ds_read_b128 v[108:111], v32 offset:35840
    s_waitcnt lgkmcnt(10)
    v_mfma_f32_32x32x16_bf16 v[144:159], v[64:67], a[132:135], v[144:159]
    ds_read_b128 v[112:115], v32 offset:36864
    v_mfma_f32_32x32x16_bf16 v[144:159], v[68:71], a[140:143], v[144:159]
    ds_read_b128 v[116:119], v32 offset:37888
    s_waitcnt lgkmcnt(10)
    v_mfma_f32_32x32x16_bf16 v[144:159], v[72:75], a[148:151], v[144:159]
    ds_read_b128 v[120:123], v32 offset:38912
    v_mfma_f32_32x32x16_bf16 v[144:159], v[76:79], a[156:159], v[144:159]
    ds_read_b128 v[124:127], v32 offset:39936
    s_waitcnt lgkmcnt(10)
    v_mfma_f32_32x32x16_bf16 v[144:159], v[80:83], a[164:167], v[144:159]
    v_mfma_f32_32x32x16_bf16 v[144:159], v[84:87], a[172:175], v[144:159]
    s_waitcnt lgkmcnt(8)
    v_mfma_f32_32x32x16_bf16 v[144:159], v[88:91], a[180:183], v[144:159]
    v_mfma_f32_32x32x16_bf16 v[144:159], v[92:95], a[188:191], v[144:159]
    s_waitcnt lgkmcnt(6)
    v_mfma_f32_32x32x16_bf16 v[144:159], v[96:99], a[196:199], v[144:159]
    v_mfma_f32_32x32x16_bf16 v[144:159], v[100:103], a[204:207], v[144:159]
    s_waitcnt lgkmcnt(4)
    v_mfma_f32_32x32x16_bf16 v[144:159], v[104:107], a[212:215], v[144:159]
    v_mfma_f32_32x32x16_bf16 v[144:159], v[108:111], a[220:223], v[144:159]
    s_waitcnt lgkmcnt(2)
    v_mfma_f32_32x32x16_bf16 v[144:159], v[112:115], a[228:231], v[144:159]
    v_mfma_f32_32x32x16_bf16 v[144:159], v[116:119], a[236:239], v[144:159]
    s_waitcnt lgkmcnt(0)
    v_mfma_f32_32x32x16_bf16 v[144:159], v[120:123], a[244:247], v[144:159]
    v_mfma_f32_32x32x16_bf16 v[144:159], v[124:127], a[252:255], v[144:159]
G1v_epi:
    s_nop 11
    v_cvt_pk_bf16_f32 v168, v144, v145
    v_cvt_pk_bf16_f32 v169, v146, v147
    v_cvt_pk_bf16_f32 v170, v152, v153
    v_cvt_pk_bf16_f32 v171, v154, v155
    buffer_store_dwordx4 v[168:171], v33, s[8:11], s57 offen offset:2048 sc1
    v_cvt_pk_bf16_f32 v172, v148, v149
    v_cvt_pk_bf16_f32 v173, v150, v151
    v_cvt_pk_bf16_f32 v174, v156, v157
    v_cvt_pk_bf16_f32 v175, v158, v159
    buffer_store_dwordx4 v[172:175], v33, s[8:11], s57 offen offset:2560 sc1
    s_add_u32 s57, s57, 262144
    s_add_u32 s55, s55, 1
    s_mov_b32 s61, 1
    s_cmp_eq_u32 s63, 0
    s_cbranch_scc1 G1v_late
    buffer_load_dwordx4 v[4:7], v2, s[8:11], s58 offen sc1
    s_branch G1v_top
G1v_late:
    s_mov_b32 s61, 0
    s_waitcnt vmcnt(2)
    v_min3_u32 v4, v4, v5, v6
    v_min_u32 v4, v4, v7
    v_max_u32 v4, v4, v34
    s_nop 1
    v_min_u32_dpp v4, v4, v4 row_ror:1 row_mask:0xf bank_mask:0xf
    s_nop 1
    v_min_u32_dpp v4, v4, v4 row_ror:2 row_mask:0xf bank_mask:0xf
    s_nop 1
    v_min_u32_dpp v4, v4, v4 row_ror:4 row_mask:0xf bank_mask:0xf
    s_nop 1
    v_min_u32_dpp v4, v4, v4 row_ror:8 row_mask:0xf bank_mask:0xf
    s_nop 0
    v_readlane_b32 s70, v4, 0
    s_nop 0
    s_max_u32 s60, s60, s70
    s_min_u32 s60, s60, 64
    s_cmp_gt_u32 s60, s55
    s_cbranch_scc0 G1v_idle
    s_add_u32 m0, s62, 0
    s_add_u32 s70, s56, 0
    buffer_load_dwordx4 v1, s[8:11], s70 offen sc1 lds
    s_add_u32 m0, s62, 4096
    s_add_u32 s70, s56, 4096
    buffer_load_dwordx4 v1, s[8:11], s70 offen sc1 lds
    s_add_u32 m0, s62, 8192
    s_add_u32 s70, s56, 8192
    buffer_load_dwordx4 v1, s[8:11], s70 offen sc1 lds
    s_add_u32 m0, s62, 12288
    s_add_u32 s70, s56, 12288
    buffer_load_dwordx4 v1, s[8:11], s70 offen sc1 lds
    s_add_u32 m0, s62, 16384
    s_add_u32 s70, s56, 16384
    buffer_load_dwordx4 v1, s[8:11], s70 offen sc1 lds
    s_add_u32 m0, s62, 20480
    s_add_u32 s70, s56, 20480
    buffer_load_dwordx4 v1, s[8:11], s70 offen sc1 lds
    s_add_u32 m0, s62, 24576
    s_add_u32 s70, s56, 24576
    buffer_load_dwordx4 v1, s[8:11], s70 offen sc1 lds
    s_add_u32 m0, s62, 28672
    s_add_u32 s70, s56, 28672
    buffer_load_dwordx4 v1, s[8:11], s70 offen sc1 lds
    s_add_u32 m0, s62, 32768
    s_add_u32 s70, s56, 32768
    buffer_load_dwordx4 v1, s[8:11], s70 offen sc1 lds
    s_add_u32 m0, s62, 36864
    s_add_u32 s70, s56, 36864
    buffer_load_dwordx4 v1, s[8:11], s70 offen sc1 lds
    s_add_u32 s56, s56, 40960
    s_mov_b32 s63, 1
    s_add_u32 s70, s62, 40960
    s_sub_u32 s71, s62, 40960
    s_cmp_ge_u32 s62, 40960
    s_cselect_b32 s62, s71, s70
    s_waitcnt vmcnt(10)
    v_mov_b32 v3, s55
    s_mov_b64 exec, 1
    buffer_store_dword v3, off, s[8:11], s59 sc1
    s_mov_b64 exec, -1
    buffer_load_dwordx4 v[4:7], v2, s[8:11], s58 offen sc1
    s_branch G1v_top
G1v_idle:
    buffer_load_dwordx4 v[4:7], v2, s[8:11], s58 offen sc1
    s_waitcnt vmcnt(0)
    v_mov_b32 v3, s55
    s_mov_b64 exec, 1
    buffer_store_dword v3, off, s[8:11], s59 sc1
    s_mov_b64 exec, -1
    v_min3_u32 v4, v4, v5, v6
    v_min_u32 v4, v4, v7
    v_max_u32 v4, v4, v34
    s_nop 1
    v_min_u32_dpp v4, v4, v4 row_ror:1 row_mask:0xf bank_mask:0xf
    s_nop 1
    v_min_u32_dpp v4, v4, v4 row_ror:2 row_mask:0xf bank_mask:0xf
    s_nop 1
    v_min_u32_dpp v4, v4, v4 row_ror:4 row_mask:0xf bank_mask:0xf
    s_nop 1
    v_min_u32_dpp v4, v4, v4 row_ror:8 row_mask:0xf bank_mask:0xf
    s_nop 0
    v_readlane_b32 s70, v4, 0
    s_nop 0
    s_max_u32 s60, s60, s70
    s_cmp_lt_u32 s55, 64
    s_cbranch_scc1 G1v_fetch
    s_endpgm
G1f1_entry:
    v_and_b32 v0, 63, v0
    v_lshlrev_b32 v1, 4, v0
    v_min_u32 v2, 1, v0
    v_lshlrev_b32 v2, 7, v2
    s_mov_b32 s55, 0
    s_mov_b32 s60, 0
    s_mov_b32 s61, 0
    s_mov_b32 s69, 0
    v_mov_b32 v34, 0
    s_lshl_b32 s71, s53, 2
    s_add_u32 s71, s71, s52
    s_lshl_b32 s64, s71, 7
    s_cmp_lt_u32 s71, 27
    s_cselect_b32 s64, s64, 0x20000000
    s_mul_i32 s57, s54, 7340032
    s_lshl_b32 s71, s71, 12
    s_add_u32 s57, s57, s71
    s_add_u32 s57, s57, 191758336
    v_lshrrev_b32 v11, 5, v0
    v_mul_u32_u24 v11, 4, v11
    v_bfe_u32 v12, v0, 3, 2
    v_add_u32 v11, v11, v12
    s_mov_b32 s70, 3456
    v_mul_lo_u32 v11, v11, s70
    v_bfe_u32 v12, v0, 4, 1
    v_lshlrev_b32 v12, 2, v12
    v_and_b32 v13, 7, v0
    v_xor_b32 v12, v12, v13
    v_lshl_add_u32 v11, v12, 4, v11
    v_add_u32 v8, s64, v11
    s_mul_i32 s62, s52, 40960
    v_lshrrev_b32 v11, 5, v0
    v_lshlrev_b32 v11, 10, v11
    v_bfe_u32 v12, v0, 2, 2
    v_lshl_add_u32 v11, v12, 7, v11
    v_bfe_u32 v12, v0, 3, 1
    v_lshl_add_u32 v11, v12, 6, v11
    v_bfe_u32 v12, v0, 4, 1
    v_lshl_add_u32 v11, v12, 5, v11
    v_and_b32 v12, 3, v0
    v_lshl_add_u32 v11, v12, 3, v11
    v_add_u32 v9, s62, v11
    v_xor_b32 v10, 64, v9
    s_add_u32 m0, s62, 0
    s_mov_b32 s70, 0
    buffer_load_dwordx4 v8, s[36:39], s70 offen lds
    s_add_u32 m0, s62, 1024
    s_mov_b32 s70, 27648
    buffer_load_dwordx4 v8, s[36:39], s70 offen lds
    s_add_u32 m0, s62, 2048
    s_mov_b32 s70, 55296
    buffer_load_dwordx4 v8, s[36:39], s70 offen lds
    s_add_u32 m0, s62, 3072
    s_mov_b32 s70, 82944
    buffer_load_dwordx4 v8, s[36:39], s70 offen lds
    s_add_u32 m0, s62, 4096
    s_mov_b32 s70, 110592
    buffer_load_dwordx4 v8, s[36:39], s70 offen lds
    s_add_u32 m0, s62, 5120
    s_mov_b32 s70, 138240
    buffer_load_dwordx4 v8, s[36:39], s70 offen lds
    s_add_u32 m0, s62, 6144
    s_mov_b32 s70, 165888
    buffer_load_dwordx4 v8, s[36:39], s70 offen lds
    s_add_u32 m0, s62, 7168
    s_mov_b32 s70, 193536
    buffer_load_dwordx4 v8, s[36:39], s70 offen lds
    s_add_u32 m0, s62, 8192
    s_mov_b32 s70, 221184
    buffer_load_dwordx4 v8, s[36:39], s70 offen lds
    s_add_u32 m0, s62, 9216
    s_mov_b32 s70, 248832
    buffer_load_dwordx4 v8, s[36:39], s70 offen lds
    s_add_u32 m0, s62, 10240
    s_mov_b32 s70, 276480
    buffer_load_dwordx4 v8, s[36:39], s70 offen lds
    s_add_u32 m0, s62, 11264
    s_mov_b32 s70, 304128
    buffer_load_dwordx4 v8, s[36:39], s70 offen lds
    s_add_u32 m0, s62, 12288
    s_mov_b32 s70, 331776
    buffer_load_dwordx4 v8, s[36:39], s70 offen lds
    s_add_u32 m0, s62, 13312
    s_mov_b32 s70, 359424
    buffer_load_dwordx4 v8, s[36:39], s70 offen lds
    s_add_u32 m0, s62, 14336
    s_mov_b32 s70, 387072
    buffer_load_dwordx4 v8, s[36:39], s70 offen lds
    s_add_u32 m0, s62, 15360
    s_mov_b32 s70, 414720
    buffer_load_dwordx4 v8, s[36:39], s70 offen lds
    s_add_u32 m0, s62, 16384
    s_mov_b32 s70, 442368
    buffer_load_dwordx4 v8, s[36:39], s70 offen lds
    s_add_u32 m0, s62, 17408
    s_mov_b32 s70, 470016
    buffer_load_dwordx4 v8, s[36:39], s70 offen lds
    s_add_u32 m0, s62, 18432
    s_mov_b32 s70, 497664
    buffer_load_dwordx4 v8, s[36:39], s70 offen lds
    s_add_u32 m0, s62, 19456
    s_mov_b32 s70, 525312
    buffer_load_dwordx4 v8, s[36:39], s70 offen lds
    s_add_u32 m0, s62, 20480
    s_mov_b32 s70, 552960
    buffer_load_dwordx4 v8, s[36:39], s70 offen lds
    s_add_u32 m0, s62, 21504
    s_mov_b32 s70, 580608
    buffer_load_dwordx4 v8, s[36:39], s70 offen lds
    s_add_u32 m0, s62, 22528
    s_mov_b32 s70, 608256
    buffer_load_dwordx4 v8, s[36:39], s70 offen lds
    s_add_u32 m0, s62, 23552
    s_mov_b32 s70, 635904
    buffer_load_dwordx4 v8, s[36:39], s70 offen lds
    s_add_u32 m0, s62, 24576
    s_mov_b32 s70, 663552
    buffer_load_dwordx4 v8, s[36:39], s70 offen lds
    s_add_u32 m0, s62, 25600
    s_mov_b32 s70, 691200
    buffer_load_dwordx4 v8, s[36:39], s70 offen lds
    s_add_u32 m0, s62, 26624
    s_mov_b32 s70, 718848
    buffer_load_dwordx4 v8, s[36:39], s70 offen lds
    s_add_u32 m0, s62, 27648
    s_mov_b32 s70, 746496
    buffer_load_dwordx4 v8, s[36:39], s70 offen lds
    s_add_u32 m0, s62, 28672
    s_mov_b32 s70, 774144
    buffer_load_dwordx4 v8, s[36:39], s70 offen lds
    s_add_u32 m0, s62, 29696
    s_mov_b32 s70, 801792
    buffer_load_dwordx4 v8, s[36:39], s70 offen lds
    s_add_u32 m0, s62, 30720
    s_mov_b32 s70, 829440
    buffer_load_dwordx4 v8, s[36:39], s70 offen lds
    s_add_u32 m0, s62, 31744
    s_mov_b32 s70, 857088
    buffer_load_dwordx4 v8, s[36:39], s70 offen lds
    s_add_u32 m0, s62, 32768
    s_mov_b32 s70, 884736
    buffer_load_dwordx4 v8, s[36:39], s70 offen lds
    s_add_u32 m0, s62, 33792
    s_mov_b32 s70, 912384
    buffer_load_dwordx4 v8, s[36:39], s70 offen lds
    s_add_u32 m0, s62, 34816
    s_mov_b32 s70, 940032
    buffer_load_dwordx4 v8, s[36:39], s70 offen lds
    s_add_u32 m0, s62, 35840
    s_mov_b32 s70, 967680
    buffer_load_dwordx4 v8, s[36:39], s70 offen lds
    s_add_u32 m0, s62, 36864
    s_mov_b32 s70, 995328
    buffer_load_dwordx4 v8, s[36:39], s70 offen lds
    s_add_u32 m0, s62, 37888
    s_mov_b32 s70, 1022976
    buffer_load_dwordx4 v8, s[36:39], s70 offen lds
    s_add_u32 m0, s62, 38912
    s_mov_b32 s70, 1050624
    buffer_load_dwordx4 v8, s[36:39], s70 offen lds
    s_add_u32 m0, s62, 39936
    s_mov_b32 s70, 1078272
    buffer_load_dwordx4 v8, s[36:39], s70 offen lds
    s_waitcnt vmcnt(38)
    ds_read_b64_tr_b16 v[192:193], v9 offset:0
    ds_read_b64_tr_b16 v[194:195], v9 offset:512
    ds_read_b64_tr_b16 v[196:197], v10 offset:0
    ds_read_b64_tr_b16 v[198:199], v10 offset:512
    s_waitcnt vmcnt(36)
    ds_read_b64_tr_b16 v[200:201], v9 offset:2048
    ds_read_b64_tr_b16 v[202:203], v9 offset:2560
    ds_read_b64_tr_b16 v[204:205], v10 offset:2048
    ds_read_b64_tr_b16 v[206:207], v10 offset:2560
    s_waitcnt lgkmcnt(4)
    s_add_u32 m0, s62, 0
    s_mov_b32 s70, 1105920
    buffer_load_dwordx4 v8, s[36:39], s70 offen lds
    s_add_u32 m0, s62, 1024
    s_mov_b32 s70, 1133568
    buffer_load_dwordx4 v8, s[36:39], s70 offen lds
    s_waitcnt vmcnt(36)
    ds_read_b64_tr_b16 v[208:209], v9 offset:4096
    ds_read_b64_tr_b16 v[210:211], v9 offset:4608
    ds_read_b64_tr_b16 v[212:213], v10 offset:4096
    ds_read_b64_tr_b16 v[214:215], v10 offset:4608
    s_waitcnt lgkmcnt(4)
    s_add_u32 m0, s62, 2048
    s_mov_b32 s70, 1161216
    buffer_load_dwordx4 v8, s[36:39], s70 offen lds
    s_add_u32 m0, s62, 3072
    s_mov_b32 s70, 1188864
    buffer_load_dwordx4 v8, s[36:39], s70 offen lds
    s_waitcnt vmcnt(36)
    ds_read_b64_tr_b16 v[216:217], v9 offset:6144
    ds_read_b64_tr_b16 v[218:219], v9 offset:6656
    ds_read_b64_tr_b16 v[220:221], v10 offset:6144
    ds_read_b64_tr_b16 v[222:223], v10 offset:6656
    s_waitcnt lgkmcnt(4)
    s_add_u32 m0, s62, 4096
    s_mov_b32 s70, 1216512
    buffer_load_dwordx4 v8, s[36:39], s70 offen lds
    s_add_u32 m0, s62, 5120
    s_mov_b32 s70, 1244160
    buffer_load_dwordx4 v8, s[36:39], s70 offen lds
    s_waitcnt vmcnt(36)
    ds_read_b64_tr_b16 v[224:225], v9 offset:8192
    ds_read_b64_tr_b16 v[226:227], v9 offset:8704
    ds_read_b64_tr_b16 v[228:229], v10 offset:8192
    ds_read_b64_tr_b16 v[230:231], v10 offset:8704
    s_waitcnt lgkmcnt(4)
    s_add_u32 m0, s62, 6144
    s_mov_b32 s70, 1271808
    buffer_load_dwordx4 v8, s[36:39], s70 offen lds
    s_add_u32 m0, s62, 7168
    s_mov_b32 s70, 1299456
    buffer_load_dwordx4 v8, s[36:39], s70 offen lds
    s_waitcnt vmcnt(36)
    ds_read_b64_tr_b16 v[232:233], v9 offset:10240
    ds_read_b64_tr_b16 v[234:235], v9 offset:10752
    ds_read_b64_tr_b16 v[236:237], v10 offset:10240
    ds_read_b64_tr_b16 v[238:239], v10 offset:10752
    s_waitcnt lgkmcnt(4)
    s_add_u32 m0, s62, 8192
    s_mov_b32 s70, 1327104
    buffer_load_dwordx4 v8, s[36:39], s70 offen lds
    s_add_u32 m0, s62, 9216
    s_mov_b32 s70, 1354752
    buffer_load_dwordx4 v8, s[36:39], s70 offen lds
    s_waitcnt vmcnt(36)
    ds_read_b64_tr_b16 v[240:241], v9 offset:12288
    ds_read_b64_tr_b16 v[242:243], v9 offset:12800
    ds_read_b64_tr_b16 v[244:245], v10 offset:12288
    ds_read_b64_tr_b16 v[246:247], v10 offset:12800
    s_waitcnt lgkmcnt(4)
    s_add_u32 m0, s62, 10240
    s_mov_b32 s70, 1382400
    buffer_load_dwordx4 v8, s[36:39], s70 offen lds
    s_add_u32 m0, s62, 11264
    s_mov_b32 s70, 1410048
    buffer_load_dwordx4 v8, s[36:39], s70 offen lds
    s_waitcnt vmcnt(36)
    ds_read_b64_tr_b16 v[248:249], v9 offset:14336
    ds_read_b64_tr_b16 v[250:251], v9 offset:14848
    ds_read_b64_tr_b16 v[252:253], v10 offset:14336
    ds_read_b64_tr_b16 v[254:255], v10 offset:14848
    s_waitcnt lgkmcnt(4)
    s_add_u32 m0, s62, 12288
    s_mov_b32 s70, 1437696
    buffer_load_dwordx4 v8, s[36:39], s70 offen lds
    s_add_u32 m0, s62, 13312
    s_mov_b32 s70, 1465344
    buffer_load_dwordx4 v8, s[36:39], s70 offen lds
    s_waitcnt vmcnt(36)
    ds_read_b64_tr_b16 a[0:1], v9 offset:16384
    ds_read_b64_tr_b16 a[2:3], v9 offset:16896
    ds_read_b64_tr_b16 a[4:5], v10 offset:16384
    ds_read_b64_tr_b16 a[6:7], v10 offset:16896
    s_waitcnt lgkmcnt(4)
    s_add_u32 m0, s62, 14336
    s_mov_b32 s70, 1492992
    buffer_load_dwordx4 v8, s[36:39], s70 offen lds
    s_add_u32 m0, s62, 15360
    s_mov_b32 s70, 1520640
    buffer_load_dwordx4 v8, s[36:39], s70 offen lds
    s_waitcnt vmcnt(36)
    ds_read_b64_tr_b16 a[8:9], v9 offset:18432
    ds_read_b64_tr_b16 a[10:11], v9 offset:18944
    ds_read_b64_tr_b16 a[12:13], v10 offset:18432
    ds_read_b64_tr_b16 a[14:15], v10 offset:18944
    s_waitcnt lgkmcnt(4)
    s_add_u32 m0, s62, 16384
    s_mov_b32 s70, 1548288
    buffer_load_dwordx4 v8, s[36:39], s70 offen lds
    s_add_u32 m0, s62, 17408
    s_mov_b32 s70, 1575936
    buffer_load_dwordx4 v8, s[36:39], s70 offen lds
    s_waitcnt vmcnt(36)
    ds_read_b64_tr_b16 a[16:17], v9 offset:20480
    ds_read_b64_tr_b16 a[18:19], v9 offset:20992
    ds_read_b64_tr_b16 a[20:21], v10 offset:20480
    ds_read_b64_tr_b16 a[22:23], v10 offset:20992
    s_waitcnt lgkmcnt(4)
    s_add_u32 m0, s62, 18432
    s_mov_b32 s70, 1603584
    buffer_load_dwordx4 v8, s[36:39], s70 offen lds
    s_add_u32 m0, s62, 19456
    s_mov_b32 s70, 1631232
    buffer_load_dwordx4 v8, s[36:39], s70 offen lds
    s_waitcnt vmcnt(36)
    ds_read_b64_tr_b16 a[24:25], v9 offset:22528
    ds_read_b64_tr_b16 a[26:27], v9 offset:23040
    ds_read_b64_tr_b16 a[28:29], v10 offset:22528
    ds_read_b64_tr_b16 a[30:31], v10 offset:23040
    s_waitcnt lgkmcnt(4)
    s_add_u32 m0, s62, 20480
    s_mov_b32 s70, 1658880
    buffer_load_dwordx4 v8, s[36:39], s70 offen lds
    s_add_u32 m0, s62, 21504
    s_mov_b32 s70, 1686528
    buffer_load_dwordx4 v8, s[36:39], s70 offen lds
    s_waitcnt vmcnt(36)
    ds_read_b64_tr_b16 a[32:33], v9 offset:24576
    ds_read_b64_tr_b16 a[34:35], v9 offset:25088
    ds_read_b64_tr_b16 a[36:37], v10 offset:24576
    ds_read_b64_tr_b16 a[38:39], v10 offset:25088
    s_waitcnt lgkmcnt(4)
    s_add_u32 m0, s62, 22528
    s_mov_b32 s70, 1714176
    buffer_load_dwordx4 v8, s[36:39], s70 offen lds
    s_add_u32 m0, s62, 23552
    s_mov_b32 s70, 1741824
    buffer_load_dwordx4 v8, s[36:39], s70 offen lds
    s_waitcnt vmcnt(36)
    ds_read_b64_tr_b16 a[40:41], v9 offset:26624
    ds_read_b64_tr_b16 a[42:43], v9 offset:27136
    ds_read_b64_tr_b16 a[44:45], v10 offset:26624
    ds_read_b64_tr_b16 a[46:47], v10 offset:27136
    s_waitcnt lgkmcnt(4)
    s_add_u32 m0, s62, 24576
    s_mov_b32 s70, 1769472
    buffer_load_dwordx4 v8, s[36:39], s70 offen lds
    s_add_u32 m0, s62, 25600
    s_mov_b32 s70, 1797120
    buffer_load_dwordx4 v8, s[36:39], s70 offen lds
    s_waitcnt vmcnt(36)
    ds_read_b64_tr_b16 a[48:49], v9 offset:28672
    ds_read_b64_tr_b16 a[50:51], v9 offset:29184
    ds_read_b64_tr_b16 a[52:53], v10 offset:28672
    ds_read_b64_tr_b16 a[54:55], v10 offset:29184
    s_waitcnt lgkmcnt(4)
    s_add_u32 m0, s62, 26624
    s_mov_b32 s70, 1824768
    buffer_load_dwordx4 v8, s[36:39], s70 offen lds
    s_add_u32 m0, s62, 27648
    s_mov_b32 s70, 1852416
    buffer_load_dwordx4 v8, s[36:39], s70 offen lds
    s_waitcnt vmcnt(36)
    ds_read_b64_tr_b16 a[56:57], v9 offset:30720
    ds_read_b64_tr_b16 a[58:59], v9 offset:31232
    ds_read_b64_tr_b16 a[60:61], v10 offset:30720
    ds_read_b64_tr_b16 a[62:63], v10 offset:31232
    s_waitcnt lgkmcnt(4)
    s_add_u32 m0, s62, 28672
    s_mov_b32 s70, 1880064
    buffer_load_dwordx4 v8, s[36:39], s70 offen lds
    s_add_u32 m0, s62, 29696
    s_mov_b32 s70, 1907712
    buffer_load_dwordx4 v8, s[36:39], s70 offen lds
    s_waitcnt vmcnt(36)
    ds_read_b64_tr_b16 a[64:65], v9 offset:32768
    ds_read_b64_tr_b16 a[66:67], v9 offset:33280
    ds_read_b64_tr_b16 a[68:69], v10 offset:32768
    ds_read_b64_tr_b16 a[70:71], v10 offset:33280
    s_waitcnt lgkmcnt(4)
    s_add_u32 m0, s62, 30720
    s_mov_b32 s70, 1935360
    buffer_load_dwordx4 v8, s[36:39], s70 offen lds
    s_add_u32 m0, s62, 31744
    s_mov_b32 s70, 1963008
    buffer_load_dwordx4 v8, s[36:39], s70 offen lds
    s_waitcnt vmcnt(36)
    ds_read_b64_tr_b16 a[72:73], v9 offset:34816
    ds_read_b64_tr_b16 a[74:75], v9 offset:35328
    ds_read_b64_tr_b16 a[76:77], v10 offset:34816
    ds_read_b64_tr_b16 a[78:79], v10 offset:35328
    s_waitcnt lgkmcnt(4)
    s_add_u32 m0, s62, 32768
    s_mov_b32 s70, 1990656
    buffer_load_dwordx4 v8, s[36:39], s70 offen lds
    s_add_u32 m0, s62, 33792
    s_mov_b32 s70, 2018304
    buffer_load_dwordx4 v8, s[36:39], s70 offen lds
    s_waitcnt vmcnt(36)
    ds_read_b64_tr_b16 a[80:81], v9 offset:36864
    ds_read_b64_tr_b16 a[82:83], v9 offset:37376
    ds_read_b64_tr_b16 a[84:85], v10 offset:36864
    ds_read_b64_tr_b16 a[86:87], v10 offset:37376
    s_waitcnt lgkmcnt(4)
    s_add_u32 m0, s62, 34816
    s_mov_b32 s70, 2045952
    buffer_load_dwordx4 v8, s[36:39], s70 offen lds
    s_add_u32 m0, s62, 35840
    s_mov_b32 s70, 2073600
    buffer_load_dwordx4 v8, s[36:39], s70 offen lds
    s_waitcnt vmcnt(36)
    ds_read_b64_tr_b16 a[88:89], v9 offset:38912
    ds_read_b64_tr_b16 a[90:91], v9 offset:39424
    ds_read_b64_tr_b16 a[92:93], v10 offset:38912
    ds_read_b64_tr_b16 a[94:95], v10 offset:39424
    s_waitcnt lgkmcnt(4)
    s_add_u32 m0, s62, 36864
    s_mov_b32 s70, 2101248
    buffer_load_dwordx4 v8, s[36:39], s70 offen lds
    s_add_u32 m0, s62, 37888
    s_mov_b32 s70, 2128896
    buffer_load_dwordx4 v8, s[36:39], s70 offen lds
    s_waitcnt vmcnt(36)
    ds_read_b64_tr_b16 a[96:97], v9 offset:0
    ds_read_b64_tr_b16 a[98:99], v9 offset:512
    ds_read_b64_tr_b16 a[100:101], v10 offset:0
    ds_read_b64_tr_b16 a[102:103], v10 offset:512
    s_waitcnt lgkmcnt(4)
    s_add_u32 m0, s62, 38912
    s_mov_b32 s70, 2156544
    buffer_load_dwordx4 v8, s[36:39], s70 offen lds
    s_add_u32 m0, s62, 39936
    s_mov_b32 s70, 2184192
    buffer_load_dwordx4 v8, s[36:39], s70 offen lds
    s_waitcnt vmcnt(36)
    ds_read_b64_tr_b16 a[104:105], v9 offset:2048
    ds_read_b64_tr_b16 a[106:107], v9 offset:2560
    ds_read_b64_tr_b16 a[108:109], v10 offset:2048
    ds_read_b64_tr_b16 a[110:111], v10 offset:2560
    s_waitcnt vmcnt(34)
    ds_read_b64_tr_b16 a[112:113], v9 offset:4096
    ds_read_b64_tr_b16 a[114:115], v9 offset:4608
    ds_read_b64_tr_b16 a[116:117], v10 offset:4096
    ds_read_b64_tr_b16 a[118:119], v10 offset:4608
    s_waitcnt vmcnt(32)
    ds_read_b64_tr_b16 a[120:121], v9 offset:6144
    ds_read_b64_tr_b16 a[122:123], v9 offset:6656
    ds_read_b64_tr_b16 a[124:125], v10 offset:6144
    ds_read_b64_tr_b16 a[126:127], v10 offset:6656
    s_waitcnt vmcnt(30)
    ds_read_b64_tr_b16 a[128:129], v9 offset:8192
    ds_read_b64_tr_b16 a[130:131], v9 offset:8704
    ds_read_b64_tr_b16 a[132:133], v10 offset:8192
    ds_read_b64_tr_b16 a[134:135], v10 offset:8704
    s_waitcnt vmcnt(28)
    ds_read_b64_tr_b16 a[136:137], v9 offset:10240
    ds_read_b64_tr_b16 a[138:139], v9 offset:10752
    ds_read_b64_tr_b16 a[140:141], v10 offset:10240
    ds_read_b64_tr_b16 a[142:143], v10 offset:10752
    s_waitcnt vmcnt(26)
    ds_read_b64_tr_b16 a[144:145], v9 offset:12288
    ds_read_b64_tr_b16 a[146:147], v9 offset:12800
    ds_read_b64_tr_b16 a[148:149], v10 offset:12288
    ds_read_b64_tr_b16 a[150:151], v10 offset:12800
    s_waitcnt vmcnt(24)
    ds_read_b64_tr_b16 a[152:153], v9 offset:14336
    ds_read_b64_tr_b16 a[154:155], v9 offset:14848
    ds_read_b64_tr_b16 a[156:157], v10 offset:14336
    ds_read_b64_tr_b16 a[158:159], v10 offset:14848
    s_waitcnt vmcnt(22)
    ds_read_b64_tr_b16 a[160:161], v9 offset:16384
    ds_read_b64_tr_b16 a[162:163], v9 offset:16896
    ds_read_b64_tr_b16 a[164:165], v10 offset:16384
    ds_read_b64_tr_b16 a[166:167], v10 offset:16896
    s_waitcnt vmcnt(20)
    ds_read_b64_tr_b16 a[168:169], v9 offset:18432
    ds_read_b64_tr_b16 a[170:171], v9 offset:18944
    ds_read_b64_tr_b16 a[172:173], v10 offset:18432
    ds_read_b64_tr_b16 a[174:175], v10 offset:18944
    s_waitcnt vmcnt(18)
    ds_read_b64_tr_b16 a[176:177], v9 offset:20480
    ds_read_b64_tr_b16 a[178:179], v9 offset:20992
    ds_read_b64_tr_b16 a[180:181], v10 offset:20480
    ds_read_b64_tr_b16 a[182:183], v10 offset:20992
    s_waitcnt vmcnt(16)
    ds_read_b64_tr_b16 a[184:185], v9 offset:22528
    ds_read_b64_tr_b16 a[186:187], v9 offset:23040
    ds_read_b64_tr_b16 a[188:189], v10 offset:22528
    ds_read_b64_tr_b16 a[190:191], v10 offset:23040
    s_waitcnt vmcnt(14)
    ds_read_b64_tr_b16 a[192:193], v9 offset:24576
    ds_read_b64_tr_b16 a[194:195], v9 offset:25088
    ds_read_b64_tr_b16 a[196:197], v10 offset:24576
    ds_read_b64_tr_b16 a[198:199], v10 offset:25088
    s_waitcnt vmcnt(12)
    ds_read_b64_tr_b16 a[200:201], v9 offset:26624
    ds_read_b64_tr_b16 a[202:203], v9 offset:27136
    ds_read_b64_tr_b16 a[204:205], v10 offset:26624
    ds_read_b64_tr_b16 a[206:207], v10 offset:27136
    s_waitcnt vmcnt(10)
    ds_read_b64_tr_b16 a[208:209], v9 offset:28672
    ds_read_b64_tr_b16 a[210:211], v9 offset:29184
    ds_read_b64_tr_b16 a[212:213], v10 offset:28672
    ds_read_b64_tr_b16 a[214:215], v10 offset:29184
    s_waitcnt vmcnt(8)
    ds_read_b64_tr_b16 a[216:217], v9 offset:30720
    ds_read_b64_tr_b16 a[218:219], v9 offset:31232
    ds_read_b64_tr_b16 a[220:221], v10 offset:30720
    ds_read_b64_tr_b16 a[222:223], v10 offset:31232
    s_waitcnt vmcnt(6)
    ds_read_b64_tr_b16 a[224:225], v9 offset:32768
    ds_read_b64_tr_b16 a[226:227], v9 offset:33280
    ds_read_b64_tr_b16 a[228:229], v10 offset:32768
    ds_read_b64_tr_b16 a[230:231], v10 offset:33280
    s_waitcnt vmcnt(4)
    ds_read_b64_tr_b16 a[232:233], v9 offset:34816
    ds_read_b64_tr_b16 a[234:235], v9 offset:35328
    ds_read_b64_tr_b16 a[236:237], v10 offset:34816
    ds_read_b64_tr_b16 a[238:239], v10 offset:35328
    s_waitcnt vmcnt(2)
    ds_read_b64_tr_b16 a[240:241], v9 offset:36864
    ds_read_b64_tr_b16 a[242:243], v9 offset:37376
    ds_read_b64_tr_b16 a[244:245], v10 offset:36864
    ds_read_b64_tr_b16 a[246:247], v10 offset:37376
    s_waitcnt vmcnt(0)
    ds_read_b64_tr_b16 a[248:249], v9 offset:38912
    ds_read_b64_tr_b16 a[250:251], v9 offset:39424
    ds_read_b64_tr_b16 a[252:253], v10 offset:38912
    ds_read_b64_tr_b16 a[254:255], v10 offset:39424
    s_waitcnt vmcnt(0) lgkmcnt(0)
    s_mul_i32 s56, s54, 2621440
    s_add_u32 s56, s56, 183894016
    s_mul_i32 s58, s54, 8192
    s_add_u32 s58, s58, 81920
    s_mul_i32 s59, s54, 8192
    s_lshl_b32 s70, s53, 7
    s_add_u32 s59, s59, s70
    s_lshl_b32 s70, s52, 2
    s_add_u32 s59, s59, s70
    s_add_u32 s59, s59, 98304
    v_mov_b32 v33, v1
    s_lshl_b32 s70, s52, 10
    s_add_u32 s56, s56, s70
    s_mov_b32 s62, s70
    s_mov_b32 s67, 0
    s_cmp_lg_u32 s96, 0
    s_cbranch_scc1 RDY_ok_37
    s_mov_b32 s68, 0
RDY_lp_38:
    buffer_load_dword v40, off, s[48:51], 0 offset:32 sc1
    s_waitcnt vmcnt(0)
    v_readfirstlane_b32 s70, v40
    s_nop 0
    s_cmp_ge_u32 s70, 256
    s_cbranch_scc1 RDY_all_39
    s_sleep 8
    s_add_u32 s68, s68, 1
    s_cmp_lt_u32 s68, 65536
    s_cbranch_scc1 RDY_lp_38
    s_branch RDY_ok_37
RDY_all_39:
    v_mbcnt_lo_u32_b32 v41, -1, 0
    v_and_b32 v41, 7, v41
    v_min_u32 v42, 1, v41
    v_lshlrev_b32 v41, 2, v41
    v_lshl_add_u32 v41, v42, 7, v41
    buffer_load_dword v40, v41, s[48:51], 0 offen sc1
    s_waitcnt vmcnt(0)
    v_cmp_ne_u32 vcc, 32, v40
    s_nop 0
    s_cbranch_vccnz L_slow
RDY_ok_37:
    s_cmp_eq_u32 s53, 6
    s_cselect_b32 s96, 1, s96
    s_barrier
    v_mov_b32 v35, 81920
    v_mov_b32 v3, 0
    ds_write_b32 v35, v3
    s_waitcnt lgkmcnt(0)
    s_barrier
    s_mov_b32 s78, 1
G1f1_fetch:
    s_cmp_gt_u32 s60, s55
    s_cbranch_scc1 G1f1_p_ok_40
    s_mov_b32 s68, 0
G1f1_p_lp_41:
    buffer_load_dwordx4 v[4:7], v2, s[8:11], s58 offen sc1
    s_waitcnt vmcnt(0)
    v_min3_u32 v4, v4, v5, v6
    v_min_u32 v4, v4, v7
    v_max_u32 v4, v4, v34
    s_nop 1
    v_min_u32_dpp v4, v4, v4 row_ror:1 row_mask:0xf bank_mask:0xf
    s_nop 1
    v_min_u32_dpp v4, v4, v4 row_ror:2 row_mask:0xf bank_mask:0xf
    s_nop 1
    v_min_u32_dpp v4, v4, v4 row_ror:4 row_mask:0xf bank_mask:0xf
    s_nop 1
    v_min_u32_dpp v4, v4, v4 row_ror:8 row_mask:0xf bank_mask:0xf
    s_nop 0
    v_readlane_b32 s70, v4, 0
    s_nop 0
    s_max_u32 s60, s60, s70
    s_cmp_gt_u32 s60, s55
    s_cbranch_scc1 G1f1_p_ok_40
    s_cmp_lg_u32 s69, 0
    s_cbranch_scc1 G1f1_p_ok_40
    s_sleep 2
    s_add_u32 s68, s68, 1
    s_cmp_lt_u32 s68, 65536
    s_cbranch_scc1 G1f1_p_lp_41
    s_mov_b32 s69, 1
G1f1_p_ok_40:
    s_add_u32 m0, s62, 0
    s_add_u32 s70, s56, 0
    buffer_load_dwordx4 v1, s[8:11], s70 offen sc1 lds
    s_add_u32 m0, s62, 4096
    s_add_u32 s70, s56, 4096
    buffer_load_dwordx4 v1, s[8:11], s70 offen sc1 lds
    s_add_u32 m0, s62, 8192
    s_add_u32 s70, s56, 8192
    buffer_load_dwordx4 v1, s[8:11], s70 offen sc1 lds
    s_add_u32 m0, s62, 12288
    s_add_u32 s70, s56, 12288
    buffer_load_dwordx4 v1, s[8:11], s70 offen sc1 lds
    s_add_u32 m0, s62, 16384
    s_add_u32 s70, s56, 16384
    buffer_load_dwordx4 v1, s[8:11], s70 offen sc1 lds
    s_add_u32 m0, s62, 20480
    s_add_u32 s70, s56, 20480
    buffer_load_dwordx4 v1, s[8:11], s70 offen sc1 lds
    s_add_u32 m0, s62, 24576
    s_add_u32 s70, s56, 24576
    buffer_load_dwordx4 v1, s[8:11], s70 offen sc1 lds
    s_add_u32 m0, s62, 28672
    s_add_u32 s70, s56, 28672
    buffer_load_dwordx4 v1, s[8:11], s70 offen sc1 lds
    s_add_u32 m0, s62, 32768
    s_add_u32 s70, s56, 32768
    buffer_load_dwordx4 v1, s[8:11], s70 offen sc1 lds
    s_add_u32 m0, s62, 36864
    s_add_u32 s70, s56, 36864
    buffer_load_dwordx4 v1, s[8:11], s70 offen sc1 lds
    s_add_u32 s56, s56, 40960
    s_mov_b32 s63, 1
    s_add_u32 s70, s62, 40960
    s_sub_u32 s71, s62, 40960
    s_cmp_ge_u32 s62, 40960
    s_cselect_b32 s62, s71, s70
    buffer_load_dwordx4 v[4:7], v2, s[8:11], s58 offen sc1
G1f1_top:
    s_waitcnt vmcnt(7)
    s_barrier
    v_add_u32 v32, s67, v1
    s_xor_b32 s67, s67, 40960
    ds_read_b128 v[64:67], v32 offset:0
    ds_read_b128 v[68:71], v32 offset:1024
    ds_read_b128 v[72:75], v32 offset:2048
    ds_read_b128 v[76:79], v32 offset:3072
    ds_read_b128 v[80:83], v32 offset:4096
    ds_read_b128 v[84:87], v32 offset:5120
    ds_read_b128 v[88:91], v32 offset:6144
    ds_read_b128 v[92:95], v32 offset:7168
    ds_read_b128 v[96:99], v32 offset:8192
    ds_read_b128 v[100:103], v32 offset:9216
    ds_read_b128 v[104:107], v32 offset:10240
    ds_read_b128 v[108:111], v32 offset:11264
    s_mov_b32 s63, 0
    s_add_u32 s72, s55, 1
    s_cmp_lt_u32 s72, 64
    s_cselect_b32 s77, s72, 0x7fffffff
    s_waitcnt lgkmcnt(10)
    v_mfma_f32_32x32x16_bf16 v[128:143], v[192:195], v[64:67], 0
    ds_read_b128 v[112:115], v32 offset:12288
    v_mfma_f32_32x32x16_bf16 v[128:143], v[200:203], v[68:71], v[128:143]
    ds_read_b128 v[116:119], v32 offset:13312
    s_waitcnt lgkmcnt(10)
    v_mfma_f32_32x32x16_bf16 v[128:143], v[208:211], v[72:75], v[128:143]
    ds_read_b128 v[120:123], v32 offset:14336
    v_mfma_f32_32x32x16_bf16 v[128:143], v[216:219], v[76:79], v[128:143]
    ds_read_b128 v[124:127], v32 offset:15360
    s_waitcnt vmcnt(5) lgkmcnt(10)
    s_barrier
    v_mfma_f32_32x32x16_bf16 v[128:143], v[224:227], v[80:83], v[128:143]
    ds_read_b128 v[64:67], v32 offset:16384
    v_mfma_f32_32x32x16_bf16 v[128:143], v[232:235], v[84:87], v[128:143]
    ds_read_b128 v[68:71], v32 offset:17408
    s_waitcnt lgkmcnt(10)
    v_mfma_f32_32x32x16_bf16 v[128:143], v[240:243], v[88:91], v[128:143]
    ds_read_b128 v[72:75], v32 offset:18432
    v_mfma_f32_32x32x16_bf16 v[128:143], v[248:251], v[92:95], v[128:143]
    ds_read_b128 v[76:79], v32 offset:19456
    s_waitcnt lgkmcnt(10)
    v_mfma_f32_32x32x16_bf16 v[128:143], a[0:3], v[96:99], v[128:143]
    ds_read_b128 v[80:83], v32 offset:20480
    v_mfma_f32_32x32x16_bf16 v[128:143], a[8:11], v[100:103], v[128:143]
    ds_read_b128 v[84:87], v32 offset:21504
    s_waitcnt lgkmcnt(10)
    v_mfma_f32_32x32x16_bf16 v[128:143], a[16:19], v[104:107], v[128:143]
    ds_read_b128 v[88:91], v32 offset:22528
    v_mfma_f32_32x32x16_bf16 v[128:143], a[24:27], v[108:111], v[128:143]
    ds_read_b128 v[92:95], v32 offset:23552
    s_waitcnt vmcnt(3) lgkmcnt(10)
    s_barrier
    v_mfma_f32_32x32x16_bf16 v[128:143], a[32:35], v[112:115], v[128:143]
    ds_read_b128 v[96:99], v32 offset:24576
    v_mfma_f32_32x32x16_bf16 v[128:143], a[40:43], v[116:119], v[128:143]
    ds_read_b128 v[100:103], v32 offset:25600
    s_waitcnt lgkmcnt(10)
    v_mfma_f32_32x32x16_bf16 v[128:143], a[48:51], v[120:123], v[128:143]
    ds_read_b128 v[104:107], v32 offset:26624
    v_mfma_f32_32x32x16_bf16 v[128:143], a[56:59], v[124:127], v[128:143]
    ds_read_b128 v[108:111], v32 offset:27648
    s_waitcnt lgkmcnt(10)
    v_mfma_f32_32x32x16_bf16 v[128:143], a[64:67], v[64:67], v[128:143]
    ds_read_b128 v[112:115], v32 offset:28672
    v_mfma_f32_32x32x16_bf16 v[128:143], a[72:75], v[68:71], v[128:143]
    ds_read_b128 v[116:119], v32 offset:29696
    s_waitcnt lgkmcnt(10)
    v_mfma_f32_32x32x16_bf16 v[128:143], a[80:83], v[72:75], v[128:143]
    ds_read_b128 v[120:123], v32 offset:30720
    s_waitcnt vmcnt(0)
    v_min3_u32 v4, v4, v5, v6
    v_min_u32 v4, v4, v7
    v_max_u32 v4, v4, v34
    v_cmp_ge_u32 vcc, s77, v4
    v_mfma_f32_32x32x16_bf16 v[128:143], a[88:91], v[76:79], v[128:143]
    ds_read_b128 v[124:127], v32 offset:31744
    s_cmp_eq_u32 s61, 0
    s_cbranch_scc1 G1f1_nop_42
    v_mov_b32 v3, s55
    s_mov_b64 exec, 1
    s_cmp_lg_u32 s96, 0
    s_cbranch_scc1 loc_s_43
    buffer_store_dword v3, off, s[8:11], s59
    s_branch loc_e_44
loc_s_43:
    buffer_store_dword v3, off, s[8:11], s59 sc1
loc_e_44:
    s_mov_b64 exec, -1
    s_mov_b32 s61, 0
G1f1_nop_42:
    s_cbranch_vccz G1f1_dma9
    buffer_load_dwordx4 v[4:7], v2, s[8:11], s58 offen sc1
    s_barrier
    s_waitcnt lgkmcnt(10)
    v_mfma_f32_32x32x16_bf16 v[128:143], a[96:99], v[80:83], v[128:143]
    ds_read_b128 v[64:67], v32 offset:32768
    v_mfma_f32_32x32x16_bf16 v[128:143], a[104:107], v[84:87], v[128:143]
    ds_read_b128 v[68:71], v32 offset:33792
    s_waitcnt lgkmcnt(10)
    v_mfma_f32_32x32x16_bf16 v[128:143], a[112:115], v[88:91], v[128:143]
    ds_read_b128 v[72:75], v32 offset:34816
    v_mfma_f32_32x32x16_bf16 v[128:143], a[120:123], v[92:95], v[128:143]
    ds_read_b128 v[76:79], v32 offset:35840
    s_waitcnt lgkmcnt(10)
    v_mfma_f32_32x32x16_bf16 v[128:143], a[128:131], v[96:99], v[128:143]
    ds_read_b128 v[80:83], v32 offset:36864
    v_mfma_f32_32x32x16_bf16 v[128:143], a[136:139], v[100:103], v[128:143]
    ds_read_b128 v[84:87], v32 offset:37888
    s_waitcnt lgkmcnt(10)
    v_mfma_f32_32x32x16_bf16 v[128:143], a[144:147], v[104:107], v[128:143]
    ds_read_b128 v[88:91], v32 offset:38912
    v_mfma_f32_32x32x16_bf16 v[128:143], a[152:155], v[108:111], v[128:143]
    ds_read_b128 v[92:95], v32 offset:39936
    s_waitcnt lgkmcnt(10)
    v_mfma_f32_32x32x16_bf16 v[128:143], a[160:163], v[112:115], v[128:143]
    ds_read_b128 v[96:99], v32 offset:0
    v_mfma_f32_32x32x16_bf16 v[128:143], a[168:171], v[116:119], v[128:143]
    ds_read_b128 v[100:103], v32 offset:1024
    s_waitcnt lgkmcnt(10)
    v_mfma_f32_32x32x16_bf16 v[128:143], a[176:179], v[120:123], v[128:143]
    ds_read_b128 v[104:107], v32 offset:2048
    v_mfma_f32_32x32x16_bf16 v[128:143], a[184:187], v[124:127], v[128:143]
    ds_read_b128 v[108:111], v32 offset:3072
    s_waitcnt lgkmcnt(10)
    v_mfma_f32_32x32x16_bf16 v[128:143], a[192:195], v[64:67], v[128:143]
    ds_read_b128 v[112:115], v32 offset:4096
    v_mfma_f32_32x32x16_bf16 v[128:143], a[200:203], v[68:71], v[128:143]
    ds_read_b128 v[116:119], v32 offset:5120
    s_waitcnt lgkmcnt(10)
    v_mfma_f32_32x32x16_bf16 v[128:143], a[208:211], v[72:75], v[128:143]
    ds_read_b128 v[120:123], v32 offset:6144
    v_mfma_f32_32x32x16_bf16 v[128:143], a[216:219], v[76:79], v[128:143]
    ds_read_b128 v[124:127], v32 offset:7168
    s_waitcnt lgkmcnt(10)
    v_mfma_f32_32x32x16_bf16 v[128:143], a[224:227], v[80:83], v[128:143]
    ds_read_b128 v[64:67], v32 offset:8192
    v_mfma_f32_32x32x16_bf16 v[128:143], a[232:235], v[84:87], v[128:143]
    ds_read_b128 v[68:71], v32 offset:9216
    s_waitcnt lgkmcnt(10)
    v_mfma_f32_32x32x16_bf16 v[128:143], a[240:243], v[88:91], v[128:143]
    ds_read_b128 v[72:75], v32 offset:10240
    s_waitcnt vmcnt(0)
    v_min3_u32 v4, v4, v5, v6
    v_min_u32 v4, v4, v7
    v_max_u32 v4, v4, v34
    v_cmp_ge_u32 vcc, s77, v4
    v_mfma_f32_32x32x16_bf16 v[128:143], a[248:251], v[92:95], v[128:143]
    ds_read_b128 v[76:79], v32 offset:11264
    s_cbranch_vccz G1f1_dma19
    buffer_load_dwordx4 v[4:7], v2, s[8:11], s58 offen sc1
    s_waitcnt lgkmcnt(10)
    v_mfma_f32_32x32x16_bf16 v[144:159], v[196:199], v[96:99], 0
    ds_read_b128 v[80:83], v32 offset:12288
    v_mfma_f32_32x32x16_bf16 v[144:159], v[204:207], v[100:103], v[144:159]
    ds_read_b128 v[84:87], v32 offset:13312
    s_waitcnt lgkmcnt(10)
    v_mfma_f32_32x32x16_bf16 v[144:159], v[212:215], v[104:107], v[144:159]
    ds_read_b128 v[88:91], v32 offset:14336
    v_mfma_f32_32x32x16_bf16 v[144:159], v[220:223], v[108:111], v[144:159]
    ds_read_b128 v[92:95], v32 offset:15360
    s_waitcnt lgkmcnt(10)
    v_mfma_f32_32x32x16_bf16 v[144:159], v[228:231], v[112:115], v[144:159]
    ds_read_b128 v[96:99], v32 offset:16384
    v_mfma_f32_32x32x16_bf16 v[144:159], v[236:239], v[116:119], v[144:159]
    ds_read_b128 v[100:103], v32 offset:17408
    v_cvt_pk_bf16_f32 v160, v128, v129
    v_pk_max_i16 v160, v160, 0
    v_cvt_pk_bf16_f32 v161, v130, v131
    v_pk_max_i16 v161, v161, 0
    v_cvt_pk_bf16_f32 v162, v132, v133
    v_pk_max_i16 v162, v162, 0
    v_cvt_pk_bf16_f32 v163, v134, v135
    v_pk_max_i16 v163, v163, 0
    buffer_store_dwordx4 v[160:163], v33, s[8:11], s57 offen offset:0 sc1
    s_waitcnt lgkmcnt(10)
    v_mfma_f32_32x32x16_bf16 v[144:159], v[244:247], v[120:123], v[144:159]
    ds_read_b128 v[104:107], v32 offset:18432
    v_mfma_f32_32x32x16_bf16 v[144:159], v[252:255], v[124:127], v[144:159]
    ds_read_b128 v[108:111], v32 offset:19456
    s_waitcnt lgkmcnt(10)
    v_mfma_f32_32x32x16_bf16 v[144:159], a[4:7], v[64:67], v[144:159]
    ds_read_b128 v[112:115], v32 offset:20480
    v_mfma_f32_32x32x16_bf16 v[144:159], a[12:15], v[68:71], v[144:159]
    ds_read_b128 v[116:119], v32 offset:21504
    v_cvt_pk_bf16_f32 v164, v136, v137
    v_pk_max_i16 v164, v164, 0
    v_cvt_pk_bf16_f32 v165, v138, v139
    v_pk_max_i16 v165, v165, 0
    v_cvt_pk_bf16_f32 v166, v140, v141
    v_pk_max_i16 v166, v166, 0
    v_cvt_pk_bf16_f32 v167, v142, v143
    v_pk_max_i16 v167, v167, 0
    buffer_store_dwordx4 v[164:167], v33, s[8:11], s57 offen offset:1024 sc1
    s_waitcnt lgkmcnt(10)
    v_mfma_f32_32x32x16_bf16 v[144:159], a[20:23], v[72:75], v[144:159]
    ds_read_b128 v[120:123], v32 offset:22528
    v_mfma_f32_32x32x16_bf16 v[144:159], a[28:31], v[76:79], v[144:159]
    ds_read_b128 v[124:127], v32 offset:23552
    s_waitcnt lgkmcnt(10)
    v_mfma_f32_32x32x16_bf16 v[144:159], a[36:39], v[80:83], v[144:159]
    ds_read_b128 v[64:67], v32 offset:24576
    v_mfma_f32_32x32x16_bf16 v[144:159], a[44:47], v[84:87], v[144:159]
    ds_read_b128 v[68:71], v32 offset:25600
    s_waitcnt lgkmcnt(10)
    v_mfma_f32_32x32x16_bf16 v[144:159], a[52:55], v[88:91], v[144:159]
    ds_read_b128 v[72:75], v32 offset:26624
    v_mfma_f32_32x32x16_bf16 v[144:159], a[60:63], v[92:95], v[144:159]
    ds_read_b128 v[76:79], v32 offset:27648
    s_waitcnt lgkmcnt(10)
    v_mfma_f32_32x32x16_bf16 v[144:159], a[68:71], v[96:99], v[144:159]
    ds_read_b128 v[80:83], v32 offset:28672
    v_mfma_f32_32x32x16_bf16 v[144:159], a[76:79], v[100:103], v[144:159]
    ds_read_b128 v[84:87], v32 offset:29696
    s_waitcnt lgkmcnt(10)
    v_mfma_f32_32x32x16_bf16 v[144:159], a[84:87], v[104:107], v[144:159]
    ds_read_b128 v[88:91], v32 offset:30720
    s_waitcnt vmcnt(2)
    v_min3_u32 v4, v4, v5, v6
    v_min_u32 v4, v4, v7
    v_max_u32 v4, v4, v34
    v_cmp_ge_u32 vcc, s77, v4
    v_mfma_f32_32x32x16_bf16 v[144:159], a[92:95], v[108:111], v[144:159]
    ds_read_b128 v[92:95], v32 offset:31744
    s_cbranch_vccz G1f1_dma29
    buffer_load_dwordx4 v[4:7], v2, s[8:11], s58 offen sc1
    s_waitcnt lgkmcnt(10)
    v_mfma_f32_32x32x16_bf16 v[144:159], a[100:103], v[112:115], v[144:159]
    ds_read_b128 v[96:99], v32 offset:32768
    v_mfma_f32_32x32x16_bf16 v[144:159], a[108:111], v[116:119], v[144:159]
    ds_read_b128 v[100:103], v32 offset:33792
    s_waitcnt lgkmcnt(10)
    v_mfma_f32_32x32x16_bf16 v[144:159], a[116:119], v[120:123], v[144:159]
    ds_read_b128 v[104:107], v32 offset:34816
    v_mfma_f32_32x32x16_bf16 v[144:159], a[124:127], v[124:127], v[144:159]
    ds_read_b128 v[108:111], v32 offset:35840
    s_waitcnt lgkmcnt(10)
    v_mfma_f32_32x32x16_bf16 v[144:159], a[132:135], v[64:67], v[144:159]
    ds_read_b128 v[112:115], v32 offset:36864
    v_mfma_f32_32x32x16_bf16 v[144:159], a[140:143], v[68:71], v[144:159]
    ds_read_b128 v[116:119], v32 offset:37888
    s_waitcnt lgkmcnt(10)
    v_mfma_f32_32x32x16_bf16 v[144:159], a[148:151], v[72:75], v[144:159]
    ds_read_b128 v[120:123], v32 offset:38912
    v_mfma_f32_32x32x16_bf16 v[144:159], a[156:159], v[76:79], v[144:159]
    ds_read_b128 v[124:127], v32 offset:39936
    s_waitcnt lgkmcnt(10)
    v_mfma_f32_32x32x16_bf16 v[144:159], a[164:167], v[80:83], v[144:159]
    v_mfma_f32_32x32x16_bf16 v[144:159], a[172:175], v[84:87], v[144:159]
    s_waitcnt lgkmcnt(8)
    v_mfma_f32_32x32x16_bf16 v[144:159], a[180:183], v[88:91], v[144:159]
    v_mfma_f32_32x32x16_bf16 v[144:159], a[188:191], v[92:95], v[144:159]
    s_waitcnt lgkmcnt(6)
    v_mfma_f32_32x32x16_bf16 v[144:159], a[196:199], v[96:99], v[144:159]
    v_mfma_f32_32x32x16_bf16 v[144:159], a[204:207], v[100:103], v[144:159]
    s_waitcnt lgkmcnt(4)
    v_mfma_f32_32x32x16_bf16 v[144:159], a[212:215], v[104:107], v[144:159]
    v_mfma_f32_32x32x16_bf16 v[144:159], a[220:223], v[108:111], v[144:159]
    s_waitcnt lgkmcnt(2)
    v_mfma_f32_32x32x16_bf16 v[144:159], a[228:231], v[112:115], v[144:159]
    v_mfma_f32_32x32x16_bf16 v[144:159], a[236:239], v[116:119], v[144:159]
    s_waitcnt lgkmcnt(0)
    v_mfma_f32_32x32x16_bf16 v[144:159], a[244:247], v[120:123], v[144:159]
    v_mfma_f32_32x32x16_bf16 v[144:159], a[252:255], v[124:127], v[144:159]
    s_branch G1f1_epi
G1f1_dma19:
    s_waitcnt lgkmcnt(10)
    v_mfma_f32_32x32x16_bf16 v[144:159], v[196:199], v[96:99], 0
    ds_read_b128 v[80:83], v32 offset:12288
    s_add_u32 m0, s62, 0
    s_add_u32 s70, s56, 0
    buffer_load_dwordx4 v1, s[8:11], s70 offen sc1 lds
    v_mfma_f32_32x32x16_bf16 v[144:159], v[204:207], v[100:103], v[144:159]
    ds_read_b128 v[84:87], v32 offset:13312
    s_waitcnt lgkmcnt(10)
    v_mfma_f32_32x32x16_bf16 v[144:159], v[212:215], v[104:107], v[144:159]
    ds_read_b128 v[88:91], v32 offset:14336
    s_add_u32 m0, s62, 4096
    s_add_u32 s70, s56, 4096
    buffer_load_dwordx4 v1, s[8:11], s70 offen sc1 lds
    v_mfma_f32_32x32x16_bf16 v[144:159], v[220:223], v[108:111], v[144:159]
    ds_read_b128 v[92:95], v32 offset:15360
    s_waitcnt lgkmcnt(10)
    v_mfma_f32_32x32x16_bf16 v[144:159], v[228:231], v[112:115], v[144:159]
    ds_read_b128 v[96:99], v32 offset:16384
    s_add_u32 m0, s62, 8192
    s_add_u32 s70, s56, 8192
    buffer_load_dwordx4 v1, s[8:11], s70 offen sc1 lds
    v_mfma_f32_32x32x16_bf16 v[144:159], v[236:239], v[116:119], v[144:159]
    ds_read_b128 v[100:103], v32 offset:17408
    v_cvt_pk_bf16_f32 v160, v128, v129
    v_pk_max_i16 v160, v160, 0
    v_cvt_pk_bf16_f32 v161, v130, v131
    v_pk_max_i16 v161, v161, 0
    v_cvt_pk_bf16_f32 v162, v132, v133
    v_pk_max_i16 v162, v162, 0
    v_cvt_pk_bf16_f32 v163, v134, v135
    v_pk_max_i16 v163, v163, 0
    buffer_store_dwordx4 v[160:163], v33, s[8:11], s57 offen offset:0 sc1
    s_waitcnt lgkmcnt(10)
    v_mfma_f32_32x32x16_bf16 v[144:159], v[244:247], v[120:123], v[144:159]
    ds_read_b128 v[104:107], v32 offset:18432
    s_add_u32 m0, s62, 12288
    s_add_u32 s70, s56, 12288
    buffer_load_dwordx4 v1, s[8:11], s70 offen sc1 lds
    v_mfma_f32_32x32x16_bf16 v[144:159], v[252:255], v[124:127], v[144:159]
    ds_read_b128 v[108:111], v32 offset:19456
    s_waitcnt lgkmcnt(10)
    v_mfma_f32_32x32x16_bf16 v[144:159], a[4:7], v[64:67], v[144:159]
    ds_read_b128 v[112:115], v32 offset:20480
    s_add_u32 m0, s62, 16384
    s_add_u32 s70, s56, 16384
    buffer_load_dwordx4 v1, s[8:11], s70 offen sc1 lds
    v_mfma_f32_32x32x16_bf16 v[144:159], a[12:15], v[68:71], v[144:159]
    ds_read_b128 v[116:119], v32 offset:21504
    v_cvt_pk_bf16_f32 v164, v136, v137
    v_pk_max_i16 v164, v164, 0
    v_cvt_pk_bf16_f32 v165, v138, v139
    v_pk_max_i16 v165, v165, 0
    v_cvt_pk_bf16_f32 v166, v140, v141
    v_pk_max_i16 v166, v166, 0
    v_cvt_pk_bf16_f32 v167, v142, v143
    v_pk_max_i16 v167, v167, 0
    buffer_store_dwordx4 v[164:167], v33, s[8:11], s57 offen offset:1024 sc1
    s_waitcnt lgkmcnt(10)
    v_mfma_f32_32x32x16_bf16 v[144:159], a[20:23], v[72:75], v[144:159]
    ds_read_b128 v[120:123], v32 offset:22528
    s_add_u32 m0, s62, 20480
    s_add_u32 s70, s56, 20480
    buffer_load_dwordx4 v1, s[8:11], s70 offen sc1 lds
    v_mfma_f32_32x32x16_bf16 v[144:159], a[28:31], v[76:79], v[144:159]
    ds_read_b128 v[124:127], v32 offset:23552
    s_waitcnt lgkmcnt(10)
    v_mfma_f32_32x32x16_bf16 v[144:159], a[36:39], v[80:83], v[144:159]
    ds_read_b128 v[64:67], v32 offset:24576
    s_add_u32 m0, s62, 24576
    s_add_u32 s70, s56, 24576
    buffer_load_dwordx4 v1, s[8:11], s70 offen sc1 lds
    v_mfma_f32_32x32x16_bf16 v[144:159], a[44:47], v[84:87], v[144:159]
    ds_read_b128 v[68:71], v32 offset:25600
    s_waitcnt lgkmcnt(10)
    v_mfma_f32_32x32x16_bf16 v[144:159], a[52:55], v[88:91], v[144:159]
    ds_read_b128 v[72:75], v32 offset:26624
    s_add_u32 m0, s62, 28672
    s_add_u32 s70, s56, 28672
    buffer_load_dwordx4 v1, s[8:11], s70 offen sc1 lds
    v_mfma_f32_32x32x16_bf16 v[144:159], a[60:63], v[92:95], v[144:159]
    ds_read_b128 v[76:79], v32 offset:27648
    s_waitcnt lgkmcnt(10)
    v_mfma_f32_32x32x16_bf16 v[144:159], a[68:71], v[96:99], v[144:159]
    ds_read_b128 v[80:83], v32 offset:28672
    s_add_u32 m0, s62, 32768
    s_add_u32 s70, s56, 32768
    buffer_load_dwordx4 v1, s[8:11], s70 offen sc1 lds
    v_mfma_f32_32x32x16_bf16 v[144:159], a[76:79], v[100:103], v[144:159]
    ds_read_b128 v[84:87], v32 offset:29696
    s_waitcnt lgkmcnt(10)
    v_mfma_f32_32x32x16_bf16 v[144:159], a[84:87], v[104:107], v[144:159]
    ds_read_b128 v[88:91], v32 offset:30720
    s_add_u32 m0, s62, 36864
    s_add_u32 s70, s56, 36864
    buffer_load_dwordx4 v1, s[8:11], s70 offen sc1 lds
    s_add_u32 s56, s56, 40960
    s_mov_b32 s63, 1
    s_add_u32 s70, s62, 40960
    s_sub_u32 s71, s62, 40960
    s_cmp_ge_u32 s62, 40960
    s_cselect_b32 s62, s71, s70
    v_mfma_f32_32x32x16_bf16 v[144:159], a[92:95], v[108:111], v[144:159]
    ds_read_b128 v[92:95], v32 offset:31744
    s_branch G1f1_rest30
G1f1_dma29:
    s_waitcnt lgkmcnt(10)
    v_mfma_f32_32x32x16_bf16 v[144:159], a[100:103], v[112:115], v[144:159]
    ds_read_b128 v[96:99], v32 offset:32768
    s_add_u32 m0, s62, 0
    s_add_u32 s70, s56, 0
    buffer_load_dwordx4 v1, s[8:11], s70 offen sc1 lds
    v_mfma_f32_32x32x16_bf16 v[144:159], a[108:111], v[116:119], v[144:159]
    ds_read_b128 v[100:103], v32 offset:33792
    s_waitcnt lgkmcnt(10)
    v_mfma_f32_32x32x16_bf16 v[144:159], a[116:119], v[120:123], v[144:159]
    ds_read_b128 v[104:107], v32 offset:34816
    s_add_u32 m0, s62, 4096
    s_add_u32 s70, s56, 4096
    buffer_load_dwordx4 v1, s[8:11], s70 offen sc1 lds
    v_mfma_f32_32x32x16_bf16 v[144:159], a[124:127], v[124:127], v[144:159]
    ds_read_b128 v[108:111], v32 offset:35840
    s_waitcnt lgkmcnt(10)
    v_mfma_f32_32x32x16_bf16 v[144:159], a[132:135], v[64:67], v[144:159]
    ds_read_b128 v[112:115], v32 offset:36864
    s_add_u32 m0, s62, 8192
    s_add_u32 s70, s56, 8192
    buffer_load_dwordx4 v1, s[8:11], s70 offen sc1 lds
    v_mfma_f32_32x32x16_bf16 v[144:159], a[140:143], v[68:71], v[144:159]
    ds_read_b128 v[116:119], v32 offset:37888
    s_waitcnt lgkmcnt(10)
    v_mfma_f32_32x32x16_bf16 v[144:159], a[148:151], v[72:75], v[144:159]
    ds_read_b128 v[120:123], v32 offset:38912
    s_add_u32 m0, s62, 12288
    s_add_u32 s70, s56, 12288
    buffer_load_dwordx4 v1, s[8:11], s70 offen sc1 lds
    v_mfma_f32_32x32x16_bf16 v[144:159], a[156:159], v[76:79], v[144:159]
    ds_read_b128 v[124:127], v32 offset:39936
    s_waitcnt lgkmcnt(10)
    v_mfma_f32_32x32x16_bf16 v[144:159], a[164:167], v[80:83], v[144:159]
    s_add_u32 m0, s62, 16384
    s_add_u32 s70, s56, 16384
    buffer_load_dwordx4 v1, s[8:11], s70 offen sc1 lds
    v_mfma_f32_32x32x16_bf16 v[144:159], a[172:175], v[84:87], v[144:159]
    s_waitcnt lgkmcnt(8)
    v_mfma_f32_32x32x16_bf16 v[144:159], a[180:183], v[88:91], v[144:159]
    s_add_u32 m0, s62, 20480
    s_add_u32 s70, s56, 20480
    buffer_load_dwordx4 v1, s[8:11], s70 offen sc1 lds
    v_mfma_f32_32x32x16_bf16 v[144:159], a[188:191], v[92:95], v[144:159]
    s_waitcnt lgkmcnt(6)
    v_mfma_f32_32x32x16_bf16 v[144:159], a[196:199], v[96:99], v[144:159]
    s_add_u32 m0, s62, 24576
    s_add_u32 s70, s56, 24576
    buffer_load_dwordx4 v1, s[8:11], s70 offen sc1 lds
    v_mfma_f32_32x32x16_bf16 v[144:159], a[204:207], v[100:103], v[144:159]
    s_waitcnt lgkmcnt(4)
    v_mfma_f32_32x32x16_bf16 v[144:159], a[212:215], v[104:107], v[144:159]
    s_add_u32 m0, s62, 28672
    s_add_u32 s70, s56, 28672
    buffer_load_dwordx4 v1, s[8:11], s70 offen sc1 lds
    v_mfma_f32_32x32x16_bf16 v[144:159], a[220:223], v[108:111], v[144:159]
    s_waitcnt lgkmcnt(2)
    v_mfma_f32_32x32x16_bf16 v[144:159], a[228:231], v[112:115], v[144:159]
    s_add_u32 m0, s62, 32768
    s_add_u32 s70, s56, 32768
    buffer_load_dwordx4 v1, s[8:11], s70 offen sc1 lds
    v_mfma_f32_32x32x16_bf16 v[144:159], a[236:239], v[116:119], v[144:159]
    s_waitcnt lgkmcnt(0)
    v_mfma_f32_32x32x16_bf16 v[144:159], a[244:247], v[120:123], v[144:159]
    s_add_u32 m0, s62, 36864
    s_add_u32 s70, s56, 36864
    buffer_load_dwordx4 v1, s[8:11], s70 offen sc1 lds
    s_add_u32 s56, s56, 40960
    s_mov_b32 s63, 1
    s_add_u32 s70, s62, 40960
    s_sub_u32 s71, s62, 40960
    s_cmp_ge_u32 s62, 40960
    s_cselect_b32 s62, s71, s70
    v_mfma_f32_32x32x16_bf16 v[144:159], a[252:255], v[124:127], v[144:159]
    s_branch G1f1_epi
G1f1_dma9:
    s_barrier
    s_waitcnt lgkmcnt(10)
    v_mfma_f32_32x32x16_bf16 v[128:143], a[96:99], v[80:83], v[128:143]
    ds_read_b128 v[64:67], v32 offset:32768
    s_add_u32 m0, s62, 0
    s_add_u32 s70, s56, 0
    buffer_load_dwordx4 v1, s[8:11], s70 offen sc1 lds
    v_mfma_f32_32x32x16_bf16 v[128:143], a[104:107], v[84:87], v[128:143]
    ds_read_b128 v[68:71], v32 offset:33792
    s_waitcnt lgkmcnt(10)
    v_mfma_f32_32x32x16_bf16 v[128:143], a[112:115], v[88:91], v[128:143]
    ds_read_b128 v[72:75], v32 offset:34816
    s_add_u32 m0, s62, 4096
    s_add_u32 s70, s56, 4096
    buffer_load_dwordx4 v1, s[8:11], s70 offen sc1 lds
    v_mfma_f32_32x32x16_bf16 v[128:143], a[120:123], v[92:95], v[128:143]
    ds_read_b128 v[76:79], v32 offset:35840
    s_waitcnt lgkmcnt(10)
    v_mfma_f32_32x32x16_bf16 v[128:143], a[128:131], v[96:99], v[128:143]
    ds_read_b128 v[80:83], v32 offset:36864
    s_add_u32 m0, s62, 8192
    s_add_u32 s70, s56, 8192
    buffer_load_dwordx4 v1, s[8:11], s70 offen sc1 lds
    v_mfma_f32_32x32x16_bf16 v[128:143], a[136:139], v[100:103], v[128:143]
    ds_read_b128 v[84:87], v32 offset:37888
    s_waitcnt lgkmcnt(10)
    v_mfma_f32_32x32x16_bf16 v[128:143], a[144:147], v[104:107], v[128:143]
    ds_read_b128 v[88:91], v32 offset:38912
    s_add_u32 m0, s62, 12288
    s_add_u32 s70, s56, 12288
    buffer_load_dwordx4 v1, s[8:11], s70 offen sc1 lds
    v_mfma_f32_32x32x16_bf16 v[128:143], a[152:155], v[108:111], v[128:143]
    ds_read_b128 v[92:95], v32 offset:39936
    s_waitcnt lgkmcnt(10)
    v_mfma_f32_32x32x16_bf16 v[128:143], a[160:163], v[112:115], v[128:143]
    ds_read_b128 v[96:99], v32 offset:0
    s_add_u32 m0, s62, 16384
    s_add_u32 s70, s56, 16384
    buffer_load_dwordx4 v1, s[8:11], s70 offen sc1 lds
    v_mfma_f32_32x32x16_bf16 v[128:143], a[168:171], v[116:119], v[128:143]
    ds_read_b128 v[100:103], v32 offset:1024
    s_waitcnt lgkmcnt(10)
    v_mfma_f32_32x32x16_bf16 v[128:143], a[176:179], v[120:123], v[128:143]
    ds_read_b128 v[104:107], v32 offset:2048
    s_add_u32 m0, s62, 20480
    s_add_u32 s70, s56, 20480
    buffer_load_dwordx4 v1, s[8:11], s70 offen sc1 lds
    v_mfma_f32_32x32x16_bf16 v[128:143], a[184:187], v[124:127], v[128:143]
    ds_read_b128 v[108:111], v32 offset:3072
    s_waitcnt lgkmcnt(10)
    v_mfma_f32_32x32x16_bf16 v[128:143], a[192:195], v[64:67], v[128:143]
    ds_read_b128 v[112:115], v32 offset:4096
    s_add_u32 m0, s62, 24576
    s_add_u32 s70, s56, 24576
    buffer_load_dwordx4 v1, s[8:11], s70 offen sc1 lds
    v_mfma_f32_32x32x16_bf16 v[128:143], a[200:203], v[68:71], v[128:143]
    ds_read_b128 v[116:119], v32 offset:5120
    s_waitcnt lgkmcnt(10)
    v_mfma_f32_32x32x16_bf16 v[128:143], a[208:211], v[72:75], v[128:143]
    ds_read_b128 v[120:123], v32 offset:6144
    s_add_u32 m0, s62, 28672
    s_add_u32 s70, s56, 28672
    buffer_load_dwordx4 v1, s[8:11], s70 offen sc1 lds
    v_mfma_f32_32x32x16_bf16 v[128:143], a[216:219], v[76:79], v[128:143]
    ds_read_b128 v[124:127], v32 offset:7168
    s_waitcnt lgkmcnt(10)
    v_mfma_f32_32x32x16_bf16 v[128:143], a[224:227], v[80:83], v[128:143]
    ds_read_b128 v[64:67], v32 offset:8192
    s_add_u32 m0, s62, 32768
    s_add_u32 s70, s56, 32768
    buffer_load_dwordx4 v1, s[8:11], s70 offen sc1 lds
    v_mfma_f32_32x32x16_bf16 v[128:143], a[232:235], v[84:87], v[128:143]
    ds_read_b128 v[68:71], v32 offset:9216
    s_waitcnt lgkmcnt(10)
    v_mfma_f32_32x32x16_bf16 v[128:143], a[240:243], v[88:91], v[128:143]
    ds_read_b128 v[72:75], v32 offset:10240
    s_add_u32 m0, s62, 36864
    s_add_u32 s70, s56, 36864
    buffer_load_dwordx4 v1, s[8:11], s70 offen sc1 lds
    s_add_u32 s56, s56, 40960
    s_mov_b32 s63, 1
    s_add_u32 s70, s62, 40960
    s_sub_u32 s71, s62, 40960
    s_cmp_ge_u32 s62, 40960
    s_cselect_b32 s62, s71, s70
    v_mfma_f32_32x32x16_bf16 v[128:143], a[248:251], v[92:95], v[128:143]
    ds_read_b128 v[76:79], v32 offset:11264
G1f1_rest20:
    s_waitcnt lgkmcnt(10)
    v_mfma_f32_32x32x16_bf16 v[144:159], v[196:199], v[96:99], 0
    ds_read_b128 v[80:83], v32 offset:12288
    v_mfma_f32_32x32x16_bf16 v[144:159], v[204:207], v[100:103], v[144:159]
    ds_read_b128 v[84:87], v32 offset:13312
    s_waitcnt lgkmcnt(10)
    v_mfma_f32_32x32x16_bf16 v[144:159], v[212:215], v[104:107], v[144:159]
    ds_read_b128 v[88:91], v32 offset:14336
    v_mfma_f32_32x32x16_bf16 v[144:159], v[220:223], v[108:111], v[144:159]
    ds_read_b128 v[92:95], v32 offset:15360
    s_waitcnt lgkmcnt(10)
    v_mfma_f32_32x32x16_bf16 v[144:159], v[228:231], v[112:115], v[144:159]
    ds_read_b128 v[96:99], v32 offset:16384
    v_mfma_f32_32x32x16_bf16 v[144:159], v[236:239], v[116:119], v[144:159]
    ds_read_b128 v[100:103], v32 offset:17408
    v_cvt_pk_bf16_f32 v160, v128, v129
    v_pk_max_i16 v160, v160, 0
    v_cvt_pk_bf16_f32 v161, v130, v131
    v_pk_max_i16 v161, v161, 0
    v_cvt_pk_bf16_f32 v162, v132, v133
    v_pk_max_i16 v162, v162, 0
    v_cvt_pk_bf16_f32 v163, v134, v135
    v_pk_max_i16 v163, v163, 0
    buffer_store_dwordx4 v[160:163], v33, s[8:11], s57 offen offset:0 sc1
    s_waitcnt lgkmcnt(10)
    v_mfma_f32_32x32x16_bf16 v[144:159], v[244:247], v[120:123], v[144:159]
    ds_read_b128 v[104:107], v32 offset:18432
    v_mfma_f32_32x32x16_bf16 v[144:159], v[252:255], v[124:127], v[144:159]
    ds_read_b128 v[108:111], v32 offset:19456
    s_waitcnt lgkmcnt(10)
    v_mfma_f32_32x32x16_bf16 v[144:159], a[4:7], v[64:67], v[144:159]
    ds_read_b128 v[112:115], v32 offset:20480
    v_mfma_f32_32x32x16_bf16 v[144:159], a[12:15], v[68:71], v[144:159]
    ds_read_b128 v[116:119], v32 offset:21504
    v_cvt_pk_bf16_f32 v164, v136, v137
    v_pk_max_i16 v164, v164, 0
    v_cvt_pk_bf16_f32 v165, v138, v139
    v_pk_max_i16 v165, v165, 0
    v_cvt_pk_bf16_f32 v166, v140, v141
    v_pk_max_i16 v166, v166, 0
    v_cvt_pk_bf16_f32 v167, v142, v143
    v_pk_max_i16 v167, v167, 0
    buffer_store_dwordx4 v[164:167], v33, s[8:11], s57 offen offset:1024 sc1
    s_waitcnt lgkmcnt(10)
    v_mfma_f32_32x32x16_bf16 v[144:159], a[20:23], v[72:75], v[144:159]
    ds_read_b128 v[120:123], v32 offset:22528
    v_mfma_f32_32x32x16_bf16 v[144:159], a[28:31], v[76:79], v[144:159]
    ds_read_b128 v[124:127], v32 offset:23552
    s_waitcnt lgkmcnt(10)
    v_mfma_f32_32x32x16_bf16 v[144:159], a[36:39], v[80:83], v[144:159]
    ds_read_b128 v[64:67], v32 offset:24576
    v_mfma_f32_32x32x16_bf16 v[144:159], a[44:47], v[84:87], v[144:159]
    ds_read_b128 v[68:71], v32 offset:25600
    s_waitcnt lgkmcnt(10)
    v_mfma_f32_32x32x16_bf16 v[144:159], a[52:55], v[88:91], v[144:159]
    ds_read_b128 v[72:75], v32 offset:26624
    v_mfma_f32_32x32x16_bf16 v[144:159], a[60:63], v[92:95], v[144:159]
    ds_read_b128 v[76:79], v32 offset:27648
    s_waitcnt lgkmcnt(10)
    v_mfma_f32_32x32x16_bf16 v[144:159], a[68:71], v[96:99], v[144:159]
    ds_read_b128 v[80:83], v32 offset:28672
    v_mfma_f32_32x32x16_bf16 v[144:159], a[76:79], v[100:103], v[144:159]
    ds_read_b128 v[84:87], v32 offset:29696
    s_waitcnt lgkmcnt(10)
    v_mfma_f32_32x32x16_bf16 v[144:159], a[84:87], v[104:107], v[144:159]
    ds_read_b128 v[88:91], v32 offset:30720
    v_mfma_f32_32x32x16_bf16 v[144:159], a[92:95], v[108:111], v[144:159]
    ds_read_b128 v[92:95], v32 offset:31744
G1f1_rest30:
    s_waitcnt lgkmcnt(10)
    v_mfma_f32_32x32x16_bf16 v[144:159], a[100:103], v[112:115], v[144:159]
    ds_read_b128 v[96:99], v32 offset:32768
    v_mfma_f32_32x32x16_bf16 v[144:159], a[108:111], v[116:119], v[144:159]
    ds_read_b128 v[100:103], v32 offset:33792
    s_waitcnt lgkmcnt(10)
    v_mfma_f32_32x32x16_bf16 v[144:159], a[116:119], v[120:123], v[144:159]
    ds_read_b128 v[104:107], v32 offset:34816
    v_mfma_f32_32x32x16_bf16 v[144:159], a[124:127], v[124:127], v[144:159]
    ds_read_b128 v[108:111], v32 offset:35840
    s_waitcnt lgkmcnt(10)
    v_mfma_f32_32x32x16_bf16 v[144:159], a[132:135], v[64:67], v[144:159]
    ds_read_b128 v[112:115], v32 offset:36864
    v_mfma_f32_32x32x16_bf16 v[144:159], a[140:143], v[68:71], v[144:159]
    ds_read_b128 v[116:119], v32 offset:37888
    s_waitcnt lgkmcnt(10)
    v_mfma_f32_32x32x16_bf16 v[144:159], a[148:151], v[72:75], v[144:159]
    ds_read_b128 v[120:123], v32 offset:38912
    v_mfma_f32_32x32x16_bf16 v[144:159], a[156:159], v[76:79], v[144:159]
    ds_read_b128 v[124:127], v32 offset:39936
    s_waitcnt lgkmcnt(10)
    v_mfma_f32_32x32x16_bf16 v[144:159], a[164:167], v[80:83], v[144:159]
    v_mfma_f32_32x32x16_bf16 v[144:159], a[172:175], v[84:87], v[144:159]
    s_waitcnt lgkmcnt(8)
    v_mfma_f32_32x32x16_bf16 v[144:159], a[180:183], v[88:91], v[144:159]
    v_mfma_f32_32x32x16_bf16 v[144:159], a[188:191], v[92:95], v[144:159]
    s_waitcnt lgkmcnt(6)
    v_mfma_f32_32x32x16_bf16 v[144:159], a[196:199], v[96:99], v[144:159]
    v_mfma_f32_32x32x16_bf16 v[144:159], a[204:207], v[100:103], v[144:159]
    s_waitcnt lgkmcnt(4)
    v_mfma_f32_32x32x16_bf16 v[144:159], a[212:215], v[104:107], v[144:159]
    v_mfma_f32_32x32x16_bf16 v[144:159], a[220:223], v[108:111], v[144:159]
    s_waitcnt lgkmcnt(2)
    v_mfma_f32_32x32x16_bf16 v[144:159], a[228:231], v[112:115], v[144:159]
    v_mfma_f32_32x32x16_bf16 v[144:159], a[236:239], v[116:119], v[144:159]
    s_waitcnt lgkmcnt(0)
    v_mfma_f32_32x32x16_bf16 v[144:159], a[244:247], v[120:123], v[144:159]
    v_mfma_f32_32x32x16_bf16 v[144:159], a[252:255], v[124:127], v[144:159]
G1f1_epi:
    s_nop 11
    v_cvt_pk_bf16_f32 v168, v144, v145
    v_pk_max_i16 v168, v168, 0
    v_cvt_pk_bf16_f32 v169, v146, v147
    v_pk_max_i16 v169, v169, 0
    v_cvt_pk_bf16_f32 v170, v148, v149
    v_pk_max_i16 v170, v170, 0
    v_cvt_pk_bf16_f32 v171, v150, v151
    v_pk_max_i16 v171, v171, 0
    buffer_store_dwordx4 v[168:171], v33, s[8:11], s57 offen offset:2048 sc1
    v_cvt_pk_bf16_f32 v172, v152, v153
    v_pk_max_i16 v172, v172, 0
    v_cvt_pk_bf16_f32 v173, v154, v155
    v_pk_max_i16 v173, v173, 0
    v_cvt_pk_bf16_f32 v174, v156, v157
    v_pk_max_i16 v174, v174, 0
    v_cvt_pk_bf16_f32 v175, v158, v159
    v_pk_max_i16 v175, v175, 0
    buffer_store_dwordx4 v[172:175], v33, s[8:11], s57 offen offset:3072 sc1
    s_add_u32 s57, s57, 114688
    s_add_u32 s55, s55, 1
    s_mov_b32 s61, 1
    s_cmp_eq_u32 s63, 0
    s_cbranch_scc1 G1f1_late
    buffer_load_dwordx4 v[4:7], v2, s[8:11], s58 offen sc1
    s_branch G1f1_top
G1f1_late:
    s_mov_b32 s61, 0
    s_waitcnt vmcnt(2)
    v_min3_u32 v4, v4, v5, v6
    v_min_u32 v4, v4, v7
    v_max_u32 v4, v4, v34
    s_nop 1
    v_min_u32_dpp v4, v4, v4 row_ror:1 row_mask:0xf bank_mask:0xf
    s_nop 1
    v_min_u32_dpp v4, v4, v4 row_ror:2 row_mask:0xf bank_mask:0xf
    s_nop 1
    v_min_u32_dpp v4, v4, v4 row_ror:4 row_mask:0xf bank_mask:0xf
    s_nop 1
    v_min_u32_dpp v4, v4, v4 row_ror:8 row_mask:0xf bank_mask:0xf
    s_nop 0
    v_readlane_b32 s70, v4, 0
    s_nop 0
    s_max_u32 s60, s60, s70
    s_min_u32 s60, s60, 64
    s_cmp_gt_u32 s60, s55
    s_cbranch_scc0 G1f1_idle
    s_add_u32 m0, s62, 0
    s_add_u32 s70, s56, 0
    buffer_load_dwordx4 v1, s[8:11], s70 offen sc1 lds
    s_add_u32 m0, s62, 4096
    s_add_u32 s70, s56, 4096
    buffer_load_dwordx4 v1, s[8:11], s70 offen sc1 lds
    s_add_u32 m0, s62, 8192
    s_add_u32 s70, s56, 8192
    buffer_load_dwordx4 v1, s[8:11], s70 offen sc1 lds
    s_add_u32 m0, s62, 12288
    s_add_u32 s70, s56, 12288
    buffer_load_dwordx4 v1, s[8:11], s70 offen sc1 lds
    s_add_u32 m0, s62, 16384
    s_add_u32 s70, s56, 16384
    buffer_load_dwordx4 v1, s[8:11], s70 offen sc1 lds
    s_add_u32 m0, s62, 20480
    s_add_u32 s70, s56, 20480
    buffer_load_dwordx4 v1, s[8:11], s70 offen sc1 lds
    s_add_u32 m0, s62, 24576
    s_add_u32 s70, s56, 24576
    buffer_load_dwordx4 v1, s[8:11], s70 offen sc1 lds
    s_add_u32 m0, s62, 28672
    s_add_u32 s70, s56, 28672
    buffer_load_dwordx4 v1, s[8:11], s70 offen sc1 lds
    s_add_u32 m0, s62, 32768
    s_add_u32 s70, s56, 32768
    buffer_load_dwordx4 v1, s[8:11], s70 offen sc1 lds
    s_add_u32 m0, s62, 36864
    s_add_u32 s70, s56, 36864
    buffer_load_dwordx4 v1, s[8:11], s70 offen sc1 lds
    s_add_u32 s56, s56, 40960
    s_mov_b32 s63, 1
    s_add_u32 s70, s62, 40960
    s_sub_u32 s71, s62, 40960
    s_cmp_ge_u32 s62, 40960
    s_cselect_b32 s62, s71, s70
    s_waitcnt vmcnt(10)
    v_mov_b32 v3, s55
    s_mov_b64 exec, 1
    s_cmp_lg_u32 s96, 0
    s_cbranch_scc1 loc_s_45
    buffer_store_dword v3, off, s[8:11], s59
    s_branch loc_e_46
loc_s_45:
    buffer_store_dword v3, off, s[8:11], s59 sc1
loc_e_46:
    s_mov_b64 exec, -1
    buffer_load_dwordx4 v[4:7], v2, s[8:11], s58 offen sc1
    s_branch G1f1_top
G1f1_idle:
    buffer_load_dwordx4 v[4:7], v2, s[8:11], s58 offen sc1
    s_waitcnt vmcnt(0)
    v_mov_b32 v3, s55
    s_mov_b64 exec, 1
    s_cmp_lg_u32 s96, 0
    s_cbranch_scc1 loc_s_47
    buffer_store_dword v3, off, s[8:11], s59
    s_branch loc_e_48
loc_s_47:
    buffer_store_dword v3, off, s[8:11], s59 sc1
loc_e_48:
    s_mov_b64 exec, -1
    v_min3_u32 v4, v4, v5, v6
    v_min_u32 v4, v4, v7
    v_max_u32 v4, v4, v34
    s_nop 1
    v_min_u32_dpp v4, v4, v4 row_ror:1 row_mask:0xf bank_mask:0xf
    s_nop 1
    v_min_u32_dpp v4, v4, v4 row_ror:2 row_mask:0xf bank_mask:0xf
    s_nop 1
    v_min_u32_dpp v4, v4, v4 row_ror:4 row_mask:0xf bank_mask:0xf
    s_nop 1
    v_min_u32_dpp v4, v4, v4 row_ror:8 row_mask:0xf bank_mask:0xf
    s_nop 0
    v_readlane_b32 s70, v4, 0
    s_nop 0
    s_max_u32 s60, s60, s70
    s_cmp_lt_u32 s55, 64
    s_cbranch_scc1 G1f1_fetch
    s_endpgm
G2op_entry:
    v_and_b32 v0, 63, v0
    v_lshlrev_b32 v1, 4, v0
    v_min_u32 v2, 0, v0
    v_lshlrev_b32 v2, 7, v2
    s_mov_b32 s55, 0
    s_mov_b32 s60, 0
    s_mov_b32 s61, 0
    s_mov_b32 s69, 0
    s_cmp_ge_u32 s53, 10
    s_cselect_b32 s65, 1, 0
    s_mul_i32 s71, s65, 10
    s_sub_u32 s66, s53, s71
    s_lshl_b32 s71, s65, 2
    s_add_u32 s71, s71, s52
    s_mul_i32 s64, s71, 655360
    s_lshl_b32 s72, s66, 7
    s_add_u32 s64, s64, s72
    s_mul_i32 s56, s54, 16777216
    s_lshl_b32 s72, s71, 15
    s_add_u32 s56, s56, s72
    s_add_u32 s56, s56, 117440512
    s_mul_i32 s58, s54, 8192
    s_lshl_b32 s72, s71, 7
    s_add_u32 s58, s58, s72
    s_add_u32 s58, s58, 49152
    v_lshrrev_b32 v11, 5, v0
    v_mul_u32_u24 v11, 16, v11
    v_bfe_u32 v12, v0, 3, 2
    v_add_u32 v11, v11, v12
    s_mov_b32 s70, 1280
    v_mul_lo_u32 v11, v11, s70
    v_bfe_u32 v12, v0, 4, 1
    v_lshlrev_b32 v12, 2, v12
    v_and_b32 v13, 7, v0
    v_xor_b32 v12, v12, v13
    v_lshl_add_u32 v11, v12, 4, v11
    v_add_u32 v8, s64, v11
    s_mul_i32 s62, s52, 40960
    v_lshrrev_b32 v11, 5, v0
    v_lshlrev_b32 v11, 10, v11
    v_bfe_u32 v12, v0, 2, 2
    v_lshl_add_u32 v11, v12, 7, v11
    v_bfe_u32 v12, v0, 3, 1
    v_lshl_add_u32 v11, v12, 6, v11
    v_bfe_u32 v12, v0, 4, 1
    v_lshl_add_u32 v11, v12, 5, v11
    v_and_b32 v12, 1, v0
    v_lshl_add_u32 v11, v12, 4, v11
    v_bfe_u32 v12, v0, 1, 1
    v_lshl_add_u32 v11, v12, 3, v11
    s_lshl_b32 s70, s52, 5
    v_xor_b32 v11, s70, v11
    v_add_u32 v9, s62, v11
    v_xor_b32 v10, 64, v9
    s_add_u32 m0, s62, 0
    s_mov_b32 s70, 0
    buffer_load_dwordx4 v8, s[24:27], s70 offen lds
    s_add_u32 m0, s62, 1024
    s_mov_b32 s70, 5120
    buffer_load_dwordx4 v8, s[24:27], s70 offen lds
    s_add_u32 m0, s62, 2048
    s_mov_b32 s70, 10240
    buffer_load_dwordx4 v8, s[24:27], s70 offen lds
    s_add_u32 m0, s62, 3072
    s_mov_b32 s70, 15360
    buffer_load_dwordx4 v8, s[24:27], s70 offen lds
    s_add_u32 m0, s62, 4096
    s_mov_b32 s70, 40960
    buffer_load_dwordx4 v8, s[24:27], s70 offen lds
    s_add_u32 m0, s62, 5120
    s_mov_b32 s70, 46080
    buffer_load_dwordx4 v8, s[24:27], s70 offen lds
    s_add_u32 m0, s62, 6144
    s_mov_b32 s70, 51200
    buffer_load_dwordx4 v8, s[24:27], s70 offen lds
    s_add_u32 m0, s62, 7168
    s_mov_b32 s70, 56320
    buffer_load_dwordx4 v8, s[24:27], s70 offen lds
    s_add_u32 m0, s62, 8192
    s_mov_b32 s70, 81920
    buffer_load_dwordx4 v8, s[24:27], s70 offen lds
    s_add_u32 m0, s62, 9216
    s_mov_b32 s70, 87040
    buffer_load_dwordx4 v8, s[24:27], s70 offen lds
    s_add_u32 m0, s62, 10240
    s_mov_b32 s70, 92160
    buffer_load_dwordx4 v8, s[24:27], s70 offen lds
    s_add_u32 m0, s62, 11264
    s_mov_b32 s70, 97280
    buffer_load_dwordx4 v8, s[24:27], s70 offen lds
    s_add_u32 m0, s62, 12288
    s_mov_b32 s70, 122880
    buffer_load_dwordx4 v8, s[24:27], s70 offen lds
    s_add_u32 m0, s62, 13312
    s_mov_b32 s70, 128000
    buffer_load_dwordx4 v8, s[24:27], s70 offen lds
    s_add_u32 m0, s62, 14336
    s_mov_b32 s70, 133120
    buffer_load_dwordx4 v8, s[24:27], s70 offen lds
    s_add_u32 m0, s62, 15360
    s_mov_b32 s70, 138240
    buffer_load_dwordx4 v8, s[24:27], s70 offen lds
    s_add_u32 m0, s62, 16384
    s_mov_b32 s70, 163840
    buffer_load_dwordx4 v8, s[24:27], s70 offen lds
    s_add_u32 m0, s62, 17408
    s_mov_b32 s70, 168960
    buffer_load_dwordx4 v8, s[24:27], s70 offen lds
    s_add_u32 m0, s62, 18432
    s_mov_b32 s70, 174080
    buffer_load_dwordx4 v8, s[24:27], s70 offen lds
    s_add_u32 m0, s62, 19456
    s_mov_b32 s70, 179200
    buffer_load_dwordx4 v8, s[24:27], s70 offen lds
    s_add_u32 m0, s62, 20480
    s_mov_b32 s70, 204800
    buffer_load_dwordx4 v8, s[24:27], s70 offen lds
    s_add_u32 m0, s62, 21504
    s_mov_b32 s70, 209920
    buffer_load_dwordx4 v8, s[24:27], s70 offen lds
    s_add_u32 m0, s62, 22528
    s_mov_b32 s70, 215040
    buffer_load_dwordx4 v8, s[24:27], s70 offen lds
    s_add_u32 m0, s62, 23552
    s_mov_b32 s70, 220160
    buffer_load_dwordx4 v8, s[24:27], s70 offen lds
    s_add_u32 m0, s62, 24576
    s_mov_b32 s70, 245760
    buffer_load_dwordx4 v8, s[24:27], s70 offen lds
    s_add_u32 m0, s62, 25600
    s_mov_b32 s70, 250880
    buffer_load_dwordx4 v8, s[24:27], s70 offen lds
    s_add_u32 m0, s62, 26624
    s_mov_b32 s70, 256000
    buffer_load_dwordx4 v8, s[24:27], s70 offen lds
    s_add_u32 m0, s62, 27648
    s_mov_b32 s70, 261120
    buffer_load_dwordx4 v8, s[24:27], s70 offen lds
    s_add_u32 m0, s62, 28672
    s_mov_b32 s70, 286720
    buffer_load_dwordx4 v8, s[24:27], s70 offen lds
    s_add_u32 m0, s62, 29696
    s_mov_b32 s70, 291840
    buffer_load_dwordx4 v8, s[24:27], s70 offen lds
    s_add_u32 m0, s62, 30720
    s_mov_b32 s70, 296960
    buffer_load_dwordx4 v8, s[24:27], s70 offen lds
    s_add_u32 m0, s62, 31744
    s_mov_b32 s70, 302080
    buffer_load_dwordx4 v8, s[24:27], s70 offen lds
    s_add_u32 m0, s62, 32768
    s_mov_b32 s70, 327680
    buffer_load_dwordx4 v8, s[24:27], s70 offen lds
    s_add_u32 m0, s62, 33792
    s_mov_b32 s70, 332800
    buffer_load_dwordx4 v8, s[24:27], s70 offen lds
    s_add_u32 m0, s62, 34816
    s_mov_b32 s70, 337920
    buffer_load_dwordx4 v8, s[24:27], s70 offen lds
    s_add_u32 m0, s62, 35840
    s_mov_b32 s70, 343040
    buffer_load_dwordx4 v8, s[24:27], s70 offen lds
    s_add_u32 m0, s62, 36864
    s_mov_b32 s70, 368640
    buffer_load_dwordx4 v8, s[24:27], s70 offen lds
    s_add_u32 m0, s62, 37888
    s_mov_b32 s70, 373760
    buffer_load_dwordx4 v8, s[24:27], s70 offen lds
    s_add_u32 m0, s62, 38912
    s_mov_b32 s70, 378880
    buffer_load_dwordx4 v8, s[24:27], s70 offen lds
    s_add_u32 m0, s62, 39936
    s_mov_b32 s70, 384000
    buffer_load_dwordx4 v8, s[24:27], s70 offen lds
    s_waitcnt vmcnt(38)
    ds_read_b64_tr_b16 a[0:1], v9 offset:0
    ds_read_b64_tr_b16 a[2:3], v9 offset:512
    ds_read_b64_tr_b16 a[4:5], v10 offset:0
    ds_read_b64_tr_b16 a[6:7], v10 offset:512
    s_waitcnt vmcnt(36)
    ds_read_b64_tr_b16 a[8:9], v9 offset:2048
    ds_read_b64_tr_b16 a[10:11], v9 offset:2560
    ds_read_b64_tr_b16 a[12:13], v10 offset:2048
    ds_read_b64_tr_b16 a[14:15], v10 offset:2560
    s_waitcnt lgkmcnt(4)
    s_add_u32 m0, s62, 0
    s_mov_b32 s70, 409600
    buffer_load_dwordx4 v8, s[24:27], s70 offen lds
    s_add_u32 m0, s62, 1024
    s_mov_b32 s70, 414720
    buffer_load_dwordx4 v8, s[24:27], s70 offen lds
    s_waitcnt vmcnt(36)
    ds_read_b64_tr_b16 a[16:17], v9 offset:4096
    ds_read_b64_tr_b16 a[18:19], v9 offset:4608
    ds_read_b64_tr_b16 a[20:21], v10 offset:4096
    ds_read_b64_tr_b16 a[22:23], v10 offset:4608
    s_waitcnt lgkmcnt(4)
    s_add_u32 m0, s62, 2048
    s_mov_b32 s70, 419840
    buffer_load_dwordx4 v8, s[24:27], s70 offen lds
    s_add_u32 m0, s62, 3072
    s_mov_b32 s70, 424960
    buffer_load_dwordx4 v8, s[24:27], s70 offen lds
    s_waitcnt vmcnt(36)
    ds_read_b64_tr_b16 a[24:25], v9 offset:6144
    ds_read_b64_tr_b16 a[26:27], v9 offset:6656
    ds_read_b64_tr_b16 a[28:29], v10 offset:6144
    ds_read_b64_tr_b16 a[30:31], v10 offset:6656
    s_waitcnt lgkmcnt(4)
    s_add_u32 m0, s62, 4096
    s_mov_b32 s70, 450560
    buffer_load_dwordx4 v8, s[24:27], s70 offen lds
    s_add_u32 m0, s62, 5120
    s_mov_b32 s70, 455680
    buffer_load_dwordx4 v8, s[24:27], s70 offen lds
    s_waitcnt vmcnt(36)
    ds_read_b64_tr_b16 a[32:33], v9 offset:8192
    ds_read_b64_tr_b16 a[34:35], v9 offset:8704
    ds_read_b64_tr_b16 a[36:37], v10 offset:8192
    ds_read_b64_tr_b16 a[38:39], v10 offset:8704
    s_waitcnt lgkmcnt(4)
    s_add_u32 m0, s62, 6144
    s_mov_b32 s70, 460800
    buffer_load_dwordx4 v8, s[24:27], s70 offen lds
    s_add_u32 m0, s62, 7168
    s_mov_b32 s70, 465920
    buffer_load_dwordx4 v8, s[24:27], s70 offen lds
    s_waitcnt vmcnt(36)
    ds_read_b64_tr_b16 a[40:41], v9 offset:10240
    ds_read_b64_tr_b16 a[42:43], v9 offset:10752
    ds_read_b64_tr_b16 a[44:45], v10 offset:10240
    ds_read_b64_tr_b16 a[46:47], v10 offset:10752
    s_waitcnt lgkmcnt(4)
    s_add_u32 m0, s62, 8192
    s_mov_b32 s70, 491520
    buffer_load_dwordx4 v8, s[24:27], s70 offen lds
    s_add_u32 m0, s62, 9216
    s_mov_b32 s70, 496640
    buffer_load_dwordx4 v8, s[24:27], s70 offen lds
    s_waitcnt vmcnt(36)
    ds_read_b64_tr_b16 a[48:49], v9 offset:12288
    ds_read_b64_tr_b16 a[50:51], v9 offset:12800
    ds_read_b64_tr_b16 a[52:53], v10 offset:12288
    ds_read_b64_tr_b16 a[54:55], v10 offset:12800
    s_waitcnt lgkmcnt(4)
    s_add_u32 m0, s62, 10240
    s_mov_b32 s70, 501760
    buffer_load_dwordx4 v8, s[24:27], s70 offen lds
    s_add_u32 m0, s62, 11264
    s_mov_b32 s70, 506880
    buffer_load_dwordx4 v8, s[24:27], s70 offen lds
    s_waitcnt vmcnt(36)
    ds_read_b64_tr_b16 a[56:57], v9 offset:14336
    ds_read_b64_tr_b16 a[58:59], v9 offset:14848
    ds_read_b64_tr_b16 a[60:61], v10 offset:14336
    ds_read_b64_tr_b16 a[62:63], v10 offset:14848
    s_waitcnt lgkmcnt(4)
    s_add_u32 m0, s62, 12288
    s_mov_b32 s70, 532480
    buffer_load_dwordx4 v8, s[24:27], s70 offen lds
    s_add_u32 m0, s62, 13312
    s_mov_b32 s70, 537600
    buffer_load_dwordx4 v8, s[24:27], s70 offen lds
    s_waitcnt vmcnt(36)
    ds_read_b64_tr_b16 a[64:65], v9 offset:16384
    ds_read_b64_tr_b16 a[66:67], v9 offset:16896
    ds_read_b64_tr_b16 a[68:69], v10 offset:16384
    ds_read_b64_tr_b16 a[70:71], v10 offset:16896
    s_waitcnt lgkmcnt(4)
    s_add_u32 m0, s62, 14336
    s_mov_b32 s70, 542720
    buffer_load_dwordx4 v8, s[24:27], s70 offen lds
    s_add_u32 m0, s62, 15360
    s_mov_b32 s70, 547840
    buffer_load_dwordx4 v8, s[24:27], s70 offen lds
    s_waitcnt vmcnt(36)
    ds_read_b64_tr_b16 a[72:73], v9 offset:18432
    ds_read_b64_tr_b16 a[74:75], v9 offset:18944
    ds_read_b64_tr_b16 a[76:77], v10 offset:18432
    ds_read_b64_tr_b16 a[78:79], v10 offset:18944
    s_waitcnt lgkmcnt(4)
    s_add_u32 m0, s62, 16384
    s_mov_b32 s70, 573440
    buffer_load_dwordx4 v8, s[24:27], s70 offen lds
    s_add_u32 m0, s62, 17408
    s_mov_b32 s70, 578560
    buffer_load_dwordx4 v8, s[24:27], s70 offen lds
    s_waitcnt vmcnt(36)
    ds_read_b64_tr_b16 a[80:81], v9 offset:20480
    ds_read_b64_tr_b16 a[82:83], v9 offset:20992
    ds_read_b64_tr_b16 a[84:85], v10 offset:20480
    ds_read_b64_tr_b16 a[86:87], v10 offset:20992
    s_waitcnt lgkmcnt(4)
    s_add_u32 m0, s62, 18432
    s_mov_b32 s70, 583680
    buffer_load_dwordx4 v8, s[24:27], s70 offen lds
    s_add_u32 m0, s62, 19456
    s_mov_b32 s70, 588800
    buffer_load_dwordx4 v8, s[24:27], s70 offen lds
    s_waitcnt vmcnt(36)
    ds_read_b64_tr_b16 a[88:89], v9 offset:22528
    ds_read_b64_tr_b16 a[90:91], v9 offset:23040
    ds_read_b64_tr_b16 a[92:93], v10 offset:22528
    ds_read_b64_tr_b16 a[94:95], v10 offset:23040
    s_waitcnt lgkmcnt(4)
    s_add_u32 m0, s62, 20480
    s_mov_b32 s70, 614400
    buffer_load_dwordx4 v8, s[24:27], s70 offen lds
    s_add_u32 m0, s62, 21504
    s_mov_b32 s70, 619520
    buffer_load_dwordx4 v8, s[24:27], s70 offen lds
    s_waitcnt vmcnt(36)
    ds_read_b64_tr_b16 a[96:97], v9 offset:24576
    ds_read_b64_tr_b16 a[98:99], v9 offset:25088
    ds_read_b64_tr_b16 a[100:101], v10 offset:24576
    ds_read_b64_tr_b16 a[102:103], v10 offset:25088
    s_waitcnt lgkmcnt(4)
    s_add_u32 m0, s62, 22528
    s_mov_b32 s70, 624640
    buffer_load_dwordx4 v8, s[24:27], s70 offen lds
    s_add_u32 m0, s62, 23552
    s_mov_b32 s70, 629760
    buffer_load_dwordx4 v8, s[24:27], s70 offen lds
    s_waitcnt vmcnt(36)
    ds_read_b64_tr_b16 a[104:105], v9 offset:26624
    ds_read_b64_tr_b16 a[106:107], v9 offset:27136
    ds_read_b64_tr_b16 a[108:109], v10 offset:26624
    ds_read_b64_tr_b16 a[110:111], v10 offset:27136
    s_waitcnt vmcnt(34)
    ds_read_b64_tr_b16 a[112:113], v9 offset:28672
    ds_read_b64_tr_b16 a[114:115], v9 offset:29184
    ds_read_b64_tr_b16 a[116:117], v10 offset:28672
    ds_read_b64_tr_b16 a[118:119], v10 offset:29184
    s_waitcnt vmcnt(32)
    ds_read_b64_tr_b16 a[120:121], v9 offset:30720
    ds_read_b64_tr_b16 a[122:123], v9 offset:31232
    ds_read_b64_tr_b16 a[124:125], v10 offset:30720
    ds_read_b64_tr_b16 a[126:127], v10 offset:31232
    s_waitcnt vmcnt(30)
    ds_read_b64_tr_b16 a[128:129], v9 offset:32768
    ds_read_b64_tr_b16 a[130:131], v9 offset:33280
    ds_read_b64_tr_b16 a[132:133], v10 offset:32768
    ds_read_b64_tr_b16 a[134:135], v10 offset:33280
    s_waitcnt vmcnt(28)
    ds_read_b64_tr_b16 a[136:137], v9 offset:34816
    ds_read_b64_tr_b16 a[138:139], v9 offset:35328
    ds_read_b64_tr_b16 a[140:141], v10 offset:34816
    ds_read_b64_tr_b16 a[142:143], v10 offset:35328
    s_waitcnt vmcnt(26)
    ds_read_b64_tr_b16 a[144:145], v9 offset:36864
    ds_read_b64_tr_b16 a[146:147], v9 offset:37376
    ds_read_b64_tr_b16 a[148:149], v10 offset:36864
    ds_read_b64_tr_b16 a[150:151], v10 offset:37376
    s_waitcnt vmcnt(24)
    ds_read_b64_tr_b16 a[152:153], v9 offset:38912
    ds_read_b64_tr_b16 a[154:155], v9 offset:39424
    ds_read_b64_tr_b16 a[156:157], v10 offset:38912
    ds_read_b64_tr_b16 a[158:159], v10 offset:39424
    s_waitcnt vmcnt(22)
    ds_read_b64_tr_b16 a[160:161], v9 offset:0
    ds_read_b64_tr_b16 a[162:163], v9 offset:512
    ds_read_b64_tr_b16 a[164:165], v10 offset:0
    ds_read_b64_tr_b16 a[166:167], v10 offset:512
    s_waitcnt vmcnt(20)
    ds_read_b64_tr_b16 a[168:169], v9 offset:2048
    ds_read_b64_tr_b16 a[170:171], v9 offset:2560
    ds_read_b64_tr_b16 a[172:173], v10 offset:2048
    ds_read_b64_tr_b16 a[174:175], v10 offset:2560
    s_waitcnt vmcnt(18)
    ds_read_b64_tr_b16 a[176:177], v9 offset:4096
    ds_read_b64_tr_b16 a[178:179], v9 offset:4608
    ds_read_b64_tr_b16 a[180:181], v10 offset:4096
    ds_read_b64_tr_b16 a[182:183], v10 offset:4608
    s_waitcnt vmcnt(16)
    ds_read_b64_tr_b16 a[184:185], v9 offset:6144
    ds_read_b64_tr_b16 a[186:187], v9 offset:6656
    ds_read_b64_tr_b16 a[188:189], v10 offset:6144
    ds_read_b64_tr_b16 a[190:191], v10 offset:6656
    s_waitcnt vmcnt(14)
    ds_read_b64_tr_b16 a[192:193], v9 offset:8192
    ds_read_b64_tr_b16 a[194:195], v9 offset:8704
    ds_read_b64_tr_b16 a[196:197], v10 offset:8192
    ds_read_b64_tr_b16 a[198:199], v10 offset:8704
    s_waitcnt vmcnt(12)
    ds_read_b64_tr_b16 a[200:201], v9 offset:10240
    ds_read_b64_tr_b16 a[202:203], v9 offset:10752
    ds_read_b64_tr_b16 a[204:205], v10 offset:10240
    ds_read_b64_tr_b16 a[206:207], v10 offset:10752
    s_waitcnt vmcnt(10)
    ds_read_b64_tr_b16 a[208:209], v9 offset:12288
    ds_read_b64_tr_b16 a[210:211], v9 offset:12800
    ds_read_b64_tr_b16 a[212:213], v10 offset:12288
    ds_read_b64_tr_b16 a[214:215], v10 offset:12800
    s_waitcnt vmcnt(8)
    ds_read_b64_tr_b16 a[216:217], v9 offset:14336
    ds_read_b64_tr_b16 a[218:219], v9 offset:14848
    ds_read_b64_tr_b16 a[220:221], v10 offset:14336
    ds_read_b64_tr_b16 a[222:223], v10 offset:14848
    s_waitcnt vmcnt(6)
    ds_read_b64_tr_b16 a[224:225], v9 offset:16384
    ds_read_b64_tr_b16 a[226:227], v9 offset:16896
    ds_read_b64_tr_b16 a[228:229], v10 offset:16384
    ds_read_b64_tr_b16 a[230:231], v10 offset:16896
    s_waitcnt vmcnt(4)
    ds_read_b64_tr_b16 a[232:233], v9 offset:18432
    ds_read_b64_tr_b16 a[234:235], v9 offset:18944
    ds_read_b64_tr_b16 a[236:237], v10 offset:18432
    ds_read_b64_tr_b16 a[238:239], v10 offset:18944
    s_waitcnt vmcnt(2)
    ds_read_b64_tr_b16 a[240:241], v9 offset:20480
    ds_read_b64_tr_b16 a[242:243], v9 offset:20992
    ds_read_b64_tr_b16 a[244:245], v10 offset:20480
    ds_read_b64_tr_b16 a[246:247], v10 offset:20992
    s_waitcnt vmcnt(0)
    ds_read_b64_tr_b16 a[248:249], v9 offset:22528
    ds_read_b64_tr_b16 a[250:251], v9 offset:23040
    ds_read_b64_tr_b16 a[252:253], v10 offset:22528
    ds_read_b64_tr_b16 a[254:255], v10 offset:23040
    s_waitcnt vmcnt(0) lgkmcnt(0)
    s_mul_i32 s57, s54, 5242880
    s_mul_i32 s72, s65, 40960
    s_add_u32 s57, s57, s72
    s_lshl_b32 s72, s66, 12
    s_add_u32 s57, s57, s72
    s_lshl_b32 s72, s52, 10
    s_add_u32 s57, s57, s72
    s_add_u32 s57, s57, 206438400
    s_mul_i32 s59, s54, 8192
    s_lshl_b32 s70, s53, 7
    s_add_u32 s59, s59, s70
    s_lshl_b32 s70, s52, 2
    s_add_u32 s59, s59, s70
    s_add_u32 s59, s59, 65536
    s_mul_i32 s72, s66, 26
    v_add_u32 v54, s72, v0
    v_lshlrev_b32 v53, 7, v54
    v_mov_b32 v55, 0x40000000
    v_cmp_gt_u32 vcc, 26, v0
    s_nop 1
    v_cndmask_b32 v53, v55, v53, vcc
    v_cmp_gt_u32 vcc, 256, v54
    s_nop 1
    v_cndmask_b32 v53, v55, v53, vcc
    s_xor_b32 s72, s52, 1
    s_lshl_b32 s72, s72, 13
    s_add_u32 s72, s72, 2048
    v_add_u32 v60, s72, v1
    s_xor_b32 s72, s52, 2
    s_lshl_b32 s72, s72, 13
    s_add_u32 s72, s72, 4096
    v_add_u32 v61, s72, v1
    s_xor_b32 s72, s52, 3
    s_lshl_b32 s72, s72, 13
    s_add_u32 s72, s72, 6144
    v_add_u32 v62, s72, v1
    s_lshl_b32 s72, s52, 13
    v_add_u32 v33, s72, v1
    s_cmp_lg_u32 s96, 0
    s_cbranch_scc1 RDY_ok_49
    s_mov_b32 s68, 0
RDY_lp_50:
    buffer_load_dword v40, off, s[48:51], 0 offset:32 sc1
    s_waitcnt vmcnt(0)
    v_readfirstlane_b32 s70, v40
    s_nop 0
    s_cmp_ge_u32 s70, 256
    s_cbranch_scc1 RDY_all_51
    s_sleep 8
    s_add_u32 s68, s68, 1
    s_cmp_lt_u32 s68, 65536
    s_cbranch_scc1 RDY_lp_50
    s_branch RDY_ok_49
RDY_all_51:
    v_mbcnt_lo_u32_b32 v41, -1, 0
    v_and_b32 v41, 7, v41
    v_min_u32 v42, 1, v41
    v_lshlrev_b32 v41, 2, v41
    v_lshl_add_u32 v41, v42, 7, v41
    buffer_load_dword v40, v41, s[48:51], 0 offen sc1
    s_waitcnt vmcnt(0)
    v_cmp_ne_u32 vcc, 32, v40
    s_nop 0
    s_cbranch_vccnz L_slow
RDY_ok_49:
    s_barrier
G2op_fetch:
    s_cmp_gt_u32 s60, s55
    s_cbranch_scc1 G2op_p_ok_52
    s_mov_b32 s68, 0
G2op_p_lp_53:
    buffer_load_dwordx4 v[4:7], v2, s[8:11], s58 offen sc1
    s_waitcnt vmcnt(0)
    v_min3_u32 v4, v4, v5, v6
    v_min_u32 v4, v4, v7
    s_nop 0
    v_readlane_b32 s70, v4, 0
    s_nop 0
    s_max_u32 s60, s60, s70
    s_cmp_gt_u32 s60, s55
    s_cbranch_scc1 G2op_p_ok_52
    s_cmp_lg_u32 s69, 0
    s_cbranch_scc1 G2op_p_ok_52
    s_sleep 2
    s_add_u32 s68, s68, 1
    s_cmp_lt_u32 s68, 65536
    s_cbranch_scc1 G2op_p_lp_53
    s_mov_b32 s69, 1
G2op_p_ok_52:
    s_add_u32 s73, s56, 0
    buffer_load_dwordx4 v[64:67], v1, s[8:11], s73 offen offset:0 sc1
    buffer_load_dwordx4 v[68:71], v1, s[8:11], s73 offen offset:1024 sc1
    buffer_load_dwordx4 v[72:75], v1, s[8:11], s73 offen offset:2048 sc1
    buffer_load_dwordx4 v[76:79], v1, s[8:11], s73 offen offset:3072 sc1
    s_add_u32 s73, s56, 4096
    buffer_load_dwordx4 v[80:83], v1, s[8:11], s73 offen offset:0 sc1
    buffer_load_dwordx4 v[84:87], v1, s[8:11], s73 offen offset:1024 sc1
    buffer_load_dwordx4 v[88:91], v1, s[8:11], s73 offen offset:2048 sc1
    buffer_load_dwordx4 v[92:95], v1, s[8:11], s73 offen offset:3072 sc1
    s_add_u32 s73, s56, 8192
    buffer_load_dwordx4 v[96:99], v1, s[8:11], s73 offen offset:0 sc1
    buffer_load_dwordx4 v[100:103], v1, s[8:11], s73 offen offset:1024 sc1
G2op_top:
    s_add_u32 s73, s56, 8192
    s_waitcnt vmcnt(9)
    v_mfma_f32_32x32x16_bf16 v[192:207], a[0:3], v[64:67], 0
    v_mfma_f32_32x32x16_bf16 v[208:223], a[4:7], v[64:67], 0
    buffer_load_dwordx4 v[104:107], v1, s[8:11], s73 offen offset:2048 sc1
    s_waitcnt vmcnt(9)
    v_mfma_f32_32x32x16_bf16 v[192:207], a[8:11], v[68:71], v[192:207]
    v_mfma_f32_32x32x16_bf16 v[208:223], a[12:15], v[68:71], v[208:223]
    buffer_load_dwordx4 v[108:111], v1, s[8:11], s73 offen offset:3072 sc1
    s_waitcnt vmcnt(9)
    v_mfma_f32_32x32x16_bf16 v[192:207], a[16:19], v[72:75], v[192:207]
    v_mfma_f32_32x32x16_bf16 v[208:223], a[20:23], v[72:75], v[208:223]
    s_add_u32 s73, s56, 12288
    buffer_load_dwordx4 v[112:115], v1, s[8:11], s73 offen offset:0 sc1
    s_waitcnt vmcnt(9)
    v_mfma_f32_32x32x16_bf16 v[192:207], a[24:27], v[76:79], v[192:207]
    v_mfma_f32_32x32x16_bf16 v[208:223], a[28:31], v[76:79], v[208:223]
    buffer_load_dwordx4 v[116:119], v1, s[8:11], s73 offen offset:1024 sc1
    s_waitcnt vmcnt(9)
    v_mfma_f32_32x32x16_bf16 v[192:207], a[32:35], v[80:83], v[192:207]
    v_mfma_f32_32x32x16_bf16 v[208:223], a[36:39], v[80:83], v[208:223]
    buffer_load_dwordx4 v[120:123], v1, s[8:11], s73 offen offset:2048 sc1
    s_waitcnt vmcnt(9)
    v_mfma_f32_32x32x16_bf16 v[192:207], a[40:43], v[84:87], v[192:207]
    v_mfma_f32_32x32x16_bf16 v[208:223], a[44:47], v[84:87], v[208:223]
    buffer_load_dwordx4 v[124:127], v1, s[8:11], s73 offen offset:3072 sc1
    s_waitcnt vmcnt(9)
    v_mfma_f32_32x32x16_bf16 v[192:207], a[48:51], v[88:91], v[192:207]
    v_mfma_f32_32x32x16_bf16 v[208:223], a[52:55], v[88:91], v[208:223]
    s_add_u32 s73, s56, 16384
    buffer_load_dwordx4 v[128:131], v1, s[8:11], s73 offen offset:0 sc1
    s_waitcnt vmcnt(9)
    v_mfma_f32_32x32x16_bf16 v[192:207], a[56:59], v[92:95], v[192:207]
    v_mfma_f32_32x32x16_bf16 v[208:223], a[60:63], v[92:95], v[208:223]
    buffer_load_dwordx4 v[132:135], v1, s[8:11], s73 offen offset:1024 sc1
    s_waitcnt vmcnt(9)
    v_mfma_f32_32x32x16_bf16 v[192:207], a[64:67], v[96:99], v[192:207]
    v_mfma_f32_32x32x16_bf16 v[208:223], a[68:71], v[96:99], v[208:223]
    buffer_load_dwordx4 v[136:139], v1, s[8:11], s73 offen offset:2048 sc1
    s_waitcnt vmcnt(9)
    v_mfma_f32_32x32x16_bf16 v[192:207], a[72:75], v[100:103], v[192:207]
    v_mfma_f32_32x32x16_bf16 v[208:223], a[76:79], v[100:103], v[208:223]
    buffer_load_dwordx4 v[140:143], v1, s[8:11], s73 offen offset:3072 sc1
    s_waitcnt vmcnt(9)
    v_mfma_f32_32x32x16_bf16 v[192:207], a[80:83], v[104:107], v[192:207]
    v_mfma_f32_32x32x16_bf16 v[208:223], a[84:87], v[104:107], v[208:223]
    s_cmp_eq_u32 s61, 0
    s_cbranch_scc1 G2op_nop_54
    v_mov_b32 v3, s55
    s_mov_b64 exec, 1
    s_cmp_lg_u32 s96, 0
    s_cbranch_scc1 loc_s_55
    buffer_store_dword v3, off, s[8:11], s59
    s_branch loc_e_56
loc_s_55:
    buffer_store_dword v3, off, s[8:11], s59 sc1
loc_e_56:
    s_mov_b64 exec, -1
    s_mov_b32 s61, 0
G2op_nop_54:
    s_add_u32 s73, s56, 20480
    buffer_load_dwordx4 v[144:147], v1, s[8:11], s73 offen offset:0 sc1
    s_waitcnt vmcnt(9)
    v_mfma_f32_32x32x16_bf16 v[192:207], a[88:91], v[108:111], v[192:207]
    v_mfma_f32_32x32x16_bf16 v[208:223], a[92:95], v[108:111], v[208:223]
    buffer_load_dwordx4 v[148:151], v1, s[8:11], s73 offen offset:1024 sc1
    s_waitcnt vmcnt(9)
    v_mfma_f32_32x32x16_bf16 v[192:207], a[96:99], v[112:115], v[192:207]
    v_mfma_f32_32x32x16_bf16 v[208:223], a[100:103], v[112:115], v[208:223]
    buffer_load_dwordx4 v[4:7], v2, s[8:11], s58 offen sc1
    buffer_load_dwordx4 v[152:155], v1, s[8:11], s73 offen offset:2048 sc1
    s_waitcnt vmcnt(9)
    v_mfma_f32_32x32x16_bf16 v[192:207], a[104:107], v[116:119], v[192:207]
    v_mfma_f32_32x32x16_bf16 v[208:223], a[108:111], v[116:119], v[208:223]
    buffer_load_dwordx4 v[156:159], v1, s[8:11], s73 offen offset:3072 sc1
    s_waitcnt vmcnt(9)
    v_mfma_f32_32x32x16_bf16 v[192:207], a[112:115], v[120:123], v[192:207]
    v_mfma_f32_32x32x16_bf16 v[208:223], a[116:119], v[120:123], v[208:223]
    s_add_u32 s73, s56, 24576
    buffer_load_dwordx4 v[160:163], v1, s[8:11], s73 offen offset:0 sc1
    s_waitcnt vmcnt(9)
    v_mfma_f32_32x32x16_bf16 v[192:207], a[120:123], v[124:127], v[192:207]
    v_mfma_f32_32x32x16_bf16 v[208:223], a[124:127], v[124:127], v[208:223]
    buffer_load_dwordx4 v[164:167], v1, s[8:11], s73 offen offset:1024 sc1
    s_waitcnt vmcnt(9)
    v_mfma_f32_32x32x16_bf16 v[192:207], a[128:131], v[128:131], v[192:207]
    v_mfma_f32_32x32x16_bf16 v[208:223], a[132:135], v[128:131], v[208:223]
    buffer_load_dwordx4 v[168:171], v1, s[8:11], s73 offen offset:2048 sc1
    s_waitcnt vmcnt(9)
    v_mfma_f32_32x32x16_bf16 v[192:207], a[136:139], v[132:135], v[192:207]
    v_mfma_f32_32x32x16_bf16 v[208:223], a[140:143], v[132:135], v[208:223]
    buffer_load_dwordx4 v[172:175], v1, s[8:11], s73 offen offset:3072 sc1
    s_waitcnt vmcnt(9)
    v_mfma_f32_32x32x16_bf16 v[192:207], a[144:147], v[136:139], v[192:207]
    v_mfma_f32_32x32x16_bf16 v[208:223], a[148:151], v[136:139], v[208:223]
    s_add_u32 s73, s56, 28672
    buffer_load_dwordx4 v[176:179], v1, s[8:11], s73 offen offset:0 sc1
    s_waitcnt vmcnt(9)
    v_mfma_f32_32x32x16_bf16 v[192:207], a[152:155], v[140:143], v[192:207]
    v_mfma_f32_32x32x16_bf16 v[208:223], a[156:159], v[140:143], v[208:223]
    buffer_load_dwordx4 v[180:183], v1, s[8:11], s73 offen offset:1024 sc1
    s_waitcnt vmcnt(9)
    v_mfma_f32_32x32x16_bf16 v[192:207], a[160:163], v[144:147], v[192:207]
    v_mfma_f32_32x32x16_bf16 v[208:223], a[164:167], v[144:147], v[208:223]
    buffer_load_dwordx4 v[184:187], v1, s[8:11], s73 offen offset:2048 sc1
    s_waitcnt vmcnt(9)
    v_mfma_f32_32x32x16_bf16 v[192:207], a[168:171], v[148:151], v[192:207]
    v_mfma_f32_32x32x16_bf16 v[208:223], a[172:175], v[148:151], v[208:223]
    buffer_load_dwordx4 v[188:191], v1, s[8:11], s73 offen offset:3072 sc1
    s_waitcnt vmcnt(9)
    v_mfma_f32_32x32x16_bf16 v[192:207], a[176:179], v[152:155], v[192:207]
    v_mfma_f32_32x32x16_bf16 v[208:223], a[180:183], v[152:155], v[208:223]
    v_min3_u32 v4, v4, v5, v6
    v_min_u32 v4, v4, v7
    s_nop 0
    v_readlane_b32 s70, v4, 0
    s_nop 0
    s_max_u32 s60, s60, s70
    s_add_u32 s56, s56, 262144
    s_add_u32 s72, s55, 1
    s_cmp_gt_u32 s60, s72
    s_cselect_b32 s63, 1, 0
    s_cbranch_scc1 G2op_pf
    buffer_load_dwordx4 v[4:7], v2, s[8:11], s58 offen sc1
    s_waitcnt vmcnt(9)
    v_mfma_f32_32x32x16_bf16 v[192:207], a[184:187], v[156:159], v[192:207]
    v_mfma_f32_32x32x16_bf16 v[208:223], a[188:191], v[156:159], v[208:223]
    s_waitcnt vmcnt(8)
    v_mfma_f32_32x32x16_bf16 v[192:207], a[192:195], v[160:163], v[192:207]
    v_mfma_f32_32x32x16_bf16 v[208:223], a[196:199], v[160:163], v[208:223]
    s_waitcnt vmcnt(7)
    v_mfma_f32_32x32x16_bf16 v[192:207], a[200:203], v[164:167], v[192:207]
    v_mfma_f32_32x32x16_bf16 v[208:223], a[204:207], v[164:167], v[208:223]
    s_waitcnt vmcnt(6)
    v_mfma_f32_32x32x16_bf16 v[192:207], a[208:211], v[168:171], v[192:207]
    v_mfma_f32_32x32x16_bf16 v[208:223], a[212:215], v[168:171], v[208:223]
    s_waitcnt vmcnt(5)
    v_mfma_f32_32x32x16_bf16 v[192:207], a[216:219], v[172:175], v[192:207]
    v_mfma_f32_32x32x16_bf16 v[208:223], a[220:223], v[172:175], v[208:223]
    s_waitcnt vmcnt(4)
    v_mfma_f32_32x32x16_bf16 v[192:207], a[224:227], v[176:179], v[192:207]
    v_mfma_f32_32x32x16_bf16 v[208:223], a[228:231], v[176:179], v[208:223]
    s_waitcnt vmcnt(3)
    v_mfma_f32_32x32x16_bf16 v[192:207], a[232:235], v[180:183], v[192:207]
    v_mfma_f32_32x32x16_bf16 v[208:223], a[236:239], v[180:183], v[208:223]
    s_waitcnt vmcnt(2)
    v_mfma_f32_32x32x16_bf16 v[192:207], a[240:243], v[184:187], v[192:207]
    v_mfma_f32_32x32x16_bf16 v[208:223], a[244:247], v[184:187], v[208:223]
    s_waitcnt vmcnt(1)
    v_mfma_f32_32x32x16_bf16 v[192:207], a[248:251], v[188:191], v[192:207]
    v_mfma_f32_32x32x16_bf16 v[208:223], a[252:255], v[188:191], v[208:223]
    s_branch G2op_red
G2op_pf:
    s_add_u32 s73, s56, 0
    buffer_load_dwordx4 v[64:67], v1, s[8:11], s73 offen offset:0 sc1
    s_waitcnt vmcnt(9)
    v_mfma_f32_32x32x16_bf16 v[192:207], a[184:187], v[156:159], v[192:207]
    v_mfma_f32_32x32x16_bf16 v[208:223], a[188:191], v[156:159], v[208:223]
    buffer_load_dwordx4 v[68:71], v1, s[8:11], s73 offen offset:1024 sc1
    s_waitcnt vmcnt(9)
    v_mfma_f32_32x32x16_bf16 v[192:207], a[192:195], v[160:163], v[192:207]
    v_mfma_f32_32x32x16_bf16 v[208:223], a[196:199], v[160:163], v[208:223]
    buffer_load_dwordx4 v[72:75], v1, s[8:11], s73 offen offset:2048 sc1
    s_waitcnt vmcnt(9)
    v_mfma_f32_32x32x16_bf16 v[192:207], a[200:203], v[164:167], v[192:207]
    v_mfma_f32_32x32x16_bf16 v[208:223], a[204:207], v[164:167], v[208:223]
    buffer_load_dwordx4 v[76:79], v1, s[8:11], s73 offen offset:3072 sc1
    s_waitcnt vmcnt(9)
    v_mfma_f32_32x32x16_bf16 v[192:207], a[208:211], v[168:171], v[192:207]
    v_mfma_f32_32x32x16_bf16 v[208:223], a[212:215], v[168:171], v[208:223]
    s_add_u32 s73, s56, 4096
    buffer_load_dwordx4 v[80:83], v1, s[8:11], s73 offen offset:0 sc1
    s_waitcnt vmcnt(9)
    v_mfma_f32_32x32x16_bf16 v[192:207], a[216:219], v[172:175], v[192:207]
    v_mfma_f32_32x32x16_bf16 v[208:223], a[220:223], v[172:175], v[208:223]
    buffer_load_dwordx4 v[84:87], v1, s[8:11], s73 offen offset:1024 sc1
    s_waitcnt vmcnt(9)
    v_mfma_f32_32x32x16_bf16 v[192:207], a[224:227], v[176:179], v[192:207]
    v_mfma_f32_32x32x16_bf16 v[208:223], a[228:231], v[176:179], v[208:223]
    buffer_load_dwordx4 v[88:91], v1, s[8:11], s73 offen offset:2048 sc1
    s_waitcnt vmcnt(9)
    v_mfma_f32_32x32x16_bf16 v[192:207], a[232:235], v[180:183], v[192:207]
    v_mfma_f32_32x32x16_bf16 v[208:223], a[236:239], v[180:183], v[208:223]
    buffer_load_dwordx4 v[92:95], v1, s[8:11], s73 offen offset:3072 sc1
    s_waitcnt vmcnt(9)
    v_mfma_f32_32x32x16_bf16 v[192:207], a[240:243], v[184:187], v[192:207]
    v_mfma_f32_32x32x16_bf16 v[208:223], a[244:247], v[184:187], v[208:223]
    s_add_u32 s73, s56, 8192
    buffer_load_dwordx4 v[96:99], v1, s[8:11], s73 offen offset:0 sc1
    s_waitcnt vmcnt(9)
    v_mfma_f32_32x32x16_bf16 v[192:207], a[248:251], v[188:191], v[192:207]
    v_mfma_f32_32x32x16_bf16 v[208:223], a[252:255], v[188:191], v[208:223]
    buffer_load_dwordx4 v[100:103], v1, s[8:11], s73 offen offset:1024 sc1
G2op_red:
    s_nop 9
    ds_write_b128 v60, v[200:203]
    ds_write_b128 v60, v[204:207] offset:1024
    ds_write_b128 v61, v[208:211]
    ds_write_b128 v61, v[212:215] offset:1024
    ds_write_b128 v62, v[216:219]
    ds_write_b128 v62, v[220:223] offset:1024
    v_xor_b32 v60, 32768, v60
    v_xor_b32 v61, 32768, v61
    v_xor_b32 v62, 32768, v62
    s_waitcnt lgkmcnt(0)
    s_barrier
    ds_read_b128 v[224:227], v33 offset:2048
    ds_read_b128 v[228:231], v33 offset:3072
    ds_read_b128 v[232:235], v33 offset:4096
    ds_read_b128 v[236:239], v33 offset:5120
    ds_read_b128 v[240:243], v33 offset:6144
    ds_read_b128 v[244:247], v33 offset:7168
    v_xor_b32 v33, 32768, v33
    s_waitcnt lgkmcnt(4)
    v_pk_add_f32 v[248:249], v[192:193], v[224:225]
    v_pk_add_f32 v[250:251], v[194:195], v[226:227]
    v_pk_add_f32 v[252:253], v[196:197], v[228:229]
    v_pk_add_f32 v[254:255], v[198:199], v[230:231]
    s_waitcnt lgkmcnt(0)
    v_pk_add_f32 v[232:233], v[232:233], v[240:241]
    v_pk_add_f32 v[234:235], v[234:235], v[242:243]
    v_pk_add_f32 v[236:237], v[236:237], v[244:245]
    v_pk_add_f32 v[238:239], v[238:239], v[246:247]
    v_pk_add_f32 v[248:249], v[248:249], v[232:233]
    v_pk_add_f32 v[250:251], v[250:251], v[234:235]
    v_pk_add_f32 v[252:253], v[252:253], v[236:237]
    v_pk_add_f32 v[254:255], v[254:255], v[238:239]
    v_cvt_pk_bf16_f32 v224, v248, v249
    v_cvt_pk_bf16_f32 v225, v250, v251
    v_cvt_pk_bf16_f32 v226, v252, v253
    v_cvt_pk_bf16_f32 v227, v254, v255
    buffer_store_dwordx4 v[224:227], v1, s[8:11], s57 offen sc1
    s_add_u32 s57, s57, 81920
    s_add_u32 s55, s55, 1
    s_mov_b32 s61, 1
    s_cmp_lg_u32 s63, 0
    s_cbranch_scc1 G2op_top
    s_waitcnt vmcnt(1)
    v_min3_u32 v4, v4, v5, v6
    v_min_u32 v4, v4, v7
    s_nop 0
    v_readlane_b32 s70, v4, 0
    s_nop 0
    s_max_u32 s60, s60, s70
    s_cmp_gt_u32 s60, s55
    s_cbranch_scc0 G2op_idle
    s_add_u32 s73, s56, 0
    buffer_load_dwordx4 v[64:67], v1, s[8:11], s73 offen offset:0 sc1
    buffer_load_dwordx4 v[68:71], v1, s[8:11], s73 offen offset:1024 sc1
    buffer_load_dwordx4 v[72:75], v1, s[8:11], s73 offen offset:2048 sc1
    buffer_load_dwordx4 v[76:79], v1, s[8:11], s73 offen offset:3072 sc1
    s_add_u32 s73, s56, 4096
    buffer_load_dwordx4 v[80:83], v1, s[8:11], s73 offen offset:0 sc1
    buffer_load_dwordx4 v[84:87], v1, s[8:11], s73 offen offset:1024 sc1
    buffer_load_dwordx4 v[88:91], v1, s[8:11], s73 offen offset:2048 sc1
    buffer_load_dwordx4 v[92:95], v1, s[8:11], s73 offen offset:3072 sc1
    s_add_u32 s73, s56, 8192
    buffer_load_dwordx4 v[96:99], v1, s[8:11], s73 offen offset:0 sc1
    buffer_load_dwordx4 v[100:103], v1, s[8:11], s73 offen offset:1024 sc1
    s_waitcnt vmcnt(10)
    v_mov_b32 v3, s55
    s_mov_b64 exec, 1
    s_cmp_lg_u32 s96, 0
    s_cbranch_scc1 loc_s_57
    buffer_store_dword v3, off, s[8:11], s59
    s_branch loc_e_58
loc_s_57:
    buffer_store_dword v3, off, s[8:11], s59 sc1
loc_e_58:
    s_mov_b64 exec, -1
    s_mov_b32 s61, 0
    s_branch G2op_top
G2op_idle:
    buffer_load_dwordx4 v[4:7], v2, s[8:11], s58 offen sc1
    s_waitcnt vmcnt(0)
    v_mov_b32 v3, s55
    s_mov_b64 exec, 1
    s_cmp_lg_u32 s96, 0
    s_cbranch_scc1 loc_s_59
    buffer_store_dword v3, off, s[8:11], s59
    s_branch loc_e_60
loc_s_59:
    buffer_store_dword v3, off, s[8:11], s59 sc1
loc_e_60:
    s_mov_b64 exec, -1
    v_min3_u32 v4, v4, v5, v6
    v_min_u32 v4, v4, v7
    s_nop 0
    v_readlane_b32 s70, v4, 0
    s_nop 0
    s_max_u32 s60, s60, s70
    s_mov_b32 s61, 0
    s_cmp_lt_u32 s55, 64
    s_cbranch_scc1 G2op_fetch
    s_endpgm
G2f2_entry:
    v_and_b32 v0, 63, v0
    v_lshlrev_b32 v1, 4, v0
    v_min_u32 v2, 6, v0
    v_lshlrev_b32 v2, 7, v2
    s_mov_b32 s55, 0
    s_mov_b32 s60, 0
    s_mov_b32 s61, 0
    s_mov_b32 s69, 0
    s_mul_i32 s64, s52, 552960
    s_lshl_b32 s72, s53, 7
    s_add_u32 s64, s64, s72
    s_mul_i32 s56, s54, 7340032
    s_mul_i32 s72, s52, 27648
    s_add_u32 s56, s56, s72
    s_add_u32 s56, s56, 191758336
    s_mul_i32 s58, s54, 8192
    s_add_u32 s58, s58, 98304
    v_lshrrev_b32 v11, 5, v0
    v_mul_u32_u24 v11, 8, v11
    v_bfe_u32 v12, v0, 3, 2
    v_add_u32 v11, v11, v12
    s_mov_b32 s70, 1280
    v_mul_lo_u32 v11, v11, s70
    v_bfe_u32 v12, v0, 4, 1
    v_lshlrev_b32 v12, 2, v12
    v_and_b32 v13, 7, v0
    v_xor_b32 v12, v12, v13
    v_lshl_add_u32 v11, v12, 4, v11
    v_add_u32 v8, s64, v11
    s_mul_i32 s62, s52, 40960
    v_lshrrev_b32 v11, 5, v0
    v_lshlrev_b32 v11, 10, v11
    v_bfe_u32 v12, v0, 2, 2
    v_lshl_add_u32 v11, v12, 7, v11
    v_bfe_u32 v12, v0, 3, 1
    v_lshl_add_u32 v11, v12, 6, v11
    v_bfe_u32 v12, v0, 4, 1
    v_lshl_add_u32 v11, v12, 5, v11
    v_and_b32 v12, 1, v0
    v_lshl_add_u32 v11, v12, 4, v11
    v_bfe_u32 v12, v0, 1, 1
    v_lshl_add_u32 v11, v12, 3, v11
    s_lshl_b32 s70, s52, 5
    v_xor_b32 v11, s70, v11
    v_add_u32 v9, s62, v11
    v_xor_b32 v10, 64, v9
    s_add_u32 m0, s62, 0
    s_mov_b32 s70, 0
    buffer_load_dwordx4 v8, s[40:43], s70 offen lds
    s_add_u32 m0, s62, 1024
    s_mov_b32 s70, 5120
    buffer_load_dwordx4 v8, s[40:43], s70 offen lds
    s_add_u32 m0, s62, 2048
    s_mov_b32 s70, 20480
    buffer_load_dwordx4 v8, s[40:43], s70 offen lds
    s_add_u32 m0, s62, 3072
    s_mov_b32 s70, 25600
    buffer_load_dwordx4 v8, s[40:43], s70 offen lds
    s_add_u32 m0, s62, 4096
    s_mov_b32 s70, 40960
    buffer_load_dwordx4 v8, s[40:43], s70 offen lds
    s_add_u32 m0, s62, 5120
    s_mov_b32 s70, 46080
    buffer_load_dwordx4 v8, s[40:43], s70 offen lds
    s_add_u32 m0, s62, 6144
    s_mov_b32 s70, 61440
    buffer_load_dwordx4 v8, s[40:43], s70 offen lds
    s_add_u32 m0, s62, 7168
    s_mov_b32 s70, 66560
    buffer_load_dwordx4 v8, s[40:43], s70 offen lds
    s_add_u32 m0, s62, 8192
    s_mov_b32 s70, 81920
    buffer_load_dwordx4 v8, s[40:43], s70 offen lds
    s_add_u32 m0, s62, 9216
    s_mov_b32 s70, 87040
    buffer_load_dwordx4 v8, s[40:43], s70 offen lds
    s_add_u32 m0, s62, 10240
    s_mov_b32 s70, 102400
    buffer_load_dwordx4 v8, s[40:43], s70 offen lds
    s_add_u32 m0, s62, 11264
    s_mov_b32 s70, 107520
    buffer_load_dwordx4 v8, s[40:43], s70 offen lds
    s_add_u32 m0, s62, 12288
    s_mov_b32 s70, 122880
    buffer_load_dwordx4 v8, s[40:43], s70 offen lds
    s_add_u32 m0, s62, 13312
    s_mov_b32 s70, 128000
    buffer_load_dwordx4 v8, s[40:43], s70 offen lds
    s_add_u32 m0, s62, 14336
    s_mov_b32 s70, 143360
    buffer_load_dwordx4 v8, s[40:43], s70 offen lds
    s_add_u32 m0, s62, 15360
    s_mov_b32 s70, 148480
    buffer_load_dwordx4 v8, s[40:43], s70 offen lds
    s_add_u32 m0, s62, 16384
    s_mov_b32 s70, 163840
    buffer_load_dwordx4 v8, s[40:43], s70 offen lds
    s_add_u32 m0, s62, 17408
    s_mov_b32 s70, 168960
    buffer_load_dwordx4 v8, s[40:43], s70 offen lds
    s_add_u32 m0, s62, 18432
    s_mov_b32 s70, 184320
    buffer_load_dwordx4 v8, s[40:43], s70 offen lds
    s_add_u32 m0, s62, 19456
    s_mov_b32 s70, 189440
    buffer_load_dwordx4 v8, s[40:43], s70 offen lds
    s_add_u32 m0, s62, 20480
    s_mov_b32 s70, 204800
    buffer_load_dwordx4 v8, s[40:43], s70 offen lds
    s_add_u32 m0, s62, 21504
    s_mov_b32 s70, 209920
    buffer_load_dwordx4 v8, s[40:43], s70 offen lds
    s_add_u32 m0, s62, 22528
    s_mov_b32 s70, 225280
    buffer_load_dwordx4 v8, s[40:43], s70 offen lds
    s_add_u32 m0, s62, 23552
    s_mov_b32 s70, 230400
    buffer_load_dwordx4 v8, s[40:43], s70 offen lds
    s_add_u32 m0, s62, 24576
    s_mov_b32 s70, 245760
    buffer_load_dwordx4 v8, s[40:43], s70 offen lds
    s_add_u32 m0, s62, 25600
    s_mov_b32 s70, 250880
    buffer_load_dwordx4 v8, s[40:43], s70 offen lds
    s_add_u32 m0, s62, 26624
    s_mov_b32 s70, 266240
    buffer_load_dwordx4 v8, s[40:43], s70 offen lds
    s_add_u32 m0, s62, 27648
    s_mov_b32 s70, 271360
    buffer_load_dwordx4 v8, s[40:43], s70 offen lds
    s_add_u32 m0, s62, 28672
    s_mov_b32 s70, 286720
    buffer_load_dwordx4 v8, s[40:43], s70 offen lds
    s_add_u32 m0, s62, 29696
    s_mov_b32 s70, 291840
    buffer_load_dwordx4 v8, s[40:43], s70 offen lds
    s_add_u32 m0, s62, 30720
    s_mov_b32 s70, 307200
    buffer_load_dwordx4 v8, s[40:43], s70 offen lds
    s_add_u32 m0, s62, 31744
    s_mov_b32 s70, 312320
    buffer_load_dwordx4 v8, s[40:43], s70 offen lds
    s_add_u32 m0, s62, 32768
    s_mov_b32 s70, 327680
    buffer_load_dwordx4 v8, s[40:43], s70 offen lds
    s_add_u32 m0, s62, 33792
    s_mov_b32 s70, 332800
    buffer_load_dwordx4 v8, s[40:43], s70 offen lds
    s_add_u32 m0, s62, 34816
    s_mov_b32 s70, 348160
    buffer_load_dwordx4 v8, s[40:43], s70 offen lds
    s_add_u32 m0, s62, 35840
    s_mov_b32 s70, 353280
    buffer_load_dwordx4 v8, s[40:43], s70 offen lds
    s_add_u32 m0, s62, 36864
    s_mov_b32 s70, 368640
    buffer_load_dwordx4 v8, s[40:43], s70 offen lds
    s_add_u32 m0, s62, 37888
    s_mov_b32 s70, 373760
    buffer_load_dwordx4 v8, s[40:43], s70 offen lds
    s_add_u32 m0, s62, 38912
    s_mov_b32 s70, 389120
    buffer_load_dwordx4 v8, s[40:43], s70 offen lds
    s_add_u32 m0, s62, 39936
    s_mov_b32 s70, 394240
    buffer_load_dwordx4 v8, s[40:43], s70 offen lds
    s_waitcnt vmcnt(38)
    ds_read_b64_tr_b16 a[0:1], v9 offset:0
    ds_read_b64_tr_b16 a[2:3], v9 offset:512
    ds_read_b64_tr_b16 a[4:5], v10 offset:0
    ds_read_b64_tr_b16 a[6:7], v10 offset:512
    s_waitcnt vmcnt(36)
    ds_read_b64_tr_b16 a[8:9], v9 offset:2048
    ds_read_b64_tr_b16 a[10:11], v9 offset:2560
    ds_read_b64_tr_b16 a[12:13], v10 offset:2048
    ds_read_b64_tr_b16 a[14:15], v10 offset:2560
    s_waitcnt lgkmcnt(4)
    s_add_u32 m0, s62, 0
    s_mov_b32 s70, 409600
    buffer_load_dwordx4 v8, s[40:43], s70 offen lds
    s_add_u32 m0, s62, 1024
    s_mov_b32 s70, 414720
    buffer_load_dwordx4 v8, s[40:43], s70 offen lds
    s_waitcnt vmcnt(36)
    ds_read_b64_tr_b16 a[16:17], v9 offset:4096
    ds_read_b64_tr_b16 a[18:19], v9 offset:4608
    ds_read_b64_tr_b16 a[20:21], v10 offset:4096
    ds_read_b64_tr_b16 a[22:23], v10 offset:4608
    s_waitcnt lgkmcnt(4)
    s_add_u32 m0, s62, 2048
    s_mov_b32 s70, 430080
    buffer_load_dwordx4 v8, s[40:43], s70 offen lds
    s_add_u32 m0, s62, 3072
    s_mov_b32 s70, 435200
    buffer_load_dwordx4 v8, s[40:43], s70 offen lds
    s_waitcnt vmcnt(36)
    ds_read_b64_tr_b16 a[24:25], v9 offset:6144
    ds_read_b64_tr_b16 a[26:27], v9 offset:6656
    ds_read_b64_tr_b16 a[28:29], v10 offset:6144
    ds_read_b64_tr_b16 a[30:31], v10 offset:6656
    s_waitcnt lgkmcnt(4)
    s_add_u32 m0, s62, 4096
    s_mov_b32 s70, 450560
    buffer_load_dwordx4 v8, s[40:43], s70 offen lds
    s_add_u32 m0, s62, 5120
    s_mov_b32 s70, 455680
    buffer_load_dwordx4 v8, s[40:43], s70 offen lds
    s_waitcnt vmcnt(36)
    ds_read_b64_tr_b16 a[32:33], v9 offset:8192
    ds_read_b64_tr_b16 a[34:35], v9 offset:8704
    ds_read_b64_tr_b16 a[36:37], v10 offset:8192
    ds_read_b64_tr_b16 a[38:39], v10 offset:8704
    s_waitcnt lgkmcnt(4)
    s_add_u32 m0, s62, 6144
    s_mov_b32 s70, 471040
    buffer_load_dwordx4 v8, s[40:43], s70 offen lds
    s_add_u32 m0, s62, 7168
    s_mov_b32 s70, 476160
    buffer_load_dwordx4 v8, s[40:43], s70 offen lds
    s_waitcnt vmcnt(36)
    ds_read_b64_tr_b16 a[40:41], v9 offset:10240
    ds_read_b64_tr_b16 a[42:43], v9 offset:10752
    ds_read_b64_tr_b16 a[44:45], v10 offset:10240
    ds_read_b64_tr_b16 a[46:47], v10 offset:10752
    s_waitcnt lgkmcnt(4)
    s_add_u32 m0, s62, 8192
    s_mov_b32 s70, 491520
    buffer_load_dwordx4 v8, s[40:43], s70 offen lds
    s_add_u32 m0, s62, 9216
    s_mov_b32 s70, 496640
    buffer_load_dwordx4 v8, s[40:43], s70 offen lds
    s_waitcnt vmcnt(36)
    ds_read_b64_tr_b16 a[48:49], v9 offset:12288
    ds_read_b64_tr_b16 a[50:51], v9 offset:12800
    ds_read_b64_tr_b16 a[52:53], v10 offset:12288
    ds_read_b64_tr_b16 a[54:55], v10 offset:12800
    s_waitcnt lgkmcnt(4)
    s_add_u32 m0, s62, 10240
    s_mov_b32 s70, 512000
    buffer_load_dwordx4 v8, s[40:43], s70 offen lds
    s_add_u32 m0, s62, 11264
    s_mov_b32 s70, 517120
    buffer_load_dwordx4 v8, s[40:43], s70 offen lds
    s_waitcnt vmcnt(36)
    ds_read_b64_tr_b16 a[56:57], v9 offset:14336
    ds_read_b64_tr_b16 a[58:59], v9 offset:14848
    ds_read_b64_tr_b16 a[60:61], v10 offset:14336
    ds_read_b64_tr_b16 a[62:63], v10 offset:14848
    s_waitcnt lgkmcnt(4)
    s_add_u32 m0, s62, 12288
    s_mov_b32 s70, 532480
    buffer_load_dwordx4 v8, s[40:43], s70 offen lds
    s_add_u32 m0, s62, 13312
    s_mov_b32 s70, 537600
    buffer_load_dwordx4 v8, s[40:43], s70 offen lds
    s_waitcnt vmcnt(36)
    ds_read_b64_tr_b16 a[64:65], v9 offset:16384
    ds_read_b64_tr_b16 a[66:67], v9 offset:16896
    ds_read_b64_tr_b16 a[68:69], v10 offset:16384
    ds_read_b64_tr_b16 a[70:71], v10 offset:16896
    s_waitcnt vmcnt(34)
    ds_read_b64_tr_b16 a[72:73], v9 offset:18432
    ds_read_b64_tr_b16 a[74:75], v9 offset:18944
    ds_read_b64_tr_b16 a[76:77], v10 offset:18432
    ds_read_b64_tr_b16 a[78:79], v10 offset:18944
    s_waitcnt vmcnt(32)
    ds_read_b64_tr_b16 a[80:81], v9 offset:20480
    ds_read_b64_tr_b16 a[82:83], v9 offset:20992
    ds_read_b64_tr_b16 a[84:85], v10 offset:20480
    ds_read_b64_tr_b16 a[86:87], v10 offset:20992
    s_waitcnt vmcnt(30)
    ds_read_b64_tr_b16 a[88:89], v9 offset:22528
    ds_read_b64_tr_b16 a[90:91], v9 offset:23040
    ds_read_b64_tr_b16 a[92:93], v10 offset:22528
    ds_read_b64_tr_b16 a[94:95], v10 offset:23040
    s_waitcnt vmcnt(28)
    ds_read_b64_tr_b16 a[96:97], v9 offset:24576
    ds_read_b64_tr_b16 a[98:99], v9 offset:25088
    ds_read_b64_tr_b16 a[100:101], v10 offset:24576
    ds_read_b64_tr_b16 a[102:103], v10 offset:25088
    s_waitcnt vmcnt(26)
    ds_read_b64_tr_b16 a[104:105], v9 offset:26624
    ds_read_b64_tr_b16 a[106:107], v9 offset:27136
    ds_read_b64_tr_b16 a[108:109], v10 offset:26624
    ds_read_b64_tr_b16 a[110:111], v10 offset:27136
    s_waitcnt vmcnt(24)
    ds_read_b64_tr_b16 a[112:113], v9 offset:28672
    ds_read_b64_tr_b16 a[114:115], v9 offset:29184
    ds_read_b64_tr_b16 a[116:117], v10 offset:28672
    ds_read_b64_tr_b16 a[118:119], v10 offset:29184
    s_waitcnt vmcnt(22)
    ds_read_b64_tr_b16 a[120:121], v9 offset:30720
    ds_read_b64_tr_b16 a[122:123], v9 offset:31232
    ds_read_b64_tr_b16 a[124:125], v10 offset:30720
    ds_read_b64_tr_b16 a[126:127], v10 offset:31232
    s_waitcnt vmcnt(20)
    ds_read_b64_tr_b16 a[128:129], v9 offset:32768
    ds_read_b64_tr_b16 a[130:131], v9 offset:33280
    ds_read_b64_tr_b16 a[132:133], v10 offset:32768
    ds_read_b64_tr_b16 a[134:135], v10 offset:33280
    s_waitcnt vmcnt(18)
    ds_read_b64_tr_b16 a[136:137], v9 offset:34816
    ds_read_b64_tr_b16 a[138:139], v9 offset:35328
    ds_read_b64_tr_b16 a[140:141], v10 offset:34816
    ds_read_b64_tr_b16 a[142:143], v10 offset:35328
    s_waitcnt vmcnt(16)
    ds_read_b64_tr_b16 a[144:145], v9 offset:36864
    ds_read_b64_tr_b16 a[146:147], v9 offset:37376
    ds_read_b64_tr_b16 a[148:149], v10 offset:36864
    ds_read_b64_tr_b16 a[150:151], v10 offset:37376
    s_waitcnt vmcnt(14)
    ds_read_b64_tr_b16 a[152:153], v9 offset:38912
    ds_read_b64_tr_b16 a[154:155], v9 offset:39424
    ds_read_b64_tr_b16 a[156:157], v10 offset:38912
    ds_read_b64_tr_b16 a[158:159], v10 offset:39424
    s_waitcnt vmcnt(12)
    ds_read_b64_tr_b16 a[160:161], v9 offset:0
    ds_read_b64_tr_b16 a[162:163], v9 offset:512
    ds_read_b64_tr_b16 a[164:165], v10 offset:0
    ds_read_b64_tr_b16 a[166:167], v10 offset:512
    s_waitcnt vmcnt(10)
    ds_read_b64_tr_b16 a[168:169], v9 offset:2048
    ds_read_b64_tr_b16 a[170:171], v9 offset:2560
    ds_read_b64_tr_b16 a[172:173], v10 offset:2048
    ds_read_b64_tr_b16 a[174:175], v10 offset:2560
    s_waitcnt vmcnt(8)
    ds_read_b64_tr_b16 a[176:177], v9 offset:4096
    ds_read_b64_tr_b16 a[178:179], v9 offset:4608
    ds_read_b64_tr_b16 a[180:181], v10 offset:4096
    ds_read_b64_tr_b16 a[182:183], v10 offset:4608
    s_waitcnt vmcnt(6)
    ds_read_b64_tr_b16 a[184:185], v9 offset:6144
    ds_read_b64_tr_b16 a[186:187], v9 offset:6656
    ds_read_b64_tr_b16 a[188:189], v10 offset:6144
    ds_read_b64_tr_b16 a[190:191], v10 offset:6656
    s_waitcnt vmcnt(4)
    ds_read_b64_tr_b16 a[192:193], v9 offset:8192
    ds_read_b64_tr_b16 a[194:195], v9 offset:8704
    ds_read_b64_tr_b16 a[196:197], v10 offset:8192
    ds_read_b64_tr_b16 a[198:199], v10 offset:8704
    s_waitcnt vmcnt(2)
    ds_read_b64_tr_b16 a[200:201], v9 offset:10240
    ds_read_b64_tr_b16 a[202:203], v9 offset:10752
    ds_read_b64_tr_b16 a[204:205], v10 offset:10240
    ds_read_b64_tr_b16 a[206:207], v10 offset:10752
    s_waitcnt vmcnt(0)
    ds_read_b64_tr_b16 a[208:209], v9 offset:12288
    ds_read_b64_tr_b16 a[210:211], v9 offset:12800
    ds_read_b64_tr_b16 a[212:213], v10 offset:12288
    ds_read_b64_tr_b16 a[214:215], v10 offset:12800
    s_waitcnt vmcnt(0) lgkmcnt(0)
    s_lshl_b32 s72, s53, 12
    s_lshl_b32 s73, s52, 10
    s_add_u32 s72, s72, s73
    s_mul_i32 s65, s54, 2621440
    s_add_u32 s65, s65, s72
    s_add_u32 s65, s65, 173408256
    s_mul_i32 s74, s54, 5242880
    s_add_u32 s74, s74, s72
    s_add_u32 s74, s74, 206438400
    s_add_u32 s57, s72, 176029696
    s_lshl_b32 s72, s53, 7
    s_lshl_b32 s73, s52, 5
    s_add_u32 s66, s72, s73
    v_and_b32 v8, 31, v0
    v_mul_u32_u24 v8, 1280, v8
    v_lshrrev_b32 v9, 5, v0
    v_lshl_add_u32 v34, v9, 4, v8
    s_mul_i32 s59, s54, 8192
    s_lshl_b32 s70, s53, 7
    s_add_u32 s59, s59, s70
    s_lshl_b32 s70, s52, 2
    s_add_u32 s59, s59, s70
    s_add_u32 s59, s59, 114688
    s_cmp_lg_u32 s54, 0
    s_cselect_b32 s59, 0x20000000, s59
    v_and_b32 v8, 31, v0
    v_mul_u32_u24 v8, 144, v8
    v_lshl_add_u32 v8, v9, 4, v8
    s_lshl_b32 s72, s52, 5
    s_add_u32 s72, s72, 65536
    v_add_u32 v50, s72, v8
    v_lshrrev_b32 v8, 3, v0
    v_and_b32 v9, 7, v0
    v_lshlrev_b32 v9, 4, v9
    v_mad_u32_u24 v51, v8, 36, 0
    v_lshl_add_u32 v51, v51, 2, v9
    s_mul_i32 s72, s52, 1152
    s_add_u32 s72, s72, 65536
    v_add_u32 v51, s72, v51
    v_mul_u32_u24 v8, 1280, v8
    v_add_u32 v52, v8, v9
    s_lshl_b32 s75, s53, 7
    s_mul_i32 s72, s52, 10240
    s_add_u32 s75, s75, s72
    s_mul_i32 s72, s53, 22
    v_add_u32 v54, s72, v0
    v_lshlrev_b32 v53, 7, v54
    v_mov_b32 v55, 0x40000000
    v_cmp_gt_u32 vcc, 22, v0
    s_nop 1
    v_cndmask_b32 v53, v55, v53, vcc
    v_cmp_gt_u32 vcc, 216, v54
    s_nop 1
    v_cndmask_b32 v53, v55, v53, vcc
    s_xor_b32 s72, s52, 1
    s_lshl_b32 s72, s72, 13
    s_add_u32 s72, s72, 2048
    v_add_u32 v60, s72, v1
    s_xor_b32 s72, s52, 2
    s_lshl_b32 s72, s72, 13
    s_add_u32 s72, s72, 4096
    v_add_u32 v61, s72, v1
    s_xor_b32 s72, s52, 3
    s_lshl_b32 s72, s72, 13
    s_add_u32 s72, s72, 6144
    v_add_u32 v62, s72, v1
    s_lshl_b32 s72, s52, 13
    v_add_u32 v33, s72, v1
    s_cmp_lg_u32 s96, 0
    s_cbranch_scc1 RDY_ok_61
    s_mov_b32 s68, 0
RDY_lp_62:
    buffer_load_dword v40, off, s[48:51], 0 offset:32 sc1
    s_waitcnt vmcnt(0)
    v_readfirstlane_b32 s70, v40
    s_nop 0
    s_cmp_ge_u32 s70, 256
    s_cbranch_scc1 RDY_all_63
    s_sleep 8
    s_add_u32 s68, s68, 1
    s_cmp_lt_u32 s68, 65536
    s_cbranch_scc1 RDY_lp_62
    s_branch RDY_ok_61
RDY_all_63:
    v_mbcnt_lo_u32_b32 v41, -1, 0
    v_and_b32 v41, 7, v41
    v_min_u32 v42, 1, v41
    v_lshlrev_b32 v41, 2, v41
    v_lshl_add_u32 v41, v42, 7, v41
    buffer_load_dword v40, v41, s[48:51], 0 offen sc1
    s_waitcnt vmcnt(0)
    v_cmp_ne_u32 vcc, 32, v40
    s_nop 0
    s_cbranch_vccnz L_slow
RDY_ok_61:
    s_barrier
G2f2_fetch:
    s_cmp_gt_u32 s60, s55
    s_cbranch_scc1 G2f2_p_ok_64
    s_mov_b32 s68, 0
G2f2_p_lp_65:
    buffer_load_dwordx4 v[4:7], v2, s[8:11], s58 offen sc1
    s_waitcnt vmcnt(0)
    v_min3_u32 v4, v4, v5, v6
    v_min_u32 v4, v4, v7
    s_nop 1
    v_min_u32_dpp v4, v4, v4 row_ror:1 row_mask:0xf bank_mask:0xf
    s_nop 1
    v_min_u32_dpp v4, v4, v4 row_ror:2 row_mask:0xf bank_mask:0xf
    s_nop 1
    v_min_u32_dpp v4, v4, v4 row_ror:4 row_mask:0xf bank_mask:0xf
    s_nop 1
    v_min_u32_dpp v4, v4, v4 row_ror:8 row_mask:0xf bank_mask:0xf
    s_nop 0
    v_readlane_b32 s70, v4, 0
    s_nop 0
    s_max_u32 s60, s60, s70
    s_cmp_gt_u32 s60, s55
    s_cbranch_scc1 G2f2_p_ok_64
    s_cmp_lg_u32 s69, 0
    s_cbranch_scc1 G2f2_p_ok_64
    s_sleep 2
    s_add_u32 s68, s68, 1
    s_cmp_lt_u32 s68, 65536
    s_cbranch_scc1 G2f2_p_lp_65
    s_mov_b32 s69, 1
G2f2_p_ok_64:
    buffer_load_dwordx4 v[36:39], v1, s[8:11], s65 offen sc1
    s_add_u32 s65, s65, 40960
    buffer_load_dwordx4 v[40:43], v1, s[8:11], s74 offen sc1
    s_add_u32 s74, s74, 40960
    buffer_load_dwordx4 v[44:47], v1, s[8:11], s74 offen sc1
    s_add_u32 s74, s74, 40960
    s_add_u32 s73, s56, 0
    buffer_load_dwordx4 v[64:67], v1, s[8:11], s73 offen offset:0 sc1
    buffer_load_dwordx4 v[68:71], v1, s[8:11], s73 offen offset:1024 sc1
    buffer_load_dwordx4 v[72:75], v1, s[8:11], s73 offen offset:2048 sc1
    buffer_load_dwordx4 v[76:79], v1, s[8:11], s73 offen offset:3072 sc1
    s_add_u32 s73, s56, 4096
    buffer_load_dwordx4 v[80:83], v1, s[8:11], s73 offen offset:0 sc1
    buffer_load_dwordx4 v[84:87], v1, s[8:11], s73 offen offset:1024 sc1
    buffer_load_dwordx4 v[88:91], v1, s[8:11], s73 offen offset:2048 sc1
    buffer_load_dwordx4 v[92:95], v1, s[8:11], s73 offen offset:3072 sc1
    s_add_u32 s73, s56, 8192
    buffer_load_dwordx4 v[96:99], v1, s[8:11], s73 offen offset:0 sc1
    buffer_load_dwordx4 v[100:103], v1, s[8:11], s73 offen offset:1024 sc1
G2f2_top:
    s_add_u32 s73, s56, 8192
    s_waitcnt vmcnt(9)
    v_mfma_f32_32x32x16_bf16 v[192:207], a[0:3], v[64:67], 0
    v_mfma_f32_32x32x16_bf16 v[208:223], a[4:7], v[64:67], 0
    buffer_load_dwordx4 v[104:107], v1, s[8:11], s73 offen offset:2048 sc1
    s_waitcnt vmcnt(9)
    v_mfma_f32_32x32x16_bf16 v[192:207], a[8:11], v[68:71], v[192:207]
    v_mfma_f32_32x32x16_bf16 v[208:223], a[12:15], v[68:71], v[208:223]
    buffer_load_dwordx4 v[108:111], v1, s[8:11], s73 offen offset:3072 sc1
    s_waitcnt vmcnt(9)
    v_mfma_f32_32x32x16_bf16 v[192:207], a[16:19], v[72:75], v[192:207]
    v_mfma_f32_32x32x16_bf16 v[208:223], a[20:23], v[72:75], v[208:223]
    s_add_u32 s73, s56, 12288
    buffer_load_dwordx4 v[112:115], v1, s[8:11], s73 offen offset:0 sc1
    s_waitcnt vmcnt(9)
    v_mfma_f32_32x32x16_bf16 v[192:207], a[24:27], v[76:79], v[192:207]
    v_mfma_f32_32x32x16_bf16 v[208:223], a[28:31], v[76:79], v[208:223]
    v_lshlrev_b32 v8, 16, v36
    v_and_b32 v9, 0xffff0000, v36
    v_lshlrev_b32 v10, 16, v40
    v_and_b32 v11, 0xffff0000, v40
    v_add_f32 v8, v8, v10
    v_add_f32 v9, v9, v11
    v_lshlrev_b32 v10, 16, v44
    v_and_b32 v11, 0xffff0000, v44
    v_add_f32 v8, v8, v10
    v_add_f32 v9, v9, v11
    v_cvt_pk_bf16_f32 v56, v8, v9
    v_lshlrev_b32 v8, 16, v37
    v_and_b32 v9, 0xffff0000, v37
    v_lshlrev_b32 v10, 16, v41
    v_and_b32 v11, 0xffff0000, v41
    v_add_f32 v8, v8, v10
    v_add_f32 v9, v9, v11
    v_lshlrev_b32 v10, 16, v45
    v_and_b32 v11, 0xffff0000, v45
    v_add_f32 v8, v8, v10
    v_add_f32 v9, v9, v11
    v_cvt_pk_bf16_f32 v57, v8, v9
    v_lshlrev_b32 v8, 16, v38
    v_and_b32 v9, 0xffff0000, v38
    v_lshlrev_b32 v10, 16, v42
    v_and_b32 v11, 0xffff0000, v42
    v_add_f32 v8, v8, v10
    v_add_f32 v9, v9, v11
    v_lshlrev_b32 v10, 16, v46
    v_and_b32 v11, 0xffff0000, v46
    v_add_f32 v8, v8, v10
    v_add_f32 v9, v9, v11
    v_cvt_pk_bf16_f32 v58, v8, v9
    v_lshlrev_b32 v8, 16, v39
    v_and_b32 v9, 0xffff0000, v39
    v_lshlrev_b32 v10, 16, v43
    v_and_b32 v11, 0xffff0000, v43
    v_add_f32 v8, v8, v10
    v_add_f32 v9, v9, v11
    v_lshlrev_b32 v10, 16, v47
    v_and_b32 v11, 0xffff0000, v47
    v_add_f32 v8, v8, v10
    v_add_f32 v9, v9, v11
    v_cvt_pk_bf16_f32 v59, v8, v9
    buffer_load_dwordx4 v[116:119], v1, s[8:11], s73 offen offset:1024 sc1
    s_waitcnt vmcnt(9)
    v_mfma_f32_32x32x16_bf16 v[192:207], a[32:35], v[80:83], v[192:207]
    v_mfma_f32_32x32x16_bf16 v[208:223], a[36:39], v[80:83], v[208:223]
    buffer_load_dwordx4 v[120:123], v1, s[8:11], s73 offen offset:2048 sc1
    s_waitcnt vmcnt(9)
    v_mfma_f32_32x32x16_bf16 v[192:207], a[40:43], v[84:87], v[192:207]
    v_mfma_f32_32x32x16_bf16 v[208:223], a[44:47], v[84:87], v[208:223]
    buffer_load_dwordx4 v[124:127], v1, s[8:11], s73 offen offset:3072 sc1
    s_waitcnt vmcnt(9)
    v_mfma_f32_32x32x16_bf16 v[192:207], a[48:51], v[88:91], v[192:207]
    v_mfma_f32_32x32x16_bf16 v[208:223], a[52:55], v[88:91], v[208:223]
    s_add_u32 s73, s56, 16384
    buffer_load_dwordx4 v[128:131], v1, s[8:11], s73 offen offset:0 sc1
    s_waitcnt vmcnt(9)
    v_mfma_f32_32x32x16_bf16 v[192:207], a[56:59], v[92:95], v[192:207]
    v_mfma_f32_32x32x16_bf16 v[208:223], a[60:63], v[92:95], v[208:223]
    buffer_load_dwordx4 v[4:7], v2, s[8:11], s58 offen sc1
    buffer_load_dwordx4 v[132:135], v1, s[8:11], s73 offen offset:1024 sc1
    s_waitcnt vmcnt(9)
    v_mfma_f32_32x32x16_bf16 v[192:207], a[64:67], v[96:99], v[192:207]
    v_mfma_f32_32x32x16_bf16 v[208:223], a[68:71], v[96:99], v[208:223]
    buffer_load_dwordx4 v[136:139], v1, s[8:11], s73 offen offset:2048 sc1
    s_waitcnt vmcnt(9)
    v_mfma_f32_32x32x16_bf16 v[192:207], a[72:75], v[100:103], v[192:207]
    v_mfma_f32_32x32x16_bf16 v[208:223], a[76:79], v[100:103], v[208:223]
    buffer_load_dwordx4 v[140:143], v1, s[8:11], s73 offen offset:3072 sc1
    s_waitcnt vmcnt(9)
    v_mfma_f32_32x32x16_bf16 v[192:207], a[80:83], v[104:107], v[192:207]
    v_mfma_f32_32x32x16_bf16 v[208:223], a[84:87], v[104:107], v[208:223]
    s_cmp_eq_u32 s61, 0
    s_cbranch_scc1 G2f2_nop_66
    v_mov_b32 v3, s55
    s_mov_b64 exec, 1
    buffer_store_dword v3, off, s[8:11], s59 sc1
    s_mov_b64 exec, -1
    s_mov_b32 s61, 0
G2f2_nop_66:
    s_add_u32 s73, s56, 20480
    buffer_load_dwordx4 v[144:147], v1, s[8:11], s73 offen offset:0 sc1
    s_waitcnt vmcnt(9)
    v_mfma_f32_32x32x16_bf16 v[192:207], a[88:91], v[108:111], v[192:207]
    v_mfma_f32_32x32x16_bf16 v[208:223], a[92:95], v[108:111], v[208:223]
    buffer_load_dwordx4 v[148:151], v1, s[8:11], s73 offen offset:1024 sc1
    s_waitcnt vmcnt(9)
    v_mfma_f32_32x32x16_bf16 v[192:207], a[96:99], v[112:115], v[192:207]
    v_mfma_f32_32x32x16_bf16 v[208:223], a[100:103], v[112:115], v[208:223]
    buffer_load_dwordx4 v[152:155], v1, s[8:11], s73 offen offset:2048 sc1
    s_waitcnt vmcnt(9)
    v_mfma_f32_32x32x16_bf16 v[192:207], a[104:107], v[116:119], v[192:207]
    v_mfma_f32_32x32x16_bf16 v[208:223], a[108:111], v[116:119], v[208:223]
    buffer_load_dwordx4 v[156:159], v1, s[8:11], s73 offen offset:3072 sc1
    s_waitcnt vmcnt(9)
    v_mfma_f32_32x32x16_bf16 v[192:207], a[112:115], v[120:123], v[192:207]
    v_mfma_f32_32x32x16_bf16 v[208:223], a[116:119], v[120:123], v[208:223]
    s_add_u32 s73, s56, 24576
    buffer_load_dwordx4 v[160:163], v1, s[8:11], s73 offen offset:0 sc1
    s_waitcnt vmcnt(9)
    v_mfma_f32_32x32x16_bf16 v[192:207], a[120:123], v[124:127], v[192:207]
    v_mfma_f32_32x32x16_bf16 v[208:223], a[124:127], v[124:127], v[208:223]
    buffer_load_dwordx4 v[164:167], v1, s[8:11], s73 offen offset:1024 sc1
    s_waitcnt vmcnt(9)
    v_mfma_f32_32x32x16_bf16 v[192:207], a[128:131], v[128:131], v[192:207]
    v_mfma_f32_32x32x16_bf16 v[208:223], a[132:135], v[128:131], v[208:223]
    buffer_load_dwordx4 v[168:171], v1, s[8:11], s73 offen offset:2048 sc1
    s_waitcnt vmcnt(9)
    v_mfma_f32_32x32x16_bf16 v[192:207], a[136:139], v[132:135], v[192:207]
    v_mfma_f32_32x32x16_bf16 v[208:223], a[140:143], v[132:135], v[208:223]
    v_min3_u32 v4, v4, v5, v6
    v_min_u32 v4, v4, v7
    s_nop 1
    v_min_u32_dpp v4, v4, v4 row_ror:1 row_mask:0xf bank_mask:0xf
    s_nop 1
    v_min_u32_dpp v4, v4, v4 row_ror:2 row_mask:0xf bank_mask:0xf
    s_nop 1
    v_min_u32_dpp v4, v4, v4 row_ror:4 row_mask:0xf bank_mask:0xf
    s_nop 1
    v_min_u32_dpp v4, v4, v4 row_ror:8 row_mask:0xf bank_mask:0xf
    s_nop 0
    v_readlane_b32 s70, v4, 0
    s_nop 0
    s_max_u32 s60, s60, s70
    s_add_u32 s56, s56, 114688
    s_add_u32 s72, s55, 1
    s_cmp_gt_u32 s60, s72
    s_cselect_b32 s63, 1, 0
    s_cbranch_scc1 G2f2_pf
    buffer_load_dwordx4 v[4:7], v2, s[8:11], s58 offen sc1
    s_waitcnt vmcnt(9)
    v_mfma_f32_32x32x16_bf16 v[192:207], a[144:147], v[136:139], v[192:207]
    v_mfma_f32_32x32x16_bf16 v[208:223], a[148:151], v[136:139], v[208:223]
    s_waitcnt vmcnt(8)
    v_mfma_f32_32x32x16_bf16 v[192:207], a[152:155], v[140:143], v[192:207]
    v_mfma_f32_32x32x16_bf16 v[208:223], a[156:159], v[140:143], v[208:223]
    s_waitcnt vmcnt(7)
    v_mfma_f32_32x32x16_bf16 v[192:207], a[160:163], v[144:147], v[192:207]
    v_mfma_f32_32x32x16_bf16 v[208:223], a[164:167], v[144:147], v[208:223]
    s_waitcnt vmcnt(6)
    v_mfma_f32_32x32x16_bf16 v[192:207], a[168:171], v[148:151], v[192:207]
    v_mfma_f32_32x32x16_bf16 v[208:223], a[172:175], v[148:151], v[208:223]
    s_waitcnt vmcnt(5)
    v_mfma_f32_32x32x16_bf16 v[192:207], a[176:179], v[152:155], v[192:207]
    v_mfma_f32_32x32x16_bf16 v[208:223], a[180:183], v[152:155], v[208:223]
    s_waitcnt vmcnt(4)
    v_mfma_f32_32x32x16_bf16 v[192:207], a[184:187], v[156:159], v[192:207]
    v_mfma_f32_32x32x16_bf16 v[208:223], a[188:191], v[156:159], v[208:223]
    s_waitcnt vmcnt(3)
    v_mfma_f32_32x32x16_bf16 v[192:207], a[192:195], v[160:163], v[192:207]
    v_mfma_f32_32x32x16_bf16 v[208:223], a[196:199], v[160:163], v[208:223]
    s_waitcnt vmcnt(2)
    v_mfma_f32_32x32x16_bf16 v[192:207], a[200:203], v[164:167], v[192:207]
    v_mfma_f32_32x32x16_bf16 v[208:223], a[204:207], v[164:167], v[208:223]
    s_waitcnt vmcnt(1)
    v_mfma_f32_32x32x16_bf16 v[192:207], a[208:211], v[168:171], v[192:207]
    v_mfma_f32_32x32x16_bf16 v[208:223], a[212:215], v[168:171], v[208:223]
    s_branch G2f2_red
G2f2_pf:
    buffer_load_dwordx4 v[36:39], v1, s[8:11], s65 offen sc1
    s_add_u32 s65, s65, 40960
    buffer_load_dwordx4 v[40:43], v1, s[8:11], s74 offen sc1
    s_add_u32 s74, s74, 40960
    buffer_load_dwordx4 v[44:47], v1, s[8:11], s74 offen sc1
    s_add_u32 s74, s74, 40960
    s_add_u32 s73, s56, 0
    buffer_load_dwordx4 v[64:67], v1, s[8:11], s73 offen offset:0 sc1
    s_waitcnt vmcnt(12)
    v_mfma_f32_32x32x16_bf16 v[192:207], a[144:147], v[136:139], v[192:207]
    v_mfma_f32_32x32x16_bf16 v[208:223], a[148:151], v[136:139], v[208:223]
    buffer_load_dwordx4 v[68:71], v1, s[8:11], s73 offen offset:1024 sc1
    s_waitcnt vmcnt(12)
    v_mfma_f32_32x32x16_bf16 v[192:207], a[152:155], v[140:143], v[192:207]
    v_mfma_f32_32x32x16_bf16 v[208:223], a[156:159], v[140:143], v[208:223]
    buffer_load_dwordx4 v[72:75], v1, s[8:11], s73 offen offset:2048 sc1
    s_waitcnt vmcnt(12)
    v_mfma_f32_32x32x16_bf16 v[192:207], a[160:163], v[144:147], v[192:207]
    v_mfma_f32_32x32x16_bf16 v[208:223], a[164:167], v[144:147], v[208:223]
    buffer_load_dwordx4 v[76:79], v1, s[8:11], s73 offen offset:3072 sc1
    s_waitcnt vmcnt(12)
    v_mfma_f32_32x32x16_bf16 v[192:207], a[168:171], v[148:151], v[192:207]
    v_mfma_f32_32x32x16_bf16 v[208:223], a[172:175], v[148:151], v[208:223]
    s_add_u32 s73, s56, 4096
    buffer_load_dwordx4 v[80:83], v1, s[8:11], s73 offen offset:0 sc1
    s_waitcnt vmcnt(12)
    v_mfma_f32_32x32x16_bf16 v[192:207], a[176:179], v[152:155], v[192:207]
    v_mfma_f32_32x32x16_bf16 v[208:223], a[180:183], v[152:155], v[208:223]
    buffer_load_dwordx4 v[84:87], v1, s[8:11], s73 offen offset:1024 sc1
    s_waitcnt vmcnt(12)
    v_mfma_f32_32x32x16_bf16 v[192:207], a[184:187], v[156:159], v[192:207]
    v_mfma_f32_32x32x16_bf16 v[208:223], a[188:191], v[156:159], v[208:223]
    buffer_load_dwordx4 v[88:91], v1, s[8:11], s73 offen offset:2048 sc1
    s_waitcnt vmcnt(12)
    v_mfma_f32_32x32x16_bf16 v[192:207], a[192:195], v[160:163], v[192:207]
    v_mfma_f32_32x32x16_bf16 v[208:223], a[196:199], v[160:163], v[208:223]
    buffer_load_dwordx4 v[92:95], v1, s[8:11], s73 offen offset:3072 sc1
    s_waitcnt vmcnt(12)
    v_mfma_f32_32x32x16_bf16 v[192:207], a[200:203], v[164:167], v[192:207]
    v_mfma_f32_32x32x16_bf16 v[208:223], a[204:207], v[164:167], v[208:223]
    s_add_u32 s73, s56, 8192
    buffer_load_dwordx4 v[96:99], v1, s[8:11], s73 offen offset:0 sc1
    s_waitcnt vmcnt(12)
    v_mfma_f32_32x32x16_bf16 v[192:207], a[208:211], v[168:171], v[192:207]
    v_mfma_f32_32x32x16_bf16 v[208:223], a[212:215], v[168:171], v[208:223]
    buffer_load_dwordx4 v[100:103], v1, s[8:11], s73 offen offset:1024 sc1
G2f2_red:
    s_nop 9
    ds_write_b128 v60, v[200:203]
    ds_write_b128 v60, v[204:207] offset:1024
    ds_write_b128 v61, v[208:211]
    ds_write_b128 v61, v[212:215] offset:1024
    ds_write_b128 v62, v[216:219]
    ds_write_b128 v62, v[220:223] offset:1024
    v_xor_b32 v60, 32768, v60
    v_xor_b32 v61, 32768, v61
    v_xor_b32 v62, 32768, v62
    s_waitcnt lgkmcnt(0)
    s_barrier
    ds_read_b128 v[224:227], v33 offset:2048
    ds_read_b128 v[228:231], v33 offset:3072
    ds_read_b128 v[232:235], v33 offset:4096
    ds_read_b128 v[236:239], v33 offset:5120
    ds_read_b128 v[240:243], v33 offset:6144
    ds_read_b128 v[244:247], v33 offset:7168
    v_xor_b32 v33, 32768, v33
    s_waitcnt lgkmcnt(4)
    v_pk_add_f32 v[248:249], v[192:193], v[224:225]
    v_pk_add_f32 v[250:251], v[194:195], v[226:227]
    v_pk_add_f32 v[252:253], v[196:197], v[228:229]
    v_pk_add_f32 v[254:255], v[198:199], v[230:231]
    s_waitcnt lgkmcnt(0)
    v_pk_add_f32 v[232:233], v[232:233], v[240:241]
    v_pk_add_f32 v[234:235], v[234:235], v[242:243]
    v_pk_add_f32 v[236:237], v[236:237], v[244:245]
    v_pk_add_f32 v[238:239], v[238:239], v[246:247]
    v_pk_add_f32 v[248:249], v[248:249], v[232:233]
    v_pk_add_f32 v[250:251], v[250:251], v[234:235]
    v_pk_add_f32 v[252:253], v[252:253], v[236:237]
    v_pk_add_f32 v[254:255], v[254:255], v[238:239]
    v_cvt_pk_bf16_f32 v224, v248, v249
    v_lshlrev_b32 v248, 16, v224
    v_and_b32 v249, 0xffff0000, v224
    v_lshlrev_b32 v232, 16, v56
    v_and_b32 v233, 0xffff0000, v56
    v_add_f32 v248, v248, v232
    v_add_f32 v249, v249, v233
    v_cvt_pk_bf16_f32 v228, v248, v249
    v_cvt_pk_bf16_f32 v225, v250, v251
    v_lshlrev_b32 v250, 16, v225
    v_and_b32 v251, 0xffff0000, v225
    v_lshlrev_b32 v232, 16, v57
    v_and_b32 v233, 0xffff0000, v57
    v_add_f32 v250, v250, v232
    v_add_f32 v251, v251, v233
    v_cvt_pk_bf16_f32 v229, v250, v251
    v_cvt_pk_bf16_f32 v226, v252, v253
    v_lshlrev_b32 v252, 16, v226
    v_and_b32 v253, 0xffff0000, v226
    v_lshlrev_b32 v232, 16, v58
    v_and_b32 v233, 0xffff0000, v58
    v_add_f32 v252, v252, v232
    v_add_f32 v253, v253, v233
    v_cvt_pk_bf16_f32 v230, v252, v253
    v_cvt_pk_bf16_f32 v227, v254, v255
    v_lshlrev_b32 v254, 16, v227
    v_and_b32 v255, 0xffff0000, v227
    v_lshlrev_b32 v232, 16, v59
    v_and_b32 v233, 0xffff0000, v59
    v_add_f32 v254, v254, v232
    v_add_f32 v255, v255, v233
    v_cvt_pk_bf16_f32 v231, v254, v255
    s_cmp_lg_u32 s54, 0
    s_cbranch_scc1 G2f2_l1_67
    buffer_store_dwordx4 v[228:231], v1, s[8:11], s57 offen sc1
    s_branch G2f2_l1_67e
G2f2_l1_67:
    ds_write_b128 v50, v[228:231]
    s_waitcnt lgkmcnt(0)
    s_barrier
    ds_read_b128 v[232:235], v51
    s_waitcnt lgkmcnt(0)
    buffer_store_dwordx4 v[232:235], v52, s[44:47], s75 offen nt
    s_add_u32 s75, s75, 40960
G2f2_l1_67e:
    s_add_u32 s57, s57, 40960
    s_add_u32 s55, s55, 1
    s_mov_b32 s61, 1
    s_cmp_lg_u32 s63, 0
    s_cbranch_scc1 G2f2_top
    s_waitcnt vmcnt(1)
    v_min3_u32 v4, v4, v5, v6
    v_min_u32 v4, v4, v7
    s_nop 1
    v_min_u32_dpp v4, v4, v4 row_ror:1 row_mask:0xf bank_mask:0xf
    s_nop 1
    v_min_u32_dpp v4, v4, v4 row_ror:2 row_mask:0xf bank_mask:0xf
    s_nop 1
    v_min_u32_dpp v4, v4, v4 row_ror:4 row_mask:0xf bank_mask:0xf
    s_nop 1
    v_min_u32_dpp v4, v4, v4 row_ror:8 row_mask:0xf bank_mask:0xf
    s_nop 0
    v_readlane_b32 s70, v4, 0
    s_nop 0
    s_max_u32 s60, s60, s70
    s_cmp_gt_u32 s60, s55
    s_cbranch_scc0 G2f2_idle
    buffer_load_dwordx4 v[36:39], v1, s[8:11], s65 offen sc1
    s_add_u32 s65, s65, 40960
    buffer_load_dwordx4 v[40:43], v1, s[8:11], s74 offen sc1
    s_add_u32 s74, s74, 40960
    buffer_load_dwordx4 v[44:47], v1, s[8:11], s74 offen sc1
    s_add_u32 s74, s74, 40960
    s_add_u32 s73, s56, 0
    buffer_load_dwordx4 v[64:67], v1, s[8:11], s73 offen offset:0 sc1
    buffer_load_dwordx4 v[68:71], v1, s[8:11], s73 offen offset:1024 sc1
    buffer_load_dwordx4 v[72:75], v1, s[8:11], s73 offen offset:2048 sc1
    buffer_load_dwordx4 v[76:79], v1, s[8:11], s73 offen offset:3072 sc1
    s_add_u32 s73, s56, 4096
    buffer_load_dwordx4 v[80:83], v1, s[8:11], s73 offen offset:0 sc1
    buffer_load_dwordx4 v[84:87], v1, s[8:11], s73 offen offset:1024 sc1
    buffer_load_dwordx4 v[88:91], v1, s[8:11], s73 offen offset:2048 sc1
    buffer_load_dwordx4 v[92:95], v1, s[8:11], s73 offen offset:3072 sc1
    s_add_u32 s73, s56, 8192
    buffer_load_dwordx4 v[96:99], v1, s[8:11], s73 offen offset:0 sc1
    buffer_load_dwordx4 v[100:103], v1, s[8:11], s73 offen offset:1024 sc1
    s_waitcnt vmcnt(13)
    v_mov_b32 v3, s55
    s_mov_b64 exec, 1
    buffer_store_dword v3, off, s[8:11], s59 sc1
    s_mov_b64 exec, -1
    s_mov_b32 s61, 0
    s_branch G2f2_top
G2f2_idle:
    buffer_load_dwordx4 v[4:7], v2, s[8:11], s58 offen sc1
    s_waitcnt vmcnt(0)
    v_mov_b32 v3, s55
    s_mov_b64 exec, 1
    buffer_store_dword v3, off, s[8:11], s59 sc1
    s_mov_b64 exec, -1
    v_min3_u32 v4, v4, v5, v6
    v_min_u32 v4, v4, v7
    s_nop 1
    v_min_u32_dpp v4, v4, v4 row_ror:1 row_mask:0xf bank_mask:0xf
    s_nop 1
    v_min_u32_dpp v4, v4, v4 row_ror:2 row_mask:0xf bank_mask:0xf
    s_nop 1
    v_min_u32_dpp v4, v4, v4 row_ror:4 row_mask:0xf bank_mask:0xf
    s_nop 1
    v_min_u32_dpp v4, v4, v4 row_ror:8 row_mask:0xf bank_mask:0xf
    s_nop 0
    v_readlane_b32 s70, v4, 0
    s_nop 0
    s_max_u32 s60, s60, s70
    s_mov_b32 s61, 0
    s_cmp_lt_u32 s55, 64
    s_cbranch_scc1 G2f2_fetch
    s_endpgm
CH0_entry:
    v_and_b32 v40, 63, v0
    v_lshlrev_b32 v0, 4, v40
    v_lshrrev_b32 v41, 4, v40
    v_and_b32 v42, 15, v40
    v_and_b32 v43, 2, v40
    v_cmp_ne_u32 vcc, 0, v43
    v_mov_b32 v44, 0x4444
    v_mov_b32 v45, 0xeeee
    v_cndmask_b32 v1, v44, v45, vcc
    v_and_b32 v43, 13, v42
    v_and_b32 v44, 1, v41
    v_lshl_or_b32 v43, v44, 1, v43
    v_lshlrev_b32 v43, 4, v43
    v_lshrrev_b32 v44, 1, v41
    v_lshl_add_u32 v6, v44, 8, v43
    v_lshrrev_b32 v43, 3, v42
    v_lshlrev_b32 v43, 8, v43
    v_lshl_add_u32 v43, v41, 6, v43
    v_bfe_u32 v44, v42, 2, 1
    v_lshl_add_u32 v43, v44, 5, v43
    v_and_b32 v44, 3, v42
    v_lshl_add_u32 v43, v44, 2, v43
    v_add_u32 v5, 10240, v43
    v_add_u32 v7, 24576, v0
    v_add_u32 v3, 2048, v5
    s_mov_b32 s70, 2176
    v_lshrrev_b32 v43, 3, v42
    v_lshl_add_u32 v43, v43, 2, v41
    v_mul_lo_u32 v43, v43, s70
    v_and_b32 v44, 7, v42
    v_lshl_add_u32 v4, v44, 3, v43
    s_mul_i32 s70, s53, 5
    s_add_u32 s70, s70, 0
    v_lshrrev_b32 v43, 3, v42
    v_add_u32 v43, s70, v43
    v_and_b32 v49, 3, v42
    v_lshlrev_b32 v49, 4, v49
    v_lshl_add_u32 v49, v41, 2, v49
    v_bfe_u32 v48, v42, 2, 1
    v_lshl_add_u32 v49, v48, 1, v49
    v_lshl_add_u32 v2, v43, 6, v49
    s_mul_i32 s70, s54, 20480
    s_add_u32 s56, s70, 131072
    s_add_u32 s57, s56, 10240
    s_xor_b32 s74, s56, s57
    s_mul_i32 s70, s54, 348160
    s_add_u32 s70, s70, 196608
    s_lshl_b32 s71, s53, 6
    s_add_u32 s58, s70, s71
    s_add_u32 s58, s58, 0
    s_add_u32 s75, s58, 69632
    s_add_u32 s76, s58, 139264
    s_add_u32 s77, s58, 208896
    s_add_u32 s4, s58, 278528
    s_mul_i32 s71, s53, 10880
    s_add_u32 s59, s71, s70
    s_add_u32 s59, s59, 0
    s_add_u32 s60, s59, 2176
    s_mov_b32 s65, 0
    s_mul_i32 s61, s53, 75776
    s_add_u32 s61, s61, 1048576
    s_add_u32 s3, s61, 4096
    s_add_u32 s5, s61, 8192
    s_add_u32 s6, s61, 12288
    s_add_u32 s7, s61, 16384
    s_mul_i32 s70, s54, 16777216
    s_lshl_b32 s71, s53, 13
    s_add_u32 s70, s70, s71
    s_add_u32 s62, s70, 50331648
    s_add_u32 s63, s70, 16777216
    s_mul_i32 s70, s54, 8519680
    s_lshl_b32 s71, s53, 12
    s_add_u32 s70, s70, s71
    s_add_u32 s64, s70, 150994944
    s_mul_i32 s70, s54, 8192
    s_lshr_b32 s71, s53, 1
    s_mul_i32 s71, s71, 384
    s_add_u32 s78, s70, s71
    s_add_u32 s78, s78, 128
    s_and_b32 s71, s53, 1
    s_lshl_b32 s71, s71, 3
    s_add_u32 s78, s78, s71
    s_lshl_b32 s71, s53, 7
    s_add_u32 s66, s70, s71
    s_add_u32 s66, s66, 16384
    s_mov_b32 s55, 0
    s_mov_b32 s67, 0
    s_mov_b32 s69, 0
    s_mov_b32 s79, 0x3e0293ee
    v_and_b32 v44, 3, v40
    v_lshlrev_b32 v46, 1, v41
    v_xor_b32 v46, v46, v42
    v_lshlrev_b32 v46, 4, v46
    v_lshrrev_b32 v45, 1, v41
    v_lshlrev_b32 v45, 3, v45
    v_and_b32 v47, 1, v41
    v_add_u32 v45, v45, v47
    v_lshlrev_b32 v45, 13, v45
    s_lshl_b32 s70, s53, 8
    v_add3_u32 v32, v45, v46, s70
    v_xor_b32 v34, 128, v32
    v_lshrrev_b32 v45, 1, v41
    v_lshlrev_b32 v45, 2, v45
    v_add_u32 v45, v45, v47
    v_mul_u32_u24 v45, 1280, v45
    s_mul_i32 s70, s53, 163840
    v_add3_u32 v33, v45, v46, s70
    v_xor_b32 v35, 128, v33
    v_bfe_u32 v45, v40, 2, 2
    v_lshl_add_u32 v48, v47, 2, v45
    v_lshlrev_b32 v48, 5, v48
    v_lshl_add_u32 v45, v47, 3, v45
    v_lshlrev_b32 v45, 8, v45
    v_lshrrev_b32 v51, 1, v41
    v_mul_u32_u24 v52, 36864, v51
    v_add_u32 v52, 24576, v52
    v_add_u32 v52, v52, v45
    v_mul_u32_u24 v53, 32768, v51
    v_add_u32 v53, 94208, v53
    v_add_u32 v53, v53, v45
    v_lshlrev_b32 v49, 3, v44
    v_add_u32 v49, 0, v49
    v_xor_b32 v49, v49, v48
    v_add_u32 v16, v49, v52
    v_add_u32 v20, v49, v53
    v_lshrrev_b32 v49, 1, v44
    v_lshlrev_b32 v49, 5, v49
    v_and_b32 v50, 1, v44
    v_lshl_add_u32 v49, v50, 3, v49
    v_add_u32 v49, 0, v49
    v_xor_b32 v49, v49, v48
    v_add_u32 v18, v49, v52
    v_add_u32 v22, v49, v53
    v_lshlrev_b32 v49, 3, v44
    v_add_u32 v49, 32, v49
    v_xor_b32 v49, v49, v48
    v_add_u32 v17, v49, v52
    v_add_u32 v21, v49, v53
    v_lshrrev_b32 v49, 1, v44
    v_lshlrev_b32 v49, 5, v49
    v_and_b32 v50, 1, v44
    v_lshl_add_u32 v49, v50, 3, v49
    v_add_u32 v49, 16, v49
    v_xor_b32 v49, v49, v48
    v_add_u32 v19, v49, v52
    v_add_u32 v23, v49, v53
    s_cmp_eq_u32 s54, 0
    s_cselect_b32 s72, 0x20000000, 0
    s_mov_b32 m0, 24576
    s_mov_b32 s70, 0
    buffer_load_dwordx4 v32, s[12:15], s70 offen lds
    s_mov_b32 m0, 25600
    s_mov_b32 s70, 16384
    buffer_load_dwordx4 v32, s[12:15], s70 offen lds
    s_mov_b32 m0, 26624
    s_mov_b32 s70, 32768
    buffer_load_dwordx4 v34, s[12:15], s70 offen lds
    s_mov_b32 m0, 27648
    s_mov_b32 s70, 49152
    buffer_load_dwordx4 v34, s[12:15], s70 offen lds
    s_mov_b32 m0, 28672
    s_mov_b32 s70, 1572864
    buffer_load_dwordx4 v32, s[12:15], s70 offen lds
    s_mov_b32 m0, 29696
    s_mov_b32 s70, 1589248
    buffer_load_dwordx4 v32, s[12:15], s70 offen lds
    s_mov_b32 m0, 30720
    s_mov_b32 s70, 1605632
    buffer_load_dwordx4 v34, s[12:15], s70 offen lds
    s_mov_b32 m0, 31744
    s_mov_b32 s70, 1622016
    buffer_load_dwordx4 v34, s[12:15], s70 offen lds
    s_mov_b32 m0, 32768
    s_mov_b32 s70, 2097152
    buffer_load_dwordx4 v32, s[12:15], s70 offen lds
    s_mov_b32 m0, 33792
    s_mov_b32 s70, 2113536
    buffer_load_dwordx4 v32, s[12:15], s70 offen lds
    s_mov_b32 m0, 34816
    s_mov_b32 s70, 2129920
    buffer_load_dwordx4 v34, s[12:15], s70 offen lds
    s_mov_b32 m0, 35840
    s_mov_b32 s70, 2146304
    buffer_load_dwordx4 v34, s[12:15], s70 offen lds
    s_mov_b32 m0, 36864
    s_mov_b32 s70, 2621440
    buffer_load_dwordx4 v32, s[12:15], s70 offen lds
    s_mov_b32 m0, 37888
    s_mov_b32 s70, 2637824
    buffer_load_dwordx4 v32, s[12:15], s70 offen lds
    s_mov_b32 m0, 38912
    s_mov_b32 s70, 2654208
    buffer_load_dwordx4 v34, s[12:15], s70 offen lds
    s_mov_b32 m0, 39936
    s_mov_b32 s70, 2670592
    buffer_load_dwordx4 v34, s[12:15], s70 offen lds
    s_mov_b32 m0, 40960
    s_mov_b32 s70, 3145728
    buffer_load_dwordx4 v32, s[12:15], s70 offen lds
    s_mov_b32 m0, 41984
    s_mov_b32 s70, 3162112
    buffer_load_dwordx4 v32, s[12:15], s70 offen lds
    s_mov_b32 m0, 43008
    s_mov_b32 s70, 3178496
    buffer_load_dwordx4 v34, s[12:15], s70 offen lds
    s_mov_b32 m0, 44032
    s_mov_b32 s70, 3194880
    buffer_load_dwordx4 v34, s[12:15], s70 offen lds
    s_mov_b32 m0, 45056
    s_mov_b32 s70, 3670016
    buffer_load_dwordx4 v32, s[12:15], s70 offen lds
    s_mov_b32 m0, 46080
    s_mov_b32 s70, 3686400
    buffer_load_dwordx4 v32, s[12:15], s70 offen lds
    s_mov_b32 m0, 47104
    s_mov_b32 s70, 3702784
    buffer_load_dwordx4 v34, s[12:15], s70 offen lds
    s_mov_b32 m0, 48128
    s_mov_b32 s70, 3719168
    buffer_load_dwordx4 v34, s[12:15], s70 offen lds
    s_mov_b32 m0, 49152
    s_mov_b32 s70, 4194304
    buffer_load_dwordx4 v32, s[12:15], s70 offen lds
    s_mov_b32 m0, 50176
    s_mov_b32 s70, 4210688
    buffer_load_dwordx4 v32, s[12:15], s70 offen lds
    s_mov_b32 m0, 51200
    s_mov_b32 s70, 4227072
    buffer_load_dwordx4 v34, s[12:15], s70 offen lds
    s_mov_b32 m0, 52224
    s_mov_b32 s70, 4243456
    buffer_load_dwordx4 v34, s[12:15], s70 offen lds
    s_mov_b32 m0, 53248
    s_mov_b32 s70, 4718592
    buffer_load_dwordx4 v32, s[12:15], s70 offen lds
    s_mov_b32 m0, 54272
    s_mov_b32 s70, 4734976
    buffer_load_dwordx4 v32, s[12:15], s70 offen lds
    s_mov_b32 m0, 55296
    s_mov_b32 s70, 4751360
    buffer_load_dwordx4 v34, s[12:15], s70 offen lds
    s_mov_b32 m0, 56320
    s_mov_b32 s70, 4767744
    buffer_load_dwordx4 v34, s[12:15], s70 offen lds
    s_waitcnt vmcnt(28) lgkmcnt(0)
    s_barrier
    ds_read_b64_tr_b16 v[40:41], v16 offset:0
    ds_read_b64_tr_b16 v[42:43], v16 offset:1024
    ds_read_b64_tr_b16 v[44:45], v20 offset:0
    ds_read_b64_tr_b16 v[46:47], v20 offset:1024
    ds_read_b64_tr_b16 v[48:49], v17 offset:0
    ds_read_b64_tr_b16 v[50:51], v17 offset:1024
    ds_read_b64_tr_b16 v[52:53], v21 offset:0
    ds_read_b64_tr_b16 v[54:55], v21 offset:1024
    s_waitcnt vmcnt(24) lgkmcnt(0)
    s_barrier
    s_add_u32 s71, s61, s72
    buffer_store_dwordx4 v[40:43], v0, s[8:11], s71 offen offset:2048 sc1
    buffer_store_dwordx4 v[44:47], v0, s[8:11], s71 offen offset:3072 sc1
    s_add_u32 s71, s61, s72
    buffer_store_dwordx4 v[48:51], v0, s[8:11], s71 offen offset:0 sc1
    buffer_store_dwordx4 v[52:55], v0, s[8:11], s71 offen offset:1024 sc1
    s_mov_b32 m0, 24576
    s_add_u32 s70, s72, 256
    buffer_load_dwordx4 v33, s[24:27], s70 offen lds
    s_mov_b32 m0, 25600
    s_add_u32 s70, s72, 2816
    buffer_load_dwordx4 v33, s[24:27], s70 offen lds
    s_mov_b32 m0, 26624
    s_add_u32 s70, s72, 20736
    buffer_load_dwordx4 v35, s[24:27], s70 offen lds
    s_mov_b32 m0, 27648
    s_add_u32 s70, s72, 23296
    buffer_load_dwordx4 v35, s[24:27], s70 offen lds
    ds_read_b64_tr_b16 v[160:161], v16 offset:4096
    ds_read_b64_tr_b16 v[162:163], v16 offset:5120
    ds_read_b64_tr_b16 v[164:165], v20 offset:4096
    ds_read_b64_tr_b16 v[166:167], v20 offset:5120
    ds_read_b64_tr_b16 v[168:169], v17 offset:4096
    ds_read_b64_tr_b16 v[170:171], v17 offset:5120
    ds_read_b64_tr_b16 v[172:173], v21 offset:4096
    ds_read_b64_tr_b16 v[174:175], v21 offset:5120
    s_waitcnt vmcnt(28) lgkmcnt(0)
    s_barrier
    s_mov_b32 m0, 28672
    s_mov_b32 s70, 512
    buffer_load_dwordx4 v33, s[24:27], s70 offen lds
    s_mov_b32 m0, 29696
    s_mov_b32 s70, 3072
    buffer_load_dwordx4 v33, s[24:27], s70 offen lds
    s_mov_b32 m0, 30720
    s_mov_b32 s70, 20992
    buffer_load_dwordx4 v35, s[24:27], s70 offen lds
    s_mov_b32 m0, 31744
    s_mov_b32 s70, 23552
    buffer_load_dwordx4 v35, s[24:27], s70 offen lds
    ds_read_b64_tr_b16 v[128:129], v16 offset:8192
    ds_read_b64_tr_b16 v[130:131], v16 offset:9216
    ds_read_b64_tr_b16 v[132:133], v20 offset:8192
    ds_read_b64_tr_b16 v[134:135], v20 offset:9216
    ds_read_b64_tr_b16 v[136:137], v17 offset:8192
    ds_read_b64_tr_b16 v[138:139], v17 offset:9216
    ds_read_b64_tr_b16 v[140:141], v21 offset:8192
    ds_read_b64_tr_b16 v[142:143], v21 offset:9216
    s_waitcnt vmcnt(28) lgkmcnt(0)
    s_barrier
    s_mov_b32 m0, 32768
    s_add_u32 s70, s72, 81920
    buffer_load_dwordx4 v33, s[24:27], s70 offen lds
    s_mov_b32 m0, 33792
    s_add_u32 s70, s72, 84480
    buffer_load_dwordx4 v33, s[24:27], s70 offen lds
    s_mov_b32 m0, 34816
    s_add_u32 s70, s72, 102400
    buffer_load_dwordx4 v35, s[24:27], s70 offen lds
    s_mov_b32 m0, 35840
    s_add_u32 s70, s72, 104960
    buffer_load_dwordx4 v35, s[24:27], s70 offen lds
    ds_read_b64_tr_b16 v[232:233], v16 offset:12288
    ds_read_b64_tr_b16 v[234:235], v16 offset:13312
    ds_read_b64_tr_b16 v[236:237], v20 offset:12288
    ds_read_b64_tr_b16 v[238:239], v20 offset:13312
    ds_read_b64_tr_b16 v[240:241], v17 offset:12288
    ds_read_b64_tr_b16 v[242:243], v17 offset:13312
    ds_read_b64_tr_b16 v[244:245], v21 offset:12288
    ds_read_b64_tr_b16 v[246:247], v21 offset:13312
    s_waitcnt vmcnt(28) lgkmcnt(0)
    s_barrier
    s_mov_b32 m0, 36864
    s_mov_b32 s70, 524288
    buffer_load_dwordx4 v32, s[12:15], s70 offen lds
    s_mov_b32 m0, 37888
    s_mov_b32 s70, 540672
    buffer_load_dwordx4 v32, s[12:15], s70 offen lds
    s_mov_b32 m0, 38912
    s_mov_b32 s70, 557056
    buffer_load_dwordx4 v34, s[12:15], s70 offen lds
    s_mov_b32 m0, 39936
    s_mov_b32 s70, 573440
    buffer_load_dwordx4 v34, s[12:15], s70 offen lds
    ds_read_b64_tr_b16 v[176:177], v16 offset:16384
    ds_read_b64_tr_b16 v[178:179], v16 offset:17408
    ds_read_b64_tr_b16 v[180:181], v20 offset:16384
    ds_read_b64_tr_b16 v[182:183], v20 offset:17408
    ds_read_b64_tr_b16 v[184:185], v17 offset:16384
    ds_read_b64_tr_b16 v[186:187], v17 offset:17408
    ds_read_b64_tr_b16 v[188:189], v21 offset:16384
    ds_read_b64_tr_b16 v[190:191], v21 offset:17408
    s_waitcnt vmcnt(28) lgkmcnt(0)
    s_barrier
    s_mov_b32 m0, 40960
    s_mov_b32 s70, 1048576
    buffer_load_dwordx4 v32, s[12:15], s70 offen lds
    s_mov_b32 m0, 41984
    s_mov_b32 s70, 1064960
    buffer_load_dwordx4 v32, s[12:15], s70 offen lds
    s_mov_b32 m0, 43008
    s_mov_b32 s70, 1081344
    buffer_load_dwordx4 v34, s[12:15], s70 offen lds
    s_mov_b32 m0, 44032
    s_mov_b32 s70, 1097728
    buffer_load_dwordx4 v34, s[12:15], s70 offen lds
    ds_read_b64_tr_b16 v[192:193], v16 offset:20480
    ds_read_b64_tr_b16 v[194:195], v16 offset:21504
    ds_read_b64_tr_b16 v[196:197], v20 offset:20480
    ds_read_b64_tr_b16 v[198:199], v20 offset:21504
    ds_read_b64_tr_b16 v[64:65], v17 offset:20480
    ds_read_b64_tr_b16 v[66:67], v17 offset:21504
    ds_read_b64_tr_b16 v[68:69], v21 offset:20480
    ds_read_b64_tr_b16 v[70:71], v21 offset:21504
    s_waitcnt vmcnt(28) lgkmcnt(0)
    s_barrier
    s_add_u32 s71, s3, s72
    buffer_store_dwordx4 v[64:67], v0, s[8:11], s71 offen offset:0 sc1
    buffer_store_dwordx4 v[68:71], v0, s[8:11], s71 offen offset:1024 sc1
    s_mov_b32 m0, 45056
    s_mov_b32 s70, 524288
    buffer_load_dwordx4 v32, s[16:19], s70 offen lds
    s_mov_b32 m0, 46080
    s_mov_b32 s70, 540672
    buffer_load_dwordx4 v32, s[16:19], s70 offen lds
    s_mov_b32 m0, 47104
    s_mov_b32 s70, 557056
    buffer_load_dwordx4 v34, s[16:19], s70 offen lds
    s_mov_b32 m0, 48128
    s_mov_b32 s70, 573440
    buffer_load_dwordx4 v34, s[16:19], s70 offen lds
    ds_read_b64_tr_b16 v[216:217], v16 offset:24576
    ds_read_b64_tr_b16 v[218:219], v16 offset:25600
    ds_read_b64_tr_b16 v[220:221], v20 offset:24576
    ds_read_b64_tr_b16 v[222:223], v20 offset:25600
    ds_read_b64_tr_b16 v[224:225], v17 offset:24576
    ds_read_b64_tr_b16 v[226:227], v17 offset:25600
    ds_read_b64_tr_b16 v[228:229], v21 offset:24576
    ds_read_b64_tr_b16 v[230:231], v21 offset:25600
    s_waitcnt vmcnt(30) lgkmcnt(0)
    s_barrier
    s_mov_b32 m0, 49152
    s_mov_b32 s70, 2097152
    buffer_load_dwordx4 v32, s[16:19], s70 offen lds
    s_mov_b32 m0, 50176
    s_mov_b32 s70, 2113536
    buffer_load_dwordx4 v32, s[16:19], s70 offen lds
    s_mov_b32 m0, 51200
    s_mov_b32 s70, 2129920
    buffer_load_dwordx4 v34, s[16:19], s70 offen lds
    s_mov_b32 m0, 52224
    s_mov_b32 s70, 2146304
    buffer_load_dwordx4 v34, s[16:19], s70 offen lds
    ds_read_b64_tr_b16 v[248:249], v16 offset:28672
    ds_read_b64_tr_b16 v[250:251], v16 offset:29696
    ds_read_b64_tr_b16 v[252:253], v20 offset:28672
    ds_read_b64_tr_b16 v[254:255], v20 offset:29696
    ds_read_b64_tr_b16 a[0:1], v17 offset:28672
    ds_read_b64_tr_b16 a[2:3], v17 offset:29696
    ds_read_b64_tr_b16 a[4:5], v21 offset:28672
    ds_read_b64_tr_b16 a[6:7], v21 offset:29696
    s_waitcnt vmcnt(26) lgkmcnt(0)
    s_barrier
    s_mov_b32 m0, 53248
    s_mov_b32 s70, 2621440
    buffer_load_dwordx4 v32, s[16:19], s70 offen lds
    s_mov_b32 m0, 54272
    s_mov_b32 s70, 2637824
    buffer_load_dwordx4 v32, s[16:19], s70 offen lds
    s_mov_b32 m0, 55296
    s_mov_b32 s70, 2654208
    buffer_load_dwordx4 v34, s[16:19], s70 offen lds
    s_mov_b32 m0, 56320
    s_mov_b32 s70, 2670592
    buffer_load_dwordx4 v34, s[16:19], s70 offen lds
    ds_read_b64_tr_b16 v[40:41], v18 offset:0
    ds_read_b64_tr_b16 v[42:43], v18 offset:1024
    ds_read_b64_tr_b16 v[44:45], v22 offset:0
    ds_read_b64_tr_b16 v[46:47], v22 offset:1024
    ds_read_b64_tr_b16 v[48:49], v19 offset:0
    ds_read_b64_tr_b16 v[50:51], v19 offset:1024
    ds_read_b64_tr_b16 v[52:53], v23 offset:0
    ds_read_b64_tr_b16 v[54:55], v23 offset:1024
    s_waitcnt vmcnt(26) lgkmcnt(0)
    s_barrier
    s_add_u32 s71, s5, s72
    buffer_store_dwordx4 v[40:43], v0, s[8:11], s71 offen offset:2048 sc1
    buffer_store_dwordx4 v[44:47], v0, s[8:11], s71 offen offset:3072 sc1
    s_add_u32 s71, s6, s72
    buffer_store_dwordx4 v[48:51], v0, s[8:11], s71 offen offset:0 sc1
    buffer_store_dwordx4 v[52:55], v0, s[8:11], s71 offen offset:1024 sc1
    s_mov_b32 m0, 24576
    s_mov_b32 s70, 3670016
    buffer_load_dwordx4 v32, s[16:19], s70 offen lds
    s_mov_b32 m0, 25600
    s_mov_b32 s70, 3686400
    buffer_load_dwordx4 v32, s[16:19], s70 offen lds
    s_mov_b32 m0, 26624
    s_mov_b32 s70, 3702784
    buffer_load_dwordx4 v34, s[16:19], s70 offen lds
    s_mov_b32 m0, 27648
    s_mov_b32 s70, 3719168
    buffer_load_dwordx4 v34, s[16:19], s70 offen lds
    ds_read_b64_tr_b16 a[216:217], v18 offset:4096
    ds_read_b64_tr_b16 a[218:219], v18 offset:5120
    ds_read_b64_tr_b16 a[220:221], v22 offset:4096
    ds_read_b64_tr_b16 a[222:223], v22 offset:5120
    ds_read_b64_tr_b16 v[64:65], v19 offset:4096
    ds_read_b64_tr_b16 v[66:67], v19 offset:5120
    ds_read_b64_tr_b16 v[68:69], v23 offset:4096
    ds_read_b64_tr_b16 v[70:71], v23 offset:5120
    s_waitcnt vmcnt(30) lgkmcnt(0)
    s_barrier
    s_add_u32 s71, s6, s72
    buffer_store_dwordx4 v[64:67], v0, s[8:11], s71 offen offset:2048 sc1
    buffer_store_dwordx4 v[68:71], v0, s[8:11], s71 offen offset:3072 sc1
    s_mov_b32 m0, 28672
    s_mov_b32 s70, 4718592
    buffer_load_dwordx4 v32, s[16:19], s70 offen lds
    s_mov_b32 m0, 29696
    s_mov_b32 s70, 4734976
    buffer_load_dwordx4 v32, s[16:19], s70 offen lds
    s_mov_b32 m0, 30720
    s_mov_b32 s70, 4751360
    buffer_load_dwordx4 v34, s[16:19], s70 offen lds
    s_mov_b32 m0, 31744
    s_mov_b32 s70, 4767744
    buffer_load_dwordx4 v34, s[16:19], s70 offen lds
    ds_read_b64_tr_b16 v[40:41], v18 offset:8192
    ds_read_b64_tr_b16 v[42:43], v18 offset:9216
    ds_read_b64_tr_b16 v[44:45], v22 offset:8192
    ds_read_b64_tr_b16 v[46:47], v22 offset:9216
    ds_read_b64_tr_b16 v[48:49], v19 offset:8192
    ds_read_b64_tr_b16 v[50:51], v19 offset:9216
    ds_read_b64_tr_b16 v[52:53], v23 offset:8192
    ds_read_b64_tr_b16 v[54:55], v23 offset:9216
    s_waitcnt vmcnt(32) lgkmcnt(0)
    s_barrier
    s_add_u32 s71, s3, s72
    buffer_store_dwordx4 v[40:43], v0, s[8:11], s71 offen offset:2048 sc1
    buffer_store_dwordx4 v[44:47], v0, s[8:11], s71 offen offset:3072 sc1
    s_add_u32 s71, s5, s72
    buffer_store_dwordx4 v[48:51], v0, s[8:11], s71 offen offset:0 sc1
    buffer_store_dwordx4 v[52:55], v0, s[8:11], s71 offen offset:1024 sc1
    s_mov_b32 m0, 32768
    s_mov_b32 s70, 0
    buffer_load_dwordx4 v32, s[20:23], s70 offen lds
    s_mov_b32 m0, 33792
    s_mov_b32 s70, 16384
    buffer_load_dwordx4 v32, s[20:23], s70 offen lds
    s_mov_b32 m0, 34816
    s_mov_b32 s70, 32768
    buffer_load_dwordx4 v34, s[20:23], s70 offen lds
    s_mov_b32 m0, 35840
    s_mov_b32 s70, 49152
    buffer_load_dwordx4 v34, s[20:23], s70 offen lds
    ds_read_b64_tr_b16 v[80:81], v16 offset:12288
    ds_read_b64_tr_b16 v[82:83], v16 offset:13312
    ds_read_b64_tr_b16 v[84:85], v20 offset:12288
    ds_read_b64_tr_b16 v[86:87], v20 offset:13312
    ds_read_b64_tr_b16 v[88:89], v17 offset:12288
    ds_read_b64_tr_b16 v[90:91], v17 offset:13312
    ds_read_b64_tr_b16 v[92:93], v21 offset:12288
    ds_read_b64_tr_b16 v[94:95], v21 offset:13312
    s_waitcnt vmcnt(36) lgkmcnt(0)
    s_barrier
    s_mov_b32 m0, 36864
    s_mov_b32 s70, 524288
    buffer_load_dwordx4 v32, s[20:23], s70 offen lds
    s_mov_b32 m0, 37888
    s_mov_b32 s70, 540672
    buffer_load_dwordx4 v32, s[20:23], s70 offen lds
    s_mov_b32 m0, 38912
    s_mov_b32 s70, 557056
    buffer_load_dwordx4 v34, s[20:23], s70 offen lds
    s_mov_b32 m0, 39936
    s_mov_b32 s70, 573440
    buffer_load_dwordx4 v34, s[20:23], s70 offen lds
    ds_read_b64_tr_b16 v[112:113], v16 offset:16384
    ds_read_b64_tr_b16 v[114:115], v16 offset:17408
    ds_read_b64_tr_b16 v[116:117], v20 offset:16384
    ds_read_b64_tr_b16 v[118:119], v20 offset:17408
    ds_read_b64_tr_b16 v[120:121], v17 offset:16384
    ds_read_b64_tr_b16 v[122:123], v17 offset:17408
    ds_read_b64_tr_b16 v[124:125], v21 offset:16384
    ds_read_b64_tr_b16 v[126:127], v21 offset:17408
    s_cmp_eq_u32 s54, 0
    s_cbranch_scc1 CH0_nosend_68
    s_waitcnt vmcnt(0)
    s_cmp_lg_u32 s96, 0
    s_cbranch_scc1 RDY_ok_69
    s_mov_b32 s68, 0
RDY_lp_70:
    buffer_load_dword v24, off, s[48:51], 0 offset:32 sc1
    s_waitcnt vmcnt(0)
    v_readfirstlane_b32 s70, v24
    s_nop 0
    s_cmp_ge_u32 s70, 256
    s_cbranch_scc1 RDY_all_71
    s_sleep 8
    s_add_u32 s68, s68, 1
    s_cmp_lt_u32 s68, 65536
    s_cbranch_scc1 RDY_lp_70
    s_branch RDY_ok_69
RDY_all_71:
    v_mbcnt_lo_u32_b32 v25, -1, 0
    v_and_b32 v25, 7, v25
    v_min_u32 v26, 1, v25
    v_lshlrev_b32 v25, 2, v25
    v_lshl_add_u32 v25, v26, 7, v25
    buffer_load_dword v24, v25, s[48:51], 0 offen sc1
    s_waitcnt vmcnt(0)
    v_cmp_ne_u32 vcc, 32, v24
    s_nop 0
    s_cbranch_vccnz L_slow
RDY_ok_69:
    v_mov_b32 v24, 1
    s_add_u32 s71, s66, 0
    buffer_store_dword v24, off, s[8:11], s71 sc1
CH0_nosend_68:
    s_waitcnt vmcnt(34) lgkmcnt(0)
    s_barrier
    s_mov_b32 m0, 40960
    s_mov_b32 s70, 1048576
    buffer_load_dwordx4 v32, s[20:23], s70 offen lds
    s_mov_b32 m0, 41984
    s_mov_b32 s70, 1064960
    buffer_load_dwordx4 v32, s[20:23], s70 offen lds
    s_mov_b32 m0, 43008
    s_mov_b32 s70, 1081344
    buffer_load_dwordx4 v34, s[20:23], s70 offen lds
    s_mov_b32 m0, 44032
    s_mov_b32 s70, 1097728
    buffer_load_dwordx4 v34, s[20:23], s70 offen lds
    ds_read_b64_tr_b16 v[96:97], v16 offset:20480
    ds_read_b64_tr_b16 v[98:99], v16 offset:21504
    ds_read_b64_tr_b16 v[100:101], v20 offset:20480
    ds_read_b64_tr_b16 v[102:103], v20 offset:21504
    ds_read_b64_tr_b16 v[104:105], v17 offset:20480
    ds_read_b64_tr_b16 v[106:107], v17 offset:21504
    ds_read_b64_tr_b16 v[108:109], v21 offset:20480
    ds_read_b64_tr_b16 v[110:111], v21 offset:21504
    s_waitcnt vmcnt(34) lgkmcnt(0)
    s_barrier
    s_mov_b32 m0, 45056
    s_mov_b32 s70, 1572864
    buffer_load_dwordx4 v32, s[20:23], s70 offen lds
    s_mov_b32 m0, 46080
    s_mov_b32 s70, 1589248
    buffer_load_dwordx4 v32, s[20:23], s70 offen lds
    s_mov_b32 m0, 47104
    s_mov_b32 s70, 1605632
    buffer_load_dwordx4 v34, s[20:23], s70 offen lds
    s_mov_b32 m0, 48128
    s_mov_b32 s70, 1622016
    buffer_load_dwordx4 v34, s[20:23], s70 offen lds
    ds_read_b64_tr_b16 v[144:145], v16 offset:24576
    ds_read_b64_tr_b16 v[146:147], v16 offset:25600
    ds_read_b64_tr_b16 v[148:149], v20 offset:24576
    ds_read_b64_tr_b16 v[150:151], v20 offset:25600
    ds_read_b64_tr_b16 v[152:153], v17 offset:24576
    ds_read_b64_tr_b16 v[154:155], v17 offset:25600
    ds_read_b64_tr_b16 v[156:157], v21 offset:24576
    ds_read_b64_tr_b16 v[158:159], v21 offset:25600
    s_waitcnt vmcnt(34) lgkmcnt(0)
    s_barrier
    s_mov_b32 m0, 49152
    s_mov_b32 s70, 2097152
    buffer_load_dwordx4 v32, s[20:23], s70 offen lds
    s_mov_b32 m0, 50176
    s_mov_b32 s70, 2113536
    buffer_load_dwordx4 v32, s[20:23], s70 offen lds
    s_mov_b32 m0, 51200
    s_mov_b32 s70, 2129920
    buffer_load_dwordx4 v34, s[20:23], s70 offen lds
    s_mov_b32 m0, 52224
    s_mov_b32 s70, 2146304
    buffer_load_dwordx4 v34, s[20:23], s70 offen lds
    ds_read_b64_tr_b16 v[56:57], v16 offset:28672
    ds_read_b64_tr_b16 v[58:59], v16 offset:29696
    ds_read_b64_tr_b16 v[60:61], v20 offset:28672
    ds_read_b64_tr_b16 v[62:63], v20 offset:29696
    ds_read_b64_tr_b16 v[64:65], v17 offset:28672
    ds_read_b64_tr_b16 v[66:67], v17 offset:29696
    ds_read_b64_tr_b16 v[68:69], v21 offset:28672
    ds_read_b64_tr_b16 v[70:71], v21 offset:29696
    s_waitcnt vmcnt(30) lgkmcnt(0)
    s_barrier
    ds_write_b128 v7, v[56:59] offset:32768
    ds_write_b128 v7, v[60:63] offset:33792
    ds_write_b128 v7, v[64:67] offset:34816
    ds_write_b128 v7, v[68:71] offset:35840
    s_mov_b32 m0, 53248
    s_mov_b32 s70, 2621440
    buffer_load_dwordx4 v32, s[20:23], s70 offen lds
    s_mov_b32 m0, 54272
    s_mov_b32 s70, 2637824
    buffer_load_dwordx4 v32, s[20:23], s70 offen lds
    s_mov_b32 m0, 55296
    s_mov_b32 s70, 2654208
    buffer_load_dwordx4 v34, s[20:23], s70 offen lds
    s_mov_b32 m0, 56320
    s_mov_b32 s70, 2670592
    buffer_load_dwordx4 v34, s[20:23], s70 offen lds
    ds_read_b64_tr_b16 v[200:201], v16 offset:0
    ds_read_b64_tr_b16 v[202:203], v16 offset:1024
    ds_read_b64_tr_b16 v[204:205], v20 offset:0
    ds_read_b64_tr_b16 v[206:207], v20 offset:1024
    ds_read_b64_tr_b16 v[208:209], v17 offset:0
    ds_read_b64_tr_b16 v[210:211], v17 offset:1024
    ds_read_b64_tr_b16 v[212:213], v21 offset:0
    ds_read_b64_tr_b16 v[214:215], v21 offset:1024
    s_waitcnt vmcnt(28) lgkmcnt(0)
    s_barrier
    s_mov_b32 m0, 24576
    s_mov_b32 s70, 3145728
    buffer_load_dwordx4 v32, s[20:23], s70 offen lds
    s_mov_b32 m0, 25600
    s_mov_b32 s70, 3162112
    buffer_load_dwordx4 v32, s[20:23], s70 offen lds
    s_mov_b32 m0, 26624
    s_mov_b32 s70, 3178496
    buffer_load_dwordx4 v34, s[20:23], s70 offen lds
    s_mov_b32 m0, 27648
    s_mov_b32 s70, 3194880
    buffer_load_dwordx4 v34, s[20:23], s70 offen lds
    ds_read_b64_tr_b16 a[8:9], v16 offset:4096
    ds_read_b64_tr_b16 a[10:11], v16 offset:5120
    ds_read_b64_tr_b16 a[12:13], v20 offset:4096
    ds_read_b64_tr_b16 a[14:15], v20 offset:5120
    ds_read_b64_tr_b16 a[16:17], v17 offset:4096
    ds_read_b64_tr_b16 a[18:19], v17 offset:5120
    ds_read_b64_tr_b16 a[20:21], v21 offset:4096
    ds_read_b64_tr_b16 a[22:23], v21 offset:5120
    s_waitcnt vmcnt(24) lgkmcnt(0)
    s_barrier
    s_mov_b32 m0, 28672
    s_mov_b32 s70, 3670016
    buffer_load_dwordx4 v32, s[20:23], s70 offen lds
    s_mov_b32 m0, 29696
    s_mov_b32 s70, 3686400
    buffer_load_dwordx4 v32, s[20:23], s70 offen lds
    s_mov_b32 m0, 30720
    s_mov_b32 s70, 3702784
    buffer_load_dwordx4 v34, s[20:23], s70 offen lds
    s_mov_b32 m0, 31744
    s_mov_b32 s70, 3719168
    buffer_load_dwordx4 v34, s[20:23], s70 offen lds
    ds_read_b64_tr_b16 a[24:25], v16 offset:8192
    ds_read_b64_tr_b16 a[26:27], v16 offset:9216
    ds_read_b64_tr_b16 a[28:29], v20 offset:8192
    ds_read_b64_tr_b16 a[30:31], v20 offset:9216
    ds_read_b64_tr_b16 a[32:33], v17 offset:8192
    ds_read_b64_tr_b16 a[34:35], v17 offset:9216
    ds_read_b64_tr_b16 a[36:37], v21 offset:8192
    ds_read_b64_tr_b16 a[38:39], v21 offset:9216
    s_waitcnt vmcnt(24) lgkmcnt(0)
    s_barrier
    s_mov_b32 m0, 32768
    s_mov_b32 s70, 4194304
    buffer_load_dwordx4 v32, s[20:23], s70 offen lds
    s_mov_b32 m0, 33792
    s_mov_b32 s70, 4210688
    buffer_load_dwordx4 v32, s[20:23], s70 offen lds
    s_mov_b32 m0, 34816
    s_mov_b32 s70, 4227072
    buffer_load_dwordx4 v34, s[20:23], s70 offen lds
    s_mov_b32 m0, 35840
    s_mov_b32 s70, 4243456
    buffer_load_dwordx4 v34, s[20:23], s70 offen lds
    ds_read_b64_tr_b16 a[40:41], v16 offset:12288
    ds_read_b64_tr_b16 a[42:43], v16 offset:13312
    ds_read_b64_tr_b16 a[44:45], v20 offset:12288
    ds_read_b64_tr_b16 a[46:47], v20 offset:13312
    ds_read_b64_tr_b16 a[48:49], v17 offset:12288
    ds_read_b64_tr_b16 a[50:51], v17 offset:13312
    ds_read_b64_tr_b16 a[52:53], v21 offset:12288
    ds_read_b64_tr_b16 a[54:55], v21 offset:13312
    s_waitcnt vmcnt(24) lgkmcnt(0)
    s_barrier
    s_mov_b32 m0, 36864
    s_mov_b32 s70, 4718592
    buffer_load_dwordx4 v32, s[20:23], s70 offen lds
    s_mov_b32 m0, 37888
    s_mov_b32 s70, 4734976
    buffer_load_dwordx4 v32, s[20:23], s70 offen lds
    s_mov_b32 m0, 38912
    s_mov_b32 s70, 4751360
    buffer_load_dwordx4 v34, s[20:23], s70 offen lds
    s_mov_b32 m0, 39936
    s_mov_b32 s70, 4767744
    buffer_load_dwordx4 v34, s[20:23], s70 offen lds
    ds_read_b64_tr_b16 a[56:57], v16 offset:16384
    ds_read_b64_tr_b16 a[58:59], v16 offset:17408
    ds_read_b64_tr_b16 a[60:61], v20 offset:16384
    ds_read_b64_tr_b16 a[62:63], v20 offset:17408
    ds_read_b64_tr_b16 a[64:65], v17 offset:16384
    ds_read_b64_tr_b16 a[66:67], v17 offset:17408
    ds_read_b64_tr_b16 a[68:69], v21 offset:16384
    ds_read_b64_tr_b16 a[70:71], v21 offset:17408
    s_waitcnt vmcnt(24) lgkmcnt(0)
    s_barrier
    s_mov_b32 m0, 40960
    s_mov_b32 s70, 0
    buffer_load_dwordx4 v33, s[24:27], s70 offen lds
    s_mov_b32 m0, 41984
    s_mov_b32 s70, 2560
    buffer_load_dwordx4 v33, s[24:27], s70 offen lds
    s_mov_b32 m0, 43008
    s_mov_b32 s70, 20480
    buffer_load_dwordx4 v35, s[24:27], s70 offen lds
    s_mov_b32 m0, 44032
    s_mov_b32 s70, 23040
    buffer_load_dwordx4 v35, s[24:27], s70 offen lds
    ds_read_b64_tr_b16 a[88:89], v16 offset:20480
    ds_read_b64_tr_b16 a[90:91], v16 offset:21504
    ds_read_b64_tr_b16 a[92:93], v20 offset:20480
    ds_read_b64_tr_b16 a[94:95], v20 offset:21504
    ds_read_b64_tr_b16 a[96:97], v17 offset:20480
    ds_read_b64_tr_b16 a[98:99], v17 offset:21504
    ds_read_b64_tr_b16 a[100:101], v21 offset:20480
    ds_read_b64_tr_b16 a[102:103], v21 offset:21504
    s_waitcnt vmcnt(24) lgkmcnt(0)
    s_barrier
    s_mov_b32 m0, 45056
    s_mov_b32 s70, 768
    buffer_load_dwordx4 v33, s[24:27], s70 offen lds
    s_mov_b32 m0, 46080
    s_mov_b32 s70, 3328
    buffer_load_dwordx4 v33, s[24:27], s70 offen lds
    s_mov_b32 m0, 47104
    s_mov_b32 s70, 21248
    buffer_load_dwordx4 v35, s[24:27], s70 offen lds
    s_mov_b32 m0, 48128
    s_mov_b32 s70, 23808
    buffer_load_dwordx4 v35, s[24:27], s70 offen lds
    ds_read_b64_tr_b16 a[72:73], v16 offset:24576
    ds_read_b64_tr_b16 a[74:75], v16 offset:25600
    ds_read_b64_tr_b16 a[76:77], v20 offset:24576
    ds_read_b64_tr_b16 a[78:79], v20 offset:25600
    ds_read_b64_tr_b16 a[80:81], v17 offset:24576
    ds_read_b64_tr_b16 a[82:83], v17 offset:25600
    ds_read_b64_tr_b16 a[84:85], v21 offset:24576
    ds_read_b64_tr_b16 a[86:87], v21 offset:25600
    s_waitcnt vmcnt(24) lgkmcnt(0)
    s_barrier
    s_mov_b32 m0, 49152
    s_mov_b32 s70, 1024
    buffer_load_dwordx4 v33, s[24:27], s70 offen lds
    s_mov_b32 m0, 50176
    s_mov_b32 s70, 3584
    buffer_load_dwordx4 v33, s[24:27], s70 offen lds
    s_mov_b32 m0, 51200
    s_mov_b32 s70, 21504
    buffer_load_dwordx4 v35, s[24:27], s70 offen lds
    s_mov_b32 m0, 52224
    s_mov_b32 s70, 24064
    buffer_load_dwordx4 v35, s[24:27], s70 offen lds
    ds_read_b64_tr_b16 a[152:153], v16 offset:28672
    ds_read_b64_tr_b16 a[154:155], v16 offset:29696
    ds_read_b64_tr_b16 a[156:157], v20 offset:28672
    ds_read_b64_tr_b16 a[158:159], v20 offset:29696
    ds_read_b64_tr_b16 a[160:161], v17 offset:28672
    ds_read_b64_tr_b16 a[162:163], v17 offset:29696
    ds_read_b64_tr_b16 a[164:165], v21 offset:28672
    ds_read_b64_tr_b16 a[166:167], v21 offset:29696
    s_waitcnt vmcnt(24) lgkmcnt(0)
    s_barrier
    s_mov_b32 m0, 53248
    s_mov_b32 s70, 82176
    buffer_load_dwordx4 v33, s[24:27], s70 offen lds
    s_mov_b32 m0, 54272
    s_mov_b32 s70, 84736
    buffer_load_dwordx4 v33, s[24:27], s70 offen lds
    s_mov_b32 m0, 55296
    s_mov_b32 s70, 102656
    buffer_load_dwordx4 v35, s[24:27], s70 offen lds
    s_mov_b32 m0, 56320
    s_mov_b32 s70, 105216
    buffer_load_dwordx4 v35, s[24:27], s70 offen lds
    ds_read_b64_tr_b16 a[104:105], v16 offset:0
    ds_read_b64_tr_b16 a[106:107], v16 offset:1024
    ds_read_b64_tr_b16 a[108:109], v20 offset:0
    ds_read_b64_tr_b16 a[110:111], v20 offset:1024
    ds_read_b64_tr_b16 a[112:113], v17 offset:0
    ds_read_b64_tr_b16 a[114:115], v17 offset:1024
    ds_read_b64_tr_b16 a[116:117], v21 offset:0
    ds_read_b64_tr_b16 a[118:119], v21 offset:1024
    s_waitcnt vmcnt(24) lgkmcnt(0)
    s_barrier
    s_mov_b32 m0, 24576
    s_mov_b32 s70, 0
    buffer_load_dwordx4 v32, s[16:19], s70 offen lds
    s_mov_b32 m0, 25600
    s_mov_b32 s70, 16384
    buffer_load_dwordx4 v32, s[16:19], s70 offen lds
    s_mov_b32 m0, 26624
    s_mov_b32 s70, 32768
    buffer_load_dwordx4 v34, s[16:19], s70 offen lds
    s_mov_b32 m0, 27648
    s_mov_b32 s70, 49152
    buffer_load_dwordx4 v34, s[16:19], s70 offen lds
    ds_read_b64_tr_b16 a[120:121], v16 offset:4096
    ds_read_b64_tr_b16 a[122:123], v16 offset:5120
    ds_read_b64_tr_b16 a[124:125], v20 offset:4096
    ds_read_b64_tr_b16 a[126:127], v20 offset:5120
    ds_read_b64_tr_b16 a[128:129], v17 offset:4096
    ds_read_b64_tr_b16 a[130:131], v17 offset:5120
    ds_read_b64_tr_b16 a[132:133], v21 offset:4096
    ds_read_b64_tr_b16 a[134:135], v21 offset:5120
    s_waitcnt vmcnt(24) lgkmcnt(0)
    s_barrier
    s_mov_b32 m0, 28672
    s_mov_b32 s70, 1048576
    buffer_load_dwordx4 v32, s[16:19], s70 offen lds
    s_mov_b32 m0, 29696
    s_mov_b32 s70, 1064960
    buffer_load_dwordx4 v32, s[16:19], s70 offen lds
    s_mov_b32 m0, 30720
    s_mov_b32 s70, 1081344
    buffer_load_dwordx4 v34, s[16:19], s70 offen lds
    s_mov_b32 m0, 31744
    s_mov_b32 s70, 1097728
    buffer_load_dwordx4 v34, s[16:19], s70 offen lds
    ds_read_b64_tr_b16 a[136:137], v16 offset:8192
    ds_read_b64_tr_b16 a[138:139], v16 offset:9216
    ds_read_b64_tr_b16 a[140:141], v20 offset:8192
    ds_read_b64_tr_b16 a[142:143], v20 offset:9216
    ds_read_b64_tr_b16 a[144:145], v17 offset:8192
    ds_read_b64_tr_b16 a[146:147], v17 offset:9216
    ds_read_b64_tr_b16 a[148:149], v21 offset:8192
    ds_read_b64_tr_b16 a[150:151], v21 offset:9216
    s_waitcnt vmcnt(24) lgkmcnt(0)
    s_barrier
    s_mov_b32 m0, 32768
    s_mov_b32 s70, 1572864
    buffer_load_dwordx4 v32, s[16:19], s70 offen lds
    s_mov_b32 m0, 33792
    s_mov_b32 s70, 1589248
    buffer_load_dwordx4 v32, s[16:19], s70 offen lds
    s_mov_b32 m0, 34816
    s_mov_b32 s70, 1605632
    buffer_load_dwordx4 v34, s[16:19], s70 offen lds
    s_mov_b32 m0, 35840
    s_mov_b32 s70, 1622016
    buffer_load_dwordx4 v34, s[16:19], s70 offen lds
    ds_read_b64_tr_b16 a[168:169], v16 offset:12288
    ds_read_b64_tr_b16 a[170:171], v16 offset:13312
    ds_read_b64_tr_b16 a[172:173], v20 offset:12288
    ds_read_b64_tr_b16 a[174:175], v20 offset:13312
    ds_read_b64_tr_b16 a[176:177], v17 offset:12288
    ds_read_b64_tr_b16 a[178:179], v17 offset:13312
    ds_read_b64_tr_b16 a[180:181], v21 offset:12288
    ds_read_b64_tr_b16 a[182:183], v21 offset:13312
    s_waitcnt vmcnt(24) lgkmcnt(0)
    s_barrier
    s_mov_b32 m0, 36864
    s_mov_b32 s70, 3145728
    buffer_load_dwordx4 v32, s[16:19], s70 offen lds
    s_mov_b32 m0, 37888
    s_mov_b32 s70, 3162112
    buffer_load_dwordx4 v32, s[16:19], s70 offen lds
    s_mov_b32 m0, 38912
    s_mov_b32 s70, 3178496
    buffer_load_dwordx4 v34, s[16:19], s70 offen lds
    s_mov_b32 m0, 39936
    s_mov_b32 s70, 3194880
    buffer_load_dwordx4 v34, s[16:19], s70 offen lds
    ds_read_b64_tr_b16 a[184:185], v18 offset:16384
    ds_read_b64_tr_b16 a[186:187], v18 offset:17408
    ds_read_b64_tr_b16 a[188:189], v22 offset:16384
    ds_read_b64_tr_b16 a[190:191], v22 offset:17408
    ds_read_b64_tr_b16 a[192:193], v19 offset:16384
    ds_read_b64_tr_b16 a[194:195], v19 offset:17408
    ds_read_b64_tr_b16 a[196:197], v23 offset:16384
    ds_read_b64_tr_b16 a[198:199], v23 offset:17408
    s_waitcnt vmcnt(24) lgkmcnt(0)
    s_barrier
    s_mov_b32 m0, 40960
    s_mov_b32 s70, 4194304
    buffer_load_dwordx4 v32, s[16:19], s70 offen lds
    s_mov_b32 m0, 41984
    s_mov_b32 s70, 4210688
    buffer_load_dwordx4 v32, s[16:19], s70 offen lds
    s_mov_b32 m0, 43008
    s_mov_b32 s70, 4227072
    buffer_load_dwordx4 v34, s[16:19], s70 offen lds
    s_mov_b32 m0, 44032
    s_mov_b32 s70, 4243456
    buffer_load_dwordx4 v34, s[16:19], s70 offen lds
    ds_read_b64_tr_b16 a[224:225], v18 offset:20480
    ds_read_b64_tr_b16 a[226:227], v18 offset:21504
    ds_read_b64_tr_b16 a[228:229], v22 offset:20480
    ds_read_b64_tr_b16 a[230:231], v22 offset:21504
    ds_read_b64_tr_b16 a[232:233], v19 offset:20480
    ds_read_b64_tr_b16 a[234:235], v19 offset:21504
    ds_read_b64_tr_b16 a[236:237], v23 offset:20480
    ds_read_b64_tr_b16 a[238:239], v23 offset:21504
    s_waitcnt vmcnt(24) lgkmcnt(0)
    s_barrier
    s_mov_b32 m0, 45056
    s_mov_b32 s70, 82432
    buffer_load_dwordx4 v33, s[24:27], s70 offen lds
    s_mov_b32 m0, 46080
    s_mov_b32 s70, 84992
    buffer_load_dwordx4 v33, s[24:27], s70 offen lds
    s_mov_b32 m0, 47104
    s_mov_b32 s70, 102912
    buffer_load_dwordx4 v35, s[24:27], s70 offen lds
    s_mov_b32 m0, 48128
    s_mov_b32 s70, 105472
    buffer_load_dwordx4 v35, s[24:27], s70 offen lds
    ds_read_b64_tr_b16 a[240:241], v18 offset:24576
    ds_read_b64_tr_b16 a[242:243], v18 offset:25600
    ds_read_b64_tr_b16 a[244:245], v22 offset:24576
    ds_read_b64_tr_b16 a[246:247], v22 offset:25600
    ds_read_b64_tr_b16 a[248:249], v19 offset:24576
    ds_read_b64_tr_b16 a[250:251], v19 offset:25600
    ds_read_b64_tr_b16 a[252:253], v23 offset:24576
    ds_read_b64_tr_b16 a[254:255], v23 offset:25600
    s_waitcnt vmcnt(24) lgkmcnt(0)
    s_barrier
    s_mov_b32 m0, 49152
    s_mov_b32 s70, 82688
    buffer_load_dwordx4 v33, s[24:27], s70 offen lds
    s_mov_b32 m0, 50176
    s_mov_b32 s70, 85248
    buffer_load_dwordx4 v33, s[24:27], s70 offen lds
    s_mov_b32 m0, 51200
    s_mov_b32 s70, 103168
    buffer_load_dwordx4 v35, s[24:27], s70 offen lds
    s_mov_b32 m0, 52224
    s_mov_b32 s70, 105728
    buffer_load_dwordx4 v35, s[24:27], s70 offen lds
    ds_read_b64_tr_b16 a[200:201], v18 offset:28672
    ds_read_b64_tr_b16 a[202:203], v18 offset:29696
    ds_read_b64_tr_b16 a[204:205], v22 offset:28672
    ds_read_b64_tr_b16 a[206:207], v22 offset:29696
    ds_read_b64_tr_b16 a[208:209], v19 offset:28672
    ds_read_b64_tr_b16 a[210:211], v19 offset:29696
    ds_read_b64_tr_b16 a[212:213], v23 offset:28672
    ds_read_b64_tr_b16 a[214:215], v23 offset:29696
    s_waitcnt vmcnt(24) lgkmcnt(0)
    s_barrier
    s_mov_b32 m0, 53248
    s_mov_b32 s70, 82944
    buffer_load_dwordx4 v33, s[24:27], s70 offen lds
    s_mov_b32 m0, 54272
    s_mov_b32 s70, 85504
    buffer_load_dwordx4 v33, s[24:27], s70 offen lds
    s_mov_b32 m0, 55296
    s_mov_b32 s70, 103424
    buffer_load_dwordx4 v35, s[24:27], s70 offen lds
    s_mov_b32 m0, 56320
    s_mov_b32 s70, 105984
    buffer_load_dwordx4 v35, s[24:27], s70 offen lds
    ds_read_b64_tr_b16 v[40:41], v16 offset:0
    ds_read_b64_tr_b16 v[42:43], v16 offset:1024
    ds_read_b64_tr_b16 v[44:45], v20 offset:0
    ds_read_b64_tr_b16 v[46:47], v20 offset:1024
    ds_read_b64_tr_b16 v[48:49], v17 offset:0
    ds_read_b64_tr_b16 v[50:51], v17 offset:1024
    ds_read_b64_tr_b16 v[52:53], v21 offset:0
    ds_read_b64_tr_b16 v[54:55], v21 offset:1024
    v_lshrrev_b32 v24, 4, v0
    v_bfe_u32 v25, v24, 2, 2
    v_lshlrev_b32 v25, 1, v25
    v_and_b32 v26, 1, v24
    v_add_u32 v25, v25, v26
    v_mul_u32_u24 v25, 1280, v25
    v_lshrrev_b32 v26, 4, v24
    v_lshl_add_u32 v25, v26, 5, v25
    v_bfe_u32 v26, v24, 1, 1
    v_lshl_add_u32 v25, v26, 4, v25
    buffer_load_dwordx4 v[8:11], v25, s[32:35], 0 offen offset:0
    buffer_load_dwordx4 v[12:15], v25, s[32:35], 0 offen offset:128
    buffer_load_dwordx4 v[36:39], v25, s[32:35], 0 offen offset:256
    v_and_b32 v26, 7, v24
    v_min_u32 v27, 1, v26
    v_lshlrev_b32 v26, 2, v26
    v_lshl_add_u32 v26, v27, 7, v26
    buffer_load_dword v72, off, s[48:51], 0 offset:32 sc1
    buffer_load_dword v73, v26, s[48:51], 0 offen sc1
    v_lshlrev_b32 v24, 3, v0
    buffer_load_dwordx4 v[28:31], v0, s[8:11], s59 offen offset:0 sc1
    buffer_load_dwordx4 v[28:31], v0, s[8:11], s59 offen offset:1024 sc1
    buffer_load_dwordx4 v[28:31], v0, s[8:11], s60 offen offset:0 sc1
    buffer_load_dwordx4 v[28:31], v0, s[8:11], s60 offen offset:1024 sc1
    s_add_u32 s70, s56, 0
    buffer_load_dword v74, v24, s[8:11], s70 offen sc1
    s_waitcnt vmcnt(34) lgkmcnt(0)
    s_barrier
    ds_write_b128 v7, v[40:43] offset:0
    ds_write_b128 v7, v[44:47] offset:1024
    ds_write_b128 v7, v[48:51] offset:2048
    ds_write_b128 v7, v[52:55] offset:3072
    ds_read_b64_tr_b16 v[56:57], v16 offset:4096
    ds_read_b64_tr_b16 v[58:59], v16 offset:5120
    ds_read_b64_tr_b16 v[60:61], v20 offset:4096
    ds_read_b64_tr_b16 v[62:63], v20 offset:5120
    ds_read_b64_tr_b16 v[64:65], v17 offset:4096
    ds_read_b64_tr_b16 v[66:67], v17 offset:5120
    ds_read_b64_tr_b16 v[68:69], v21 offset:4096
    ds_read_b64_tr_b16 v[70:71], v21 offset:5120
    s_waitcnt vmcnt(30) lgkmcnt(0)
    s_barrier
    ds_write_b128 v7, v[56:59] offset:4096
    ds_write_b128 v7, v[60:63] offset:5120
    ds_write_b128 v7, v[64:67] offset:6144
    ds_write_b128 v7, v[68:71] offset:7168
    ds_read_b64_tr_b16 v[40:41], v16 offset:8192
    ds_read_b64_tr_b16 v[42:43], v16 offset:9216
    ds_read_b64_tr_b16 v[44:45], v20 offset:8192
    ds_read_b64_tr_b16 v[46:47], v20 offset:9216
    ds_read_b64_tr_b16 v[48:49], v17 offset:8192
    ds_read_b64_tr_b16 v[50:51], v17 offset:9216
    ds_read_b64_tr_b16 v[52:53], v21 offset:8192
    ds_read_b64_tr_b16 v[54:55], v21 offset:9216
    s_waitcnt vmcnt(26) lgkmcnt(0)
    s_barrier
    ds_write_b128 v7, v[40:43] offset:8192
    ds_write_b128 v7, v[44:47] offset:9216
    ds_write_b128 v7, v[48:51] offset:10240
    ds_write_b128 v7, v[52:55] offset:11264
    ds_read_b64_tr_b16 v[56:57], v16 offset:12288
    ds_read_b64_tr_b16 v[58:59], v16 offset:13312
    ds_read_b64_tr_b16 v[60:61], v20 offset:12288
    ds_read_b64_tr_b16 v[62:63], v20 offset:13312
    ds_read_b64_tr_b16 v[64:65], v17 offset:12288
    ds_read_b64_tr_b16 v[66:67], v17 offset:13312
    ds_read_b64_tr_b16 v[68:69], v21 offset:12288
    ds_read_b64_tr_b16 v[70:71], v21 offset:13312
    s_waitcnt vmcnt(22) lgkmcnt(0)
    s_barrier
    ds_write_b128 v7, v[56:59] offset:12288
    ds_write_b128 v7, v[60:63] offset:13312
    ds_write_b128 v7, v[64:67] offset:14336
    ds_write_b128 v7, v[68:71] offset:15360
    ds_read_b64_tr_b16 v[40:41], v16 offset:16384
    ds_read_b64_tr_b16 v[42:43], v16 offset:17408
    ds_read_b64_tr_b16 v[44:45], v20 offset:16384
    ds_read_b64_tr_b16 v[46:47], v20 offset:17408
    ds_read_b64_tr_b16 v[48:49], v17 offset:16384
    ds_read_b64_tr_b16 v[50:51], v17 offset:17408
    ds_read_b64_tr_b16 v[52:53], v21 offset:16384
    ds_read_b64_tr_b16 v[54:55], v21 offset:17408
    s_waitcnt vmcnt(18) lgkmcnt(0)
    s_barrier
    ds_write_b128 v7, v[40:43] offset:16384
    ds_write_b128 v7, v[44:47] offset:17408
    ds_write_b128 v7, v[48:51] offset:18432
    ds_write_b128 v7, v[52:55] offset:19456
    ds_read_b64_tr_b16 v[56:57], v18 offset:20480
    ds_read_b64_tr_b16 v[58:59], v18 offset:21504
    ds_read_b64_tr_b16 v[60:61], v22 offset:20480
    ds_read_b64_tr_b16 v[62:63], v22 offset:21504
    ds_read_b64_tr_b16 v[64:65], v19 offset:20480
    ds_read_b64_tr_b16 v[66:67], v19 offset:21504
    ds_read_b64_tr_b16 v[68:69], v23 offset:20480
    ds_read_b64_tr_b16 v[70:71], v23 offset:21504
    s_waitcnt vmcnt(14) lgkmcnt(0)
    s_barrier
    ds_write_b128 v7, v[56:59] offset:20480
    ds_write_b128 v7, v[60:63] offset:21504
    ds_write_b128 v7, v[64:67] offset:22528
    ds_write_b128 v7, v[68:71] offset:23552
    ds_read_b64_tr_b16 v[40:41], v18 offset:24576
    ds_read_b64_tr_b16 v[42:43], v18 offset:25600
    ds_read_b64_tr_b16 v[44:45], v22 offset:24576
    ds_read_b64_tr_b16 v[46:47], v22 offset:25600
    ds_read_b64_tr_b16 v[48:49], v19 offset:24576
    ds_read_b64_tr_b16 v[50:51], v19 offset:25600
    ds_read_b64_tr_b16 v[52:53], v23 offset:24576
    ds_read_b64_tr_b16 v[54:55], v23 offset:25600
    s_waitcnt vmcnt(10) lgkmcnt(0)
    s_barrier
    ds_write_b128 v7, v[40:43] offset:24576
    ds_write_b128 v7, v[44:47] offset:25600
    ds_write_b128 v7, v[48:51] offset:26624
    ds_write_b128 v7, v[52:55] offset:27648
    ds_read_b64_tr_b16 v[56:57], v18 offset:28672
    ds_read_b64_tr_b16 v[58:59], v18 offset:29696
    ds_read_b64_tr_b16 v[60:61], v22 offset:28672
    ds_read_b64_tr_b16 v[62:63], v22 offset:29696
    ds_read_b64_tr_b16 v[64:65], v19 offset:28672
    ds_read_b64_tr_b16 v[66:67], v19 offset:29696
    ds_read_b64_tr_b16 v[68:69], v23 offset:28672
    ds_read_b64_tr_b16 v[70:71], v23 offset:29696
    s_waitcnt vmcnt(0)
    s_lshl_b32 s71, s53, 7
    s_add_u32 s71, s71, 24576
    buffer_load_dword v75, off, s[8:11], s71 sc1
    s_waitcnt lgkmcnt(0)
    s_barrier
    ds_write_b128 v7, v[56:59] offset:28672
    ds_write_b128 v7, v[60:63] offset:29696
    ds_write_b128 v7, v[64:67] offset:30720
    ds_write_b128 v7, v[68:71] offset:31744
    s_waitcnt vmcnt(0) lgkmcnt(0)
    v_readfirstlane_b32 s70, v72
    v_cmp_ne_u32 vcc, 32, v73
    s_cmp_ge_u32 s70, 256
    s_cselect_b32 s70, vcc_lo, 1
    s_cmp_eq_u32 s70, 0
    s_cbranch_scc1 CH0_rdy
    s_cmp_lg_u32 s96, 0
    s_cbranch_scc1 RDY_ok_72
    s_mov_b32 s68, 0
RDY_lp_73:
    buffer_load_dword v40, off, s[48:51], 0 offset:32 sc1
    s_waitcnt vmcnt(0)
    v_readfirstlane_b32 s70, v40
    s_nop 0
    s_cmp_ge_u32 s70, 256
    s_cbranch_scc1 RDY_all_74
    s_sleep 8
    s_add_u32 s68, s68, 1
    s_cmp_lt_u32 s68, 65536
    s_cbranch_scc1 RDY_lp_73
    s_branch RDY_ok_72
RDY_all_74:
    v_mbcnt_lo_u32_b32 v41, -1, 0
    v_and_b32 v41, 7, v41
    v_min_u32 v42, 1, v41
    v_lshlrev_b32 v41, 2, v41
    v_lshl_add_u32 v41, v42, 7, v41
    buffer_load_dword v40, v41, s[48:51], 0 offen sc1
    s_waitcnt vmcnt(0)
    v_cmp_ne_u32 vcc, 32, v40
    s_nop 0
    s_cbranch_vccnz L_slow
RDY_ok_72:
    v_mov_b32 v75, 0
CH0_rdy:
    s_mov_b32 s40, 0x3f803f80
    s_mov_b32 s41, 0x3f803f80
    ds_write_b128 v0, v[36:39] offset:2048
    v_mov_b64 v[28:29], v[36:37]
    v_mov_b64 v[30:31], v[38:39]
    ds_write_b128 v0, v[12:15] offset:1024
    v_mov_b64 v[36:37], v[12:13]
    v_mov_b64 v[38:39], v[14:15]
    ds_write_b128 v0, v[8:11] offset:0
    v_mov_b64 v[32:33], v[8:9]
    v_mov_b64 v[34:35], v[10:11]
    s_lshl_b32 s71, s53, 7
    s_add_u32 s71, s71, 24576
    s_mov_b32 s68, 0
    v_readfirstlane_b32 s70, v75
    s_nop 0
    s_cmp_lg_u32 s70, 0
    s_cbranch_scc1 CH0_sok
CH0_sw:
    buffer_load_dword v72, off, s[8:11], s71 sc1
    s_waitcnt vmcnt(0)
    v_readfirstlane_b32 s70, v72
    s_nop 0
    s_cmp_lg_u32 s70, 0
    s_cbranch_scc1 CH0_sok
    s_sleep 2
    s_add_u32 s68, s68, 1
    s_cmp_lt_u32 s68, 65536
    s_cbranch_scc1 CH0_sw
CH0_sok:
    buffer_load_dwordx4 v[40:43], v0, s[8:11], s61 offen offset:2048
    buffer_load_dwordx4 v[44:47], v0, s[8:11], s61 offen offset:3072
    buffer_load_dwordx4 v[72:75], v0, s[8:11], s61 offen offset:0
    buffer_load_dwordx4 v[76:79], v0, s[8:11], s61 offen offset:1024
    ds_read_b128 v[56:59], v7 offset:0
    ds_read_b128 v[60:63], v7 offset:1024
    ds_read_b128 v[64:67], v7 offset:2048
    ds_read_b128 v[68:71], v7 offset:3072
    s_waitcnt lgkmcnt(0)
    v_mov_b64 v[8:9], 0
    v_mov_b64 v[10:11], 0
    v_mov_b64 v[12:13], 0
    v_mov_b64 v[14:15], 0
    v_mov_b64 v[16:17], 0
    v_mov_b64 v[18:19], 0
    v_mov_b64 v[20:21], 0
    v_mov_b64 v[22:23], 0
    s_cmp_lg_u32 s96, 0
    s_cbranch_scc1 CHS0_start
CHF0_start:
    s_barrier
    s_mov_b32 m0, 16384
    s_nop 0
    buffer_load_dwordx4 v0, s[8:11], s63 offen offset:0 sc1 lds
    buffer_load_dwordx4 v0, s[8:11], s63 offen offset:1024 sc1 lds
    s_add_u32 s63, s63, 262144
    s_waitcnt vmcnt(0) lgkmcnt(0)
CHF0_loop:
    s_barrier
    v_mov_b32 v23, 0
    v_smfmac_f32_16x16x64_bf16 v[8:11], v[32:35], v[40:47], v1
    buffer_load_dwordx4 v[40:43], v0, s[8:11], s3 offen offset:0
    v_smfmac_f32_16x16x64_bf16 v[12:15], v[32:35], v[72:79], v1
    buffer_load_dwordx4 v[44:47], v0, s[8:11], s3 offen offset:1024
    v_smfmac_f32_16x16x64_bf16 v[16:19], v[32:35], v[56:63], v1
    ds_read_b128 v[56:59], v7 offset:4096
    v_smfmac_f32_16x16x64_bf16 v[20:23], v[32:35], v[64:71], v1
    ds_read_b128 v[32:35], v0 offset:4096
    ds_read_b128 v[60:63], v7 offset:5120
    v_smfmac_f32_16x16x64_bf16 v[8:11], v[36:39], v[80:87], v1
    ds_read_b128 v[64:67], v7 offset:6144
    v_smfmac_f32_16x16x64_bf16 v[12:15], v[36:39], v[88:95], v1
    ds_read_b128 v[68:71], v7 offset:7168
    v_smfmac_f32_16x16x64_bf16 v[16:19], v[36:39], v[96:103], v1
    ds_read_b128 v[72:75], v7 offset:8192
    buffer_load_dwordx4 v[48:51], v0, s[8:11], s62 offen offset:0 sc1
    v_smfmac_f32_16x16x64_bf16 v[20:23], v[36:39], v[104:111], v1
    ds_read_b128 v[36:39], v0 offset:3072
    v_smfmac_f32_16x16x64_bf16 v[8:11], v[28:31], v[112:119], v1
    ds_read_b128 v[76:79], v7 offset:9216
    buffer_load_dwordx4 v[52:55], v0, s[8:11], s62 offen offset:1024 sc1
    v_smfmac_f32_16x16x64_bf16 v[12:15], v[28:31], v[120:127], v1
    buffer_store_dwordx4 v[24:27], v0, s[8:11], s64 offen sc1
    s_waitcnt lgkmcnt(3)
    v_smfmac_f32_16x16x64_bf16 v[16:19], v[28:31], v[56:63], v1
    ds_read_b128 v[24:27], v0 offset:6144
    ds_read_b128 v[56:59], v7 offset:10240
    ds_read_b128 v[60:63], v7 offset:11264
    v_smfmac_f32_16x16x64_bf16 v[20:23], v[28:31], v[64:71], v1
    ds_read_b128 v[28:31], v0 offset:7168
    v_smfmac_f32_16x16x64_bf16 v[8:11], v[32:35], v[128:135], v1
    ds_read_b128 v[64:67], v7 offset:12288
    v_smfmac_f32_16x16x64_bf16 v[12:15], v[32:35], v[136:143], v1
    ds_read_b128 v[68:71], v7 offset:13312
    v_smfmac_f32_16x16x64_bf16 v[16:19], v[32:35], v[144:151], v1
    v_smfmac_f32_16x16x64_bf16 v[20:23], v[32:35], v[152:159], v1
    ds_read_b128 v[32:35], v0 offset:5120
    s_waitcnt lgkmcnt(4)
    v_smfmac_f32_16x16x64_bf16 v[16:19], v[36:39], v[72:79], v1
    ds_read_b128 v[72:75], v7 offset:14336
    ds_read_b128 v[76:79], v7 offset:15360
    v_smfmac_f32_16x16x64_bf16 v[20:23], v[36:39], v[56:63], v1
    v_smfmac_f32_16x16x64_bf16 v[8:11], v[36:39], v[160:167], v1
    ds_read_b128 v[56:59], v7 offset:16384
    v_smfmac_f32_16x16x64_bf16 v[12:15], v[36:39], v[168:175], v1
    ds_read_b128 v[36:39], v0 offset:9216
    v_smfmac_f32_16x16x64_bf16 v[8:11], v[24:27], v[176:183], v1
    ds_read_b128 v[60:63], v7 offset:17408
    v_smfmac_f32_16x16x64_bf16 v[12:15], v[24:27], v[184:191], v1
    s_waitcnt lgkmcnt(3)
    v_smfmac_f32_16x16x64_bf16 v[16:19], v[24:27], v[64:71], v1
    ds_read_b128 v[64:67], v7 offset:18432
    ds_read_b128 v[68:71], v7 offset:19456
    v_smfmac_f32_16x16x64_bf16 v[20:23], v[24:27], v[72:79], v1
    ds_read_b128 v[24:27], v0 offset:8192
    v_smfmac_f32_16x16x64_bf16 v[8:11], v[28:31], v[192:199], v1
    ds_read_b128 v[72:75], v7 offset:32768
    s_waitcnt vmcnt(3)
    v_smfmac_f32_16x16x64_bf16 v[12:15], v[28:31], v[40:47], v1
    ds_read_b128 v[76:79], v7 offset:33792
    v_smfmac_f32_16x16x64_bf16 v[16:19], v[28:31], v[200:207], v1
    v_smfmac_f32_16x16x64_bf16 v[20:23], v[28:31], v[208:215], v1
    s_waitcnt lgkmcnt(2)
    v_smfmac_f32_16x16x64_bf16 v[16:19], v[24:27], v[56:63], v1
    ds_read_b128 v[56:59], v7 offset:34816
    ds_read_b128 v[60:63], v7 offset:35840
    v_mov_b64 v[28:29], 0
    v_smfmac_f32_16x16x64_bf16 v[20:23], v[24:27], v[64:71], v1
    v_mov_b64 v[30:31], 0
    v_smfmac_f32_16x16x64_bf16 v[8:11], v[24:27], v[216:223], v1
    ds_read_b128 v[40:43], v0 offset:16384
    v_smfmac_f32_16x16x64_bf16 v[12:15], v[24:27], v[224:231], v1
    ds_read_b128 v[44:47], v0 offset:20480
    v_smfmac_f32_16x16x64_bf16 v[8:11], v[32:35], v[232:239], v1
    v_mov_b64 v[24:25], 0
    v_smfmac_f32_16x16x64_bf16 v[12:15], v[32:35], v[240:247], v1
    v_mov_b64 v[26:27], 0
    s_waitcnt lgkmcnt(2)
    v_smfmac_f32_16x16x64_bf16 v[16:19], v[32:35], v[72:79], v1
    v_smfmac_f32_16x16x64_bf16 v[20:23], v[32:35], v[56:63], v1
    v_smfmac_f32_16x16x64_bf16 v[8:11], v[36:39], v[248:255], v1
    ds_read_b128 v[64:67], v0 offset:17408
    v_smfmac_f32_16x16x64_bf16 v[12:15], v[36:39], a[0:7], v1
    ds_read_b128 v[68:71], v0 offset:21504
    v_smfmac_f32_16x16x64_bf16 v[16:19], v[36:39], a[8:15], v1
    v_smfmac_f32_16x16x64_bf16 v[20:23], v[36:39], a[16:23], v1
    v_smfmac_f32_16x16x64_bf16 v[24:27], v[36:39], a[168:175], v1
    s_nop 1
    v_add_f32 v8, v8, v10
    v_add_f32 v9, v9, v11
    v_add_f32 v12, v12, v14
    v_add_f32 v13, v13, v15
    v_mul_f32 v8, s79, v8
    v_mul_f32 v12, s79, v12
    v_mul_f32 v9, s79, v9
    v_mul_f32 v13, s79, v13
    v_cvt_pk_bf16_f32 v10, v8, v12
    v_cvt_pk_bf16_f32 v11, v9, v13
    ds_write2_b32 v5, v10, v11 offset0:0 offset1:4
    v_add_f32 v16, v16, v18
    v_add_f32 v17, v17, v19
    v_add_f32 v20, v20, v22
    v_add_f32 v21, v21, v23
    v_cvt_pk_bf16_f32 v18, v16, v20
    v_cvt_pk_bf16_f32 v19, v17, v21
    ds_write2_b32 v3, v18, v19 offset0:0 offset1:4
    v_smfmac_f32_16x16x64_bf16 v[28:31], v[36:39], a[176:183], v1
    ds_read_b128 v[36:39], v0 offset:0
    v_smfmac_f32_16x16x64_bf16 v[24:27], v[32:35], a[152:159], v1
    v_smfmac_f32_16x16x64_bf16 v[28:31], v[32:35], a[160:167], v1
    ds_read_b128 v[32:35], v0 offset:1024
    s_waitcnt lgkmcnt(2)
    s_barrier
    ds_read_b128 v[56:59], v6 offset:10240
    ds_read_b128 v[60:63], v6 offset:10752
    ds_read_b128 v[20:23], v6 offset:12288
    ds_read_b128 v[72:75], v6 offset:11264
    ds_read_b128 v[76:79], v6 offset:11776
    s_waitcnt lgkmcnt(6)
    v_smfmac_f32_16x16x64_bf16 v[24:27], v[36:39], a[24:31], v1
    v_smfmac_f32_16x16x64_bf16 v[28:31], v[36:39], a[32:39], v1
    ds_read_b128 v[36:39], v0 offset:2048
    s_waitcnt lgkmcnt(6)
    v_smfmac_f32_16x16x64_bf16 v[24:27], v[32:35], a[40:47], v1
    v_smfmac_f32_16x16x64_bf16 v[28:31], v[32:35], a[48:55], v1
    ds_read_b128 v[32:35], v0 offset:4096
    s_waitcnt lgkmcnt(6)
    v_mfma_f32_16x16x32_bf16 v[12:15], v[40:43], v[56:59], 0
    ds_read_b128 v[40:43], v6 offset:12800
    v_mfma_f32_16x16x32_bf16 v[16:19], v[44:47], v[56:59], 0
    ds_read_b128 v[44:47], v0 offset:18432
    s_waitcnt lgkmcnt(7)
    v_mfma_f32_16x16x32_bf16 v[12:15], v[64:67], v[60:63], v[12:15]
    ds_read_b128 v[64:67], v0 offset:22528
    v_mfma_f32_16x16x32_bf16 v[16:19], v[68:71], v[60:63], v[16:19]
    ds_read_b128 v[68:71], v6 offset:13312
    s_waitcnt lgkmcnt(8)
    v_mfma_f32_16x16x32_bf16 v[8:11], v[20:23], v[56:59], 0
    ds_read_b128 v[20:23], v6 offset:13824
    s_waitcnt lgkmcnt(4)
    v_mfma_f32_16x16x32_bf16 v[8:11], v[40:43], v[60:63], v[8:11]
    ds_read_b128 v[40:43], v0 offset:19456
    s_waitcnt lgkmcnt(4)
    v_mfma_f32_16x16x32_bf16 v[12:15], v[44:47], v[72:75], v[12:15]
    ds_read_b128 v[44:47], v0 offset:23552
    s_waitcnt lgkmcnt(4)
    v_mfma_f32_16x16x32_bf16 v[16:19], v[64:67], v[72:75], v[16:19]
    s_waitcnt lgkmcnt(3)
    v_mfma_f32_16x16x32_bf16 v[8:11], v[68:71], v[72:75], v[8:11]
    s_waitcnt lgkmcnt(2)
    v_mfma_f32_16x16x32_bf16 v[8:11], v[20:23], v[76:79], v[8:11]
    s_waitcnt lgkmcnt(1)
    v_mfma_f32_16x16x32_bf16 v[12:15], v[40:43], v[76:79], v[12:15]
    s_waitcnt lgkmcnt(0)
    v_mfma_f32_16x16x32_bf16 v[16:19], v[44:47], v[76:79], v[16:19]
    v_smfmac_f32_16x16x64_bf16 v[24:27], v[36:39], a[56:63], v1
    buffer_load_dwordx4 v[72:75], v0, s[8:11], s3 offen offset:2048
    v_smfmac_f32_16x16x64_bf16 v[28:31], v[36:39], a[64:71], v1
    ds_read_b128 v[36:39], v0 offset:3072
    buffer_load_dwordx4 v[76:79], v0, s[8:11], s3 offen offset:3072
    s_nop 0
    v_max3_f32 v10, v8, v9, v12
    v_max3_f32 v11, v13, v14, v15
    v_max3_f32 v10, v10, v16, v17
    v_max3_f32 v11, v11, v18, v19
    v_max_f32 v10, v10, v11
    v_max_f32 v11, v10, v11
    v_smfmac_f32_16x16x64_bf16 v[24:27], v[32:35], a[72:79], v1
    buffer_load_dwordx4 v[40:43], v0, s[8:11], s5 offen offset:0
    v_permlane32_swap_b32 v11, v10
    v_max_f32 v10, v10, v11
    v_max_f32 v11, v10, v11
    v_smfmac_f32_16x16x64_bf16 v[28:31], v[32:35], a[80:87], v1
    ds_read_b128 v[32:35], v0 offset:6144
    v_permlane16_swap_b32 v11, v10
    v_max_f32 v10, v10, v11
    v_sub_f32 v12, v12, v10
    s_waitcnt lgkmcnt(1)
    v_smfmac_f32_16x16x64_bf16 v[24:27], v[36:39], a[88:95], v1
    v_sub_f32 v13, v13, v10
    v_exp_f32 v12, v12
    v_smfmac_f32_16x16x64_bf16 v[28:31], v[36:39], a[96:103], v1
    ds_read_b128 v[36:39], v0 offset:7168
    buffer_load_dwordx4 v[44:47], v0, s[8:11], s5 offen offset:1024
    v_sub_f32 v14, v14, v10
    v_exp_f32 v13, v13
    s_waitcnt lgkmcnt(1)
    v_smfmac_f32_16x16x64_bf16 v[24:27], v[32:35], a[104:111], v1
    v_sub_f32 v15, v15, v10
    v_exp_f32 v14, v14
    v_smfmac_f32_16x16x64_bf16 v[28:31], v[32:35], a[112:119], v1
    ds_read_b128 v[32:35], v0 offset:8192
    v_cvt_pk_bf16_f32 v20, v12, v13
    v_sub_f32 v16, v16, v10
    v_exp_f32 v15, v15
    s_waitcnt lgkmcnt(1)
    v_smfmac_f32_16x16x64_bf16 v[24:27], v[36:39], a[120:127], v1
    buffer_load_dwordx4 v[56:59], v0, s[8:11], s5 offen offset:2048
    v_sub_f32 v17, v17, v10
    v_exp_f32 v16, v16
    v_smfmac_f32_16x16x64_bf16 v[28:31], v[36:39], a[128:135], v1
    v_cvt_pk_bf16_f32 v21, v14, v15
    v_sub_f32 v18, v18, v10
    v_exp_f32 v17, v17
    s_waitcnt lgkmcnt(0)
    v_smfmac_f32_16x16x64_bf16 v[24:27], v[32:35], a[136:143], v1
    v_mov_b64 v[12:13], s[40:41]
    v_mov_b64 v[14:15], s[40:41]
    v_sub_f32 v19, v19, v10
    v_exp_f32 v18, v18
    v_smfmac_f32_16x16x64_bf16 v[28:31], v[32:35], a[144:151], v1
    buffer_load_dwordx4 v[60:63], v0, s[8:11], s5 offen offset:3072
    v_cvt_pk_bf16_f32 v22, v16, v17
    v_sub_f32 v8, v8, v10
    v_exp_f32 v19, v19
    v_sub_f32 v9, v9, v10
    v_exp_f32 v8, v8
    v_cvt_pk_bf16_f32 v23, v18, v19
    v_exp_f32 v9, v9
    v_mov_b32 v11, 0
    v_cvt_pk_bf16_f32 v10, v8, v9
    s_waitcnt vmcnt(7)
    v_mfma_f32_16x16x32_bf16 v[16:19], v[12:15], v[20:23], 0
    v_add_f32 v24, v24, v26
    v_add_f32 v25, v25, v27
    v_mfma_f32_16x16x32_bf16 v[32:35], v[48:51], v[20:23], 0
    v_add_f32 v28, v28, v30
    v_add_f32 v29, v29, v31
    v_mfma_f32_16x16x32_bf16 v[36:39], v[52:55], v[20:23], 0
    v_cvt_pk_bf16_f32 v26, v24, v25
    v_cvt_pk_bf16_f32 v27, v28, v29
    v_mfma_f32_16x16x16_bf16 v[16:19], v[12:13], v[10:11], v[16:19]
    v_cvt_pk_bf16_f32 v28, v28, v29
    v_mov_b32 v29, 0
    v_mfma_f32_16x16x16_bf16 v[32:35], v[26:27], v[10:11], v[32:35]
    buffer_load_dwordx4 v[64:67], v0, s[8:11], s6 offen offset:0
    buffer_load_dwordx4 v[68:71], v0, s[8:11], s6 offen offset:1024
    v_mfma_f32_16x16x16_bf16 v[36:39], v[28:29], v[10:11], v[36:39]
    buffer_load_dwordx4 v[48:51], v0, s[8:11], s6 offen offset:2048
    v_lshrrev_b32 v30, 1, v0
    ds_write_b64 v30, v[26:27] offset:14336
    v_rcp_f32 v8, v16
    v_mov_b64 v[12:13], 0
    v_mov_b64 v[14:15], 0
    v_mul_f32 v32, v32, v8
    v_mul_f32 v33, v33, v8
    v_cvt_pk_bf16_f32 v16, v32, v33
    v_mul_f32 v34, v34, v8
    v_mul_f32 v35, v35, v8
    v_cvt_pk_bf16_f32 v17, v34, v35
    v_mul_f32 v36, v36, v8
    v_mul_f32 v37, v37, v8
    v_cvt_pk_bf16_f32 v18, v36, v37
    v_mul_f32 v38, v38, v8
    v_mul_f32 v39, v39, v8
    v_cvt_pk_bf16_f32 v19, v38, v39
    ds_write_b128 v6, v[16:19] offset:16384
    buffer_load_dwordx4 v[52:55], v0, s[8:11], s6 offen offset:3072
    v_mov_b64 v[8:9], 0
    v_mov_b64 v[10:11], 0
    v_mov_b64 v[20:21], 0
    v_mov_b64 v[22:23], 0
    v_mov_b64 v[24:25], 0
    v_mov_b64 v[28:29], 0
    s_waitcnt lgkmcnt(0)
    s_barrier
    ds_read_b128 v[32:35], v0 offset:16384
    ds_read_b128 v[36:39], v0 offset:17408
    s_cmp_eq_u32 s55, 63
    s_cbranch_scc1 CHF0_last
    v_mov_b64 v[16:17], 0
    v_mov_b64 v[18:19], 0
    v_mov_b64 v[26:27], 0
    v_mov_b64 v[30:31], 0
    s_waitcnt lgkmcnt(1)
    v_smfmac_f32_16x16x64_bf16 v[8:11], v[32:35], a[184:191], v1
    v_smfmac_f32_16x16x64_bf16 v[12:15], v[32:35], a[192:199], v1
    s_waitcnt vmcnt(6) lgkmcnt(0)
    v_smfmac_f32_16x16x64_bf16 v[8:11], v[36:39], v[72:79], v1
    buffer_load_dwordx4 v[72:75], v0, s[8:11], s61 offen offset:0
    v_smfmac_f32_16x16x64_bf16 v[12:15], v[36:39], v[40:47], v1
    s_waitcnt vmcnt(3)
    v_smfmac_f32_16x16x64_bf16 v[16:19], v[32:35], v[56:63], v1
    ds_read_b128 v[56:59], v7 offset:20480
    ds_read_b128 v[60:63], v7 offset:21504
    buffer_load_dwordx4 v[76:79], v0, s[8:11], s61 offen offset:1024
    v_smfmac_f32_16x16x64_bf16 v[20:23], v[32:35], v[64:71], v1
    ds_read_b128 v[64:67], v7 offset:22528
    ds_read_b128 v[68:71], v7 offset:23552
    buffer_load_dwordx4 v[40:43], v0, s[8:11], s61 offen offset:2048
    v_add_f32 v8, v8, v10
    v_add_f32 v9, v9, v11
    v_cvt_pk_bf16_f32 v8, v8, v9
    v_smfmac_f32_16x16x64_bf16 v[16:19], v[36:39], a[200:207], v1
    v_and_or_b32 v8, v8, -2, s65
    v_add_f32 v12, v12, v14
    v_add_f32 v13, v13, v15
    v_smfmac_f32_16x16x64_bf16 v[20:23], v[36:39], a[208:215], v1
    buffer_load_dwordx4 v[44:47], v0, s[8:11], s61 offen offset:3072
    v_cvt_pk_bf16_f32 v9, v12, v13
    buffer_store_dwordx2 v[8:9], v4, s[8:11], s58 offen
    v_mov_b64 v[12:13], 0
    s_waitcnt vmcnt(5)
    v_smfmac_f32_16x16x64_bf16 v[24:27], v[32:35], a[216:223], v1
    v_mov_b64 v[14:15], 0
    v_mov_b64 v[10:11], 0
    v_mov_b64 v[8:9], 0
    v_smfmac_f32_16x16x64_bf16 v[28:31], v[32:35], v[48:55], v1
    v_add_f32 v16, v16, v18
    v_add_f32 v17, v17, v19
    v_cvt_pk_bf16_f32 v16, v16, v17
    s_waitcnt lgkmcnt(0)
    v_smfmac_f32_16x16x64_bf16 v[24:27], v[36:39], v[56:63], v1
    ds_read_b128 v[56:59], v7 offset:24576
    ds_read_b128 v[60:63], v7 offset:25600
    v_and_or_b32 v16, v16, -2, s65
    v_add_f32 v20, v20, v22
    v_add_f32 v21, v21, v23
    v_smfmac_f32_16x16x64_bf16 v[28:31], v[36:39], v[64:71], v1
    ds_read_b128 v[64:67], v7 offset:26624
    ds_read_b128 v[68:71], v7 offset:27648
    v_cvt_pk_bf16_f32 v17, v20, v21
    buffer_store_dwordx2 v[16:17], v4, s[8:11], s75 offen
    v_mov_b64 v[20:21], 0
    v_smfmac_f32_16x16x64_bf16 v[8:11], v[32:35], a[224:231], v1
    v_mov_b64 v[22:23], 0
    v_mov_b64 v[18:19], 0
    v_mov_b64 v[16:17], 0
    v_smfmac_f32_16x16x64_bf16 v[12:15], v[32:35], a[232:239], v1
    v_add_f32 v24, v24, v26
    v_add_f32 v25, v25, v27
    v_cvt_pk_bf16_f32 v24, v24, v25
    s_waitcnt lgkmcnt(0)
    v_smfmac_f32_16x16x64_bf16 v[8:11], v[36:39], v[56:63], v1
    ds_read_b128 v[56:59], v7 offset:28672
    ds_read_b128 v[60:63], v7 offset:29696
    v_and_or_b32 v24, v24, -2, s65
    v_add_f32 v28, v28, v30
    v_add_f32 v29, v29, v31
    v_smfmac_f32_16x16x64_bf16 v[12:15], v[36:39], v[64:71], v1
    ds_read_b128 v[64:67], v7 offset:30720
    ds_read_b128 v[68:71], v7 offset:31744
    v_cvt_pk_bf16_f32 v25, v28, v29
    buffer_store_dwordx2 v[24:25], v4, s[8:11], s76 offen
    v_smfmac_f32_16x16x64_bf16 v[16:19], v[32:35], a[240:247], v1
    v_smfmac_f32_16x16x64_bf16 v[20:23], v[32:35], a[248:255], v1
    v_add_f32 v8, v8, v10
    v_add_f32 v9, v9, v11
    v_cvt_pk_bf16_f32 v8, v8, v9
    s_waitcnt lgkmcnt(0)
    v_smfmac_f32_16x16x64_bf16 v[16:19], v[36:39], v[56:63], v1
    v_and_or_b32 v8, v8, -2, s65
    v_add_f32 v12, v12, v14
    v_add_f32 v13, v13, v15
    v_smfmac_f32_16x16x64_bf16 v[20:23], v[36:39], v[64:71], v1
    v_cvt_pk_bf16_f32 v9, v12, v13
    buffer_store_dwordx2 v[8:9], v4, s[8:11], s77 offen
    s_nop 1
    v_add_f32 v16, v16, v18
    v_add_f32 v17, v17, v19
    v_cvt_pk_bf16_f32 v16, v16, v17
    v_and_or_b32 v16, v16, -2, s65
    v_add_f32 v20, v20, v22
    v_add_f32 v21, v21, v23
    v_cvt_pk_bf16_f32 v17, v20, v21
    buffer_store_dwordx2 v[16:17], v4, s[8:11], s4 offen
    s_barrier
    s_mov_b32 s68, 0
    v_bfe_u32 v29, v0, 4, 1
    v_lshlrev_b32 v29, 4, v29
    v_mov_b32 v30, 0x3f80
    v_lshlrev_b32 v29, v29, v30
    v_bfe_u32 v30, v0, 5, 3
    v_cmp_eq_u32 vcc, 0, v30
    s_nop 1
    v_cndmask_b32 v32, 0, v29, vcc
    v_cmp_eq_u32 vcc, 1, v30
    s_nop 1
    v_cndmask_b32 v33, 0, v29, vcc
    v_cmp_eq_u32 vcc, 2, v30
    s_nop 1
    v_cndmask_b32 v34, 0, v29, vcc
    v_cmp_eq_u32 vcc, 3, v30
    s_nop 1
    v_cndmask_b32 v35, 0, v29, vcc
    buffer_load_dwordx4 v[8:11], v0, s[8:11], s59 offen offset:0 sc1
    buffer_load_dwordx4 v[12:15], v0, s[8:11], s59 offen offset:1024 sc1
    buffer_load_dwordx4 v[16:19], v0, s[8:11], s60 offen offset:0 sc1
    buffer_load_dwordx4 v[20:23], v0, s[8:11], s60 offen offset:1024 sc1
    v_cmp_eq_u32 vcc, 4, v30
    s_nop 1
    v_cndmask_b32 v36, 0, v29, vcc
    v_cmp_eq_u32 vcc, 5, v30
    s_nop 1
    v_cndmask_b32 v37, 0, v29, vcc
    v_cmp_eq_u32 vcc, 6, v30
    s_nop 1
    v_cndmask_b32 v38, 0, v29, vcc
    v_cmp_eq_u32 vcc, 7, v30
    s_nop 1
    v_cndmask_b32 v39, 0, v29, vcc
    s_sleep 2
    buffer_load_dwordx4 v[56:59], v0, s[8:11], s59 offen offset:0 sc1
    buffer_load_dwordx4 v[60:63], v0, s[8:11], s59 offen offset:1024 sc1
    buffer_load_dwordx4 v[64:67], v0, s[8:11], s60 offen offset:0 sc1
    buffer_load_dwordx4 v[68:71], v0, s[8:11], s60 offen offset:1024 sc1
CHF0_rloop:
    s_waitcnt vmcnt(4)
    v_mfma_f32_16x16x32_bf16 v[24:27], v[8:11], v[32:35], 0
    v_and_b32 v29, v8, v10
    v_or_b32 v30, v8, v10
    v_mfma_f32_16x16x32_bf16 v[24:27], v[12:15], v[32:35], v[24:27]
    v_bitop3_b32 v29, v29, v12, v14 bitop3:0x80
    v_or3_b32 v30, v30, v12, v14
    v_mfma_f32_16x16x32_bf16 v[24:27], v[16:19], v[36:39], v[24:27]
    v_bitop3_b32 v29, v29, v16, v18 bitop3:0x80
    v_or3_b32 v30, v30, v16, v18
    v_mfma_f32_16x16x32_bf16 v[24:27], v[20:23], v[36:39], v[24:27]
    v_bitop3_b32 v29, v29, v20, v22 bitop3:0x80
    v_or3_b32 v30, v30, v20, v22
    v_bitop3_b32 v29, v29, v30, s65 bitop3:0x4e
    v_and_b32 v29, 1, v29
    v_cmp_ne_u32 vcc, 0, v29
    s_nop 2
    v_permlane32_swap_b32 v24, v26
    v_permlane32_swap_b32 v25, v27
    v_add_f32 v24, v24, v26
    v_add_f32 v25, v25, v27
    s_cbranch_vccnz CHF0_rbad0
    s_nop 0
    v_permlane16_swap_b32 v24, v25
    v_add_f32 v24, v24, v25
    v_cvt_pk_bf16_f32 v24, v24, v24
    buffer_store_short v24, v2, s[8:11], s56 offen
    s_branch CHF0_rdone
CHF0_rbad0:
    buffer_load_dwordx4 v[8:11], v0, s[8:11], s59 offen offset:0 sc1
    buffer_load_dwordx4 v[12:15], v0, s[8:11], s59 offen offset:1024 sc1
    buffer_load_dwordx4 v[16:19], v0, s[8:11], s60 offen offset:0 sc1
    buffer_load_dwordx4 v[20:23], v0, s[8:11], s60 offen offset:1024 sc1
    s_waitcnt vmcnt(4)
    v_mfma_f32_16x16x32_bf16 v[24:27], v[56:59], v[32:35], 0
    v_and_b32 v29, v56, v58
    v_or_b32 v30, v56, v58
    v_mfma_f32_16x16x32_bf16 v[24:27], v[60:63], v[32:35], v[24:27]
    v_bitop3_b32 v29, v29, v60, v62 bitop3:0x80
    v_or3_b32 v30, v30, v60, v62
    v_mfma_f32_16x16x32_bf16 v[24:27], v[64:67], v[36:39], v[24:27]
    v_bitop3_b32 v29, v29, v64, v66 bitop3:0x80
    v_or3_b32 v30, v30, v64, v66
    v_mfma_f32_16x16x32_bf16 v[24:27], v[68:71], v[36:39], v[24:27]
    v_bitop3_b32 v29, v29, v68, v70 bitop3:0x80
    v_or3_b32 v30, v30, v68, v70
    v_bitop3_b32 v29, v29, v30, s65 bitop3:0x4e
    v_and_b32 v29, 1, v29
    v_cmp_ne_u32 vcc, 0, v29
    s_nop 2
    v_permlane32_swap_b32 v24, v26
    v_permlane32_swap_b32 v25, v27
    v_add_f32 v24, v24, v26
    v_add_f32 v25, v25, v27
    s_cbranch_vccnz CHF0_rbad1
CHF0_rok:
    s_nop 0
    v_permlane16_swap_b32 v24, v25
    v_add_f32 v24, v24, v25
    v_cvt_pk_bf16_f32 v24, v24, v24
    buffer_store_short v24, v2, s[8:11], s56 offen
    s_branch CHF0_rdone
CHF0_rbad1:
    buffer_load_dwordx4 v[56:59], v0, s[8:11], s59 offen offset:0 sc1
    buffer_load_dwordx4 v[60:63], v0, s[8:11], s59 offen offset:1024 sc1
    buffer_load_dwordx4 v[64:67], v0, s[8:11], s60 offen offset:0 sc1
    buffer_load_dwordx4 v[68:71], v0, s[8:11], s60 offen offset:1024 sc1
    s_cmp_lg_u32 s69, 0
    s_cbranch_scc1 CHF0_rok
    s_add_u32 s68, s68, 1
    s_cmp_lt_u32 s68, 65536
    s_cbranch_scc1 CHF0_rloop
    s_mov_b32 s69, 1
    s_branch CHF0_rok
CHF0_rdone:
    v_mov_b32 v25, 0xff81ff81
    buffer_store_short v25, v2, s[8:11], s57 offen
    s_mov_b32 m0, 16384
    s_nop 0
    buffer_load_dwordx4 v0, s[8:11], s63 offen offset:0 sc1 lds
    buffer_load_dwordx4 v0, s[8:11], s63 offen offset:1024 sc1 lds
    s_add_u32 s63, s63, 262144
    v_and_b32 v28, 512, v0
    v_mul_u32_u24 v28, 3, v28
    v_add_u32 v28, v28, v0
    ds_read_b128 v[24:27], v28 offset:12288
    s_add_u32 s72, s56, 0
    s_xor_b32 s65, s65, 1
    s_add_u32 s64, s64, 131072
    s_xor_b32 s56, s56, s74
    s_xor_b32 s57, s57, s74
    s_add_u32 s62, s62, 262144
    s_add_u32 s55, s55, 1
    s_mov_b32 s68, 0
    s_mov_b32 m0, 0
    s_sleep 3
    buffer_load_dwordx4 v0, s[8:11], s72 offen offset:0 sc1 lds
    buffer_load_dwordx4 v0, s[8:11], s72 offen offset:1024 sc1 lds
    buffer_load_dwordx4 v0, s[8:11], s72 offen offset:2048 sc1 lds
    s_waitcnt vmcnt(7)
    ds_read_b128 v[56:59], v7 offset:0
    ds_read_b128 v[60:63], v7 offset:1024
    ds_read_b128 v[64:67], v7 offset:2048
    ds_read_b128 v[68:71], v7 offset:3072
    v_mov_b64 v[8:9], 0
    v_mov_b64 v[10:11], 0
    v_mov_b64 v[12:13], 0
    v_mov_b64 v[14:15], 0
    v_mov_b64 v[16:17], 0
    v_mov_b64 v[18:19], 0
    v_mov_b64 v[20:21], 0
    v_mov_b64 v[22:23], 0
    s_sleep 2
CHF0_gloop:
    buffer_load_dwordx4 v0, s[8:11], s72 offen offset:0 sc1 lds
    buffer_load_dwordx4 v0, s[8:11], s72 offen offset:1024 sc1 lds
    buffer_load_dwordx4 v0, s[8:11], s72 offen offset:2048 sc1 lds
    s_waitcnt vmcnt(3)
    ds_read_b128 v[32:35], v0 offset:0
    ds_read_b128 v[36:39], v0 offset:1024
    ds_read_b128 v[28:31], v0 offset:2048
    s_waitcnt lgkmcnt(2)
    v_pk_max_u16 v23, v32, v33
    v_pk_max_u16 v23, v23, v34
    v_pk_max_u16 v23, v23, v35
    s_waitcnt lgkmcnt(1)
    v_pk_max_u16 v23, v23, v36
    v_pk_max_u16 v23, v23, v37
    v_pk_max_u16 v23, v23, v38
    v_pk_max_u16 v23, v23, v39
    s_waitcnt lgkmcnt(0)
    v_pk_max_u16 v23, v23, v28
    v_pk_max_u16 v23, v23, v29
    v_pk_max_u16 v23, v23, v30
    v_pk_max_u16 v23, v23, v31
    v_pk_max_u16 v23, v23, v23 op_sel:[0,1] op_sel_hi:[1,0]
    s_nop 0
    v_cmp_le_u32 vcc, 0xff810000, v23
    s_nop 0
    s_cbranch_vccz CHF0_loop
    s_add_u32 s68, s68, 1
    s_cmp_lt_u32 s68, 64
    s_cbranch_scc1 CHF0_gloop
    s_cmp_lg_u32 s69, 0
    s_cbranch_scc1 CHF0_loop
    v_mov_b32 v23, -1
    v_xor_b32 v22, 0xff81ff81, v32
    v_pk_min_u16 v23, v23, v22
    v_xor_b32 v22, 0xff81ff81, v33
    v_pk_min_u16 v23, v23, v22
    v_xor_b32 v22, 0xff81ff81, v34
    v_pk_min_u16 v23, v23, v22
    v_xor_b32 v22, 0xff81ff81, v35
    v_pk_min_u16 v23, v23, v22
    v_xor_b32 v22, 0xff81ff81, v36
    v_pk_min_u16 v23, v23, v22
    v_xor_b32 v22, 0xff81ff81, v37
    v_pk_min_u16 v23, v23, v22
    v_xor_b32 v22, 0xff81ff81, v38
    v_pk_min_u16 v23, v23, v22
    v_xor_b32 v22, 0xff81ff81, v39
    v_pk_min_u16 v23, v23, v22
    v_xor_b32 v22, 0xff81ff81, v28
    v_pk_min_u16 v23, v23, v22
    v_xor_b32 v22, 0xff81ff81, v29
    v_pk_min_u16 v23, v23, v22
    v_xor_b32 v22, 0xff81ff81, v30
    v_pk_min_u16 v23, v23, v22
    v_xor_b32 v22, 0xff81ff81, v31
    v_pk_min_u16 v23, v23, v22
    v_pk_min_u16 v23, v23, v23 op_sel:[0,1] op_sel_hi:[1,0]
    v_mov_b32 v22, 0
    v_cmp_eq_u32 vcc, 0, v23
    s_nop 0
    s_cbranch_vccz CHF0_loop
    s_sleep 1
    s_cmp_lt_u32 s68, 65536
    s_cbranch_scc1 CHF0_gloop
    s_mov_b32 s69, 1
    s_branch CHF0_loop
CHF0_last:
    v_and_b32 v28, 512, v0
    v_mul_u32_u24 v28, 3, v28
    v_add_u32 v28, v28, v0
    ds_read_b128 v[24:27], v28 offset:12288
    s_add_u32 s64, s64, 131072
    s_waitcnt lgkmcnt(0)
    buffer_store_dwordx4 v[24:27], v0, s[8:11], s64 offen sc1
    s_waitcnt vmcnt(0)
    s_barrier
    s_waitcnt vmcnt(0) lgkmcnt(0)
    s_endpgm
CHS0_start:
    s_barrier
    s_mov_b32 m0, 16384
    s_nop 0
    buffer_load_dwordx4 v0, s[8:11], s63 offen offset:0 sc1 lds
    buffer_load_dwordx4 v0, s[8:11], s63 offen offset:1024 sc1 lds
    s_add_u32 s63, s63, 262144
    s_waitcnt vmcnt(0) lgkmcnt(0)
CHS0_loop:
    s_barrier
    v_mov_b32 v23, 0
    v_smfmac_f32_16x16x64_bf16 v[8:11], v[32:35], v[40:47], v1
    buffer_load_dwordx4 v[40:43], v0, s[8:11], s3 offen offset:0
    v_smfmac_f32_16x16x64_bf16 v[12:15], v[32:35], v[72:79], v1
    buffer_load_dwordx4 v[44:47], v0, s[8:11], s3 offen offset:1024
    v_smfmac_f32_16x16x64_bf16 v[16:19], v[32:35], v[56:63], v1
    ds_read_b128 v[56:59], v7 offset:4096
    v_smfmac_f32_16x16x64_bf16 v[20:23], v[32:35], v[64:71], v1
    ds_read_b128 v[32:35], v0 offset:4096
    ds_read_b128 v[60:63], v7 offset:5120
    v_smfmac_f32_16x16x64_bf16 v[8:11], v[36:39], v[80:87], v1
    ds_read_b128 v[64:67], v7 offset:6144
    v_smfmac_f32_16x16x64_bf16 v[12:15], v[36:39], v[88:95], v1
    ds_read_b128 v[68:71], v7 offset:7168
    v_smfmac_f32_16x16x64_bf16 v[16:19], v[36:39], v[96:103], v1
    ds_read_b128 v[72:75], v7 offset:8192
    buffer_load_dwordx4 v[48:51], v0, s[8:11], s62 offen offset:0 sc1
    v_smfmac_f32_16x16x64_bf16 v[20:23], v[36:39], v[104:111], v1
    ds_read_b128 v[36:39], v0 offset:3072
    v_smfmac_f32_16x16x64_bf16 v[8:11], v[28:31], v[112:119], v1
    ds_read_b128 v[76:79], v7 offset:9216
    buffer_load_dwordx4 v[52:55], v0, s[8:11], s62 offen offset:1024 sc1
    v_smfmac_f32_16x16x64_bf16 v[12:15], v[28:31], v[120:127], v1
    buffer_store_dwordx4 v[24:27], v0, s[8:11], s64 offen sc1
    s_waitcnt lgkmcnt(3)
    v_smfmac_f32_16x16x64_bf16 v[16:19], v[28:31], v[56:63], v1
    ds_read_b128 v[24:27], v0 offset:6144
    ds_read_b128 v[56:59], v7 offset:10240
    ds_read_b128 v[60:63], v7 offset:11264
    v_smfmac_f32_16x16x64_bf16 v[20:23], v[28:31], v[64:71], v1
    ds_read_b128 v[28:31], v0 offset:7168
    v_smfmac_f32_16x16x64_bf16 v[8:11], v[32:35], v[128:135], v1
    ds_read_b128 v[64:67], v7 offset:12288
    v_smfmac_f32_16x16x64_bf16 v[12:15], v[32:35], v[136:143], v1
    ds_read_b128 v[68:71], v7 offset:13312
    v_smfmac_f32_16x16x64_bf16 v[16:19], v[32:35], v[144:151], v1
    v_smfmac_f32_16x16x64_bf16 v[20:23], v[32:35], v[152:159], v1
    ds_read_b128 v[32:35], v0 offset:5120
    s_waitcnt lgkmcnt(4)
    v_smfmac_f32_16x16x64_bf16 v[16:19], v[36:39], v[72:79], v1
    ds_read_b128 v[72:75], v7 offset:14336
    ds_read_b128 v[76:79], v7 offset:15360
    v_smfmac_f32_16x16x64_bf16 v[20:23], v[36:39], v[56:63], v1
    v_smfmac_f32_16x16x64_bf16 v[8:11], v[36:39], v[160:167], v1
    ds_read_b128 v[56:59], v7 offset:16384
    v_smfmac_f32_16x16x64_bf16 v[12:15], v[36:39], v[168:175], v1
    ds_read_b128 v[36:39], v0 offset:9216
    v_smfmac_f32_16x16x64_bf16 v[8:11], v[24:27], v[176:183], v1
    ds_read_b128 v[60:63], v7 offset:17408
    v_smfmac_f32_16x16x64_bf16 v[12:15], v[24:27], v[184:191], v1
    s_waitcnt lgkmcnt(3)
    v_smfmac_f32_16x16x64_bf16 v[16:19], v[24:27], v[64:71], v1
    ds_read_b128 v[64:67], v7 offset:18432
    ds_read_b128 v[68:71], v7 offset:19456
    v_smfmac_f32_16x16x64_bf16 v[20:23], v[24:27], v[72:79], v1
    ds_read_b128 v[24:27], v0 offset:8192
    v_smfmac_f32_16x16x64_bf16 v[8:11], v[28:31], v[192:199], v1
    ds_read_b128 v[72:75], v7 offset:32768
    s_waitcnt vmcnt(3)
    v_smfmac_f32_16x16x64_bf16 v[12:15], v[28:31], v[40:47], v1
    ds_read_b128 v[76:79], v7 offset:33792
    v_smfmac_f32_16x16x64_bf16 v[16:19], v[28:31], v[200:207], v1
    v_smfmac_f32_16x16x64_bf16 v[20:23], v[28:31], v[208:215], v1
    s_waitcnt lgkmcnt(2)
    v_smfmac_f32_16x16x64_bf16 v[16:19], v[24:27], v[56:63], v1
    ds_read_b128 v[56:59], v7 offset:34816
    ds_read_b128 v[60:63], v7 offset:35840
    v_mov_b64 v[28:29], 0
    v_smfmac_f32_16x16x64_bf16 v[20:23], v[24:27], v[64:71], v1
    v_mov_b64 v[30:31], 0
    v_smfmac_f32_16x16x64_bf16 v[8:11], v[24:27], v[216:223], v1
    ds_read_b128 v[40:43], v0 offset:16384
    v_smfmac_f32_16x16x64_bf16 v[12:15], v[24:27], v[224:231], v1
    ds_read_b128 v[44:47], v0 offset:20480
    v_smfmac_f32_16x16x64_bf16 v[8:11], v[32:35], v[232:239], v1
    v_mov_b64 v[24:25], 0
    v_smfmac_f32_16x16x64_bf16 v[12:15], v[32:35], v[240:247], v1
    v_mov_b64 v[26:27], 0
    s_waitcnt lgkmcnt(2)
    v_smfmac_f32_16x16x64_bf16 v[16:19], v[32:35], v[72:79], v1
    v_smfmac_f32_16x16x64_bf16 v[20:23], v[32:35], v[56:63], v1
    v_smfmac_f32_16x16x64_bf16 v[8:11], v[36:39], v[248:255], v1
    ds_read_b128 v[64:67], v0 offset:17408
    v_smfmac_f32_16x16x64_bf16 v[12:15], v[36:39], a[0:7], v1
    ds_read_b128 v[68:71], v0 offset:21504
    v_smfmac_f32_16x16x64_bf16 v[16:19], v[36:39], a[8:15], v1
    v_smfmac_f32_16x16x64_bf16 v[20:23], v[36:39], a[16:23], v1
    v_smfmac_f32_16x16x64_bf16 v[24:27], v[36:39], a[168:175], v1
    s_nop 1
    v_add_f32 v8, v8, v10
    v_add_f32 v9, v9, v11
    v_add_f32 v12, v12, v14
    v_add_f32 v13, v13, v15
    v_mul_f32 v8, s79, v8
    v_mul_f32 v12, s79, v12
    v_mul_f32 v9, s79, v9
    v_mul_f32 v13, s79, v13
    v_cvt_pk_bf16_f32 v10, v8, v12
    v_cvt_pk_bf16_f32 v11, v9, v13
    ds_write2_b32 v5, v10, v11 offset0:0 offset1:4
    v_add_f32 v16, v16, v18
    v_add_f32 v17, v17, v19
    v_add_f32 v20, v20, v22
    v_add_f32 v21, v21, v23
    v_cvt_pk_bf16_f32 v18, v16, v20
    v_cvt_pk_bf16_f32 v19, v17, v21
    ds_write2_b32 v3, v18, v19 offset0:0 offset1:4
    v_smfmac_f32_16x16x64_bf16 v[28:31], v[36:39], a[176:183], v1
    ds_read_b128 v[36:39], v0 offset:0
    v_smfmac_f32_16x16x64_bf16 v[24:27], v[32:35], a[152:159], v1
    v_smfmac_f32_16x16x64_bf16 v[28:31], v[32:35], a[160:167], v1
    ds_read_b128 v[32:35], v0 offset:1024
    s_waitcnt lgkmcnt(2)
    s_barrier
    ds_read_b128 v[56:59], v6 offset:10240
    ds_read_b128 v[60:63], v6 offset:10752
    ds_read_b128 v[20:23], v6 offset:12288
    ds_read_b128 v[72:75], v6 offset:11264
    ds_read_b128 v[76:79], v6 offset:11776
    s_waitcnt lgkmcnt(6)
    v_smfmac_f32_16x16x64_bf16 v[24:27], v[36:39], a[24:31], v1
    v_smfmac_f32_16x16x64_bf16 v[28:31], v[36:39], a[32:39], v1
    ds_read_b128 v[36:39], v0 offset:2048
    s_waitcnt lgkmcnt(6)
    v_smfmac_f32_16x16x64_bf16 v[24:27], v[32:35], a[40:47], v1
    v_smfmac_f32_16x16x64_bf16 v[28:31], v[32:35], a[48:55], v1
    ds_read_b128 v[32:35], v0 offset:4096
    s_waitcnt lgkmcnt(6)
    v_mfma_f32_16x16x32_bf16 v[12:15], v[40:43], v[56:59], 0
    ds_read_b128 v[40:43], v6 offset:12800
    v_mfma_f32_16x16x32_bf16 v[16:19], v[44:47], v[56:59], 0
    ds_read_b128 v[44:47], v0 offset:18432
    s_waitcnt lgkmcnt(7)
    v_mfma_f32_16x16x32_bf16 v[12:15], v[64:67], v[60:63], v[12:15]
    ds_read_b128 v[64:67], v0 offset:22528
    v_mfma_f32_16x16x32_bf16 v[16:19], v[68:71], v[60:63], v[16:19]
    ds_read_b128 v[68:71], v6 offset:13312
    s_waitcnt lgkmcnt(8)
    v_mfma_f32_16x16x32_bf16 v[8:11], v[20:23], v[56:59], 0
    ds_read_b128 v[20:23], v6 offset:13824
    s_waitcnt lgkmcnt(4)
    v_mfma_f32_16x16x32_bf16 v[8:11], v[40:43], v[60:63], v[8:11]
    ds_read_b128 v[40:43], v0 offset:19456
    s_waitcnt lgkmcnt(4)
    v_mfma_f32_16x16x32_bf16 v[12:15], v[44:47], v[72:75], v[12:15]
    ds_read_b128 v[44:47], v0 offset:23552
    s_waitcnt lgkmcnt(4)
    v_mfma_f32_16x16x32_bf16 v[16:19], v[64:67], v[72:75], v[16:19]
    s_waitcnt lgkmcnt(3)
    v_mfma_f32_16x16x32_bf16 v[8:11], v[68:71], v[72:75], v[8:11]
    s_waitcnt lgkmcnt(2)
    v_mfma_f32_16x16x32_bf16 v[8:11], v[20:23], v[76:79], v[8:11]
    s_waitcnt lgkmcnt(1)
    v_mfma_f32_16x16x32_bf16 v[12:15], v[40:43], v[76:79], v[12:15]
    s_waitcnt lgkmcnt(0)
    v_mfma_f32_16x16x32_bf16 v[16:19], v[44:47], v[76:79], v[16:19]
    v_smfmac_f32_16x16x64_bf16 v[24:27], v[36:39], a[56:63], v1
    buffer_load_dwordx4 v[72:75], v0, s[8:11], s3 offen offset:2048
    v_smfmac_f32_16x16x64_bf16 v[28:31], v[36:39], a[64:71], v1
    ds_read_b128 v[36:39], v0 offset:3072
    buffer_load_dwordx4 v[76:79], v0, s[8:11], s3 offen offset:3072
    s_nop 0
    v_max3_f32 v10, v8, v9, v12
    v_max3_f32 v11, v13, v14, v15
    v_max3_f32 v10, v10, v16, v17
    v_max3_f32 v11, v11, v18, v19
    v_max_f32 v10, v10, v11
    v_max_f32 v11, v10, v11
    v_smfmac_f32_16x16x64_bf16 v[24:27], v[32:35], a[72:79], v1
    buffer_load_dwordx4 v[40:43], v0, s[8:11], s5 offen offset:0
    v_permlane32_swap_b32 v11, v10
    v_max_f32 v10, v10, v11
    v_max_f32 v11, v10, v11
    v_smfmac_f32_16x16x64_bf16 v[28:31], v[32:35], a[80:87], v1
    ds_read_b128 v[32:35], v0 offset:6144
    v_permlane16_swap_b32 v11, v10
    v_max_f32 v10, v10, v11
    v_sub_f32 v12, v12, v10
    s_waitcnt lgkmcnt(1)
    v_smfmac_f32_16x16x64_bf16 v[24:27], v[36:39], a[88:95], v1
    v_sub_f32 v13, v13, v10
    v_exp_f32 v12, v12
    v_smfmac_f32_16x16x64_bf16 v[28:31], v[36:39], a[96:103], v1
    ds_read_b128 v[36:39], v0 offset:7168
    buffer_load_dwordx4 v[44:47], v0, s[8:11], s5 offen offset:1024
    v_sub_f32 v14, v14, v10
    v_exp_f32 v13, v13
    s_waitcnt lgkmcnt(1)
    v_smfmac_f32_16x16x64_bf16 v[24:27], v[32:35], a[104:111], v1
    v_sub_f32 v15, v15, v10
    v_exp_f32 v14, v14
    v_smfmac_f32_16x16x64_bf16 v[28:31], v[32:35], a[112:119], v1
    ds_read_b128 v[32:35], v0 offset:8192
    v_cvt_pk_bf16_f32 v20, v12, v13
    v_sub_f32 v16, v16, v10
    v_exp_f32 v15, v15
    s_waitcnt lgkmcnt(1)
    v_smfmac_f32_16x16x64_bf16 v[24:27], v[36:39], a[120:127], v1
    buffer_load_dwordx4 v[56:59], v0, s[8:11], s5 offen offset:2048
    v_sub_f32 v17, v17, v10
    v_exp_f32 v16, v16
    v_smfmac_f32_16x16x64_bf16 v[28:31], v[36:39], a[128:135], v1
    v_cvt_pk_bf16_f32 v21, v14, v15
    v_sub_f32 v18, v18, v10
    v_exp_f32 v17, v17
    s_waitcnt lgkmcnt(0)
    v_smfmac_f32_16x16x64_bf16 v[24:27], v[32:35], a[136:143], v1
    v_mov_b64 v[12:13], s[40:41]
    v_mov_b64 v[14:15], s[40:41]
    v_sub_f32 v19, v19, v10
    v_exp_f32 v18, v18
    v_smfmac_f32_16x16x64_bf16 v[28:31], v[32:35], a[144:151], v1
    buffer_load_dwordx4 v[60:63], v0, s[8:11], s5 offen offset:3072
    v_cvt_pk_bf16_f32 v22, v16, v17
    v_sub_f32 v8, v8, v10
    v_exp_f32 v19, v19
    v_sub_f32 v9, v9, v10
    v_exp_f32 v8, v8
    v_cvt_pk_bf16_f32 v23, v18, v19
    v_exp_f32 v9, v9
    v_mov_b32 v11, 0
    v_cvt_pk_bf16_f32 v10, v8, v9
    s_waitcnt vmcnt(7)
    v_mfma_f32_16x16x32_bf16 v[16:19], v[12:15], v[20:23], 0
    v_add_f32 v24, v24, v26
    v_add_f32 v25, v25, v27
    v_mfma_f32_16x16x32_bf16 v[32:35], v[48:51], v[20:23], 0
    v_add_f32 v28, v28, v30
    v_add_f32 v29, v29, v31
    v_mfma_f32_16x16x32_bf16 v[36:39], v[52:55], v[20:23], 0
    v_cvt_pk_bf16_f32 v26, v24, v25
    v_cvt_pk_bf16_f32 v27, v28, v29
    v_mfma_f32_16x16x16_bf16 v[16:19], v[12:13], v[10:11], v[16:19]
    v_cvt_pk_bf16_f32 v28, v28, v29
    v_mov_b32 v29, 0
    v_mfma_f32_16x16x16_bf16 v[32:35], v[26:27], v[10:11], v[32:35]
    buffer_load_dwordx4 v[64:67], v0, s[8:11], s6 offen offset:0
    buffer_load_dwordx4 v[68:71], v0, s[8:11], s6 offen offset:1024
    v_mfma_f32_16x16x16_bf16 v[36:39], v[28:29], v[10:11], v[36:39]
    buffer_load_dwordx4 v[48:51], v0, s[8:11], s6 offen offset:2048
    v_lshrrev_b32 v30, 1, v0
    ds_write_b64 v30, v[26:27] offset:14336
    v_rcp_f32 v8, v16
    v_mov_b64 v[12:13], 0
    v_mov_b64 v[14:15], 0
    v_mul_f32 v32, v32, v8
    v_mul_f32 v33, v33, v8
    v_cvt_pk_bf16_f32 v16, v32, v33
    v_mul_f32 v34, v34, v8
    v_mul_f32 v35, v35, v8
    v_cvt_pk_bf16_f32 v17, v34, v35
    v_mul_f32 v36, v36, v8
    v_mul_f32 v37, v37, v8
    v_cvt_pk_bf16_f32 v18, v36, v37
    v_mul_f32 v38, v38, v8
    v_mul_f32 v39, v39, v8
    v_cvt_pk_bf16_f32 v19, v38, v39
    ds_write_b128 v6, v[16:19] offset:16384
    buffer_load_dwordx4 v[52:55], v0, s[8:11], s6 offen offset:3072
    v_mov_b64 v[8:9], 0
    v_mov_b64 v[10:11], 0
    v_mov_b64 v[20:21], 0
    v_mov_b64 v[22:23], 0
    v_mov_b64 v[24:25], 0
    v_mov_b64 v[28:29], 0
    s_waitcnt lgkmcnt(0)
    s_barrier
    ds_read_b128 v[32:35], v0 offset:16384
    ds_read_b128 v[36:39], v0 offset:17408
    s_cmp_eq_u32 s55, 63
    s_cbranch_scc1 CHS0_last
    v_mov_b64 v[16:17], 0
    v_mov_b64 v[18:19], 0
    v_mov_b64 v[26:27], 0
    v_mov_b64 v[30:31], 0
    s_waitcnt lgkmcnt(1)
    v_smfmac_f32_16x16x64_bf16 v[8:11], v[32:35], a[184:191], v1
    v_smfmac_f32_16x16x64_bf16 v[12:15], v[32:35], a[192:199], v1
    s_waitcnt vmcnt(6) lgkmcnt(0)
    v_smfmac_f32_16x16x64_bf16 v[8:11], v[36:39], v[72:79], v1
    buffer_load_dwordx4 v[72:75], v0, s[8:11], s61 offen offset:0
    v_smfmac_f32_16x16x64_bf16 v[12:15], v[36:39], v[40:47], v1
    s_waitcnt vmcnt(3)
    v_smfmac_f32_16x16x64_bf16 v[16:19], v[32:35], v[56:63], v1
    ds_read_b128 v[56:59], v7 offset:20480
    ds_read_b128 v[60:63], v7 offset:21504
    buffer_load_dwordx4 v[76:79], v0, s[8:11], s61 offen offset:1024
    v_smfmac_f32_16x16x64_bf16 v[20:23], v[32:35], v[64:71], v1
    ds_read_b128 v[64:67], v7 offset:22528
    ds_read_b128 v[68:71], v7 offset:23552
    buffer_load_dwordx4 v[40:43], v0, s[8:11], s61 offen offset:2048
    v_add_f32 v8, v8, v10
    v_add_f32 v9, v9, v11
    v_cvt_pk_bf16_f32 v8, v8, v9
    v_smfmac_f32_16x16x64_bf16 v[16:19], v[36:39], a[200:207], v1
    v_and_or_b32 v8, v8, -2, s65
    v_add_f32 v12, v12, v14
    v_add_f32 v13, v13, v15
    v_smfmac_f32_16x16x64_bf16 v[20:23], v[36:39], a[208:215], v1
    buffer_load_dwordx4 v[44:47], v0, s[8:11], s61 offen offset:3072
    v_cvt_pk_bf16_f32 v9, v12, v13
    buffer_store_dwordx2 v[8:9], v4, s[8:11], s58 offen sc1
    v_mov_b64 v[12:13], 0
    s_waitcnt vmcnt(5)
    v_smfmac_f32_16x16x64_bf16 v[24:27], v[32:35], a[216:223], v1
    v_mov_b64 v[14:15], 0
    v_mov_b64 v[10:11], 0
    v_mov_b64 v[8:9], 0
    v_smfmac_f32_16x16x64_bf16 v[28:31], v[32:35], v[48:55], v1
    v_add_f32 v16, v16, v18
    v_add_f32 v17, v17, v19
    v_cvt_pk_bf16_f32 v16, v16, v17
    s_waitcnt lgkmcnt(0)
    v_smfmac_f32_16x16x64_bf16 v[24:27], v[36:39], v[56:63], v1
    ds_read_b128 v[56:59], v7 offset:24576
    ds_read_b128 v[60:63], v7 offset:25600
    v_and_or_b32 v16, v16, -2, s65
    v_add_f32 v20, v20, v22
    v_add_f32 v21, v21, v23
    v_smfmac_f32_16x16x64_bf16 v[28:31], v[36:39], v[64:71], v1
    ds_read_b128 v[64:67], v7 offset:26624
    ds_read_b128 v[68:71], v7 offset:27648
    v_cvt_pk_bf16_f32 v17, v20, v21
    buffer_store_dwordx2 v[16:17], v4, s[8:11], s75 offen sc1
    v_mov_b64 v[20:21], 0
    v_smfmac_f32_16x16x64_bf16 v[8:11], v[32:35], a[224:231], v1
    v_mov_b64 v[22:23], 0
    v_mov_b64 v[18:19], 0
    v_mov_b64 v[16:17], 0
    v_smfmac_f32_16x16x64_bf16 v[12:15], v[32:35], a[232:239], v1
    v_add_f32 v24, v24, v26
    v_add_f32 v25, v25, v27
    v_cvt_pk_bf16_f32 v24, v24, v25
    s_waitcnt lgkmcnt(0)
    v_smfmac_f32_16x16x64_bf16 v[8:11], v[36:39], v[56:63], v1
    ds_read_b128 v[56:59], v7 offset:28672
    ds_read_b128 v[60:63], v7 offset:29696
    v_and_or_b32 v24, v24, -2, s65
    v_add_f32 v28, v28, v30
    v_add_f32 v29, v29, v31
    v_smfmac_f32_16x16x64_bf16 v[12:15], v[36:39], v[64:71], v1
    ds_read_b128 v[64:67], v7 offset:30720
    ds_read_b128 v[68:71], v7 offset:31744
    v_cvt_pk_bf16_f32 v25, v28, v29
    buffer_store_dwordx2 v[24:25], v4, s[8:11], s76 offen sc1
    v_smfmac_f32_16x16x64_bf16 v[16:19], v[32:35], a[240:247], v1
    v_smfmac_f32_16x16x64_bf16 v[20:23], v[32:35], a[248:255], v1
    v_add_f32 v8, v8, v10
    v_add_f32 v9, v9, v11
    v_cvt_pk_bf16_f32 v8, v8, v9
    s_waitcnt lgkmcnt(0)
    v_smfmac_f32_16x16x64_bf16 v[16:19], v[36:39], v[56:63], v1
    v_and_or_b32 v8, v8, -2, s65
    v_add_f32 v12, v12, v14
    v_add_f32 v13, v13, v15
    v_smfmac_f32_16x16x64_bf16 v[20:23], v[36:39], v[64:71], v1
    v_cvt_pk_bf16_f32 v9, v12, v13
    buffer_store_dwordx2 v[8:9], v4, s[8:11], s77 offen sc1
    s_nop 1
    v_add_f32 v16, v16, v18
    v_add_f32 v17, v17, v19
    v_cvt_pk_bf16_f32 v16, v16, v17
    v_and_or_b32 v16, v16, -2, s65
    v_add_f32 v20, v20, v22
    v_add_f32 v21, v21, v23
    v_cvt_pk_bf16_f32 v17, v20, v21
    buffer_store_dwordx2 v[16:17], v4, s[8:11], s4 offen sc1
    s_barrier
    s_mov_b32 s68, 0
    v_bfe_u32 v29, v0, 4, 1
    v_lshlrev_b32 v29, 4, v29
    v_mov_b32 v30, 0x3f80
    v_lshlrev_b32 v29, v29, v30
    v_bfe_u32 v30, v0, 5, 3
    v_cmp_eq_u32 vcc, 0, v30
    s_nop 1
    v_cndmask_b32 v32, 0, v29, vcc
    v_cmp_eq_u32 vcc, 1, v30
    s_nop 1
    v_cndmask_b32 v33, 0, v29, vcc
    v_cmp_eq_u32 vcc, 2, v30
    s_nop 1
    v_cndmask_b32 v34, 0, v29, vcc
    v_cmp_eq_u32 vcc, 3, v30
    s_nop 1
    v_cndmask_b32 v35, 0, v29, vcc
    buffer_load_dwordx4 v[8:11], v0, s[8:11], s59 offen offset:0 sc1
    buffer_load_dwordx4 v[12:15], v0, s[8:11], s59 offen offset:1024 sc1
    buffer_load_dwordx4 v[16:19], v0, s[8:11], s60 offen offset:0 sc1
    buffer_load_dwordx4 v[20:23], v0, s[8:11], s60 offen offset:1024 sc1
    v_cmp_eq_u32 vcc, 4, v30
    s_nop 1
    v_cndmask_b32 v36, 0, v29, vcc
    v_cmp_eq_u32 vcc, 5, v30
    s_nop 1
    v_cndmask_b32 v37, 0, v29, vcc
    v_cmp_eq_u32 vcc, 6, v30
    s_nop 1
    v_cndmask_b32 v38, 0, v29, vcc
    v_cmp_eq_u32 vcc, 7, v30
    s_nop 1
    v_cndmask_b32 v39, 0, v29, vcc
    s_sleep 2
    buffer_load_dwordx4 v[56:59], v0, s[8:11], s59 offen offset:0 sc1
    buffer_load_dwordx4 v[60:63], v0, s[8:11], s59 offen offset:1024 sc1
    buffer_load_dwordx4 v[64:67], v0, s[8:11], s60 offen offset:0 sc1
    buffer_load_dwordx4 v[68:71], v0, s[8:11], s60 offen offset:1024 sc1
CHS0_rloop:
    s_waitcnt vmcnt(4)
    v_mfma_f32_16x16x32_bf16 v[24:27], v[8:11], v[32:35], 0
    v_and_b32 v29, v8, v10
    v_or_b32 v30, v8, v10
    v_mfma_f32_16x16x32_bf16 v[24:27], v[12:15], v[32:35], v[24:27]
    v_bitop3_b32 v29, v29, v12, v14 bitop3:0x80
    v_or3_b32 v30, v30, v12, v14
    v_mfma_f32_16x16x32_bf16 v[24:27], v[16:19], v[36:39], v[24:27]
    v_bitop3_b32 v29, v29, v16, v18 bitop3:0x80
    v_or3_b32 v30, v30, v16, v18
    v_mfma_f32_16x16x32_bf16 v[24:27], v[20:23], v[36:39], v[24:27]
    v_bitop3_b32 v29, v29, v20, v22 bitop3:0x80
    v_or3_b32 v30, v30, v20, v22
    v_bitop3_b32 v29, v29, v30, s65 bitop3:0x4e
    v_and_b32 v29, 1, v29
    v_cmp_ne_u32 vcc, 0, v29
    s_nop 2
    v_permlane32_swap_b32 v24, v26
    v_permlane32_swap_b32 v25, v27
    v_add_f32 v24, v24, v26
    v_add_f32 v25, v25, v27
    s_cbranch_vccnz CHS0_rbad0
    s_nop 0
    v_permlane16_swap_b32 v24, v25
    v_add_f32 v24, v24, v25
    v_cvt_pk_bf16_f32 v24, v24, v24
    buffer_store_short v24, v2, s[8:11], s56 offen sc1
    s_branch CHS0_rdone
CHS0_rbad0:
    buffer_load_dwordx4 v[8:11], v0, s[8:11], s59 offen offset:0 sc1
    buffer_load_dwordx4 v[12:15], v0, s[8:11], s59 offen offset:1024 sc1
    buffer_load_dwordx4 v[16:19], v0, s[8:11], s60 offen offset:0 sc1
    buffer_load_dwordx4 v[20:23], v0, s[8:11], s60 offen offset:1024 sc1
    s_waitcnt vmcnt(4)
    v_mfma_f32_16x16x32_bf16 v[24:27], v[56:59], v[32:35], 0
    v_and_b32 v29, v56, v58
    v_or_b32 v30, v56, v58
    v_mfma_f32_16x16x32_bf16 v[24:27], v[60:63], v[32:35], v[24:27]
    v_bitop3_b32 v29, v29, v60, v62 bitop3:0x80
    v_or3_b32 v30, v30, v60, v62
    v_mfma_f32_16x16x32_bf16 v[24:27], v[64:67], v[36:39], v[24:27]
    v_bitop3_b32 v29, v29, v64, v66 bitop3:0x80
    v_or3_b32 v30, v30, v64, v66
    v_mfma_f32_16x16x32_bf16 v[24:27], v[68:71], v[36:39], v[24:27]
    v_bitop3_b32 v29, v29, v68, v70 bitop3:0x80
    v_or3_b32 v30, v30, v68, v70
    v_bitop3_b32 v29, v29, v30, s65 bitop3:0x4e
    v_and_b32 v29, 1, v29
    v_cmp_ne_u32 vcc, 0, v29
    s_nop 2
    v_permlane32_swap_b32 v24, v26
    v_permlane32_swap_b32 v25, v27
    v_add_f32 v24, v24, v26
    v_add_f32 v25, v25, v27
    s_cbranch_vccnz CHS0_rbad1
CHS0_rok:
    s_nop 0
    v_permlane16_swap_b32 v24, v25
    v_add_f32 v24, v24, v25
    v_cvt_pk_bf16_f32 v24, v24, v24
    buffer_store_short v24, v2, s[8:11], s56 offen sc1
    s_branch CHS0_rdone
CHS0_rbad1:
    buffer_load_dwordx4 v[56:59], v0, s[8:11], s59 offen offset:0 sc1
    buffer_load_dwordx4 v[60:63], v0, s[8:11], s59 offen offset:1024 sc1
    buffer_load_dwordx4 v[64:67], v0, s[8:11], s60 offen offset:0 sc1
    buffer_load_dwordx4 v[68:71], v0, s[8:11], s60 offen offset:1024 sc1
    s_cmp_lg_u32 s69, 0
    s_cbranch_scc1 CHS0_rok
    s_add_u32 s68, s68, 1
    s_cmp_lt_u32 s68, 65536
    s_cbranch_scc1 CHS0_rloop
    s_mov_b32 s69, 1
    s_branch CHS0_rok
CHS0_rdone:
    v_mov_b32 v25, 0xff81ff81
    buffer_store_short v25, v2, s[8:11], s57 offen sc1
    s_mov_b32 m0, 16384
    s_nop 0
    buffer_load_dwordx4 v0, s[8:11], s63 offen offset:0 sc1 lds
    buffer_load_dwordx4 v0, s[8:11], s63 offen offset:1024 sc1 lds
    s_add_u32 s63, s63, 262144
    v_and_b32 v28, 512, v0
    v_mul_u32_u24 v28, 3, v28
    v_add_u32 v28, v28, v0
    ds_read_b128 v[24:27], v28 offset:12288
    s_add_u32 s72, s56, 0
    s_xor_b32 s65, s65, 1
    s_add_u32 s64, s64, 131072
    s_xor_b32 s56, s56, s74
    s_xor_b32 s57, s57, s74
    s_add_u32 s62, s62, 262144
    s_add_u32 s55, s55, 1
    s_mov_b32 s68, 0
    s_mov_b32 m0, 0
    s_sleep 3
    buffer_load_dwordx4 v0, s[8:11], s72 offen offset:0 sc1 lds
    buffer_load_dwordx4 v0, s[8:11], s72 offen offset:1024 sc1 lds
    buffer_load_dwordx4 v0, s[8:11], s72 offen offset:2048 sc1 lds
    s_waitcnt vmcnt(7)
    ds_read_b128 v[56:59], v7 offset:0
    ds_read_b128 v[60:63], v7 offset:1024
    ds_read_b128 v[64:67], v7 offset:2048
    ds_read_b128 v[68:71], v7 offset:3072
    v_mov_b64 v[8:9], 0
    v_mov_b64 v[10:11], 0
    v_mov_b64 v[12:13], 0
    v_mov_b64 v[14:15], 0
    v_mov_b64 v[16:17], 0
    v_mov_b64 v[18:19], 0
    v_mov_b64 v[20:21], 0
    v_mov_b64 v[22:23], 0
    s_sleep 2
CHS0_gloop:
    buffer_load_dwordx4 v0, s[8:11], s72 offen offset:0 sc1 lds
    buffer_load_dwordx4 v0, s[8:11], s72 offen offset:1024 sc1 lds
    buffer_load_dwordx4 v0, s[8:11], s72 offen offset:2048 sc1 lds
    s_waitcnt vmcnt(3)
    ds_read_b128 v[32:35], v0 offset:0
    ds_read_b128 v[36:39], v0 offset:1024
    ds_read_b128 v[28:31], v0 offset:2048
    s_waitcnt lgkmcnt(2)
    v_pk_max_u16 v23, v32, v33
    v_pk_max_u16 v23, v23, v34
    v_pk_max_u16 v23, v23, v35
    s_waitcnt lgkmcnt(1)
    v_pk_max_u16 v23, v23, v36
    v_pk_max_u16 v23, v23, v37
    v_pk_max_u16 v23, v23, v38
    v_pk_max_u16 v23, v23, v39
    s_waitcnt lgkmcnt(0)
    v_pk_max_u16 v23, v23, v28
    v_pk_max_u16 v23, v23, v29
    v_pk_max_u16 v23, v23, v30
    v_pk_max_u16 v23, v23, v31
    v_pk_max_u16 v23, v23, v23 op_sel:[0,1] op_sel_hi:[1,0]
    s_nop 0
    v_cmp_le_u32 vcc, 0xff810000, v23
    s_nop 0
    s_cbranch_vccz CHS0_loop
    s_add_u32 s68, s68, 1
    s_cmp_lt_u32 s68, 64
    s_cbranch_scc1 CHS0_gloop
    s_cmp_lg_u32 s69, 0
    s_cbranch_scc1 CHS0_loop
    v_mov_b32 v23, -1
    v_xor_b32 v22, 0xff81ff81, v32
    v_pk_min_u16 v23, v23, v22
    v_xor_b32 v22, 0xff81ff81, v33
    v_pk_min_u16 v23, v23, v22
    v_xor_b32 v22, 0xff81ff81, v34
    v_pk_min_u16 v23, v23, v22
    v_xor_b32 v22, 0xff81ff81, v35
    v_pk_min_u16 v23, v23, v22
    v_xor_b32 v22, 0xff81ff81, v36
    v_pk_min_u16 v23, v23, v22
    v_xor_b32 v22, 0xff81ff81, v37
    v_pk_min_u16 v23, v23, v22
    v_xor_b32 v22, 0xff81ff81, v38
    v_pk_min_u16 v23, v23, v22
    v_xor_b32 v22, 0xff81ff81, v39
    v_pk_min_u16 v23, v23, v22
    v_xor_b32 v22, 0xff81ff81, v28
    v_pk_min_u16 v23, v23, v22
    v_xor_b32 v22, 0xff81ff81, v29
    v_pk_min_u16 v23, v23, v22
    v_xor_b32 v22, 0xff81ff81, v30
    v_pk_min_u16 v23, v23, v22
    v_xor_b32 v22, 0xff81ff81, v31
    v_pk_min_u16 v23, v23, v22
    v_pk_min_u16 v23, v23, v23 op_sel:[0,1] op_sel_hi:[1,0]
    v_mov_b32 v22, 0
    v_cmp_eq_u32 vcc, 0, v23
    s_nop 0
    s_cbranch_vccz CHS0_loop
    s_sleep 1
    s_cmp_lt_u32 s68, 65536
    s_cbranch_scc1 CHS0_gloop
    s_mov_b32 s69, 1
    s_branch CHS0_loop
CHS0_last:
    v_and_b32 v28, 512, v0
    v_mul_u32_u24 v28, 3, v28
    v_add_u32 v28, v28, v0
    ds_read_b128 v[24:27], v28 offset:12288
    s_add_u32 s64, s64, 131072
    s_waitcnt lgkmcnt(0)
    buffer_store_dwordx4 v[24:27], v0, s[8:11], s64 offen sc1
    s_waitcnt vmcnt(0)
    s_barrier
    s_waitcnt vmcnt(0) lgkmcnt(0)
    s_endpgm
CH1_entry:
    v_and_b32 v40, 63, v0
    v_lshlrev_b32 v0, 4, v40
    v_lshrrev_b32 v41, 4, v40
    v_and_b32 v42, 15, v40
    v_and_b32 v43, 2, v40
    v_cmp_ne_u32 vcc, 0, v43
    v_mov_b32 v44, 0x4444
    v_mov_b32 v45, 0xeeee
    v_cndmask_b32 v1, v44, v45, vcc
    v_and_b32 v43, 13, v42
    v_and_b32 v44, 1, v41
    v_lshl_or_b32 v43, v44, 1, v43
    v_lshlrev_b32 v43, 4, v43
    v_lshrrev_b32 v44, 1, v41
    v_lshl_add_u32 v6, v44, 8, v43
    v_lshrrev_b32 v43, 3, v42
    v_lshlrev_b32 v43, 8, v43
    v_lshl_add_u32 v43, v41, 6, v43
    v_bfe_u32 v44, v42, 2, 1
    v_lshl_add_u32 v43, v44, 5, v43
    v_and_b32 v44, 3, v42
    v_lshl_add_u32 v43, v44, 2, v43
    v_add_u32 v5, 10752, v43
    v_add_u32 v7, 61440, v0
    v_add_u32 v3, 2048, v5
    s_mov_b32 s70, 2176
    v_lshrrev_b32 v43, 3, v42
    v_lshl_add_u32 v43, v43, 2, v41
    v_mul_lo_u32 v43, v43, s70
    v_and_b32 v44, 7, v42
    v_lshl_add_u32 v4, v44, 3, v43
    s_mul_i32 s70, s53, 5
    s_add_u32 s70, s70, 2
    v_lshrrev_b32 v43, 3, v42
    v_add_u32 v43, s70, v43
    v_and_b32 v49, 3, v42
    v_lshlrev_b32 v49, 4, v49
    v_lshl_add_u32 v49, v41, 2, v49
    v_bfe_u32 v48, v42, 2, 1
    v_lshl_add_u32 v49, v48, 1, v49
    v_lshl_add_u32 v2, v43, 6, v49
    v_mov_b32 v46, 0x40000000
    v_cmp_lt_u32 vcc, 7, v42
    s_nop 1
    v_cndmask_b32 v2, v2, v46, vcc
    s_mul_i32 s70, s54, 20480
    s_add_u32 s56, s70, 131072
    s_add_u32 s57, s56, 10240
    s_xor_b32 s74, s56, s57
    s_mul_i32 s70, s54, 348160
    s_add_u32 s70, s70, 196608
    s_lshl_b32 s71, s53, 6
    s_add_u32 s58, s70, s71
    s_add_u32 s58, s58, 17408
    s_add_u32 s75, s58, 69632
    s_add_u32 s76, s58, 139264
    s_add_u32 s77, s58, 208896
    s_add_u32 s4, s58, 278528
    s_mul_i32 s71, s53, 10880
    s_add_u32 s59, s71, s70
    s_add_u32 s59, s59, 4352
    s_add_u32 s60, s59, 2176
    s_mov_b32 s65, 0
    s_mul_i32 s61, s53, 75776
    s_add_u32 s61, s61, 1064960
    s_add_u32 s3, s61, 4096
    s_add_u32 s5, s61, 8192
    s_add_u32 s6, s61, 12288
    s_add_u32 s7, s61, 16384
    s_mul_i32 s70, s54, 16777216
    s_lshl_b32 s71, s53, 13
    s_add_u32 s70, s70, s71
    s_add_u32 s62, s70, 50333696
    s_add_u32 s63, s70, 16779264
    s_mul_i32 s70, s54, 8519680
    s_lshl_b32 s71, s53, 12
    s_add_u32 s70, s70, s71
    s_add_u32 s64, s70, 150995968
    s_mul_i32 s70, s54, 8192
    s_lshr_b32 s71, s53, 1
    s_mul_i32 s71, s71, 384
    s_add_u32 s78, s70, s71
    s_add_u32 s78, s78, 128
    s_and_b32 s71, s53, 1
    s_lshl_b32 s71, s71, 3
    s_add_u32 s78, s78, s71
    s_lshl_b32 s71, s53, 7
    s_add_u32 s66, s70, s71
    s_add_u32 s66, s66, 16384
    s_mov_b32 s55, 0
    s_mov_b32 s67, 0
    s_mov_b32 s69, 0
    s_mov_b32 s79, 0x3e0293ee
    v_and_b32 v44, 3, v40
    v_lshlrev_b32 v46, 1, v41
    v_xor_b32 v46, v46, v42
    v_lshlrev_b32 v46, 4, v46
    v_lshrrev_b32 v45, 1, v41
    v_lshlrev_b32 v45, 3, v45
    v_and_b32 v47, 1, v41
    v_add_u32 v45, v45, v47
    v_lshlrev_b32 v45, 13, v45
    s_lshl_b32 s70, s53, 8
    v_add3_u32 v32, v45, v46, s70
    v_xor_b32 v34, 128, v32
    v_lshrrev_b32 v45, 1, v41
    v_lshlrev_b32 v45, 2, v45
    v_add_u32 v45, v45, v47
    v_mul_u32_u24 v45, 1280, v45
    s_mul_i32 s70, s53, 163840
    v_add3_u32 v33, v45, v46, s70
    v_xor_b32 v35, 128, v33
    v_bfe_u32 v45, v40, 2, 2
    v_lshl_add_u32 v48, v47, 2, v45
    v_lshlrev_b32 v48, 5, v48
    v_lshl_add_u32 v45, v47, 3, v45
    v_lshlrev_b32 v45, 8, v45
    v_lshrrev_b32 v51, 1, v41
    v_mul_u32_u24 v52, 36864, v51
    v_add_u32 v52, 24576, v52
    v_add_u32 v52, v52, v45
    v_mul_u32_u24 v53, 32768, v51
    v_add_u32 v53, 94208, v53
    v_add_u32 v53, v53, v45
    v_lshlrev_b32 v49, 3, v44
    v_add_u32 v49, 64, v49
    v_xor_b32 v49, v49, v48
    v_add_u32 v16, v49, v52
    v_add_u32 v20, v49, v53
    v_lshrrev_b32 v49, 1, v44
    v_lshlrev_b32 v49, 5, v49
    v_and_b32 v50, 1, v44
    v_lshl_add_u32 v49, v50, 3, v49
    v_add_u32 v49, 64, v49
    v_xor_b32 v49, v49, v48
    v_add_u32 v18, v49, v52
    v_add_u32 v22, v49, v53
    v_lshlrev_b32 v49, 3, v44
    v_add_u32 v49, 96, v49
    v_xor_b32 v49, v49, v48
    v_add_u32 v17, v49, v52
    v_add_u32 v21, v49, v53
    v_lshrrev_b32 v49, 1, v44
    v_lshlrev_b32 v49, 5, v49
    v_and_b32 v50, 1, v44
    v_lshl_add_u32 v49, v50, 3, v49
    v_add_u32 v49, 80, v49
    v_xor_b32 v49, v49, v48
    v_add_u32 v19, v49, v52
    v_add_u32 v23, v49, v53
    s_cmp_eq_u32 s54, 0
    s_cselect_b32 s72, 0x20000000, 0
    s_mov_b32 m0, 61440
    s_mov_b32 s70, 131072
    buffer_load_dwordx4 v32, s[12:15], s70 offen lds
    s_mov_b32 m0, 62464
    s_mov_b32 s70, 147456
    buffer_load_dwordx4 v32, s[12:15], s70 offen lds
    s_mov_b32 m0, 63488
    s_mov_b32 s70, 163840
    buffer_load_dwordx4 v34, s[12:15], s70 offen lds
    s_mov_b32 m0, 64512
    s_mov_b32 s70, 180224
    buffer_load_dwordx4 v34, s[12:15], s70 offen lds
    s_mov_b32 m0, 65536
    s_mov_b32 s70, 1703936
    buffer_load_dwordx4 v32, s[12:15], s70 offen lds
    s_mov_b32 m0, 66560
    s_mov_b32 s70, 1720320
    buffer_load_dwordx4 v32, s[12:15], s70 offen lds
    s_mov_b32 m0, 67584
    s_mov_b32 s70, 1736704
    buffer_load_dwordx4 v34, s[12:15], s70 offen lds
    s_mov_b32 m0, 68608
    s_mov_b32 s70, 1753088
    buffer_load_dwordx4 v34, s[12:15], s70 offen lds
    s_mov_b32 m0, 69632
    s_mov_b32 s70, 2228224
    buffer_load_dwordx4 v32, s[12:15], s70 offen lds
    s_mov_b32 m0, 70656
    s_mov_b32 s70, 2244608
    buffer_load_dwordx4 v32, s[12:15], s70 offen lds
    s_mov_b32 m0, 71680
    s_mov_b32 s70, 2260992
    buffer_load_dwordx4 v34, s[12:15], s70 offen lds
    s_mov_b32 m0, 72704
    s_mov_b32 s70, 2277376
    buffer_load_dwordx4 v34, s[12:15], s70 offen lds
    s_mov_b32 m0, 73728
    s_mov_b32 s70, 2752512
    buffer_load_dwordx4 v32, s[12:15], s70 offen lds
    s_mov_b32 m0, 74752
    s_mov_b32 s70, 2768896
    buffer_load_dwordx4 v32, s[12:15], s70 offen lds
    s_mov_b32 m0, 75776
    s_mov_b32 s70, 2785280
    buffer_load_dwordx4 v34, s[12:15], s70 offen lds
    s_mov_b32 m0, 76800
    s_mov_b32 s70, 2801664
    buffer_load_dwordx4 v34, s[12:15], s70 offen lds
    s_mov_b32 m0, 77824
    s_mov_b32 s70, 3276800
    buffer_load_dwordx4 v32, s[12:15], s70 offen lds
    s_mov_b32 m0, 78848
    s_mov_b32 s70, 3293184
    buffer_load_dwordx4 v32, s[12:15], s70 offen lds
    s_mov_b32 m0, 79872
    s_mov_b32 s70, 3309568
    buffer_load_dwordx4 v34, s[12:15], s70 offen lds
    s_mov_b32 m0, 80896
    s_mov_b32 s70, 3325952
    buffer_load_dwordx4 v34, s[12:15], s70 offen lds
    s_mov_b32 m0, 81920
    s_mov_b32 s70, 3801088
    buffer_load_dwordx4 v32, s[12:15], s70 offen lds
    s_mov_b32 m0, 82944
    s_mov_b32 s70, 3817472
    buffer_load_dwordx4 v32, s[12:15], s70 offen lds
    s_mov_b32 m0, 83968
    s_mov_b32 s70, 3833856
    buffer_load_dwordx4 v34, s[12:15], s70 offen lds
    s_mov_b32 m0, 84992
    s_mov_b32 s70, 3850240
    buffer_load_dwordx4 v34, s[12:15], s70 offen lds
    s_mov_b32 m0, 86016
    s_mov_b32 s70, 4325376
    buffer_load_dwordx4 v32, s[12:15], s70 offen lds
    s_mov_b32 m0, 87040
    s_mov_b32 s70, 4341760
    buffer_load_dwordx4 v32, s[12:15], s70 offen lds
    s_mov_b32 m0, 88064
    s_mov_b32 s70, 4358144
    buffer_load_dwordx4 v34, s[12:15], s70 offen lds
    s_mov_b32 m0, 89088
    s_mov_b32 s70, 4374528
    buffer_load_dwordx4 v34, s[12:15], s70 offen lds
    s_mov_b32 m0, 90112
    s_mov_b32 s70, 4849664
    buffer_load_dwordx4 v32, s[12:15], s70 offen lds
    s_mov_b32 m0, 91136
    s_mov_b32 s70, 4866048
    buffer_load_dwordx4 v32, s[12:15], s70 offen lds
    s_mov_b32 m0, 92160
    s_mov_b32 s70, 4882432
    buffer_load_dwordx4 v34, s[12:15], s70 offen lds
    s_mov_b32 m0, 93184
    s_mov_b32 s70, 4898816
    buffer_load_dwordx4 v34, s[12:15], s70 offen lds
    s_waitcnt vmcnt(28) lgkmcnt(0)
    s_barrier
    ds_read_b64_tr_b16 v[152:153], v16 offset:0
    ds_read_b64_tr_b16 v[154:155], v16 offset:1024
    ds_read_b64_tr_b16 v[156:157], v20 offset:0
    ds_read_b64_tr_b16 v[158:159], v20 offset:1024
    ds_read_b64_tr_b16 v[160:161], v17 offset:0
    ds_read_b64_tr_b16 v[162:163], v17 offset:1024
    ds_read_b64_tr_b16 v[164:165], v21 offset:0
    ds_read_b64_tr_b16 v[166:167], v21 offset:1024
    s_waitcnt vmcnt(24) lgkmcnt(0)
    s_barrier
    s_mov_b32 m0, 61440
    s_add_u32 s70, s72, 10496
    buffer_load_dwordx4 v33, s[24:27], s70 offen lds
    s_mov_b32 m0, 62464
    s_add_u32 s70, s72, 13056
    buffer_load_dwordx4 v33, s[24:27], s70 offen lds
    s_mov_b32 m0, 63488
    s_add_u32 s70, s72, 30976
    buffer_load_dwordx4 v35, s[24:27], s70 offen lds
    s_mov_b32 m0, 64512
    s_add_u32 s70, s72, 33536
    buffer_load_dwordx4 v35, s[24:27], s70 offen lds
    ds_read_b64_tr_b16 v[56:57], v16 offset:4096
    ds_read_b64_tr_b16 v[58:59], v16 offset:5120
    ds_read_b64_tr_b16 v[60:61], v20 offset:4096
    ds_read_b64_tr_b16 v[62:63], v20 offset:5120
    ds_read_b64_tr_b16 v[64:65], v17 offset:4096
    ds_read_b64_tr_b16 v[66:67], v17 offset:5120
    ds_read_b64_tr_b16 v[68:69], v21 offset:4096
    ds_read_b64_tr_b16 v[70:71], v21 offset:5120
    s_waitcnt vmcnt(24) lgkmcnt(0)
    s_barrier
    s_add_u32 s71, s61, s72
    buffer_store_dwordx4 v[56:59], v0, s[8:11], s71 offen offset:2048 sc1
    buffer_store_dwordx4 v[60:63], v0, s[8:11], s71 offen offset:3072 sc1
    s_add_u32 s71, s61, s72
    buffer_store_dwordx4 v[64:67], v0, s[8:11], s71 offen offset:0 sc1
    buffer_store_dwordx4 v[68:71], v0, s[8:11], s71 offen offset:1024 sc1
    s_mov_b32 m0, 65536
    s_mov_b32 s70, 10752
    buffer_load_dwordx4 v33, s[24:27], s70 offen lds
    s_mov_b32 m0, 66560
    s_mov_b32 s70, 13312
    buffer_load_dwordx4 v33, s[24:27], s70 offen lds
    s_mov_b32 m0, 67584
    s_mov_b32 s70, 31232
    buffer_load_dwordx4 v35, s[24:27], s70 offen lds
    s_mov_b32 m0, 68608
    s_mov_b32 s70, 33792
    buffer_load_dwordx4 v35, s[24:27], s70 offen lds
    ds_read_b64_tr_b16 v[40:41], v16 offset:8192
    ds_read_b64_tr_b16 v[42:43], v16 offset:9216
    ds_read_b64_tr_b16 v[44:45], v20 offset:8192
    ds_read_b64_tr_b16 v[46:47], v20 offset:9216
    ds_read_b64_tr_b16 v[80:81], v17 offset:8192
    ds_read_b64_tr_b16 v[82:83], v17 offset:9216
    ds_read_b64_tr_b16 v[84:85], v21 offset:8192
    ds_read_b64_tr_b16 v[86:87], v21 offset:9216
    s_waitcnt vmcnt(28) lgkmcnt(0)
    s_barrier
    s_add_u32 s71, s3, s72
    buffer_store_dwordx4 v[40:43], v0, s[8:11], s71 offen offset:0 sc1
    buffer_store_dwordx4 v[44:47], v0, s[8:11], s71 offen offset:1024 sc1
    s_mov_b32 m0, 69632
    s_add_u32 s70, s72, 92160
    buffer_load_dwordx4 v33, s[24:27], s70 offen lds
    s_mov_b32 m0, 70656
    s_add_u32 s70, s72, 94720
    buffer_load_dwordx4 v33, s[24:27], s70 offen lds
    s_mov_b32 m0, 71680
    s_add_u32 s70, s72, 112640
    buffer_load_dwordx4 v35, s[24:27], s70 offen lds
    s_mov_b32 m0, 72704
    s_add_u32 s70, s72, 115200
    buffer_load_dwordx4 v35, s[24:27], s70 offen lds
    ds_read_b64_tr_b16 v[120:121], v16 offset:12288
    ds_read_b64_tr_b16 v[122:123], v16 offset:13312
    ds_read_b64_tr_b16 v[124:125], v20 offset:12288
    ds_read_b64_tr_b16 v[126:127], v20 offset:13312
    ds_read_b64_tr_b16 v[128:129], v17 offset:12288
    ds_read_b64_tr_b16 v[130:131], v17 offset:13312
    ds_read_b64_tr_b16 v[132:133], v21 offset:12288
    ds_read_b64_tr_b16 v[134:135], v21 offset:13312
    s_waitcnt vmcnt(30) lgkmcnt(0)
    s_barrier
    s_mov_b32 m0, 73728
    s_mov_b32 s70, 655360
    buffer_load_dwordx4 v32, s[12:15], s70 offen lds
    s_mov_b32 m0, 74752
    s_mov_b32 s70, 671744
    buffer_load_dwordx4 v32, s[12:15], s70 offen lds
    s_mov_b32 m0, 75776
    s_mov_b32 s70, 688128
    buffer_load_dwordx4 v34, s[12:15], s70 offen lds
    s_mov_b32 m0, 76800
    s_mov_b32 s70, 704512
    buffer_load_dwordx4 v34, s[12:15], s70 offen lds
    ds_read_b64_tr_b16 v[40:41], v16 offset:16384
    ds_read_b64_tr_b16 v[42:43], v16 offset:17408
    ds_read_b64_tr_b16 v[44:45], v20 offset:16384
    ds_read_b64_tr_b16 v[46:47], v20 offset:17408
    ds_read_b64_tr_b16 v[200:201], v17 offset:16384
    ds_read_b64_tr_b16 v[202:203], v17 offset:17408
    ds_read_b64_tr_b16 v[204:205], v21 offset:16384
    ds_read_b64_tr_b16 v[206:207], v21 offset:17408
    s_waitcnt vmcnt(30) lgkmcnt(0)
    s_barrier
    s_add_u32 s71, s3, s72
    buffer_store_dwordx4 v[40:43], v0, s[8:11], s71 offen offset:2048 sc1
    buffer_store_dwordx4 v[44:47], v0, s[8:11], s71 offen offset:3072 sc1
    s_mov_b32 m0, 77824
    s_mov_b32 s70, 1179648
    buffer_load_dwordx4 v32, s[12:15], s70 offen lds
    s_mov_b32 m0, 78848
    s_mov_b32 s70, 1196032
    buffer_load_dwordx4 v32, s[12:15], s70 offen lds
    s_mov_b32 m0, 79872
    s_mov_b32 s70, 1212416
    buffer_load_dwordx4 v34, s[12:15], s70 offen lds
    s_mov_b32 m0, 80896
    s_mov_b32 s70, 1228800
    buffer_load_dwordx4 v34, s[12:15], s70 offen lds
    ds_read_b64_tr_b16 v[56:57], v16 offset:20480
    ds_read_b64_tr_b16 v[58:59], v16 offset:21504
    ds_read_b64_tr_b16 v[60:61], v20 offset:20480
    ds_read_b64_tr_b16 v[62:63], v20 offset:21504
    ds_read_b64_tr_b16 v[208:209], v17 offset:20480
    ds_read_b64_tr_b16 v[210:211], v17 offset:21504
    ds_read_b64_tr_b16 v[212:213], v21 offset:20480
    ds_read_b64_tr_b16 v[214:215], v21 offset:21504
    s_waitcnt vmcnt(32) lgkmcnt(0)
    s_barrier
    s_add_u32 s71, s5, s72
    buffer_store_dwordx4 v[56:59], v0, s[8:11], s71 offen offset:0 sc1
    buffer_store_dwordx4 v[60:63], v0, s[8:11], s71 offen offset:1024 sc1
    s_mov_b32 m0, 81920
    s_mov_b32 s70, 655360
    buffer_load_dwordx4 v32, s[16:19], s70 offen lds
    s_mov_b32 m0, 82944
    s_mov_b32 s70, 671744
    buffer_load_dwordx4 v32, s[16:19], s70 offen lds
    s_mov_b32 m0, 83968
    s_mov_b32 s70, 688128
    buffer_load_dwordx4 v34, s[16:19], s70 offen lds
    s_mov_b32 m0, 84992
    s_mov_b32 s70, 704512
    buffer_load_dwordx4 v34, s[16:19], s70 offen lds
    ds_read_b64_tr_b16 v[232:233], v16 offset:24576
    ds_read_b64_tr_b16 v[234:235], v16 offset:25600
    ds_read_b64_tr_b16 v[236:237], v20 offset:24576
    ds_read_b64_tr_b16 v[238:239], v20 offset:25600
    ds_read_b64_tr_b16 v[240:241], v17 offset:24576
    ds_read_b64_tr_b16 v[242:243], v17 offset:25600
    ds_read_b64_tr_b16 v[244:245], v21 offset:24576
    ds_read_b64_tr_b16 v[246:247], v21 offset:25600
    s_waitcnt vmcnt(34) lgkmcnt(0)
    s_barrier
    s_mov_b32 m0, 86016
    s_mov_b32 s70, 2228224
    buffer_load_dwordx4 v32, s[16:19], s70 offen lds
    s_mov_b32 m0, 87040
    s_mov_b32 s70, 2244608
    buffer_load_dwordx4 v32, s[16:19], s70 offen lds
    s_mov_b32 m0, 88064
    s_mov_b32 s70, 2260992
    buffer_load_dwordx4 v34, s[16:19], s70 offen lds
    s_mov_b32 m0, 89088
    s_mov_b32 s70, 2277376
    buffer_load_dwordx4 v34, s[16:19], s70 offen lds
    ds_read_b64_tr_b16 v[248:249], v16 offset:28672
    ds_read_b64_tr_b16 v[250:251], v16 offset:29696
    ds_read_b64_tr_b16 v[252:253], v20 offset:28672
    ds_read_b64_tr_b16 v[254:255], v20 offset:29696
    ds_read_b64_tr_b16 a[0:1], v17 offset:28672
    ds_read_b64_tr_b16 a[2:3], v17 offset:29696
    ds_read_b64_tr_b16 a[4:5], v21 offset:28672
    ds_read_b64_tr_b16 a[6:7], v21 offset:29696
    s_waitcnt vmcnt(34) lgkmcnt(0)
    s_barrier
    s_mov_b32 m0, 90112
    s_mov_b32 s70, 2752512
    buffer_load_dwordx4 v32, s[16:19], s70 offen lds
    s_mov_b32 m0, 91136
    s_mov_b32 s70, 2768896
    buffer_load_dwordx4 v32, s[16:19], s70 offen lds
    s_mov_b32 m0, 92160
    s_mov_b32 s70, 2785280
    buffer_load_dwordx4 v34, s[16:19], s70 offen lds
    s_mov_b32 m0, 93184
    s_mov_b32 s70, 2801664
    buffer_load_dwordx4 v34, s[16:19], s70 offen lds
    ds_read_b64_tr_b16 v[40:41], v18 offset:0
    ds_read_b64_tr_b16 v[42:43], v18 offset:1024
    ds_read_b64_tr_b16 v[44:45], v22 offset:0
    ds_read_b64_tr_b16 v[46:47], v22 offset:1024
    ds_read_b64_tr_b16 v[48:49], v19 offset:0
    ds_read_b64_tr_b16 v[50:51], v19 offset:1024
    ds_read_b64_tr_b16 v[52:53], v23 offset:0
    ds_read_b64_tr_b16 v[54:55], v23 offset:1024
    s_waitcnt vmcnt(30) lgkmcnt(0)
    s_barrier
    s_add_u32 s71, s6, s72
    buffer_store_dwordx4 v[40:43], v0, s[8:11], s71 offen offset:2048 sc1
    buffer_store_dwordx4 v[44:47], v0, s[8:11], s71 offen offset:3072 sc1
    s_add_u32 s71, s7, s72
    buffer_store_dwordx4 v[48:51], v0, s[8:11], s71 offen offset:0 sc1
    buffer_store_dwordx4 v[52:55], v0, s[8:11], s71 offen offset:1024 sc1
    s_mov_b32 m0, 61440
    s_mov_b32 s70, 3801088
    buffer_load_dwordx4 v32, s[16:19], s70 offen lds
    s_mov_b32 m0, 62464
    s_mov_b32 s70, 3817472
    buffer_load_dwordx4 v32, s[16:19], s70 offen lds
    s_mov_b32 m0, 63488
    s_mov_b32 s70, 3833856
    buffer_load_dwordx4 v34, s[16:19], s70 offen lds
    s_mov_b32 m0, 64512
    s_mov_b32 s70, 3850240
    buffer_load_dwordx4 v34, s[16:19], s70 offen lds
    ds_read_b64_tr_b16 a[216:217], v18 offset:4096
    ds_read_b64_tr_b16 a[218:219], v18 offset:5120
    ds_read_b64_tr_b16 a[220:221], v22 offset:4096
    ds_read_b64_tr_b16 a[222:223], v22 offset:5120
    ds_read_b64_tr_b16 v[64:65], v19 offset:4096
    ds_read_b64_tr_b16 v[66:67], v19 offset:5120
    ds_read_b64_tr_b16 v[68:69], v23 offset:4096
    ds_read_b64_tr_b16 v[70:71], v23 offset:5120
    s_waitcnt vmcnt(32) lgkmcnt(0)
    s_barrier
    s_add_u32 s71, s7, s72
    buffer_store_dwordx4 v[64:67], v0, s[8:11], s71 offen offset:2048 sc1
    buffer_store_dwordx4 v[68:71], v0, s[8:11], s71 offen offset:3072 sc1
    s_mov_b32 m0, 65536
    s_mov_b32 s70, 4849664
    buffer_load_dwordx4 v32, s[16:19], s70 offen lds
    s_mov_b32 m0, 66560
    s_mov_b32 s70, 4866048
    buffer_load_dwordx4 v32, s[16:19], s70 offen lds
    s_mov_b32 m0, 67584
    s_mov_b32 s70, 4882432
    buffer_load_dwordx4 v34, s[16:19], s70 offen lds
    s_mov_b32 m0, 68608
    s_mov_b32 s70, 4898816
    buffer_load_dwordx4 v34, s[16:19], s70 offen lds
    ds_read_b64_tr_b16 v[40:41], v18 offset:8192
    ds_read_b64_tr_b16 v[42:43], v18 offset:9216
    ds_read_b64_tr_b16 v[44:45], v22 offset:8192
    ds_read_b64_tr_b16 v[46:47], v22 offset:9216
    ds_read_b64_tr_b16 v[48:49], v19 offset:8192
    ds_read_b64_tr_b16 v[50:51], v19 offset:9216
    ds_read_b64_tr_b16 v[52:53], v23 offset:8192
    ds_read_b64_tr_b16 v[54:55], v23 offset:9216
    s_waitcnt vmcnt(34) lgkmcnt(0)
    s_barrier
    s_add_u32 s71, s5, s72
    buffer_store_dwordx4 v[40:43], v0, s[8:11], s71 offen offset:2048 sc1
    buffer_store_dwordx4 v[44:47], v0, s[8:11], s71 offen offset:3072 sc1
    s_add_u32 s71, s6, s72
    buffer_store_dwordx4 v[48:51], v0, s[8:11], s71 offen offset:0 sc1
    buffer_store_dwordx4 v[52:55], v0, s[8:11], s71 offen offset:1024 sc1
    s_mov_b32 m0, 69632
    s_mov_b32 s70, 131072
    buffer_load_dwordx4 v32, s[20:23], s70 offen lds
    s_mov_b32 m0, 70656
    s_mov_b32 s70, 147456
    buffer_load_dwordx4 v32, s[20:23], s70 offen lds
    s_mov_b32 m0, 71680
    s_mov_b32 s70, 163840
    buffer_load_dwordx4 v34, s[20:23], s70 offen lds
    s_mov_b32 m0, 72704
    s_mov_b32 s70, 180224
    buffer_load_dwordx4 v34, s[20:23], s70 offen lds
    ds_read_b64_tr_b16 v[168:169], v16 offset:12288
    ds_read_b64_tr_b16 v[170:171], v16 offset:13312
    ds_read_b64_tr_b16 v[172:173], v20 offset:12288
    ds_read_b64_tr_b16 v[174:175], v20 offset:13312
    ds_read_b64_tr_b16 v[176:177], v17 offset:12288
    ds_read_b64_tr_b16 v[178:179], v17 offset:13312
    ds_read_b64_tr_b16 v[180:181], v21 offset:12288
    ds_read_b64_tr_b16 v[182:183], v21 offset:13312
    s_waitcnt vmcnt(36) lgkmcnt(0)
    s_barrier
    s_mov_b32 m0, 73728
    s_mov_b32 s70, 655360
    buffer_load_dwordx4 v32, s[20:23], s70 offen lds
    s_mov_b32 m0, 74752
    s_mov_b32 s70, 671744
    buffer_load_dwordx4 v32, s[20:23], s70 offen lds
    s_mov_b32 m0, 75776
    s_mov_b32 s70, 688128
    buffer_load_dwordx4 v34, s[20:23], s70 offen lds
    s_mov_b32 m0, 76800
    s_mov_b32 s70, 704512
    buffer_load_dwordx4 v34, s[20:23], s70 offen lds
    ds_read_b64_tr_b16 v[104:105], v16 offset:16384
    ds_read_b64_tr_b16 v[106:107], v16 offset:17408
    ds_read_b64_tr_b16 v[108:109], v20 offset:16384
    ds_read_b64_tr_b16 v[110:111], v20 offset:17408
    ds_read_b64_tr_b16 v[112:113], v17 offset:16384
    ds_read_b64_tr_b16 v[114:115], v17 offset:17408
    ds_read_b64_tr_b16 v[116:117], v21 offset:16384
    ds_read_b64_tr_b16 v[118:119], v21 offset:17408
    s_cmp_eq_u32 s54, 0
    s_cbranch_scc1 CH1_nosend_75
    s_waitcnt vmcnt(0)
    s_cmp_lg_u32 s96, 0
    s_cbranch_scc1 RDY_ok_76
    s_mov_b32 s68, 0
RDY_lp_77:
    buffer_load_dword v24, off, s[48:51], 0 offset:32 sc1
    s_waitcnt vmcnt(0)
    v_readfirstlane_b32 s70, v24
    s_nop 0
    s_cmp_ge_u32 s70, 256
    s_cbranch_scc1 RDY_all_78
    s_sleep 8
    s_add_u32 s68, s68, 1
    s_cmp_lt_u32 s68, 65536
    s_cbranch_scc1 RDY_lp_77
    s_branch RDY_ok_76
RDY_all_78:
    v_mbcnt_lo_u32_b32 v25, -1, 0
    v_and_b32 v25, 7, v25
    v_min_u32 v26, 1, v25
    v_lshlrev_b32 v25, 2, v25
    v_lshl_add_u32 v25, v26, 7, v25
    buffer_load_dword v24, v25, s[48:51], 0 offen sc1
    s_waitcnt vmcnt(0)
    v_cmp_ne_u32 vcc, 32, v24
    s_nop 0
    s_cbranch_vccnz L_slow
RDY_ok_76:
    v_mov_b32 v24, 1
    s_add_u32 s71, s66, 4
    buffer_store_dword v24, off, s[8:11], s71 sc1
CH1_nosend_75:
    s_waitcnt vmcnt(34) lgkmcnt(0)
    s_barrier
    s_mov_b32 m0, 77824
    s_mov_b32 s70, 1179648
    buffer_load_dwordx4 v32, s[20:23], s70 offen lds
    s_mov_b32 m0, 78848
    s_mov_b32 s70, 1196032
    buffer_load_dwordx4 v32, s[20:23], s70 offen lds
    s_mov_b32 m0, 79872
    s_mov_b32 s70, 1212416
    buffer_load_dwordx4 v34, s[20:23], s70 offen lds
    s_mov_b32 m0, 80896
    s_mov_b32 s70, 1228800
    buffer_load_dwordx4 v34, s[20:23], s70 offen lds
    ds_read_b64_tr_b16 v[184:185], v16 offset:20480
    ds_read_b64_tr_b16 v[186:187], v16 offset:21504
    ds_read_b64_tr_b16 v[188:189], v20 offset:20480
    ds_read_b64_tr_b16 v[190:191], v20 offset:21504
    ds_read_b64_tr_b16 v[192:193], v17 offset:20480
    ds_read_b64_tr_b16 v[194:195], v17 offset:21504
    ds_read_b64_tr_b16 v[196:197], v21 offset:20480
    ds_read_b64_tr_b16 v[198:199], v21 offset:21504
    s_waitcnt vmcnt(34) lgkmcnt(0)
    s_barrier
    s_mov_b32 m0, 81920
    s_mov_b32 s70, 1703936
    buffer_load_dwordx4 v32, s[20:23], s70 offen lds
    s_mov_b32 m0, 82944
    s_mov_b32 s70, 1720320
    buffer_load_dwordx4 v32, s[20:23], s70 offen lds
    s_mov_b32 m0, 83968
    s_mov_b32 s70, 1736704
    buffer_load_dwordx4 v34, s[20:23], s70 offen lds
    s_mov_b32 m0, 84992
    s_mov_b32 s70, 1753088
    buffer_load_dwordx4 v34, s[20:23], s70 offen lds
    ds_read_b64_tr_b16 v[88:89], v16 offset:24576
    ds_read_b64_tr_b16 v[90:91], v16 offset:25600
    ds_read_b64_tr_b16 v[92:93], v20 offset:24576
    ds_read_b64_tr_b16 v[94:95], v20 offset:25600
    ds_read_b64_tr_b16 v[96:97], v17 offset:24576
    ds_read_b64_tr_b16 v[98:99], v17 offset:25600
    ds_read_b64_tr_b16 v[100:101], v21 offset:24576
    ds_read_b64_tr_b16 v[102:103], v21 offset:25600
    s_waitcnt vmcnt(34) lgkmcnt(0)
    s_barrier
    s_mov_b32 m0, 86016
    s_mov_b32 s70, 2228224
    buffer_load_dwordx4 v32, s[20:23], s70 offen lds
    s_mov_b32 m0, 87040
    s_mov_b32 s70, 2244608
    buffer_load_dwordx4 v32, s[20:23], s70 offen lds
    s_mov_b32 m0, 88064
    s_mov_b32 s70, 2260992
    buffer_load_dwordx4 v34, s[20:23], s70 offen lds
    s_mov_b32 m0, 89088
    s_mov_b32 s70, 2277376
    buffer_load_dwordx4 v34, s[20:23], s70 offen lds
    ds_read_b64_tr_b16 v[136:137], v16 offset:28672
    ds_read_b64_tr_b16 v[138:139], v16 offset:29696
    ds_read_b64_tr_b16 v[140:141], v20 offset:28672
    ds_read_b64_tr_b16 v[142:143], v20 offset:29696
    ds_read_b64_tr_b16 v[144:145], v17 offset:28672
    ds_read_b64_tr_b16 v[146:147], v17 offset:29696
    ds_read_b64_tr_b16 v[148:149], v21 offset:28672
    ds_read_b64_tr_b16 v[150:151], v21 offset:29696
    s_waitcnt vmcnt(30) lgkmcnt(0)
    s_barrier
    s_mov_b32 m0, 90112
    s_mov_b32 s70, 2752512
    buffer_load_dwordx4 v32, s[20:23], s70 offen lds
    s_mov_b32 m0, 91136
    s_mov_b32 s70, 2768896
    buffer_load_dwordx4 v32, s[20:23], s70 offen lds
    s_mov_b32 m0, 92160
    s_mov_b32 s70, 2785280
    buffer_load_dwordx4 v34, s[20:23], s70 offen lds
    s_mov_b32 m0, 93184
    s_mov_b32 s70, 2801664
    buffer_load_dwordx4 v34, s[20:23], s70 offen lds
    ds_read_b64_tr_b16 v[216:217], v16 offset:0
    ds_read_b64_tr_b16 v[218:219], v16 offset:1024
    ds_read_b64_tr_b16 v[220:221], v20 offset:0
    ds_read_b64_tr_b16 v[222:223], v20 offset:1024
    ds_read_b64_tr_b16 v[224:225], v17 offset:0
    ds_read_b64_tr_b16 v[226:227], v17 offset:1024
    ds_read_b64_tr_b16 v[228:229], v21 offset:0
    ds_read_b64_tr_b16 v[230:231], v21 offset:1024
    s_waitcnt vmcnt(28) lgkmcnt(0)
    s_barrier
    s_mov_b32 m0, 61440
    s_mov_b32 s70, 3276800
    buffer_load_dwordx4 v32, s[20:23], s70 offen lds
    s_mov_b32 m0, 62464
    s_mov_b32 s70, 3293184
    buffer_load_dwordx4 v32, s[20:23], s70 offen lds
    s_mov_b32 m0, 63488
    s_mov_b32 s70, 3309568
    buffer_load_dwordx4 v34, s[20:23], s70 offen lds
    s_mov_b32 m0, 64512
    s_mov_b32 s70, 3325952
    buffer_load_dwordx4 v34, s[20:23], s70 offen lds
    ds_read_b64_tr_b16 a[8:9], v16 offset:4096
    ds_read_b64_tr_b16 a[10:11], v16 offset:5120
    ds_read_b64_tr_b16 a[12:13], v20 offset:4096
    ds_read_b64_tr_b16 a[14:15], v20 offset:5120
    ds_read_b64_tr_b16 a[16:17], v17 offset:4096
    ds_read_b64_tr_b16 a[18:19], v17 offset:5120
    ds_read_b64_tr_b16 a[20:21], v21 offset:4096
    ds_read_b64_tr_b16 a[22:23], v21 offset:5120
    s_waitcnt vmcnt(24) lgkmcnt(0)
    s_barrier
    s_mov_b32 m0, 65536
    s_mov_b32 s70, 3801088
    buffer_load_dwordx4 v32, s[20:23], s70 offen lds
    s_mov_b32 m0, 66560
    s_mov_b32 s70, 3817472
    buffer_load_dwordx4 v32, s[20:23], s70 offen lds
    s_mov_b32 m0, 67584
    s_mov_b32 s70, 3833856
    buffer_load_dwordx4 v34, s[20:23], s70 offen lds
    s_mov_b32 m0, 68608
    s_mov_b32 s70, 3850240
    buffer_load_dwordx4 v34, s[20:23], s70 offen lds
    ds_read_b64_tr_b16 a[88:89], v16 offset:8192
    ds_read_b64_tr_b16 a[90:91], v16 offset:9216
    ds_read_b64_tr_b16 a[92:93], v20 offset:8192
    ds_read_b64_tr_b16 a[94:95], v20 offset:9216
    ds_read_b64_tr_b16 a[96:97], v17 offset:8192
    ds_read_b64_tr_b16 a[98:99], v17 offset:9216
    ds_read_b64_tr_b16 a[100:101], v21 offset:8192
    ds_read_b64_tr_b16 a[102:103], v21 offset:9216
    s_waitcnt vmcnt(24) lgkmcnt(0)
    s_barrier
    s_mov_b32 m0, 69632
    s_mov_b32 s70, 4325376
    buffer_load_dwordx4 v32, s[20:23], s70 offen lds
    s_mov_b32 m0, 70656
    s_mov_b32 s70, 4341760
    buffer_load_dwordx4 v32, s[20:23], s70 offen lds
    s_mov_b32 m0, 71680
    s_mov_b32 s70, 4358144
    buffer_load_dwordx4 v34, s[20:23], s70 offen lds
    s_mov_b32 m0, 72704
    s_mov_b32 s70, 4374528
    buffer_load_dwordx4 v34, s[20:23], s70 offen lds
    ds_read_b64_tr_b16 a[104:105], v16 offset:12288
    ds_read_b64_tr_b16 a[106:107], v16 offset:13312
    ds_read_b64_tr_b16 a[108:109], v20 offset:12288
    ds_read_b64_tr_b16 a[110:111], v20 offset:13312
    ds_read_b64_tr_b16 a[112:113], v17 offset:12288
    ds_read_b64_tr_b16 a[114:115], v17 offset:13312
    ds_read_b64_tr_b16 a[116:117], v21 offset:12288
    ds_read_b64_tr_b16 a[118:119], v21 offset:13312
    s_waitcnt vmcnt(24) lgkmcnt(0)
    s_barrier
    s_mov_b32 m0, 73728
    s_mov_b32 s70, 4849664
    buffer_load_dwordx4 v32, s[20:23], s70 offen lds
    s_mov_b32 m0, 74752
    s_mov_b32 s70, 4866048
    buffer_load_dwordx4 v32, s[20:23], s70 offen lds
    s_mov_b32 m0, 75776
    s_mov_b32 s70, 4882432
    buffer_load_dwordx4 v34, s[20:23], s70 offen lds
    s_mov_b32 m0, 76800
    s_mov_b32 s70, 4898816
    buffer_load_dwordx4 v34, s[20:23], s70 offen lds
    ds_read_b64_tr_b16 a[56:57], v16 offset:16384
    ds_read_b64_tr_b16 a[58:59], v16 offset:17408
    ds_read_b64_tr_b16 a[60:61], v20 offset:16384
    ds_read_b64_tr_b16 a[62:63], v20 offset:17408
    ds_read_b64_tr_b16 a[64:65], v17 offset:16384
    ds_read_b64_tr_b16 a[66:67], v17 offset:17408
    ds_read_b64_tr_b16 a[68:69], v21 offset:16384
    ds_read_b64_tr_b16 a[70:71], v21 offset:17408
    s_waitcnt vmcnt(24) lgkmcnt(0)
    s_barrier
    s_mov_b32 m0, 77824
    s_mov_b32 s70, 10240
    buffer_load_dwordx4 v33, s[24:27], s70 offen lds
    s_mov_b32 m0, 78848
    s_mov_b32 s70, 12800
    buffer_load_dwordx4 v33, s[24:27], s70 offen lds
    s_mov_b32 m0, 79872
    s_mov_b32 s70, 30720
    buffer_load_dwordx4 v35, s[24:27], s70 offen lds
    s_mov_b32 m0, 80896
    s_mov_b32 s70, 33280
    buffer_load_dwordx4 v35, s[24:27], s70 offen lds
    ds_read_b64_tr_b16 a[24:25], v16 offset:20480
    ds_read_b64_tr_b16 a[26:27], v16 offset:21504
    ds_read_b64_tr_b16 a[28:29], v20 offset:20480
    ds_read_b64_tr_b16 a[30:31], v20 offset:21504
    ds_read_b64_tr_b16 a[32:33], v17 offset:20480
    ds_read_b64_tr_b16 a[34:35], v17 offset:21504
    ds_read_b64_tr_b16 a[36:37], v21 offset:20480
    ds_read_b64_tr_b16 a[38:39], v21 offset:21504
    s_waitcnt vmcnt(24) lgkmcnt(0)
    s_barrier
    s_mov_b32 m0, 81920
    s_mov_b32 s70, 11008
    buffer_load_dwordx4 v33, s[24:27], s70 offen lds
    s_mov_b32 m0, 82944
    s_mov_b32 s70, 13568
    buffer_load_dwordx4 v33, s[24:27], s70 offen lds
    s_mov_b32 m0, 83968
    s_mov_b32 s70, 31488
    buffer_load_dwordx4 v35, s[24:27], s70 offen lds
    s_mov_b32 m0, 84992
    s_mov_b32 s70, 34048
    buffer_load_dwordx4 v35, s[24:27], s70 offen lds
    ds_read_b64_tr_b16 a[40:41], v16 offset:24576
    ds_read_b64_tr_b16 a[42:43], v16 offset:25600
    ds_read_b64_tr_b16 a[44:45], v20 offset:24576
    ds_read_b64_tr_b16 a[46:47], v20 offset:25600
    ds_read_b64_tr_b16 a[48:49], v17 offset:24576
    ds_read_b64_tr_b16 a[50:51], v17 offset:25600
    ds_read_b64_tr_b16 a[52:53], v21 offset:24576
    ds_read_b64_tr_b16 a[54:55], v21 offset:25600
    s_waitcnt vmcnt(24) lgkmcnt(0)
    s_barrier
    s_mov_b32 m0, 86016
    s_mov_b32 s70, 11264
    buffer_load_dwordx4 v33, s[24:27], s70 offen lds
    s_mov_b32 m0, 87040
    s_mov_b32 s70, 13824
    buffer_load_dwordx4 v33, s[24:27], s70 offen lds
    s_mov_b32 m0, 88064
    s_mov_b32 s70, 31744
    buffer_load_dwordx4 v35, s[24:27], s70 offen lds
    s_mov_b32 m0, 89088
    s_mov_b32 s70, 34304
    buffer_load_dwordx4 v35, s[24:27], s70 offen lds
    ds_read_b64_tr_b16 a[72:73], v16 offset:28672
    ds_read_b64_tr_b16 a[74:75], v16 offset:29696
    ds_read_b64_tr_b16 a[76:77], v20 offset:28672
    ds_read_b64_tr_b16 a[78:79], v20 offset:29696
    ds_read_b64_tr_b16 a[80:81], v17 offset:28672
    ds_read_b64_tr_b16 a[82:83], v17 offset:29696
    ds_read_b64_tr_b16 a[84:85], v21 offset:28672
    ds_read_b64_tr_b16 a[86:87], v21 offset:29696
    s_waitcnt vmcnt(24) lgkmcnt(0)
    s_barrier
    s_mov_b32 m0, 90112
    s_mov_b32 s70, 92416
    buffer_load_dwordx4 v33, s[24:27], s70 offen lds
    s_mov_b32 m0, 91136
    s_mov_b32 s70, 94976
    buffer_load_dwordx4 v33, s[24:27], s70 offen lds
    s_mov_b32 m0, 92160
    s_mov_b32 s70, 112896
    buffer_load_dwordx4 v35, s[24:27], s70 offen lds
    s_mov_b32 m0, 93184
    s_mov_b32 s70, 115456
    buffer_load_dwordx4 v35, s[24:27], s70 offen lds
    ds_read_b64_tr_b16 a[120:121], v16 offset:0
    ds_read_b64_tr_b16 a[122:123], v16 offset:1024
    ds_read_b64_tr_b16 a[124:125], v20 offset:0
    ds_read_b64_tr_b16 a[126:127], v20 offset:1024
    ds_read_b64_tr_b16 a[128:129], v17 offset:0
    ds_read_b64_tr_b16 a[130:131], v17 offset:1024
    ds_read_b64_tr_b16 a[132:133], v21 offset:0
    ds_read_b64_tr_b16 a[134:135], v21 offset:1024
    s_waitcnt vmcnt(24) lgkmcnt(0)
    s_barrier
    s_mov_b32 m0, 61440
    s_mov_b32 s70, 131072
    buffer_load_dwordx4 v32, s[16:19], s70 offen lds
    s_mov_b32 m0, 62464
    s_mov_b32 s70, 147456
    buffer_load_dwordx4 v32, s[16:19], s70 offen lds
    s_mov_b32 m0, 63488
    s_mov_b32 s70, 163840
    buffer_load_dwordx4 v34, s[16:19], s70 offen lds
    s_mov_b32 m0, 64512
    s_mov_b32 s70, 180224
    buffer_load_dwordx4 v34, s[16:19], s70 offen lds
    ds_read_b64_tr_b16 a[136:137], v16 offset:4096
    ds_read_b64_tr_b16 a[138:139], v16 offset:5120
    ds_read_b64_tr_b16 a[140:141], v20 offset:4096
    ds_read_b64_tr_b16 a[142:143], v20 offset:5120
    ds_read_b64_tr_b16 a[144:145], v17 offset:4096
    ds_read_b64_tr_b16 a[146:147], v17 offset:5120
    ds_read_b64_tr_b16 a[148:149], v21 offset:4096
    ds_read_b64_tr_b16 a[150:151], v21 offset:5120
    s_waitcnt vmcnt(24) lgkmcnt(0)
    s_barrier
    s_mov_b32 m0, 65536
    s_mov_b32 s70, 1179648
    buffer_load_dwordx4 v32, s[16:19], s70 offen lds
    s_mov_b32 m0, 66560
    s_mov_b32 s70, 1196032
    buffer_load_dwordx4 v32, s[16:19], s70 offen lds
    s_mov_b32 m0, 67584
    s_mov_b32 s70, 1212416
    buffer_load_dwordx4 v34, s[16:19], s70 offen lds
    s_mov_b32 m0, 68608
    s_mov_b32 s70, 1228800
    buffer_load_dwordx4 v34, s[16:19], s70 offen lds
    ds_read_b64_tr_b16 a[152:153], v16 offset:8192
    ds_read_b64_tr_b16 a[154:155], v16 offset:9216
    ds_read_b64_tr_b16 a[156:157], v20 offset:8192
    ds_read_b64_tr_b16 a[158:159], v20 offset:9216
    ds_read_b64_tr_b16 a[160:161], v17 offset:8192
    ds_read_b64_tr_b16 a[162:163], v17 offset:9216
    ds_read_b64_tr_b16 a[164:165], v21 offset:8192
    ds_read_b64_tr_b16 a[166:167], v21 offset:9216
    s_waitcnt vmcnt(24) lgkmcnt(0)
    s_barrier
    s_mov_b32 m0, 69632
    s_mov_b32 s70, 1703936
    buffer_load_dwordx4 v32, s[16:19], s70 offen lds
    s_mov_b32 m0, 70656
    s_mov_b32 s70, 1720320
    buffer_load_dwordx4 v32, s[16:19], s70 offen lds
    s_mov_b32 m0, 71680
    s_mov_b32 s70, 1736704
    buffer_load_dwordx4 v34, s[16:19], s70 offen lds
    s_mov_b32 m0, 72704
    s_mov_b32 s70, 1753088
    buffer_load_dwordx4 v34, s[16:19], s70 offen lds
    ds_read_b64_tr_b16 a[168:169], v16 offset:12288
    ds_read_b64_tr_b16 a[170:171], v16 offset:13312
    ds_read_b64_tr_b16 a[172:173], v20 offset:12288
    ds_read_b64_tr_b16 a[174:175], v20 offset:13312
    ds_read_b64_tr_b16 a[176:177], v17 offset:12288
    ds_read_b64_tr_b16 a[178:179], v17 offset:13312
    ds_read_b64_tr_b16 a[180:181], v21 offset:12288
    ds_read_b64_tr_b16 a[182:183], v21 offset:13312
    s_waitcnt vmcnt(24) lgkmcnt(0)
    s_barrier
    s_mov_b32 m0, 73728
    s_mov_b32 s70, 3276800
    buffer_load_dwordx4 v32, s[16:19], s70 offen lds
    s_mov_b32 m0, 74752
    s_mov_b32 s70, 3293184
    buffer_load_dwordx4 v32, s[16:19], s70 offen lds
    s_mov_b32 m0, 75776
    s_mov_b32 s70, 3309568
    buffer_load_dwordx4 v34, s[16:19], s70 offen lds
    s_mov_b32 m0, 76800
    s_mov_b32 s70, 3325952
    buffer_load_dwordx4 v34, s[16:19], s70 offen lds
    ds_read_b64_tr_b16 a[184:185], v18 offset:16384
    ds_read_b64_tr_b16 a[186:187], v18 offset:17408
    ds_read_b64_tr_b16 a[188:189], v22 offset:16384
    ds_read_b64_tr_b16 a[190:191], v22 offset:17408
    ds_read_b64_tr_b16 a[192:193], v19 offset:16384
    ds_read_b64_tr_b16 a[194:195], v19 offset:17408
    ds_read_b64_tr_b16 a[196:197], v23 offset:16384
    ds_read_b64_tr_b16 a[198:199], v23 offset:17408
    s_waitcnt vmcnt(24) lgkmcnt(0)
    s_barrier
    s_mov_b32 m0, 77824
    s_mov_b32 s70, 4325376
    buffer_load_dwordx4 v32, s[16:19], s70 offen lds
    s_mov_b32 m0, 78848
    s_mov_b32 s70, 4341760
    buffer_load_dwordx4 v32, s[16:19], s70 offen lds
    s_mov_b32 m0, 79872
    s_mov_b32 s70, 4358144
    buffer_load_dwordx4 v34, s[16:19], s70 offen lds
    s_mov_b32 m0, 80896
    s_mov_b32 s70, 4374528
    buffer_load_dwordx4 v34, s[16:19], s70 offen lds
    ds_read_b64_tr_b16 a[224:225], v18 offset:20480
    ds_read_b64_tr_b16 a[226:227], v18 offset:21504
    ds_read_b64_tr_b16 a[228:229], v22 offset:20480
    ds_read_b64_tr_b16 a[230:231], v22 offset:21504
    ds_read_b64_tr_b16 a[232:233], v19 offset:20480
    ds_read_b64_tr_b16 a[234:235], v19 offset:21504
    ds_read_b64_tr_b16 a[236:237], v23 offset:20480
    ds_read_b64_tr_b16 a[238:239], v23 offset:21504
    s_waitcnt vmcnt(24) lgkmcnt(0)
    s_barrier
    s_mov_b32 m0, 81920
    s_mov_b32 s70, 92672
    buffer_load_dwordx4 v33, s[24:27], s70 offen lds
    s_mov_b32 m0, 82944
    s_mov_b32 s70, 95232
    buffer_load_dwordx4 v33, s[24:27], s70 offen lds
    s_mov_b32 m0, 83968
    s_mov_b32 s70, 113152
    buffer_load_dwordx4 v35, s[24:27], s70 offen lds
    s_mov_b32 m0, 84992
    s_mov_b32 s70, 115712
    buffer_load_dwordx4 v35, s[24:27], s70 offen lds
    ds_read_b64_tr_b16 a[240:241], v18 offset:24576
    ds_read_b64_tr_b16 a[242:243], v18 offset:25600
    ds_read_b64_tr_b16 a[244:245], v22 offset:24576
    ds_read_b64_tr_b16 a[246:247], v22 offset:25600
    ds_read_b64_tr_b16 a[248:249], v19 offset:24576
    ds_read_b64_tr_b16 a[250:251], v19 offset:25600
    ds_read_b64_tr_b16 a[252:253], v23 offset:24576
    ds_read_b64_tr_b16 a[254:255], v23 offset:25600
    s_waitcnt vmcnt(24) lgkmcnt(0)
    s_barrier
    s_mov_b32 m0, 86016
    s_mov_b32 s70, 92928
    buffer_load_dwordx4 v33, s[24:27], s70 offen lds
    s_mov_b32 m0, 87040
    s_mov_b32 s70, 95488
    buffer_load_dwordx4 v33, s[24:27], s70 offen lds
    s_mov_b32 m0, 88064
    s_mov_b32 s70, 113408
    buffer_load_dwordx4 v35, s[24:27], s70 offen lds
    s_mov_b32 m0, 89088
    s_mov_b32 s70, 115968
    buffer_load_dwordx4 v35, s[24:27], s70 offen lds
    ds_read_b64_tr_b16 a[200:201], v18 offset:28672
    ds_read_b64_tr_b16 a[202:203], v18 offset:29696
    ds_read_b64_tr_b16 a[204:205], v22 offset:28672
    ds_read_b64_tr_b16 a[206:207], v22 offset:29696
    ds_read_b64_tr_b16 a[208:209], v19 offset:28672
    ds_read_b64_tr_b16 a[210:211], v19 offset:29696
    ds_read_b64_tr_b16 a[212:213], v23 offset:28672
    ds_read_b64_tr_b16 a[214:215], v23 offset:29696
    s_waitcnt vmcnt(24) lgkmcnt(0)
    s_barrier
    s_mov_b32 m0, 90112
    s_mov_b32 s70, 93184
    buffer_load_dwordx4 v33, s[24:27], s70 offen lds
    s_mov_b32 m0, 91136
    s_mov_b32 s70, 95744
    buffer_load_dwordx4 v33, s[24:27], s70 offen lds
    s_mov_b32 m0, 92160
    s_mov_b32 s70, 113664
    buffer_load_dwordx4 v35, s[24:27], s70 offen lds
    s_mov_b32 m0, 93184
    s_mov_b32 s70, 116224
    buffer_load_dwordx4 v35, s[24:27], s70 offen lds
    ds_read_b64_tr_b16 v[40:41], v16 offset:0
    ds_read_b64_tr_b16 v[42:43], v16 offset:1024
    ds_read_b64_tr_b16 v[44:45], v20 offset:0
    ds_read_b64_tr_b16 v[46:47], v20 offset:1024
    ds_read_b64_tr_b16 v[48:49], v17 offset:0
    ds_read_b64_tr_b16 v[50:51], v17 offset:1024
    ds_read_b64_tr_b16 v[52:53], v21 offset:0
    ds_read_b64_tr_b16 v[54:55], v21 offset:1024
    v_lshrrev_b32 v24, 4, v0
    v_bfe_u32 v25, v24, 2, 2
    v_lshlrev_b32 v25, 1, v25
    v_and_b32 v26, 1, v24
    v_add_u32 v25, v25, v26
    v_mul_u32_u24 v25, 1280, v25
    v_lshrrev_b32 v26, 4, v24
    v_lshl_add_u32 v25, v26, 5, v25
    v_bfe_u32 v26, v24, 1, 1
    v_lshl_add_u32 v25, v26, 4, v25
    buffer_load_dwordx4 v[8:11], v25, s[32:35], 0 offen offset:384
    buffer_load_dwordx4 v[12:15], v25, s[32:35], 0 offen offset:512
    buffer_load_dwordx4 v[36:39], v25, s[32:35], 0 offen offset:640
    v_and_b32 v26, 7, v24
    v_min_u32 v27, 1, v26
    v_lshlrev_b32 v26, 2, v26
    v_lshl_add_u32 v26, v27, 7, v26
    buffer_load_dword v72, off, s[48:51], 0 offset:32 sc1
    buffer_load_dword v73, v26, s[48:51], 0 offen sc1
    v_lshlrev_b32 v24, 3, v0
    buffer_load_dwordx4 v[28:31], v0, s[8:11], s59 offen offset:0 sc1
    buffer_load_dwordx4 v[28:31], v0, s[8:11], s59 offen offset:1024 sc1
    s_add_u32 s70, s56, 5120
    buffer_load_dword v74, v24, s[8:11], s70 offen sc1
    s_waitcnt vmcnt(32) lgkmcnt(0)
    s_barrier
    ds_write_b128 v7, v[40:43] offset:0
    ds_write_b128 v7, v[44:47] offset:1024
    ds_write_b128 v7, v[48:51] offset:2048
    ds_write_b128 v7, v[52:55] offset:3072
    ds_read_b64_tr_b16 v[56:57], v16 offset:4096
    ds_read_b64_tr_b16 v[58:59], v16 offset:5120
    ds_read_b64_tr_b16 v[60:61], v20 offset:4096
    ds_read_b64_tr_b16 v[62:63], v20 offset:5120
    ds_read_b64_tr_b16 v[64:65], v17 offset:4096
    ds_read_b64_tr_b16 v[66:67], v17 offset:5120
    ds_read_b64_tr_b16 v[68:69], v21 offset:4096
    ds_read_b64_tr_b16 v[70:71], v21 offset:5120
    s_waitcnt vmcnt(28) lgkmcnt(0)
    s_barrier
    ds_write_b128 v7, v[56:59] offset:4096
    ds_write_b128 v7, v[60:63] offset:5120
    ds_write_b128 v7, v[64:67] offset:6144
    ds_write_b128 v7, v[68:71] offset:7168
    ds_read_b64_tr_b16 v[40:41], v16 offset:8192
    ds_read_b64_tr_b16 v[42:43], v16 offset:9216
    ds_read_b64_tr_b16 v[44:45], v20 offset:8192
    ds_read_b64_tr_b16 v[46:47], v20 offset:9216
    ds_read_b64_tr_b16 v[48:49], v17 offset:8192
    ds_read_b64_tr_b16 v[50:51], v17 offset:9216
    ds_read_b64_tr_b16 v[52:53], v21 offset:8192
    ds_read_b64_tr_b16 v[54:55], v21 offset:9216
    s_waitcnt vmcnt(24) lgkmcnt(0)
    s_barrier
    ds_write_b128 v7, v[40:43] offset:8192
    ds_write_b128 v7, v[44:47] offset:9216
    ds_write_b128 v7, v[48:51] offset:10240
    ds_write_b128 v7, v[52:55] offset:11264
    ds_read_b64_tr_b16 v[56:57], v16 offset:12288
    ds_read_b64_tr_b16 v[58:59], v16 offset:13312
    ds_read_b64_tr_b16 v[60:61], v20 offset:12288
    ds_read_b64_tr_b16 v[62:63], v20 offset:13312
    ds_read_b64_tr_b16 v[64:65], v17 offset:12288
    ds_read_b64_tr_b16 v[66:67], v17 offset:13312
    ds_read_b64_tr_b16 v[68:69], v21 offset:12288
    ds_read_b64_tr_b16 v[70:71], v21 offset:13312
    s_waitcnt vmcnt(20) lgkmcnt(0)
    s_barrier
    ds_write_b128 v7, v[56:59] offset:12288
    ds_write_b128 v7, v[60:63] offset:13312
    ds_write_b128 v7, v[64:67] offset:14336
    ds_write_b128 v7, v[68:71] offset:15360
    ds_read_b64_tr_b16 v[40:41], v16 offset:16384
    ds_read_b64_tr_b16 v[42:43], v16 offset:17408
    ds_read_b64_tr_b16 v[44:45], v20 offset:16384
    ds_read_b64_tr_b16 v[46:47], v20 offset:17408
    ds_read_b64_tr_b16 v[48:49], v17 offset:16384
    ds_read_b64_tr_b16 v[50:51], v17 offset:17408
    ds_read_b64_tr_b16 v[52:53], v21 offset:16384
    ds_read_b64_tr_b16 v[54:55], v21 offset:17408
    s_waitcnt vmcnt(16) lgkmcnt(0)
    s_barrier
    ds_write_b128 v7, v[40:43] offset:16384
    ds_write_b128 v7, v[44:47] offset:17408
    ds_write_b128 v7, v[48:51] offset:18432
    ds_write_b128 v7, v[52:55] offset:19456
    ds_read_b64_tr_b16 v[56:57], v18 offset:20480
    ds_read_b64_tr_b16 v[58:59], v18 offset:21504
    ds_read_b64_tr_b16 v[60:61], v22 offset:20480
    ds_read_b64_tr_b16 v[62:63], v22 offset:21504
    ds_read_b64_tr_b16 v[64:65], v19 offset:20480
    ds_read_b64_tr_b16 v[66:67], v19 offset:21504
    ds_read_b64_tr_b16 v[68:69], v23 offset:20480
    ds_read_b64_tr_b16 v[70:71], v23 offset:21504
    s_waitcnt vmcnt(12) lgkmcnt(0)
    s_barrier
    ds_write_b128 v7, v[56:59] offset:20480
    ds_write_b128 v7, v[60:63] offset:21504
    ds_write_b128 v7, v[64:67] offset:22528
    ds_write_b128 v7, v[68:71] offset:23552
    ds_read_b64_tr_b16 v[40:41], v18 offset:24576
    ds_read_b64_tr_b16 v[42:43], v18 offset:25600
    ds_read_b64_tr_b16 v[44:45], v22 offset:24576
    ds_read_b64_tr_b16 v[46:47], v22 offset:25600
    ds_read_b64_tr_b16 v[48:49], v19 offset:24576
    ds_read_b64_tr_b16 v[50:51], v19 offset:25600
    ds_read_b64_tr_b16 v[52:53], v23 offset:24576
    ds_read_b64_tr_b16 v[54:55], v23 offset:25600
    s_waitcnt vmcnt(8) lgkmcnt(0)
    s_barrier
    ds_write_b128 v7, v[40:43] offset:24576
    ds_write_b128 v7, v[44:47] offset:25600
    ds_write_b128 v7, v[48:51] offset:26624
    ds_write_b128 v7, v[52:55] offset:27648
    ds_read_b64_tr_b16 v[56:57], v18 offset:28672
    ds_read_b64_tr_b16 v[58:59], v18 offset:29696
    ds_read_b64_tr_b16 v[60:61], v22 offset:28672
    ds_read_b64_tr_b16 v[62:63], v22 offset:29696
    ds_read_b64_tr_b16 v[64:65], v19 offset:28672
    ds_read_b64_tr_b16 v[66:67], v19 offset:29696
    ds_read_b64_tr_b16 v[68:69], v23 offset:28672
    ds_read_b64_tr_b16 v[70:71], v23 offset:29696
    s_waitcnt vmcnt(0)
    s_lshl_b32 s71, s53, 7
    s_add_u32 s71, s71, 24580
    buffer_load_dword v75, off, s[8:11], s71 sc1
    s_waitcnt lgkmcnt(0)
    s_barrier
    ds_write_b128 v7, v[56:59] offset:28672
    ds_write_b128 v7, v[60:63] offset:29696
    ds_write_b128 v7, v[64:67] offset:30720
    ds_write_b128 v7, v[68:71] offset:31744
    s_waitcnt vmcnt(0) lgkmcnt(0)
    v_readfirstlane_b32 s70, v72
    v_cmp_ne_u32 vcc, 32, v73
    s_cmp_ge_u32 s70, 256
    s_cselect_b32 s70, vcc_lo, 1
    s_cmp_eq_u32 s70, 0
    s_cbranch_scc1 CH1_rdy
    s_cmp_lg_u32 s96, 0
    s_cbranch_scc1 RDY_ok_79
    s_mov_b32 s68, 0
RDY_lp_80:
    buffer_load_dword v40, off, s[48:51], 0 offset:32 sc1
    s_waitcnt vmcnt(0)
    v_readfirstlane_b32 s70, v40
    s_nop 0
    s_cmp_ge_u32 s70, 256
    s_cbranch_scc1 RDY_all_81
    s_sleep 8
    s_add_u32 s68, s68, 1
    s_cmp_lt_u32 s68, 65536
    s_cbranch_scc1 RDY_lp_80
    s_branch RDY_ok_79
RDY_all_81:
    v_mbcnt_lo_u32_b32 v41, -1, 0
    v_and_b32 v41, 7, v41
    v_min_u32 v42, 1, v41
    v_lshlrev_b32 v41, 2, v41
    v_lshl_add_u32 v41, v42, 7, v41
    buffer_load_dword v40, v41, s[48:51], 0 offen sc1
    s_waitcnt vmcnt(0)
    v_cmp_ne_u32 vcc, 32, v40
    s_nop 0
    s_cbranch_vccnz L_slow
RDY_ok_79:
    v_mov_b32 v75, 0
CH1_rdy:
    s_mov_b32 s40, 0x3f803f80
    s_mov_b32 s41, 0x3f803f80
    ds_write_b128 v0, v[36:39] offset:5120
    v_mov_b64 v[28:29], v[36:37]
    v_mov_b64 v[30:31], v[38:39]
    ds_write_b128 v0, v[12:15] offset:4096
    v_mov_b64 v[36:37], v[12:13]
    v_mov_b64 v[38:39], v[14:15]
    ds_write_b128 v0, v[8:11] offset:3072
    v_mov_b64 v[32:33], v[8:9]
    v_mov_b64 v[34:35], v[10:11]
    s_lshl_b32 s71, s53, 7
    s_add_u32 s71, s71, 24580
    s_mov_b32 s68, 0
    v_readfirstlane_b32 s70, v75
    s_nop 0
    s_cmp_lg_u32 s70, 0
    s_cbranch_scc1 CH1_sok
CH1_sw:
    buffer_load_dword v72, off, s[8:11], s71 sc1
    s_waitcnt vmcnt(0)
    v_readfirstlane_b32 s70, v72
    s_nop 0
    s_cmp_lg_u32 s70, 0
    s_cbranch_scc1 CH1_sok
    s_sleep 2
    s_add_u32 s68, s68, 1
    s_cmp_lt_u32 s68, 65536
    s_cbranch_scc1 CH1_sw
CH1_sok:
    buffer_load_dwordx4 v[40:43], v0, s[8:11], s61 offen offset:2048
    buffer_load_dwordx4 v[44:47], v0, s[8:11], s61 offen offset:3072
    buffer_load_dwordx4 v[72:75], v0, s[8:11], s61 offen offset:0
    buffer_load_dwordx4 v[76:79], v0, s[8:11], s61 offen offset:1024
    ds_read_b128 v[56:59], v7 offset:8192
    ds_read_b128 v[60:63], v7 offset:9216
    ds_read_b128 v[64:67], v7 offset:10240
    ds_read_b128 v[68:71], v7 offset:11264
    buffer_load_dwordx4 v[48:51], v0, s[8:11], s3 offen offset:0
    buffer_load_dwordx4 v[52:55], v0, s[8:11], s3 offen offset:1024
    s_waitcnt lgkmcnt(0)
    v_mov_b64 v[8:9], 0
    v_mov_b64 v[10:11], 0
    v_mov_b64 v[12:13], 0
    v_mov_b64 v[14:15], 0
    v_mov_b64 v[16:17], 0
    v_mov_b64 v[18:19], 0
    v_mov_b64 v[20:21], 0
    v_mov_b64 v[22:23], 0
    s_cmp_lg_u32 s96, 0
    s_cbranch_scc1 CHS1_start
CHF1_start:
    s_barrier
    s_mov_b32 m0, 18432
    s_nop 0
    buffer_load_dwordx4 v0, s[8:11], s63 offen offset:0 sc1 lds
    buffer_load_dwordx4 v0, s[8:11], s63 offen offset:1024 sc1 lds
    s_add_u32 s63, s63, 262144
    s_waitcnt vmcnt(0) lgkmcnt(0)
CHF1_loop:
    s_barrier
    ds_read_b128 v[28:31], v0 offset:2048
    v_mov_b32 v23, 0
    v_smfmac_f32_16x16x64_bf16 v[8:11], v[32:35], v[40:47], v1
    buffer_load_dwordx4 v[40:43], v0, s[8:11], s3 offen offset:2048
    v_smfmac_f32_16x16x64_bf16 v[12:15], v[32:35], v[72:79], v1
    buffer_load_dwordx4 v[44:47], v0, s[8:11], s3 offen offset:3072
    v_smfmac_f32_16x16x64_bf16 v[16:19], v[32:35], v[56:63], v1
    buffer_load_dwordx4 v[72:75], v0, s[8:11], s5 offen offset:0
    v_smfmac_f32_16x16x64_bf16 v[20:23], v[32:35], v[64:71], v1
    ds_read_b128 v[32:35], v0 offset:5120
    buffer_load_dwordx4 v[76:79], v0, s[8:11], s5 offen offset:1024
    v_smfmac_f32_16x16x64_bf16 v[8:11], v[36:39], v[48:55], v1
    ds_read_b128 v[56:59], v7 offset:4096
    v_smfmac_f32_16x16x64_bf16 v[12:15], v[36:39], v[80:87], v1
    ds_read_b128 v[60:63], v7 offset:5120
    ds_read_b128 v[64:67], v7 offset:6144
    v_smfmac_f32_16x16x64_bf16 v[16:19], v[36:39], v[88:95], v1
    ds_read_b128 v[68:71], v7 offset:7168
    buffer_load_dwordx4 v[48:51], v0, s[8:11], s62 offen offset:0 sc1
    v_smfmac_f32_16x16x64_bf16 v[20:23], v[36:39], v[96:103], v1
    ds_read_b128 v[36:39], v0 offset:0
    s_waitcnt lgkmcnt(6)
    v_smfmac_f32_16x16x64_bf16 v[8:11], v[28:31], v[104:111], v1
    buffer_load_dwordx4 v[52:55], v0, s[8:11], s62 offen offset:1024 sc1
    v_smfmac_f32_16x16x64_bf16 v[12:15], v[28:31], v[112:119], v1
    buffer_store_dwordx4 v[24:27], v0, s[8:11], s64 offen sc1
    s_waitcnt lgkmcnt(1)
    v_smfmac_f32_16x16x64_bf16 v[16:19], v[28:31], v[56:63], v1
    ds_read_b128 v[24:27], v0 offset:1024
    ds_read_b128 v[56:59], v7 offset:0
    v_smfmac_f32_16x16x64_bf16 v[20:23], v[28:31], v[64:71], v1
    ds_read_b128 v[28:31], v0 offset:6144
    ds_read_b128 v[60:63], v7 offset:1024
    v_smfmac_f32_16x16x64_bf16 v[8:11], v[32:35], v[120:127], v1
    ds_read_b128 v[64:67], v7 offset:2048
    v_smfmac_f32_16x16x64_bf16 v[12:15], v[32:35], v[128:135], v1
    ds_read_b128 v[68:71], v7 offset:3072
    v_smfmac_f32_16x16x64_bf16 v[16:19], v[32:35], v[136:143], v1
    v_smfmac_f32_16x16x64_bf16 v[20:23], v[32:35], v[144:151], v1
    ds_read_b128 v[32:35], v0 offset:8192
    s_waitcnt lgkmcnt(7)
    v_smfmac_f32_16x16x64_bf16 v[8:11], v[36:39], v[152:159], v1
    v_smfmac_f32_16x16x64_bf16 v[12:15], v[36:39], v[160:167], v1
    s_waitcnt lgkmcnt(1)
    v_smfmac_f32_16x16x64_bf16 v[16:19], v[36:39], v[56:63], v1
    ds_read_b128 v[56:59], v7 offset:12288
    v_smfmac_f32_16x16x64_bf16 v[20:23], v[36:39], v[64:71], v1
    ds_read_b128 v[36:39], v0 offset:9216
    ds_read_b128 v[60:63], v7 offset:13312
    v_smfmac_f32_16x16x64_bf16 v[8:11], v[24:27], v[168:175], v1
    ds_read_b128 v[64:67], v7 offset:14336
    v_smfmac_f32_16x16x64_bf16 v[12:15], v[24:27], v[176:183], v1
    ds_read_b128 v[68:71], v7 offset:15360
    v_smfmac_f32_16x16x64_bf16 v[16:19], v[24:27], v[184:191], v1
    v_smfmac_f32_16x16x64_bf16 v[20:23], v[24:27], v[192:199], v1
    ds_read_b128 v[24:27], v0 offset:7168
    s_waitcnt vmcnt(5)
    v_smfmac_f32_16x16x64_bf16 v[8:11], v[28:31], v[40:47], v1
    v_smfmac_f32_16x16x64_bf16 v[12:15], v[28:31], v[200:207], v1
    s_waitcnt lgkmcnt(1)
    v_smfmac_f32_16x16x64_bf16 v[16:19], v[28:31], v[56:63], v1
    ds_read_b128 v[56:59], v7 offset:16384
    v_smfmac_f32_16x16x64_bf16 v[20:23], v[28:31], v[64:71], v1
    ds_read_b128 v[60:63], v7 offset:17408
    s_waitcnt lgkmcnt(2)
    s_waitcnt vmcnt(3)
    v_smfmac_f32_16x16x64_bf16 v[8:11], v[24:27], v[72:79], v1
    ds_read_b128 v[64:67], v7 offset:18432
    v_mov_b64 v[28:29], 0
    v_smfmac_f32_16x16x64_bf16 v[12:15], v[24:27], v[208:215], v1
    ds_read_b128 v[68:71], v7 offset:19456
    v_mov_b64 v[30:31], 0
    v_smfmac_f32_16x16x64_bf16 v[16:19], v[24:27], v[216:223], v1
    ds_read_b128 v[40:43], v0 offset:16384
    v_smfmac_f32_16x16x64_bf16 v[20:23], v[24:27], v[224:231], v1
    ds_read_b128 v[44:47], v0 offset:20480
    v_smfmac_f32_16x16x64_bf16 v[8:11], v[32:35], v[232:239], v1
    v_mov_b64 v[24:25], 0
    v_smfmac_f32_16x16x64_bf16 v[12:15], v[32:35], v[240:247], v1
    v_mov_b64 v[26:27], 0
    s_waitcnt lgkmcnt(2)
    v_smfmac_f32_16x16x64_bf16 v[16:19], v[32:35], v[56:63], v1
    v_smfmac_f32_16x16x64_bf16 v[20:23], v[32:35], v[64:71], v1
    v_smfmac_f32_16x16x64_bf16 v[8:11], v[36:39], v[248:255], v1
    ds_read_b128 v[72:75], v0 offset:17408
    v_smfmac_f32_16x16x64_bf16 v[12:15], v[36:39], a[0:7], v1
    ds_read_b128 v[76:79], v0 offset:21504
    v_smfmac_f32_16x16x64_bf16 v[16:19], v[36:39], a[8:15], v1
    v_smfmac_f32_16x16x64_bf16 v[20:23], v[36:39], a[16:23], v1
    v_smfmac_f32_16x16x64_bf16 v[24:27], v[36:39], a[168:175], v1
    s_nop 1
    v_add_f32 v8, v8, v10
    v_add_f32 v9, v9, v11
    v_add_f32 v12, v12, v14
    v_add_f32 v13, v13, v15
    v_mul_f32 v8, s79, v8
    v_mul_f32 v12, s79, v12
    v_mul_f32 v9, s79, v9
    v_mul_f32 v13, s79, v13
    v_cvt_pk_bf16_f32 v10, v8, v12
    v_cvt_pk_bf16_f32 v11, v9, v13
    ds_write2_b32 v5, v10, v11 offset0:0 offset1:4
    v_add_f32 v16, v16, v18
    v_add_f32 v17, v17, v19
    v_add_f32 v20, v20, v22
    v_add_f32 v21, v21, v23
    v_cvt_pk_bf16_f32 v18, v16, v20
    v_cvt_pk_bf16_f32 v19, v17, v21
    ds_write2_b32 v3, v18, v19 offset0:0 offset1:4
    v_smfmac_f32_16x16x64_bf16 v[28:31], v[36:39], a[176:183], v1
    ds_read_b128 v[36:39], v0 offset:3072
    v_smfmac_f32_16x16x64_bf16 v[24:27], v[32:35], a[152:159], v1
    v_smfmac_f32_16x16x64_bf16 v[28:31], v[32:35], a[160:167], v1
    ds_read_b128 v[32:35], v0 offset:4096
    s_waitcnt lgkmcnt(2)
    s_barrier
    ds_read_b128 v[56:59], v6 offset:10240
    ds_read_b128 v[60:63], v6 offset:10752
    ds_read_b128 v[20:23], v6 offset:12288
    ds_read_b128 v[64:67], v6 offset:11264
    ds_read_b128 v[68:71], v6 offset:11776
    s_waitcnt lgkmcnt(6)
    v_smfmac_f32_16x16x64_bf16 v[24:27], v[36:39], a[24:31], v1
    v_smfmac_f32_16x16x64_bf16 v[28:31], v[36:39], a[32:39], v1
    ds_read_b128 v[36:39], v0 offset:2048
    s_waitcnt lgkmcnt(6)
    v_smfmac_f32_16x16x64_bf16 v[24:27], v[32:35], a[40:47], v1
    v_smfmac_f32_16x16x64_bf16 v[28:31], v[32:35], a[48:55], v1
    ds_read_b128 v[32:35], v0 offset:5120
    s_waitcnt lgkmcnt(6)
    v_mfma_f32_16x16x32_bf16 v[12:15], v[40:43], v[56:59], 0
    ds_read_b128 v[40:43], v6 offset:12800
    v_mfma_f32_16x16x32_bf16 v[16:19], v[44:47], v[56:59], 0
    ds_read_b128 v[44:47], v0 offset:18432
    s_waitcnt lgkmcnt(7)
    v_mfma_f32_16x16x32_bf16 v[12:15], v[72:75], v[60:63], v[12:15]
    ds_read_b128 v[72:75], v0 offset:22528
    v_mfma_f32_16x16x32_bf16 v[16:19], v[76:79], v[60:63], v[16:19]
    ds_read_b128 v[76:79], v6 offset:13312
    s_waitcnt lgkmcnt(8)
    v_mfma_f32_16x16x32_bf16 v[8:11], v[20:23], v[56:59], 0
    ds_read_b128 v[20:23], v6 offset:13824
    s_waitcnt lgkmcnt(4)
    v_mfma_f32_16x16x32_bf16 v[8:11], v[40:43], v[60:63], v[8:11]
    ds_read_b128 v[40:43], v0 offset:19456
    s_waitcnt lgkmcnt(4)
    v_mfma_f32_16x16x32_bf16 v[12:15], v[44:47], v[64:67], v[12:15]
    ds_read_b128 v[44:47], v0 offset:23552
    s_waitcnt lgkmcnt(4)
    v_mfma_f32_16x16x32_bf16 v[16:19], v[72:75], v[64:67], v[16:19]
    s_waitcnt lgkmcnt(3)
    v_mfma_f32_16x16x32_bf16 v[8:11], v[76:79], v[64:67], v[8:11]
    s_waitcnt lgkmcnt(2)
    v_mfma_f32_16x16x32_bf16 v[8:11], v[20:23], v[68:71], v[8:11]
    s_waitcnt lgkmcnt(1)
    v_mfma_f32_16x16x32_bf16 v[12:15], v[40:43], v[68:71], v[12:15]
    s_waitcnt lgkmcnt(0)
    v_mfma_f32_16x16x32_bf16 v[16:19], v[44:47], v[68:71], v[16:19]
    v_smfmac_f32_16x16x64_bf16 v[24:27], v[36:39], a[56:63], v1
    buffer_load_dwordx4 v[72:75], v0, s[8:11], s5 offen offset:2048
    v_smfmac_f32_16x16x64_bf16 v[28:31], v[36:39], a[64:71], v1
    ds_read_b128 v[36:39], v0 offset:0
    buffer_load_dwordx4 v[76:79], v0, s[8:11], s5 offen offset:3072
    s_nop 0
    v_max3_f32 v10, v8, v9, v12
    v_max3_f32 v11, v13, v14, v15
    v_max3_f32 v10, v10, v16, v17
    v_max3_f32 v11, v11, v18, v19
    v_max_f32 v10, v10, v11
    v_max_f32 v11, v10, v11
    v_smfmac_f32_16x16x64_bf16 v[24:27], v[32:35], a[72:79], v1
    buffer_load_dwordx4 v[40:43], v0, s[8:11], s6 offen offset:0
    v_permlane32_swap_b32 v11, v10
    v_max_f32 v10, v10, v11
    v_max_f32 v11, v10, v11
    v_smfmac_f32_16x16x64_bf16 v[28:31], v[32:35], a[80:87], v1
    ds_read_b128 v[32:35], v0 offset:1024
    v_permlane16_swap_b32 v11, v10
    v_max_f32 v10, v10, v11
    v_sub_f32 v12, v12, v10
    s_waitcnt lgkmcnt(1)
    v_smfmac_f32_16x16x64_bf16 v[24:27], v[36:39], a[88:95], v1
    v_sub_f32 v13, v13, v10
    v_exp_f32 v12, v12
    v_smfmac_f32_16x16x64_bf16 v[28:31], v[36:39], a[96:103], v1
    ds_read_b128 v[36:39], v0 offset:6144
    buffer_load_dwordx4 v[44:47], v0, s[8:11], s6 offen offset:1024
    v_sub_f32 v14, v14, v10
    v_exp_f32 v13, v13
    s_waitcnt lgkmcnt(1)
    v_smfmac_f32_16x16x64_bf16 v[24:27], v[32:35], a[104:111], v1
    v_sub_f32 v15, v15, v10
    v_exp_f32 v14, v14
    v_smfmac_f32_16x16x64_bf16 v[28:31], v[32:35], a[112:119], v1
    ds_read_b128 v[32:35], v0 offset:7168
    v_cvt_pk_bf16_f32 v20, v12, v13
    v_sub_f32 v16, v16, v10
    v_exp_f32 v15, v15
    s_waitcnt lgkmcnt(1)
    v_smfmac_f32_16x16x64_bf16 v[24:27], v[36:39], a[120:127], v1
    buffer_load_dwordx4 v[56:59], v0, s[8:11], s6 offen offset:2048
    v_sub_f32 v17, v17, v10
    v_exp_f32 v16, v16
    v_smfmac_f32_16x16x64_bf16 v[28:31], v[36:39], a[128:135], v1
    v_cvt_pk_bf16_f32 v21, v14, v15
    v_sub_f32 v18, v18, v10
    v_exp_f32 v17, v17
    s_waitcnt lgkmcnt(0)
    v_smfmac_f32_16x16x64_bf16 v[24:27], v[32:35], a[136:143], v1
    v_mov_b64 v[12:13], s[40:41]
    v_mov_b64 v[14:15], s[40:41]
    v_sub_f32 v19, v19, v10
    v_exp_f32 v18, v18
    v_smfmac_f32_16x16x64_bf16 v[28:31], v[32:35], a[144:151], v1
    buffer_load_dwordx4 v[60:63], v0, s[8:11], s6 offen offset:3072
    v_cvt_pk_bf16_f32 v22, v16, v17
    v_sub_f32 v8, v8, v10
    v_exp_f32 v19, v19
    v_sub_f32 v9, v9, v10
    v_exp_f32 v8, v8
    v_cvt_pk_bf16_f32 v23, v18, v19
    v_exp_f32 v9, v9
    v_mov_b32 v11, 0
    v_cvt_pk_bf16_f32 v10, v8, v9
    s_waitcnt vmcnt(7)
    v_mfma_f32_16x16x32_bf16 v[16:19], v[12:15], v[20:23], 0
    v_add_f32 v24, v24, v26
    v_add_f32 v25, v25, v27
    v_mfma_f32_16x16x32_bf16 v[32:35], v[48:51], v[20:23], 0
    v_add_f32 v28, v28, v30
    v_add_f32 v29, v29, v31
    v_mfma_f32_16x16x32_bf16 v[36:39], v[52:55], v[20:23], 0
    v_cvt_pk_bf16_f32 v26, v24, v25
    v_cvt_pk_bf16_f32 v27, v28, v29
    v_mfma_f32_16x16x16_bf16 v[16:19], v[12:13], v[10:11], v[16:19]
    v_cvt_pk_bf16_f32 v28, v28, v29
    v_mov_b32 v29, 0
    v_mfma_f32_16x16x16_bf16 v[32:35], v[26:27], v[10:11], v[32:35]
    buffer_load_dwordx4 v[64:67], v0, s[8:11], s7 offen offset:0
    buffer_load_dwordx4 v[68:71], v0, s[8:11], s7 offen offset:1024
    v_mfma_f32_16x16x16_bf16 v[36:39], v[28:29], v[10:11], v[36:39]
    buffer_load_dwordx4 v[48:51], v0, s[8:11], s7 offen offset:2048
    v_lshrrev_b32 v30, 1, v0
    ds_write_b64 v30, v[26:27] offset:14848
    v_rcp_f32 v8, v16
    v_mov_b64 v[12:13], 0
    v_mov_b64 v[14:15], 0
    v_mul_f32 v32, v32, v8
    v_mul_f32 v33, v33, v8
    v_cvt_pk_bf16_f32 v16, v32, v33
    v_mul_f32 v34, v34, v8
    v_mul_f32 v35, v35, v8
    v_cvt_pk_bf16_f32 v17, v34, v35
    v_mul_f32 v36, v36, v8
    v_mul_f32 v37, v37, v8
    v_cvt_pk_bf16_f32 v18, v36, v37
    v_mul_f32 v38, v38, v8
    v_mul_f32 v39, v39, v8
    v_cvt_pk_bf16_f32 v19, v38, v39
    ds_write_b128 v6, v[16:19] offset:16896
    buffer_load_dwordx4 v[52:55], v0, s[8:11], s7 offen offset:3072
    v_mov_b64 v[8:9], 0
    v_mov_b64 v[10:11], 0
    v_mov_b64 v[20:21], 0
    v_mov_b64 v[22:23], 0
    v_mov_b64 v[24:25], 0
    v_mov_b64 v[28:29], 0
    s_waitcnt lgkmcnt(0)
    s_barrier
    ds_read_b128 v[32:35], v0 offset:16384
    ds_read_b128 v[36:39], v0 offset:17408
    s_cmp_eq_u32 s55, 63
    s_cbranch_scc1 CHF1_last
    v_mov_b64 v[16:17], 0
    v_mov_b64 v[18:19], 0
    v_mov_b64 v[26:27], 0
    v_mov_b64 v[30:31], 0
    s_waitcnt lgkmcnt(1)
    v_smfmac_f32_16x16x64_bf16 v[8:11], v[32:35], a[184:191], v1
    v_smfmac_f32_16x16x64_bf16 v[12:15], v[32:35], a[192:199], v1
    s_waitcnt vmcnt(6) lgkmcnt(0)
    v_smfmac_f32_16x16x64_bf16 v[8:11], v[36:39], v[72:79], v1
    buffer_load_dwordx4 v[72:75], v0, s[8:11], s61 offen offset:0
    v_smfmac_f32_16x16x64_bf16 v[12:15], v[36:39], v[40:47], v1
    s_waitcnt vmcnt(3)
    v_smfmac_f32_16x16x64_bf16 v[16:19], v[32:35], v[56:63], v1
    ds_read_b128 v[56:59], v7 offset:20480
    ds_read_b128 v[60:63], v7 offset:21504
    buffer_load_dwordx4 v[76:79], v0, s[8:11], s61 offen offset:1024
    v_smfmac_f32_16x16x64_bf16 v[20:23], v[32:35], v[64:71], v1
    ds_read_b128 v[64:67], v7 offset:22528
    ds_read_b128 v[68:71], v7 offset:23552
    buffer_load_dwordx4 v[40:43], v0, s[8:11], s61 offen offset:2048
    v_add_f32 v8, v8, v10
    v_add_f32 v9, v9, v11
    v_cvt_pk_bf16_f32 v8, v8, v9
    v_smfmac_f32_16x16x64_bf16 v[16:19], v[36:39], a[200:207], v1
    v_and_or_b32 v8, v8, -2, s65
    v_add_f32 v12, v12, v14
    v_add_f32 v13, v13, v15
    v_smfmac_f32_16x16x64_bf16 v[20:23], v[36:39], a[208:215], v1
    buffer_load_dwordx4 v[44:47], v0, s[8:11], s61 offen offset:3072
    v_cvt_pk_bf16_f32 v9, v12, v13
    buffer_store_dwordx2 v[8:9], v4, s[8:11], s58 offen
    v_mov_b64 v[12:13], 0
    s_waitcnt vmcnt(5)
    v_smfmac_f32_16x16x64_bf16 v[24:27], v[32:35], a[216:223], v1
    v_mov_b64 v[14:15], 0
    v_mov_b64 v[10:11], 0
    v_mov_b64 v[8:9], 0
    v_smfmac_f32_16x16x64_bf16 v[28:31], v[32:35], v[48:55], v1
    buffer_load_dwordx4 v[48:51], v0, s[8:11], s3 offen offset:0
    v_add_f32 v16, v16, v18
    v_add_f32 v17, v17, v19
    v_cvt_pk_bf16_f32 v16, v16, v17
    s_waitcnt lgkmcnt(0)
    v_smfmac_f32_16x16x64_bf16 v[24:27], v[36:39], v[56:63], v1
    ds_read_b128 v[56:59], v7 offset:24576
    ds_read_b128 v[60:63], v7 offset:25600
    v_and_or_b32 v16, v16, -2, s65
    v_add_f32 v20, v20, v22
    v_add_f32 v21, v21, v23
    v_smfmac_f32_16x16x64_bf16 v[28:31], v[36:39], v[64:71], v1
    ds_read_b128 v[64:67], v7 offset:26624
    ds_read_b128 v[68:71], v7 offset:27648
    buffer_load_dwordx4 v[52:55], v0, s[8:11], s3 offen offset:1024
    v_cvt_pk_bf16_f32 v17, v20, v21
    buffer_store_dwordx2 v[16:17], v4, s[8:11], s75 offen
    v_mov_b64 v[20:21], 0
    v_smfmac_f32_16x16x64_bf16 v[8:11], v[32:35], a[224:231], v1
    v_mov_b64 v[22:23], 0
    v_mov_b64 v[18:19], 0
    v_mov_b64 v[16:17], 0
    v_smfmac_f32_16x16x64_bf16 v[12:15], v[32:35], a[232:239], v1
    v_add_f32 v24, v24, v26
    v_add_f32 v25, v25, v27
    v_cvt_pk_bf16_f32 v24, v24, v25
    s_waitcnt lgkmcnt(0)
    v_smfmac_f32_16x16x64_bf16 v[8:11], v[36:39], v[56:63], v1
    ds_read_b128 v[56:59], v7 offset:28672
    ds_read_b128 v[60:63], v7 offset:29696
    v_and_or_b32 v24, v24, -2, s65
    v_add_f32 v28, v28, v30
    v_add_f32 v29, v29, v31
    v_smfmac_f32_16x16x64_bf16 v[12:15], v[36:39], v[64:71], v1
    ds_read_b128 v[64:67], v7 offset:30720
    ds_read_b128 v[68:71], v7 offset:31744
    v_cvt_pk_bf16_f32 v25, v28, v29
    buffer_store_dwordx2 v[24:25], v4, s[8:11], s76 offen
    v_smfmac_f32_16x16x64_bf16 v[16:19], v[32:35], a[240:247], v1
    v_smfmac_f32_16x16x64_bf16 v[20:23], v[32:35], a[248:255], v1
    v_add_f32 v8, v8, v10
    v_add_f32 v9, v9, v11
    v_cvt_pk_bf16_f32 v8, v8, v9
    s_waitcnt lgkmcnt(0)
    v_smfmac_f32_16x16x64_bf16 v[16:19], v[36:39], v[56:63], v1
    v_and_or_b32 v8, v8, -2, s65
    v_add_f32 v12, v12, v14
    v_add_f32 v13, v13, v15
    v_smfmac_f32_16x16x64_bf16 v[20:23], v[36:39], v[64:71], v1
    v_cvt_pk_bf16_f32 v9, v12, v13
    buffer_store_dwordx2 v[8:9], v4, s[8:11], s77 offen
    s_nop 1
    v_add_f32 v16, v16, v18
    v_add_f32 v17, v17, v19
    v_cvt_pk_bf16_f32 v16, v16, v17
    v_and_or_b32 v16, v16, -2, s65
    v_add_f32 v20, v20, v22
    v_add_f32 v21, v21, v23
    v_cvt_pk_bf16_f32 v17, v20, v21
    buffer_store_dwordx2 v[16:17], v4, s[8:11], s4 offen
    s_barrier
    s_mov_b32 s68, 0
    v_bfe_u32 v29, v0, 4, 1
    v_lshlrev_b32 v29, 4, v29
    v_mov_b32 v30, 0x3f80
    v_lshlrev_b32 v29, v29, v30
    v_bfe_u32 v30, v0, 5, 3
    v_cmp_eq_u32 vcc, 0, v30
    s_nop 1
    v_cndmask_b32 v32, 0, v29, vcc
    v_cmp_eq_u32 vcc, 1, v30
    s_nop 1
    v_cndmask_b32 v33, 0, v29, vcc
    v_cmp_eq_u32 vcc, 2, v30
    s_nop 1
    v_cndmask_b32 v34, 0, v29, vcc
    v_cmp_eq_u32 vcc, 3, v30
    s_nop 1
    v_cndmask_b32 v35, 0, v29, vcc
    buffer_load_dwordx4 v[8:11], v0, s[8:11], s59 offen offset:0 sc1
    buffer_load_dwordx4 v[12:15], v0, s[8:11], s59 offen offset:1024 sc1
    s_sleep 3
    buffer_load_dwordx4 v[16:19], v0, s[8:11], s59 offen offset:0 sc1
    buffer_load_dwordx4 v[20:23], v0, s[8:11], s59 offen offset:1024 sc1
CHF1_rloop:
    s_waitcnt vmcnt(2)
    v_mfma_f32_16x16x32_bf16 v[24:27], v[8:11], v[32:35], 0
    v_and_b32 v29, v8, v10
    v_or_b32 v30, v8, v10
    v_mfma_f32_16x16x32_bf16 v[24:27], v[12:15], v[32:35], v[24:27]
    v_bitop3_b32 v29, v29, v12, v14 bitop3:0x80
    v_or3_b32 v30, v30, v12, v14
    v_bitop3_b32 v29, v29, v30, s65 bitop3:0x4e
    v_and_b32 v29, 1, v29
    v_cmp_ne_u32 vcc, 0, v29
    s_nop 2
    v_permlane32_swap_b32 v24, v26
    v_permlane32_swap_b32 v25, v27
    v_add_f32 v24, v24, v26
    v_add_f32 v25, v25, v27
    s_cbranch_vccnz CHF1_rbad0
    s_nop 0
    v_permlane16_swap_b32 v24, v25
    v_add_f32 v24, v24, v25
    v_cvt_pk_bf16_f32 v24, v24, v24
    buffer_store_short v24, v2, s[8:11], s56 offen
    s_branch CHF1_rdone
CHF1_rbad0:
    buffer_load_dwordx4 v[8:11], v0, s[8:11], s59 offen offset:0 sc1
    buffer_load_dwordx4 v[12:15], v0, s[8:11], s59 offen offset:1024 sc1
    s_waitcnt vmcnt(2)
    v_mfma_f32_16x16x32_bf16 v[24:27], v[16:19], v[32:35], 0
    v_and_b32 v29, v16, v18
    v_or_b32 v30, v16, v18
    v_mfma_f32_16x16x32_bf16 v[24:27], v[20:23], v[32:35], v[24:27]
    v_bitop3_b32 v29, v29, v20, v22 bitop3:0x80
    v_or3_b32 v30, v30, v20, v22
    v_bitop3_b32 v29, v29, v30, s65 bitop3:0x4e
    v_and_b32 v29, 1, v29
    v_cmp_ne_u32 vcc, 0, v29
    s_nop 2
    v_permlane32_swap_b32 v24, v26
    v_permlane32_swap_b32 v25, v27
    v_add_f32 v24, v24, v26
    v_add_f32 v25, v25, v27
    s_cbranch_vccnz CHF1_rbad1
CHF1_rok:
    s_nop 0
    v_permlane16_swap_b32 v24, v25
    v_add_f32 v24, v24, v25
    v_cvt_pk_bf16_f32 v24, v24, v24
    buffer_store_short v24, v2, s[8:11], s56 offen
    s_branch CHF1_rdone
CHF1_rbad1:
    buffer_load_dwordx4 v[16:19], v0, s[8:11], s59 offen offset:0 sc1
    buffer_load_dwordx4 v[20:23], v0, s[8:11], s59 offen offset:1024 sc1
    s_cmp_lg_u32 s69, 0
    s_cbranch_scc1 CHF1_rok
    s_add_u32 s68, s68, 1
    s_cmp_lt_u32 s68, 65536
    s_cbranch_scc1 CHF1_rloop
    s_mov_b32 s69, 1
    s_branch CHF1_rok
CHF1_rdone:
    v_mov_b32 v25, 0xff81ff81
    buffer_store_short v25, v2, s[8:11], s57 offen
    s_mov_b32 m0, 18432
    s_nop 0
    buffer_load_dwordx4 v0, s[8:11], s63 offen offset:0 sc1 lds
    buffer_load_dwordx4 v0, s[8:11], s63 offen offset:1024 sc1 lds
    s_add_u32 s63, s63, 262144
    v_and_b32 v28, 512, v0
    v_mul_u32_u24 v28, 3, v28
    v_add_u32 v28, v28, v0
    ds_read_b128 v[24:27], v28 offset:12800
    s_add_u32 s72, s56, 3072
    s_xor_b32 s65, s65, 1
    s_add_u32 s64, s64, 131072
    s_xor_b32 s56, s56, s74
    s_xor_b32 s57, s57, s74
    s_add_u32 s62, s62, 262144
    s_add_u32 s55, s55, 1
    s_mov_b32 s68, 0
    s_mov_b32 m0, 3072
    s_sleep 3
    buffer_load_dwordx4 v0, s[8:11], s72 offen offset:0 sc1 lds
    buffer_load_dwordx4 v0, s[8:11], s72 offen offset:1024 sc1 lds
    buffer_load_dwordx4 v0, s[8:11], s72 offen offset:2048 sc1 lds
    s_waitcnt vmcnt(7)
    ds_read_b128 v[56:59], v7 offset:8192
    ds_read_b128 v[60:63], v7 offset:9216
    ds_read_b128 v[64:67], v7 offset:10240
    ds_read_b128 v[68:71], v7 offset:11264
    v_mov_b64 v[8:9], 0
    v_mov_b64 v[10:11], 0
    v_mov_b64 v[12:13], 0
    v_mov_b64 v[14:15], 0
    v_mov_b64 v[16:17], 0
    v_mov_b64 v[18:19], 0
    v_mov_b64 v[20:21], 0
    v_mov_b64 v[22:23], 0
    s_sleep 2
CHF1_gloop:
    buffer_load_dwordx4 v0, s[8:11], s72 offen offset:0 sc1 lds
    buffer_load_dwordx4 v0, s[8:11], s72 offen offset:1024 sc1 lds
    buffer_load_dwordx4 v0, s[8:11], s72 offen offset:2048 sc1 lds
    s_waitcnt vmcnt(3)
    ds_read_b128 v[32:35], v0 offset:3072
    ds_read_b128 v[36:39], v0 offset:4096
    ds_read_b128 v[28:31], v0 offset:5120
    s_waitcnt lgkmcnt(2)
    v_pk_max_u16 v23, v32, v33
    v_pk_max_u16 v23, v23, v34
    v_pk_max_u16 v23, v23, v35
    s_waitcnt lgkmcnt(1)
    v_pk_max_u16 v23, v23, v36
    v_pk_max_u16 v23, v23, v37
    v_pk_max_u16 v23, v23, v38
    v_pk_max_u16 v23, v23, v39
    s_waitcnt lgkmcnt(0)
    v_pk_max_u16 v23, v23, v28
    v_pk_max_u16 v23, v23, v29
    v_pk_max_u16 v23, v23, v30
    v_pk_max_u16 v23, v23, v31
    v_pk_max_u16 v23, v23, v23 op_sel:[0,1] op_sel_hi:[1,0]
    s_nop 0
    v_cmp_le_u32 vcc, 0xff810000, v23
    s_nop 0
    s_cbranch_vccz CHF1_loop
    s_add_u32 s68, s68, 1
    s_cmp_lt_u32 s68, 64
    s_cbranch_scc1 CHF1_gloop
    s_cmp_lg_u32 s69, 0
    s_cbranch_scc1 CHF1_loop
    v_mov_b32 v23, -1
    v_xor_b32 v22, 0xff81ff81, v32
    v_pk_min_u16 v23, v23, v22
    v_xor_b32 v22, 0xff81ff81, v33
    v_pk_min_u16 v23, v23, v22
    v_xor_b32 v22, 0xff81ff81, v34
    v_pk_min_u16 v23, v23, v22
    v_xor_b32 v22, 0xff81ff81, v35
    v_pk_min_u16 v23, v23, v22
    v_xor_b32 v22, 0xff81ff81, v36
    v_pk_min_u16 v23, v23, v22
    v_xor_b32 v22, 0xff81ff81, v37
    v_pk_min_u16 v23, v23, v22
    v_xor_b32 v22, 0xff81ff81, v38
    v_pk_min_u16 v23, v23, v22
    v_xor_b32 v22, 0xff81ff81, v39
    v_pk_min_u16 v23, v23, v22
    v_xor_b32 v22, 0xff81ff81, v28
    v_pk_min_u16 v23, v23, v22
    v_xor_b32 v22, 0xff81ff81, v29
    v_pk_min_u16 v23, v23, v22
    v_xor_b32 v22, 0xff81ff81, v30
    v_pk_min_u16 v23, v23, v22
    v_xor_b32 v22, 0xff81ff81, v31
    v_pk_min_u16 v23, v23, v22
    v_pk_min_u16 v23, v23, v23 op_sel:[0,1] op_sel_hi:[1,0]
    v_mov_b32 v22, 0
    v_cmp_eq_u32 vcc, 0, v23
    s_nop 0
    s_cbranch_vccz CHF1_loop
    s_sleep 1
    s_cmp_lt_u32 s68, 65536
    s_cbranch_scc1 CHF1_gloop
    s_mov_b32 s69, 1
    s_branch CHF1_loop
CHF1_last:
    v_and_b32 v28, 512, v0
    v_mul_u32_u24 v28, 3, v28
    v_add_u32 v28, v28, v0
    ds_read_b128 v[24:27], v28 offset:12800
    s_add_u32 s64, s64, 131072
    s_waitcnt lgkmcnt(0)
    buffer_store_dwordx4 v[24:27], v0, s[8:11], s64 offen sc1
    s_waitcnt vmcnt(0)
    s_barrier
    s_waitcnt vmcnt(0) lgkmcnt(0)
    s_endpgm
CHS1_start:
    s_barrier
    s_mov_b32 m0, 18432
    s_nop 0
    buffer_load_dwordx4 v0, s[8:11], s63 offen offset:0 sc1 lds
    buffer_load_dwordx4 v0, s[8:11], s63 offen offset:1024 sc1 lds
    s_add_u32 s63, s63, 262144
    s_waitcnt vmcnt(0) lgkmcnt(0)
CHS1_loop:
    s_barrier
    ds_read_b128 v[28:31], v0 offset:2048
    v_mov_b32 v23, 0
    v_smfmac_f32_16x16x64_bf16 v[8:11], v[32:35], v[40:47], v1
    buffer_load_dwordx4 v[40:43], v0, s[8:11], s3 offen offset:2048
    v_smfmac_f32_16x16x64_bf16 v[12:15], v[32:35], v[72:79], v1
    buffer_load_dwordx4 v[44:47], v0, s[8:11], s3 offen offset:3072
    v_smfmac_f32_16x16x64_bf16 v[16:19], v[32:35], v[56:63], v1
    buffer_load_dwordx4 v[72:75], v0, s[8:11], s5 offen offset:0
    v_smfmac_f32_16x16x64_bf16 v[20:23], v[32:35], v[64:71], v1
    ds_read_b128 v[32:35], v0 offset:5120
    buffer_load_dwordx4 v[76:79], v0, s[8:11], s5 offen offset:1024
    v_smfmac_f32_16x16x64_bf16 v[8:11], v[36:39], v[48:55], v1
    ds_read_b128 v[56:59], v7 offset:4096
    v_smfmac_f32_16x16x64_bf16 v[12:15], v[36:39], v[80:87], v1
    ds_read_b128 v[60:63], v7 offset:5120
    ds_read_b128 v[64:67], v7 offset:6144
    v_smfmac_f32_16x16x64_bf16 v[16:19], v[36:39], v[88:95], v1
    ds_read_b128 v[68:71], v7 offset:7168
    buffer_load_dwordx4 v[48:51], v0, s[8:11], s62 offen offset:0 sc1
    v_smfmac_f32_16x16x64_bf16 v[20:23], v[36:39], v[96:103], v1
    ds_read_b128 v[36:39], v0 offset:0
    s_waitcnt lgkmcnt(6)
    v_smfmac_f32_16x16x64_bf16 v[8:11], v[28:31], v[104:111], v1
    buffer_load_dwordx4 v[52:55], v0, s[8:11], s62 offen offset:1024 sc1
    v_smfmac_f32_16x16x64_bf16 v[12:15], v[28:31], v[112:119], v1
    buffer_store_dwordx4 v[24:27], v0, s[8:11], s64 offen sc1
    s_waitcnt lgkmcnt(1)
    v_smfmac_f32_16x16x64_bf16 v[16:19], v[28:31], v[56:63], v1
    ds_read_b128 v[24:27], v0 offset:1024
    ds_read_b128 v[56:59], v7 offset:0
    v_smfmac_f32_16x16x64_bf16 v[20:23], v[28:31], v[64:71], v1
    ds_read_b128 v[28:31], v0 offset:6144
    ds_read_b128 v[60:63], v7 offset:1024
    v_smfmac_f32_16x16x64_bf16 v[8:11], v[32:35], v[120:127], v1
    ds_read_b128 v[64:67], v7 offset:2048
    v_smfmac_f32_16x16x64_bf16 v[12:15], v[32:35], v[128:135], v1
    ds_read_b128 v[68:71], v7 offset:3072
    v_smfmac_f32_16x16x64_bf16 v[16:19], v[32:35], v[136:143], v1
    v_smfmac_f32_16x16x64_bf16 v[20:23], v[32:35], v[144:151], v1
    ds_read_b128 v[32:35], v0 offset:8192
    s_waitcnt lgkmcnt(7)
    v_smfmac_f32_16x16x64_bf16 v[8:11], v[36:39], v[152:159], v1
    v_smfmac_f32_16x16x64_bf16 v[12:15], v[36:39], v[160:167], v1
    s_waitcnt lgkmcnt(1)
    v_smfmac_f32_16x16x64_bf16 v[16:19], v[36:39], v[56:63], v1
    ds_read_b128 v[56:59], v7 offset:12288
    v_smfmac_f32_16x16x64_bf16 v[20:23], v[36:39], v[64:71], v1
    ds_read_b128 v[36:39], v0 offset:9216
    ds_read_b128 v[60:63], v7 offset:13312
    v_smfmac_f32_16x16x64_bf16 v[8:11], v[24:27], v[168:175], v1
    ds_read_b128 v[64:67], v7 offset:14336
    v_smfmac_f32_16x16x64_bf16 v[12:15], v[24:27], v[176:183], v1
    ds_read_b128 v[68:71], v7 offset:15360
    v_smfmac_f32_16x16x64_bf16 v[16:19], v[24:27], v[184:191], v1
    v_smfmac_f32_16x16x64_bf16 v[20:23], v[24:27], v[192:199], v1
    ds_read_b128 v[24:27], v0 offset:7168
    s_waitcnt vmcnt(5)
    v_smfmac_f32_16x16x64_bf16 v[8:11], v[28:31], v[40:47], v1
    v_smfmac_f32_16x16x64_bf16 v[12:15], v[28:31], v[200:207], v1
    s_waitcnt lgkmcnt(1)
    v_smfmac_f32_16x16x64_bf16 v[16:19], v[28:31], v[56:63], v1
    ds_read_b128 v[56:59], v7 offset:16384
    v_smfmac_f32_16x16x64_bf16 v[20:23], v[28:31], v[64:71], v1
    ds_read_b128 v[60:63], v7 offset:17408
    s_waitcnt lgkmcnt(2)
    s_waitcnt vmcnt(3)
    v_smfmac_f32_16x16x64_bf16 v[8:11], v[24:27], v[72:79], v1
    ds_read_b128 v[64:67], v7 offset:18432
    v_mov_b64 v[28:29], 0
    v_smfmac_f32_16x16x64_bf16 v[12:15], v[24:27], v[208:215], v1
    ds_read_b128 v[68:71], v7 offset:19456
    v_mov_b64 v[30:31], 0
    v_smfmac_f32_16x16x64_bf16 v[16:19], v[24:27], v[216:223], v1
    ds_read_b128 v[40:43], v0 offset:16384
    v_smfmac_f32_16x16x64_bf16 v[20:23], v[24:27], v[224:231], v1
    ds_read_b128 v[44:47], v0 offset:20480
    v_smfmac_f32_16x16x64_bf16 v[8:11], v[32:35], v[232:239], v1
    v_mov_b64 v[24:25], 0
    v_smfmac_f32_16x16x64_bf16 v[12:15], v[32:35], v[240:247], v1
    v_mov_b64 v[26:27], 0
    s_waitcnt lgkmcnt(2)
    v_smfmac_f32_16x16x64_bf16 v[16:19], v[32:35], v[56:63], v1
    v_smfmac_f32_16x16x64_bf16 v[20:23], v[32:35], v[64:71], v1
    v_smfmac_f32_16x16x64_bf16 v[8:11], v[36:39], v[248:255], v1
    ds_read_b128 v[72:75], v0 offset:17408
    v_smfmac_f32_16x16x64_bf16 v[12:15], v[36:39], a[0:7], v1
    ds_read_b128 v[76:79], v0 offset:21504
    v_smfmac_f32_16x16x64_bf16 v[16:19], v[36:39], a[8:15], v1
    v_smfmac_f32_16x16x64_bf16 v[20:23], v[36:39], a[16:23], v1
    v_smfmac_f32_16x16x64_bf16 v[24:27], v[36:39], a[168:175], v1
    s_nop 1
    v_add_f32 v8, v8, v10
    v_add_f32 v9, v9, v11
    v_add_f32 v12, v12, v14
    v_add_f32 v13, v13, v15
    v_mul_f32 v8, s79, v8
    v_mul_f32 v12, s79, v12
    v_mul_f32 v9, s79, v9
    v_mul_f32 v13, s79, v13
    v_cvt_pk_bf16_f32 v10, v8, v12
    v_cvt_pk_bf16_f32 v11, v9, v13
    ds_write2_b32 v5, v10, v11 offset0:0 offset1:4
    v_add_f32 v16, v16, v18
    v_add_f32 v17, v17, v19
    v_add_f32 v20, v20, v22
    v_add_f32 v21, v21, v23
    v_cvt_pk_bf16_f32 v18, v16, v20
    v_cvt_pk_bf16_f32 v19, v17, v21
    ds_write2_b32 v3, v18, v19 offset0:0 offset1:4
    v_smfmac_f32_16x16x64_bf16 v[28:31], v[36:39], a[176:183], v1
    ds_read_b128 v[36:39], v0 offset:3072
    v_smfmac_f32_16x16x64_bf16 v[24:27], v[32:35], a[152:159], v1
    v_smfmac_f32_16x16x64_bf16 v[28:31], v[32:35], a[160:167], v1
    ds_read_b128 v[32:35], v0 offset:4096
    s_waitcnt lgkmcnt(2)
    s_barrier
    ds_read_b128 v[56:59], v6 offset:10240
    ds_read_b128 v[60:63], v6 offset:10752
    ds_read_b128 v[20:23], v6 offset:12288
    ds_read_b128 v[64:67], v6 offset:11264
    ds_read_b128 v[68:71], v6 offset:11776
    s_waitcnt lgkmcnt(6)
    v_smfmac_f32_16x16x64_bf16 v[24:27], v[36:39], a[24:31], v1
    v_smfmac_f32_16x16x64_bf16 v[28:31], v[36:39], a[32:39], v1
    ds_read_b128 v[36:39], v0 offset:2048
    s_waitcnt lgkmcnt(6)
    v_smfmac_f32_16x16x64_bf16 v[24:27], v[32:35], a[40:47], v1
    v_smfmac_f32_16x16x64_bf16 v[28:31], v[32:35], a[48:55], v1
    ds_read_b128 v[32:35], v0 offset:5120
    s_waitcnt lgkmcnt(6)
    v_mfma_f32_16x16x32_bf16 v[12:15], v[40:43], v[56:59], 0
    ds_read_b128 v[40:43], v6 offset:12800
    v_mfma_f32_16x16x32_bf16 v[16:19], v[44:47], v[56:59], 0
    ds_read_b128 v[44:47], v0 offset:18432
    s_waitcnt lgkmcnt(7)
    v_mfma_f32_16x16x32_bf16 v[12:15], v[72:75], v[60:63], v[12:15]
    ds_read_b128 v[72:75], v0 offset:22528
    v_mfma_f32_16x16x32_bf16 v[16:19], v[76:79], v[60:63], v[16:19]
    ds_read_b128 v[76:79], v6 offset:13312
    s_waitcnt lgkmcnt(8)
    v_mfma_f32_16x16x32_bf16 v[8:11], v[20:23], v[56:59], 0
    ds_read_b128 v[20:23], v6 offset:13824
    s_waitcnt lgkmcnt(4)
    v_mfma_f32_16x16x32_bf16 v[8:11], v[40:43], v[60:63], v[8:11]
    ds_read_b128 v[40:43], v0 offset:19456
    s_waitcnt lgkmcnt(4)
    v_mfma_f32_16x16x32_bf16 v[12:15], v[44:47], v[64:67], v[12:15]
    ds_read_b128 v[44:47], v0 offset:23552
    s_waitcnt lgkmcnt(4)
    v_mfma_f32_16x16x32_bf16 v[16:19], v[72:75], v[64:67], v[16:19]
    s_waitcnt lgkmcnt(3)
    v_mfma_f32_16x16x32_bf16 v[8:11], v[76:79], v[64:67], v[8:11]
    s_waitcnt lgkmcnt(2)
    v_mfma_f32_16x16x32_bf16 v[8:11], v[20:23], v[68:71], v[8:11]
    s_waitcnt lgkmcnt(1)
    v_mfma_f32_16x16x32_bf16 v[12:15], v[40:43], v[68:71], v[12:15]
    s_waitcnt lgkmcnt(0)
    v_mfma_f32_16x16x32_bf16 v[16:19], v[44:47], v[68:71], v[16:19]
    v_smfmac_f32_16x16x64_bf16 v[24:27], v[36:39], a[56:63], v1
    buffer_load_dwordx4 v[72:75], v0, s[8:11], s5 offen offset:2048
    v_smfmac_f32_16x16x64_bf16 v[28:31], v[36:39], a[64:71], v1
    ds_read_b128 v[36:39], v0 offset:0
    buffer_load_dwordx4 v[76:79], v0, s[8:11], s5 offen offset:3072
    s_nop 0
    v_max3_f32 v10, v8, v9, v12
    v_max3_f32 v11, v13, v14, v15
    v_max3_f32 v10, v10, v16, v17
    v_max3_f32 v11, v11, v18, v19
    v_max_f32 v10, v10, v11
    v_max_f32 v11, v10, v11
    v_smfmac_f32_16x16x64_bf16 v[24:27], v[32:35], a[72:79], v1
    buffer_load_dwordx4 v[40:43], v0, s[8:11], s6 offen offset:0
    v_permlane32_swap_b32 v11, v10
    v_max_f32 v10, v10, v11
    v_max_f32 v11, v10, v11
    v_smfmac_f32_16x16x64_bf16 v[28:31], v[32:35], a[80:87], v1
    ds_read_b128 v[32:35], v0 offset:1024
    v_permlane16_swap_b32 v11, v10
    v_max_f32 v10, v10, v11
    v_sub_f32 v12, v12, v10
    s_waitcnt lgkmcnt(1)
    v_smfmac_f32_16x16x64_bf16 v[24:27], v[36:39], a[88:95], v1
    v_sub_f32 v13, v13, v10
    v_exp_f32 v12, v12
    v_smfmac_f32_16x16x64_bf16 v[28:31], v[36:39], a[96:103], v1
    ds_read_b128 v[36:39], v0 offset:6144
    buffer_load_dwordx4 v[44:47], v0, s[8:11], s6 offen offset:1024
    v_sub_f32 v14, v14, v10
    v_exp_f32 v13, v13
    s_waitcnt lgkmcnt(1)
    v_smfmac_f32_16x16x64_bf16 v[24:27], v[32:35], a[104:111], v1
    v_sub_f32 v15, v15, v10
    v_exp_f32 v14, v14
    v_smfmac_f32_16x16x64_bf16 v[28:31], v[32:35], a[112:119], v1
    ds_read_b128 v[32:35], v0 offset:7168
    v_cvt_pk_bf16_f32 v20, v12, v13
    v_sub_f32 v16, v16, v10
    v_exp_f32 v15, v15
    s_waitcnt lgkmcnt(1)
    v_smfmac_f32_16x16x64_bf16 v[24:27], v[36:39], a[120:127], v1
    buffer_load_dwordx4 v[56:59], v0, s[8:11], s6 offen offset:2048
    v_sub_f32 v17, v17, v10
    v_exp_f32 v16, v16
    v_smfmac_f32_16x16x64_bf16 v[28:31], v[36:39], a[128:135], v1
    v_cvt_pk_bf16_f32 v21, v14, v15
    v_sub_f32 v18, v18, v10
    v_exp_f32 v17, v17
    s_waitcnt lgkmcnt(0)
    v_smfmac_f32_16x16x64_bf16 v[24:27], v[32:35], a[136:143], v1
    v_mov_b64 v[12:13], s[40:41]
    v_mov_b64 v[14:15], s[40:41]
    v_sub_f32 v19, v19, v10
    v_exp_f32 v18, v18
    v_smfmac_f32_16x16x64_bf16 v[28:31], v[32:35], a[144:151], v1
    buffer_load_dwordx4 v[60:63], v0, s[8:11], s6 offen offset:3072
    v_cvt_pk_bf16_f32 v22, v16, v17
    v_sub_f32 v8, v8, v10
    v_exp_f32 v19, v19
    v_sub_f32 v9, v9, v10
    v_exp_f32 v8, v8
    v_cvt_pk_bf16_f32 v23, v18, v19
    v_exp_f32 v9, v9
    v_mov_b32 v11, 0
    v_cvt_pk_bf16_f32 v10, v8, v9
    s_waitcnt vmcnt(7)
    v_mfma_f32_16x16x32_bf16 v[16:19], v[12:15], v[20:23], 0
    v_add_f32 v24, v24, v26
    v_add_f32 v25, v25, v27
    v_mfma_f32_16x16x32_bf16 v[32:35], v[48:51], v[20:23], 0
    v_add_f32 v28, v28, v30
    v_add_f32 v29, v29, v31
    v_mfma_f32_16x16x32_bf16 v[36:39], v[52:55], v[20:23], 0
    v_cvt_pk_bf16_f32 v26, v24, v25
    v_cvt_pk_bf16_f32 v27, v28, v29
    v_mfma_f32_16x16x16_bf16 v[16:19], v[12:13], v[10:11], v[16:19]
    v_cvt_pk_bf16_f32 v28, v28, v29
    v_mov_b32 v29, 0
    v_mfma_f32_16x16x16_bf16 v[32:35], v[26:27], v[10:11], v[32:35]
    buffer_load_dwordx4 v[64:67], v0, s[8:11], s7 offen offset:0
    buffer_load_dwordx4 v[68:71], v0, s[8:11], s7 offen offset:1024
    v_mfma_f32_16x16x16_bf16 v[36:39], v[28:29], v[10:11], v[36:39]
    buffer_load_dwordx4 v[48:51], v0, s[8:11], s7 offen offset:2048
    v_lshrrev_b32 v30, 1, v0
    ds_write_b64 v30, v[26:27] offset:14848
    v_rcp_f32 v8, v16
    v_mov_b64 v[12:13], 0
    v_mov_b64 v[14:15], 0
    v_mul_f32 v32, v32, v8
    v_mul_f32 v33, v33, v8
    v_cvt_pk_bf16_f32 v16, v32, v33
    v_mul_f32 v34, v34, v8
    v_mul_f32 v35, v35, v8
    v_cvt_pk_bf16_f32 v17, v34, v35
    v_mul_f32 v36, v36, v8
    v_mul_f32 v37, v37, v8
    v_cvt_pk_bf16_f32 v18, v36, v37
    v_mul_f32 v38, v38, v8
    v_mul_f32 v39, v39, v8
    v_cvt_pk_bf16_f32 v19, v38, v39
    ds_write_b128 v6, v[16:19] offset:16896
    buffer_load_dwordx4 v[52:55], v0, s[8:11], s7 offen offset:3072
    v_mov_b64 v[8:9], 0
    v_mov_b64 v[10:11], 0
    v_mov_b64 v[20:21], 0
    v_mov_b64 v[22:23], 0
    v_mov_b64 v[24:25], 0
    v_mov_b64 v[28:29], 0
    s_waitcnt lgkmcnt(0)
    s_barrier
    ds_read_b128 v[32:35], v0 offset:16384
    ds_read_b128 v[36:39], v0 offset:17408
    s_cmp_eq_u32 s55, 63
    s_cbranch_scc1 CHS1_last
    v_mov_b64 v[16:17], 0
    v_mov_b64 v[18:19], 0
    v_mov_b64 v[26:27], 0
    v_mov_b64 v[30:31], 0
    s_waitcnt lgkmcnt(1)
    v_smfmac_f32_16x16x64_bf16 v[8:11], v[32:35], a[184:191], v1
    v_smfmac_f32_16x16x64_bf16 v[12:15], v[32:35], a[192:199], v1
    s_waitcnt vmcnt(6) lgkmcnt(0)
    v_smfmac_f32_16x16x64_bf16 v[8:11], v[36:39], v[72:79], v1
    buffer_load_dwordx4 v[72:75], v0, s[8:11], s61 offen offset:0
    v_smfmac_f32_16x16x64_bf16 v[12:15], v[36:39], v[40:47], v1
    s_waitcnt vmcnt(3)
    v_smfmac_f32_16x16x64_bf16 v[16:19], v[32:35], v[56:63], v1
    ds_read_b128 v[56:59], v7 offset:20480
    ds_read_b128 v[60:63], v7 offset:21504
    buffer_load_dwordx4 v[76:79], v0, s[8:11], s61 offen offset:1024
    v_smfmac_f32_16x16x64_bf16 v[20:23], v[32:35], v[64:71], v1
    ds_read_b128 v[64:67], v7 offset:22528
    ds_read_b128 v[68:71], v7 offset:23552
    buffer_load_dwordx4 v[40:43], v0, s[8:11], s61 offen offset:2048
    v_add_f32 v8, v8, v10
    v_add_f32 v9, v9, v11
    v_cvt_pk_bf16_f32 v8, v8, v9
    v_smfmac_f32_16x16x64_bf16 v[16:19], v[36:39], a[200:207], v1
    v_and_or_b32 v8, v8, -2, s65
    v_add_f32 v12, v12, v14
    v_add_f32 v13, v13, v15
    v_smfmac_f32_16x16x64_bf16 v[20:23], v[36:39], a[208:215], v1
    buffer_load_dwordx4 v[44:47], v0, s[8:11], s61 offen offset:3072
    v_cvt_pk_bf16_f32 v9, v12, v13
    buffer_store_dwordx2 v[8:9], v4, s[8:11], s58 offen sc1
    v_mov_b64 v[12:13], 0
    s_waitcnt vmcnt(5)
    v_smfmac_f32_16x16x64_bf16 v[24:27], v[32:35], a[216:223], v1
    v_mov_b64 v[14:15], 0
    v_mov_b64 v[10:11], 0
    v_mov_b64 v[8:9], 0
    v_smfmac_f32_16x16x64_bf16 v[28:31], v[32:35], v[48:55], v1
    buffer_load_dwordx4 v[48:51], v0, s[8:11], s3 offen offset:0
    v_add_f32 v16, v16, v18
    v_add_f32 v17, v17, v19
    v_cvt_pk_bf16_f32 v16, v16, v17
    s_waitcnt lgkmcnt(0)
    v_smfmac_f32_16x16x64_bf16 v[24:27], v[36:39], v[56:63], v1
    ds_read_b128 v[56:59], v7 offset:24576
    ds_read_b128 v[60:63], v7 offset:25600
    v_and_or_b32 v16, v16, -2, s65
    v_add_f32 v20, v20, v22
    v_add_f32 v21, v21, v23
    v_smfmac_f32_16x16x64_bf16 v[28:31], v[36:39], v[64:71], v1
    ds_read_b128 v[64:67], v7 offset:26624
    ds_read_b128 v[68:71], v7 offset:27648
    buffer_load_dwordx4 v[52:55], v0, s[8:11], s3 offen offset:1024
    v_cvt_pk_bf16_f32 v17, v20, v21
    buffer_store_dwordx2 v[16:17], v4, s[8:11], s75 offen sc1
    v_mov_b64 v[20:21], 0
    v_smfmac_f32_16x16x64_bf16 v[8:11], v[32:35], a[224:231], v1
    v_mov_b64 v[22:23], 0
    v_mov_b64 v[18:19], 0
    v_mov_b64 v[16:17], 0
    v_smfmac_f32_16x16x64_bf16 v[12:15], v[32:35], a[232:239], v1
    v_add_f32 v24, v24, v26
    v_add_f32 v25, v25, v27
    v_cvt_pk_bf16_f32 v24, v24, v25
    s_waitcnt lgkmcnt(0)
    v_smfmac_f32_16x16x64_bf16 v[8:11], v[36:39], v[56:63], v1
    ds_read_b128 v[56:59], v7 offset:28672
    ds_read_b128 v[60:63], v7 offset:29696
    v_and_or_b32 v24, v24, -2, s65
    v_add_f32 v28, v28, v30
    v_add_f32 v29, v29, v31
    v_smfmac_f32_16x16x64_bf16 v[12:15], v[36:39], v[64:71], v1
    ds_read_b128 v[64:67], v7 offset:30720
    ds_read_b128 v[68:71], v7 offset:31744
    v_cvt_pk_bf16_f32 v25, v28, v29
    buffer_store_dwordx2 v[24:25], v4, s[8:11], s76 offen sc1
    v_smfmac_f32_16x16x64_bf16 v[16:19], v[32:35], a[240:247], v1
    v_smfmac_f32_16x16x64_bf16 v[20:23], v[32:35], a[248:255], v1
    v_add_f32 v8, v8, v10
    v_add_f32 v9, v9, v11
    v_cvt_pk_bf16_f32 v8, v8, v9
    s_waitcnt lgkmcnt(0)
    v_smfmac_f32_16x16x64_bf16 v[16:19], v[36:39], v[56:63], v1
    v_and_or_b32 v8, v8, -2, s65
    v_add_f32 v12, v12, v14
    v_add_f32 v13, v13, v15
    v_smfmac_f32_16x16x64_bf16 v[20:23], v[36:39], v[64:71], v1
    v_cvt_pk_bf16_f32 v9, v12, v13
    buffer_store_dwordx2 v[8:9], v4, s[8:11], s77 offen sc1
    s_nop 1
    v_add_f32 v16, v16, v18
    v_add_f32 v17, v17, v19
    v_cvt_pk_bf16_f32 v16, v16, v17
    v_and_or_b32 v16, v16, -2, s65
    v_add_f32 v20, v20, v22
    v_add_f32 v21, v21, v23
    v_cvt_pk_bf16_f32 v17, v20, v21
    buffer_store_dwordx2 v[16:17], v4, s[8:11], s4 offen sc1
    s_barrier
    s_mov_b32 s68, 0
    v_bfe_u32 v29, v0, 4, 1
    v_lshlrev_b32 v29, 4, v29
    v_mov_b32 v30, 0x3f80
    v_lshlrev_b32 v29, v29, v30
    v_bfe_u32 v30, v0, 5, 3
    v_cmp_eq_u32 vcc, 0, v30
    s_nop 1
    v_cndmask_b32 v32, 0, v29, vcc
    v_cmp_eq_u32 vcc, 1, v30
    s_nop 1
    v_cndmask_b32 v33, 0, v29, vcc
    v_cmp_eq_u32 vcc, 2, v30
    s_nop 1
    v_cndmask_b32 v34, 0, v29, vcc
    v_cmp_eq_u32 vcc, 3, v30
    s_nop 1
    v_cndmask_b32 v35, 0, v29, vcc
    buffer_load_dwordx4 v[8:11], v0, s[8:11], s59 offen offset:0 sc1
    buffer_load_dwordx4 v[12:15], v0, s[8:11], s59 offen offset:1024 sc1
    s_sleep 3
    buffer_load_dwordx4 v[16:19], v0, s[8:11], s59 offen offset:0 sc1
    buffer_load_dwordx4 v[20:23], v0, s[8:11], s59 offen offset:1024 sc1
CHS1_rloop:
    s_waitcnt vmcnt(2)
    v_mfma_f32_16x16x32_bf16 v[24:27], v[8:11], v[32:35], 0
    v_and_b32 v29, v8, v10
    v_or_b32 v30, v8, v10
    v_mfma_f32_16x16x32_bf16 v[24:27], v[12:15], v[32:35], v[24:27]
    v_bitop3_b32 v29, v29, v12, v14 bitop3:0x80
    v_or3_b32 v30, v30, v12, v14
    v_bitop3_b32 v29, v29, v30, s65 bitop3:0x4e
    v_and_b32 v29, 1, v29
    v_cmp_ne_u32 vcc, 0, v29
    s_nop 2
    v_permlane32_swap_b32 v24, v26
    v_permlane32_swap_b32 v25, v27
    v_add_f32 v24, v24, v26
    v_add_f32 v25, v25, v27
    s_cbranch_vccnz CHS1_rbad0
    s_nop 0
    v_permlane16_swap_b32 v24, v25
    v_add_f32 v24, v24, v25
    v_cvt_pk_bf16_f32 v24, v24, v24
    buffer_store_short v24, v2, s[8:11], s56 offen sc1
    s_branch CHS1_rdone
CHS1_rbad0:
    buffer_load_dwordx4 v[8:11], v0, s[8:11], s59 offen offset:0 sc1
    buffer_load_dwordx4 v[12:15], v0, s[8:11], s59 offen offset:1024 sc1
    s_waitcnt vmcnt(2)
    v_mfma_f32_16x16x32_bf16 v[24:27], v[16:19], v[32:35], 0
    v_and_b32 v29, v16, v18
    v_or_b32 v30, v16, v18
    v_mfma_f32_16x16x32_bf16 v[24:27], v[20:23], v[32:35], v[24:27]
    v_bitop3_b32 v29, v29, v20, v22 bitop3:0x80
    v_or3_b32 v30, v30, v20, v22
    v_bitop3_b32 v29, v29, v30, s65 bitop3:0x4e
    v_and_b32 v29, 1, v29
    v_cmp_ne_u32 vcc, 0, v29
    s_nop 2
    v_permlane32_swap_b32 v24, v26
    v_permlane32_swap_b32 v25, v27
    v_add_f32 v24, v24, v26
    v_add_f32 v25, v25, v27
    s_cbranch_vccnz CHS1_rbad1
CHS1_rok:
    s_nop 0
    v_permlane16_swap_b32 v24, v25
    v_add_f32 v24, v24, v25
    v_cvt_pk_bf16_f32 v24, v24, v24
    buffer_store_short v24, v2, s[8:11], s56 offen sc1
    s_branch CHS1_rdone
CHS1_rbad1:
    buffer_load_dwordx4 v[16:19], v0, s[8:11], s59 offen offset:0 sc1
    buffer_load_dwordx4 v[20:23], v0, s[8:11], s59 offen offset:1024 sc1
    s_cmp_lg_u32 s69, 0
    s_cbranch_scc1 CHS1_rok
    s_add_u32 s68, s68, 1
    s_cmp_lt_u32 s68, 65536
    s_cbranch_scc1 CHS1_rloop
    s_mov_b32 s69, 1
    s_branch CHS1_rok
CHS1_rdone:
    v_mov_b32 v25, 0xff81ff81
    buffer_store_short v25, v2, s[8:11], s57 offen sc1
    s_mov_b32 m0, 18432
    s_nop 0
    buffer_load_dwordx4 v0, s[8:11], s63 offen offset:0 sc1 lds
    buffer_load_dwordx4 v0, s[8:11], s63 offen offset:1024 sc1 lds
    s_add_u32 s63, s63, 262144
    v_and_b32 v28, 512, v0
    v_mul_u32_u24 v28, 3, v28
    v_add_u32 v28, v28, v0
    ds_read_b128 v[24:27], v28 offset:12800
    s_add_u32 s72, s56, 3072
    s_xor_b32 s65, s65, 1
    s_add_u32 s64, s64, 131072
    s_xor_b32 s56, s56, s74
    s_xor_b32 s57, s57, s74
    s_add_u32 s62, s62, 262144
    s_add_u32 s55, s55, 1
    s_mov_b32 s68, 0
    s_mov_b32 m0, 3072
    s_sleep 3
    buffer_load_dwordx4 v0, s[8:11], s72 offen offset:0 sc1 lds
    buffer_load_dwordx4 v0, s[8:11], s72 offen offset:1024 sc1 lds
    buffer_load_dwordx4 v0, s[8:11], s72 offen offset:2048 sc1 lds
    s_waitcnt vmcnt(7)
    ds_read_b128 v[56:59], v7 offset:8192
    ds_read_b128 v[60:63], v7 offset:9216
    ds_read_b128 v[64:67], v7 offset:10240
    ds_read_b128 v[68:71], v7 offset:11264
    v_mov_b64 v[8:9], 0
    v_mov_b64 v[10:11], 0
    v_mov_b64 v[12:13], 0
    v_mov_b64 v[14:15], 0
    v_mov_b64 v[16:17], 0
    v_mov_b64 v[18:19], 0
    v_mov_b64 v[20:21], 0
    v_mov_b64 v[22:23], 0
    s_sleep 2
CHS1_gloop:
    buffer_load_dwordx4 v0, s[8:11], s72 offen offset:0 sc1 lds
    buffer_load_dwordx4 v0, s[8:11], s72 offen offset:1024 sc1 lds
    buffer_load_dwordx4 v0, s[8:11], s72 offen offset:2048 sc1 lds
    s_waitcnt vmcnt(3)
    ds_read_b128 v[32:35], v0 offset:3072
    ds_read_b128 v[36:39], v0 offset:4096
    ds_read_b128 v[28:31], v0 offset:5120
    s_waitcnt lgkmcnt(2)
    v_pk_max_u16 v23, v32, v33
    v_pk_max_u16 v23, v23, v34
    v_pk_max_u16 v23, v23, v35
    s_waitcnt lgkmcnt(1)
    v_pk_max_u16 v23, v23, v36
    v_pk_max_u16 v23, v23, v37
    v_pk_max_u16 v23, v23, v38
    v_pk_max_u16 v23, v23, v39
    s_waitcnt lgkmcnt(0)
    v_pk_max_u16 v23, v23, v28
    v_pk_max_u16 v23, v23, v29
    v_pk_max_u16 v23, v23, v30
    v_pk_max_u16 v23, v23, v31
    v_pk_max_u16 v23, v23, v23 op_sel:[0,1] op_sel_hi:[1,0]
    s_nop 0
    v_cmp_le_u32 vcc, 0xff810000, v23
    s_nop 0
    s_cbranch_vccz CHS1_loop
    s_add_u32 s68, s68, 1
    s_cmp_lt_u32 s68, 64
    s_cbranch_scc1 CHS1_gloop
    s_cmp_lg_u32 s69, 0
    s_cbranch_scc1 CHS1_loop
    v_mov_b32 v23, -1
    v_xor_b32 v22, 0xff81ff81, v32
    v_pk_min_u16 v23, v23, v22
    v_xor_b32 v22, 0xff81ff81, v33
    v_pk_min_u16 v23, v23, v22
    v_xor_b32 v22, 0xff81ff81, v34
    v_pk_min_u16 v23, v23, v22
    v_xor_b32 v22, 0xff81ff81, v35
    v_pk_min_u16 v23, v23, v22
    v_xor_b32 v22, 0xff81ff81, v36
    v_pk_min_u16 v23, v23, v22
    v_xor_b32 v22, 0xff81ff81, v37
    v_pk_min_u16 v23, v23, v22
    v_xor_b32 v22, 0xff81ff81, v38
    v_pk_min_u16 v23, v23, v22
    v_xor_b32 v22, 0xff81ff81, v39
    v_pk_min_u16 v23, v23, v22
    v_xor_b32 v22, 0xff81ff81, v28
    v_pk_min_u16 v23, v23, v22
    v_xor_b32 v22, 0xff81ff81, v29
    v_pk_min_u16 v23, v23, v22
    v_xor_b32 v22, 0xff81ff81, v30
    v_pk_min_u16 v23, v23, v22
    v_xor_b32 v22, 0xff81ff81, v31
    v_pk_min_u16 v23, v23, v22
    v_pk_min_u16 v23, v23, v23 op_sel:[0,1] op_sel_hi:[1,0]
    v_mov_b32 v22, 0
    v_cmp_eq_u32 vcc, 0, v23
    s_nop 0
    s_cbranch_vccz CHS1_loop
    s_sleep 1
    s_cmp_lt_u32 s68, 65536
    s_cbranch_scc1 CHS1_gloop
    s_mov_b32 s69, 1
    s_branch CHS1_loop
CHS1_last:
    v_and_b32 v28, 512, v0
    v_mul_u32_u24 v28, 3, v28
    v_add_u32 v28, v28, v0
    ds_read_b128 v[24:27], v28 offset:12800
    s_add_u32 s64, s64, 131072
    s_waitcnt lgkmcnt(0)
    buffer_store_dwordx4 v[24:27], v0, s[8:11], s64 offen sc1
    s_waitcnt vmcnt(0)
    s_barrier
    s_waitcnt vmcnt(0) lgkmcnt(0)
    s_endpgm
CH2_entry:
    v_and_b32 v40, 63, v0
    v_lshlrev_b32 v0, 4, v40
    v_lshrrev_b32 v41, 4, v40
    v_and_b32 v42, 15, v40
    v_and_b32 v43, 2, v40
    v_cmp_ne_u32 vcc, 0, v43
    v_mov_b32 v44, 0x4444
    v_mov_b32 v45, 0xeeee
    v_cndmask_b32 v1, v44, v45, vcc
    v_and_b32 v43, 13, v42
    v_and_b32 v44, 1, v41
    v_lshl_or_b32 v43, v44, 1, v43
    v_lshlrev_b32 v43, 4, v43
    v_lshrrev_b32 v44, 1, v41
    v_lshl_add_u32 v6, v44, 8, v43
    v_lshrrev_b32 v43, 3, v42
    v_lshlrev_b32 v43, 8, v43
    v_lshl_add_u32 v43, v41, 6, v43
    v_bfe_u32 v44, v42, 2, 1
    v_lshl_add_u32 v43, v44, 5, v43
    v_and_b32 v44, 3, v42
    v_lshl_add_u32 v43, v44, 2, v43
    v_add_u32 v5, 11264, v43
    v_add_u32 v7, 94208, v0
    v_add_u32 v3, 2048, v5
    s_mov_b32 s70, 2176
    v_lshrrev_b32 v43, 3, v42
    v_lshl_add_u32 v43, v43, 2, v41
    v_mul_lo_u32 v43, v43, s70
    v_and_b32 v44, 7, v42
    v_lshl_add_u32 v4, v44, 3, v43
    s_mul_i32 s70, s53, 5
    s_add_u32 s70, s70, 3
    v_lshrrev_b32 v43, 3, v42
    v_add_u32 v43, s70, v43
    v_and_b32 v49, 3, v42
    v_lshlrev_b32 v49, 4, v49
    v_lshl_add_u32 v49, v41, 2, v49
    v_bfe_u32 v48, v42, 2, 1
    v_lshl_add_u32 v49, v48, 1, v49
    v_lshl_add_u32 v2, v43, 6, v49
    v_mov_b32 v46, 0x40000000
    v_cmp_lt_u32 vcc, 7, v42
    s_nop 1
    v_cndmask_b32 v2, v2, v46, vcc
    s_mul_i32 s70, s54, 20480
    s_add_u32 s56, s70, 131072
    s_add_u32 s57, s56, 10240
    s_xor_b32 s74, s56, s57
    s_mul_i32 s70, s54, 348160
    s_add_u32 s70, s70, 196608
    s_lshl_b32 s71, s53, 6
    s_add_u32 s58, s70, s71
    s_add_u32 s58, s58, 34816
    s_add_u32 s75, s58, 69632
    s_add_u32 s76, s58, 139264
    s_add_u32 s77, s58, 208896
    s_add_u32 s4, s58, 278528
    s_mul_i32 s71, s53, 10880
    s_add_u32 s59, s71, s70
    s_add_u32 s59, s59, 6528
    s_add_u32 s60, s59, 2176
    s_mov_b32 s65, 0
    s_mul_i32 s61, s53, 75776
    s_add_u32 s61, s61, 1085440
    s_add_u32 s3, s61, 4096
    s_add_u32 s5, s61, 8192
    s_add_u32 s6, s61, 12288
    s_add_u32 s7, s61, 16384
    s_mul_i32 s70, s54, 16777216
    s_lshl_b32 s71, s53, 13
    s_add_u32 s70, s70, s71
    s_add_u32 s62, s70, 50335744
    s_add_u32 s63, s70, 16781312
    s_mul_i32 s70, s54, 8519680
    s_lshl_b32 s71, s53, 12
    s_add_u32 s70, s70, s71
    s_add_u32 s64, s70, 150996992
    s_mul_i32 s70, s54, 8192
    s_lshr_b32 s71, s53, 1
    s_mul_i32 s71, s71, 384
    s_add_u32 s78, s70, s71
    s_add_u32 s78, s78, 128
    s_and_b32 s71, s53, 1
    s_lshl_b32 s71, s71, 3
    s_add_u32 s78, s78, s71
    s_lshl_b32 s71, s53, 7
    s_add_u32 s66, s70, s71
    s_add_u32 s66, s66, 16384
    s_mov_b32 s55, 0
    s_mov_b32 s67, 0
    s_mov_b32 s69, 0
    s_mov_b32 s79, 0x3e0293ee
    v_and_b32 v44, 3, v40
    v_lshlrev_b32 v46, 1, v41
    v_xor_b32 v46, v46, v42
    v_lshlrev_b32 v46, 4, v46
    v_lshrrev_b32 v45, 1, v41
    v_lshlrev_b32 v45, 3, v45
    v_and_b32 v47, 1, v41
    v_add_u32 v45, v45, v47
    v_lshlrev_b32 v45, 13, v45
    s_lshl_b32 s70, s53, 8
    v_add3_u32 v32, v45, v46, s70
    v_xor_b32 v34, 128, v32
    v_lshrrev_b32 v45, 1, v41
    v_lshlrev_b32 v45, 2, v45
    v_add_u32 v45, v45, v47
    v_mul_u32_u24 v45, 1280, v45
    s_mul_i32 s70, s53, 163840
    v_add3_u32 v33, v45, v46, s70
    v_xor_b32 v35, 128, v33
    v_bfe_u32 v45, v40, 2, 2
    v_lshl_add_u32 v48, v47, 2, v45
    v_lshlrev_b32 v48, 5, v48
    v_lshl_add_u32 v45, v47, 3, v45
    v_lshlrev_b32 v45, 8, v45
    v_lshrrev_b32 v51, 1, v41
    v_mul_u32_u24 v52, 36864, v51
    v_add_u32 v52, 24576, v52
    v_add_u32 v52, v52, v45
    v_mul_u32_u24 v53, 32768, v51
    v_add_u32 v53, 94208, v53
    v_add_u32 v53, v53, v45
    v_lshlrev_b32 v49, 3, v44
    v_add_u32 v49, 128, v49
    v_xor_b32 v49, v49, v48
    v_add_u32 v16, v49, v52
    v_add_u32 v20, v49, v53
    v_lshrrev_b32 v49, 1, v44
    v_lshlrev_b32 v49, 5, v49
    v_and_b32 v50, 1, v44
    v_lshl_add_u32 v49, v50, 3, v49
    v_add_u32 v49, 128, v49
    v_xor_b32 v49, v49, v48
    v_add_u32 v18, v49, v52
    v_add_u32 v22, v49, v53
    v_lshlrev_b32 v49, 3, v44
    v_add_u32 v49, 160, v49
    v_xor_b32 v49, v49, v48
    v_add_u32 v17, v49, v52
    v_add_u32 v21, v49, v53
    v_lshrrev_b32 v49, 1, v44
    v_lshlrev_b32 v49, 5, v49
    v_and_b32 v50, 1, v44
    v_lshl_add_u32 v49, v50, 3, v49
    v_add_u32 v49, 144, v49
    v_xor_b32 v49, v49, v48
    v_add_u32 v19, v49, v52
    v_add_u32 v23, v49, v53
    s_cmp_eq_u32 s54, 0
    s_cselect_b32 s72, 0x20000000, 0
    s_mov_b32 m0, 94208
    s_mov_b32 s70, 262144
    buffer_load_dwordx4 v32, s[12:15], s70 offen lds
    s_mov_b32 m0, 95232
    s_mov_b32 s70, 278528
    buffer_load_dwordx4 v32, s[12:15], s70 offen lds
    s_mov_b32 m0, 96256
    s_mov_b32 s70, 294912
    buffer_load_dwordx4 v34, s[12:15], s70 offen lds
    s_mov_b32 m0, 97280
    s_mov_b32 s70, 311296
    buffer_load_dwordx4 v34, s[12:15], s70 offen lds
    s_mov_b32 m0, 98304
    s_mov_b32 s70, 1835008
    buffer_load_dwordx4 v32, s[12:15], s70 offen lds
    s_mov_b32 m0, 99328
    s_mov_b32 s70, 1851392
    buffer_load_dwordx4 v32, s[12:15], s70 offen lds
    s_mov_b32 m0, 100352
    s_mov_b32 s70, 1867776
    buffer_load_dwordx4 v34, s[12:15], s70 offen lds
    s_mov_b32 m0, 101376
    s_mov_b32 s70, 1884160
    buffer_load_dwordx4 v34, s[12:15], s70 offen lds
    s_mov_b32 m0, 102400
    s_mov_b32 s70, 2359296
    buffer_load_dwordx4 v32, s[12:15], s70 offen lds
    s_mov_b32 m0, 103424
    s_mov_b32 s70, 2375680
    buffer_load_dwordx4 v32, s[12:15], s70 offen lds
    s_mov_b32 m0, 104448
    s_mov_b32 s70, 2392064
    buffer_load_dwordx4 v34, s[12:15], s70 offen lds
    s_mov_b32 m0, 105472
    s_mov_b32 s70, 2408448
    buffer_load_dwordx4 v34, s[12:15], s70 offen lds
    s_mov_b32 m0, 106496
    s_mov_b32 s70, 2883584
    buffer_load_dwordx4 v32, s[12:15], s70 offen lds
    s_mov_b32 m0, 107520
    s_mov_b32 s70, 2899968
    buffer_load_dwordx4 v32, s[12:15], s70 offen lds
    s_mov_b32 m0, 108544
    s_mov_b32 s70, 2916352
    buffer_load_dwordx4 v34, s[12:15], s70 offen lds
    s_mov_b32 m0, 109568
    s_mov_b32 s70, 2932736
    buffer_load_dwordx4 v34, s[12:15], s70 offen lds
    s_mov_b32 m0, 110592
    s_mov_b32 s70, 3407872
    buffer_load_dwordx4 v32, s[12:15], s70 offen lds
    s_mov_b32 m0, 111616
    s_mov_b32 s70, 3424256
    buffer_load_dwordx4 v32, s[12:15], s70 offen lds
    s_mov_b32 m0, 112640
    s_mov_b32 s70, 3440640
    buffer_load_dwordx4 v34, s[12:15], s70 offen lds
    s_mov_b32 m0, 113664
    s_mov_b32 s70, 3457024
    buffer_load_dwordx4 v34, s[12:15], s70 offen lds
    s_mov_b32 m0, 114688
    s_mov_b32 s70, 3932160
    buffer_load_dwordx4 v32, s[12:15], s70 offen lds
    s_mov_b32 m0, 115712
    s_mov_b32 s70, 3948544
    buffer_load_dwordx4 v32, s[12:15], s70 offen lds
    s_mov_b32 m0, 116736
    s_mov_b32 s70, 3964928
    buffer_load_dwordx4 v34, s[12:15], s70 offen lds
    s_mov_b32 m0, 117760
    s_mov_b32 s70, 3981312
    buffer_load_dwordx4 v34, s[12:15], s70 offen lds
    s_mov_b32 m0, 118784
    s_mov_b32 s70, 4456448
    buffer_load_dwordx4 v32, s[12:15], s70 offen lds
    s_mov_b32 m0, 119808
    s_mov_b32 s70, 4472832
    buffer_load_dwordx4 v32, s[12:15], s70 offen lds
    s_mov_b32 m0, 120832
    s_mov_b32 s70, 4489216
    buffer_load_dwordx4 v34, s[12:15], s70 offen lds
    s_mov_b32 m0, 121856
    s_mov_b32 s70, 4505600
    buffer_load_dwordx4 v34, s[12:15], s70 offen lds
    s_mov_b32 m0, 122880
    s_mov_b32 s70, 4980736
    buffer_load_dwordx4 v32, s[12:15], s70 offen lds
    s_mov_b32 m0, 123904
    s_mov_b32 s70, 4997120
    buffer_load_dwordx4 v32, s[12:15], s70 offen lds
    s_mov_b32 m0, 124928
    s_mov_b32 s70, 5013504
    buffer_load_dwordx4 v34, s[12:15], s70 offen lds
    s_mov_b32 m0, 125952
    s_mov_b32 s70, 5029888
    buffer_load_dwordx4 v34, s[12:15], s70 offen lds
    s_waitcnt vmcnt(28) lgkmcnt(0)
    s_barrier
    ds_read_b64_tr_b16 v[152:153], v16 offset:0
    ds_read_b64_tr_b16 v[154:155], v16 offset:1024
    ds_read_b64_tr_b16 v[156:157], v20 offset:0
    ds_read_b64_tr_b16 v[158:159], v20 offset:1024
    ds_read_b64_tr_b16 v[160:161], v17 offset:0
    ds_read_b64_tr_b16 v[162:163], v17 offset:1024
    ds_read_b64_tr_b16 v[164:165], v21 offset:0
    ds_read_b64_tr_b16 v[166:167], v21 offset:1024
    s_waitcnt vmcnt(24) lgkmcnt(0)
    s_barrier
    s_mov_b32 m0, 94208
    s_add_u32 s70, s72, 41216
    buffer_load_dwordx4 v33, s[24:27], s70 offen lds
    s_mov_b32 m0, 95232
    s_add_u32 s70, s72, 43776
    buffer_load_dwordx4 v33, s[24:27], s70 offen lds
    s_mov_b32 m0, 96256
    s_add_u32 s70, s72, 61696
    buffer_load_dwordx4 v35, s[24:27], s70 offen lds
    s_mov_b32 m0, 97280
    s_add_u32 s70, s72, 64256
    buffer_load_dwordx4 v35, s[24:27], s70 offen lds
    ds_read_b64_tr_b16 v[56:57], v16 offset:4096
    ds_read_b64_tr_b16 v[58:59], v16 offset:5120
    ds_read_b64_tr_b16 v[60:61], v20 offset:4096
    ds_read_b64_tr_b16 v[62:63], v20 offset:5120
    ds_read_b64_tr_b16 v[200:201], v17 offset:4096
    ds_read_b64_tr_b16 v[202:203], v17 offset:5120
    ds_read_b64_tr_b16 v[204:205], v21 offset:4096
    ds_read_b64_tr_b16 v[206:207], v21 offset:5120
    s_waitcnt vmcnt(24) lgkmcnt(0)
    s_barrier
    s_add_u32 s71, s3, s72
    buffer_store_dwordx4 v[56:59], v0, s[8:11], s71 offen offset:2048 sc1
    buffer_store_dwordx4 v[60:63], v0, s[8:11], s71 offen offset:3072 sc1
    s_mov_b32 m0, 98304
    s_mov_b32 s70, 41472
    buffer_load_dwordx4 v33, s[24:27], s70 offen lds
    s_mov_b32 m0, 99328
    s_mov_b32 s70, 44032
    buffer_load_dwordx4 v33, s[24:27], s70 offen lds
    s_mov_b32 m0, 100352
    s_mov_b32 s70, 61952
    buffer_load_dwordx4 v35, s[24:27], s70 offen lds
    s_mov_b32 m0, 101376
    s_mov_b32 s70, 64512
    buffer_load_dwordx4 v35, s[24:27], s70 offen lds
    ds_read_b64_tr_b16 v[168:169], v16 offset:8192
    ds_read_b64_tr_b16 v[170:171], v16 offset:9216
    ds_read_b64_tr_b16 v[172:173], v20 offset:8192
    ds_read_b64_tr_b16 v[174:175], v20 offset:9216
    ds_read_b64_tr_b16 v[176:177], v17 offset:8192
    ds_read_b64_tr_b16 v[178:179], v17 offset:9216
    ds_read_b64_tr_b16 v[180:181], v21 offset:8192
    ds_read_b64_tr_b16 v[182:183], v21 offset:9216
    s_waitcnt vmcnt(26) lgkmcnt(0)
    s_barrier
    s_mov_b32 m0, 102400
    s_add_u32 s70, s72, 122880
    buffer_load_dwordx4 v33, s[24:27], s70 offen lds
    s_mov_b32 m0, 103424
    s_add_u32 s70, s72, 125440
    buffer_load_dwordx4 v33, s[24:27], s70 offen lds
    s_mov_b32 m0, 104448
    s_add_u32 s70, s72, 143360
    buffer_load_dwordx4 v35, s[24:27], s70 offen lds
    s_mov_b32 m0, 105472
    s_add_u32 s70, s72, 145920
    buffer_load_dwordx4 v35, s[24:27], s70 offen lds
    ds_read_b64_tr_b16 v[56:57], v16 offset:12288
    ds_read_b64_tr_b16 v[58:59], v16 offset:13312
    ds_read_b64_tr_b16 v[60:61], v20 offset:12288
    ds_read_b64_tr_b16 v[62:63], v20 offset:13312
    ds_read_b64_tr_b16 v[208:209], v17 offset:12288
    ds_read_b64_tr_b16 v[210:211], v17 offset:13312
    ds_read_b64_tr_b16 v[212:213], v21 offset:12288
    ds_read_b64_tr_b16 v[214:215], v21 offset:13312
    s_waitcnt vmcnt(26) lgkmcnt(0)
    s_barrier
    s_add_u32 s71, s5, s72
    buffer_store_dwordx4 v[56:59], v0, s[8:11], s71 offen offset:0 sc1
    buffer_store_dwordx4 v[60:63], v0, s[8:11], s71 offen offset:1024 sc1
    s_mov_b32 m0, 106496
    s_mov_b32 s70, 786432
    buffer_load_dwordx4 v32, s[12:15], s70 offen lds
    s_mov_b32 m0, 107520
    s_mov_b32 s70, 802816
    buffer_load_dwordx4 v32, s[12:15], s70 offen lds
    s_mov_b32 m0, 108544
    s_mov_b32 s70, 819200
    buffer_load_dwordx4 v34, s[12:15], s70 offen lds
    s_mov_b32 m0, 109568
    s_mov_b32 s70, 835584
    buffer_load_dwordx4 v34, s[12:15], s70 offen lds
    ds_read_b64_tr_b16 v[40:41], v16 offset:16384
    ds_read_b64_tr_b16 v[42:43], v16 offset:17408
    ds_read_b64_tr_b16 v[44:45], v20 offset:16384
    ds_read_b64_tr_b16 v[46:47], v20 offset:17408
    ds_read_b64_tr_b16 v[48:49], v17 offset:16384
    ds_read_b64_tr_b16 v[50:51], v17 offset:17408
    ds_read_b64_tr_b16 v[52:53], v21 offset:16384
    ds_read_b64_tr_b16 v[54:55], v21 offset:17408
    s_waitcnt vmcnt(28) lgkmcnt(0)
    s_barrier
    s_add_u32 s71, s61, s72
    buffer_store_dwordx4 v[40:43], v0, s[8:11], s71 offen offset:2048 sc1
    buffer_store_dwordx4 v[44:47], v0, s[8:11], s71 offen offset:3072 sc1
    s_add_u32 s71, s61, s72
    buffer_store_dwordx4 v[48:51], v0, s[8:11], s71 offen offset:0 sc1
    buffer_store_dwordx4 v[52:55], v0, s[8:11], s71 offen offset:1024 sc1
    s_mov_b32 m0, 110592
    s_mov_b32 s70, 1310720
    buffer_load_dwordx4 v32, s[12:15], s70 offen lds
    s_mov_b32 m0, 111616
    s_mov_b32 s70, 1327104
    buffer_load_dwordx4 v32, s[12:15], s70 offen lds
    s_mov_b32 m0, 112640
    s_mov_b32 s70, 1343488
    buffer_load_dwordx4 v34, s[12:15], s70 offen lds
    s_mov_b32 m0, 113664
    s_mov_b32 s70, 1359872
    buffer_load_dwordx4 v34, s[12:15], s70 offen lds
    ds_read_b64_tr_b16 v[56:57], v16 offset:20480
    ds_read_b64_tr_b16 v[58:59], v16 offset:21504
    ds_read_b64_tr_b16 v[60:61], v20 offset:20480
    ds_read_b64_tr_b16 v[62:63], v20 offset:21504
    ds_read_b64_tr_b16 v[80:81], v17 offset:20480
    ds_read_b64_tr_b16 v[82:83], v17 offset:21504
    ds_read_b64_tr_b16 v[84:85], v21 offset:20480
    ds_read_b64_tr_b16 v[86:87], v21 offset:21504
    s_waitcnt vmcnt(32) lgkmcnt(0)
    s_barrier
    s_add_u32 s71, s3, s72
    buffer_store_dwordx4 v[56:59], v0, s[8:11], s71 offen offset:0 sc1
    buffer_store_dwordx4 v[60:63], v0, s[8:11], s71 offen offset:1024 sc1
    s_mov_b32 m0, 114688
    s_mov_b32 s70, 786432
    buffer_load_dwordx4 v32, s[16:19], s70 offen lds
    s_mov_b32 m0, 115712
    s_mov_b32 s70, 802816
    buffer_load_dwordx4 v32, s[16:19], s70 offen lds
    s_mov_b32 m0, 116736
    s_mov_b32 s70, 819200
    buffer_load_dwordx4 v34, s[16:19], s70 offen lds
    s_mov_b32 m0, 117760
    s_mov_b32 s70, 835584
    buffer_load_dwordx4 v34, s[16:19], s70 offen lds
    ds_read_b64_tr_b16 v[232:233], v16 offset:24576
    ds_read_b64_tr_b16 v[234:235], v16 offset:25600
    ds_read_b64_tr_b16 v[236:237], v20 offset:24576
    ds_read_b64_tr_b16 v[238:239], v20 offset:25600
    ds_read_b64_tr_b16 v[240:241], v17 offset:24576
    ds_read_b64_tr_b16 v[242:243], v17 offset:25600
    ds_read_b64_tr_b16 v[244:245], v21 offset:24576
    ds_read_b64_tr_b16 v[246:247], v21 offset:25600
    s_waitcnt vmcnt(34) lgkmcnt(0)
    s_barrier
    s_mov_b32 m0, 118784
    s_mov_b32 s70, 2359296
    buffer_load_dwordx4 v32, s[16:19], s70 offen lds
    s_mov_b32 m0, 119808
    s_mov_b32 s70, 2375680
    buffer_load_dwordx4 v32, s[16:19], s70 offen lds
    s_mov_b32 m0, 120832
    s_mov_b32 s70, 2392064
    buffer_load_dwordx4 v34, s[16:19], s70 offen lds
    s_mov_b32 m0, 121856
    s_mov_b32 s70, 2408448
    buffer_load_dwordx4 v34, s[16:19], s70 offen lds
    ds_read_b64_tr_b16 v[248:249], v16 offset:28672
    ds_read_b64_tr_b16 v[250:251], v16 offset:29696
    ds_read_b64_tr_b16 v[252:253], v20 offset:28672
    ds_read_b64_tr_b16 v[254:255], v20 offset:29696
    ds_read_b64_tr_b16 a[0:1], v17 offset:28672
    ds_read_b64_tr_b16 a[2:3], v17 offset:29696
    ds_read_b64_tr_b16 a[4:5], v21 offset:28672
    ds_read_b64_tr_b16 a[6:7], v21 offset:29696
    s_waitcnt vmcnt(34) lgkmcnt(0)
    s_barrier
    s_mov_b32 m0, 122880
    s_mov_b32 s70, 2883584
    buffer_load_dwordx4 v32, s[16:19], s70 offen lds
    s_mov_b32 m0, 123904
    s_mov_b32 s70, 2899968
    buffer_load_dwordx4 v32, s[16:19], s70 offen lds
    s_mov_b32 m0, 124928
    s_mov_b32 s70, 2916352
    buffer_load_dwordx4 v34, s[16:19], s70 offen lds
    s_mov_b32 m0, 125952
    s_mov_b32 s70, 2932736
    buffer_load_dwordx4 v34, s[16:19], s70 offen lds
    ds_read_b64_tr_b16 v[40:41], v18 offset:0
    ds_read_b64_tr_b16 v[42:43], v18 offset:1024
    ds_read_b64_tr_b16 v[44:45], v22 offset:0
    ds_read_b64_tr_b16 v[46:47], v22 offset:1024
    ds_read_b64_tr_b16 v[48:49], v19 offset:0
    ds_read_b64_tr_b16 v[50:51], v19 offset:1024
    ds_read_b64_tr_b16 v[52:53], v23 offset:0
    ds_read_b64_tr_b16 v[54:55], v23 offset:1024
    s_waitcnt vmcnt(32) lgkmcnt(0)
    s_barrier
    s_add_u32 s71, s6, s72
    buffer_store_dwordx4 v[40:43], v0, s[8:11], s71 offen offset:2048 sc1
    buffer_store_dwordx4 v[44:47], v0, s[8:11], s71 offen offset:3072 sc1
    s_add_u32 s71, s7, s72
    buffer_store_dwordx4 v[48:51], v0, s[8:11], s71 offen offset:0 sc1
    buffer_store_dwordx4 v[52:55], v0, s[8:11], s71 offen offset:1024 sc1
    s_mov_b32 m0, 94208
    s_mov_b32 s70, 3932160
    buffer_load_dwordx4 v32, s[16:19], s70 offen lds
    s_mov_b32 m0, 95232
    s_mov_b32 s70, 3948544
    buffer_load_dwordx4 v32, s[16:19], s70 offen lds
    s_mov_b32 m0, 96256
    s_mov_b32 s70, 3964928
    buffer_load_dwordx4 v34, s[16:19], s70 offen lds
    s_mov_b32 m0, 97280
    s_mov_b32 s70, 3981312
    buffer_load_dwordx4 v34, s[16:19], s70 offen lds
    ds_read_b64_tr_b16 a[216:217], v18 offset:4096
    ds_read_b64_tr_b16 a[218:219], v18 offset:5120
    ds_read_b64_tr_b16 a[220:221], v22 offset:4096
    ds_read_b64_tr_b16 a[222:223], v22 offset:5120
    ds_read_b64_tr_b16 v[64:65], v19 offset:4096
    ds_read_b64_tr_b16 v[66:67], v19 offset:5120
    ds_read_b64_tr_b16 v[68:69], v23 offset:4096
    ds_read_b64_tr_b16 v[70:71], v23 offset:5120
    s_waitcnt vmcnt(36) lgkmcnt(0)
    s_barrier
    s_add_u32 s71, s7, s72
    buffer_store_dwordx4 v[64:67], v0, s[8:11], s71 offen offset:2048 sc1
    buffer_store_dwordx4 v[68:71], v0, s[8:11], s71 offen offset:3072 sc1
    s_mov_b32 m0, 98304
    s_mov_b32 s70, 4980736
    buffer_load_dwordx4 v32, s[16:19], s70 offen lds
    s_mov_b32 m0, 99328
    s_mov_b32 s70, 4997120
    buffer_load_dwordx4 v32, s[16:19], s70 offen lds
    s_mov_b32 m0, 100352
    s_mov_b32 s70, 5013504
    buffer_load_dwordx4 v34, s[16:19], s70 offen lds
    s_mov_b32 m0, 101376
    s_mov_b32 s70, 5029888
    buffer_load_dwordx4 v34, s[16:19], s70 offen lds
    ds_read_b64_tr_b16 v[40:41], v18 offset:8192
    ds_read_b64_tr_b16 v[42:43], v18 offset:9216
    ds_read_b64_tr_b16 v[44:45], v22 offset:8192
    ds_read_b64_tr_b16 v[46:47], v22 offset:9216
    ds_read_b64_tr_b16 v[48:49], v19 offset:8192
    ds_read_b64_tr_b16 v[50:51], v19 offset:9216
    ds_read_b64_tr_b16 v[52:53], v23 offset:8192
    ds_read_b64_tr_b16 v[54:55], v23 offset:9216
    s_waitcnt vmcnt(36) lgkmcnt(0)
    s_barrier
    s_add_u32 s71, s5, s72
    buffer_store_dwordx4 v[40:43], v0, s[8:11], s71 offen offset:2048 sc1
    buffer_store_dwordx4 v[44:47], v0, s[8:11], s71 offen offset:3072 sc1
    s_add_u32 s71, s6, s72
    buffer_store_dwordx4 v[48:51], v0, s[8:11], s71 offen offset:0 sc1
    buffer_store_dwordx4 v[52:55], v0, s[8:11], s71 offen offset:1024 sc1
    s_mov_b32 m0, 102400
    s_mov_b32 s70, 262144
    buffer_load_dwordx4 v32, s[20:23], s70 offen lds
    s_mov_b32 m0, 103424
    s_mov_b32 s70, 278528
    buffer_load_dwordx4 v32, s[20:23], s70 offen lds
    s_mov_b32 m0, 104448
    s_mov_b32 s70, 294912
    buffer_load_dwordx4 v34, s[20:23], s70 offen lds
    s_mov_b32 m0, 105472
    s_mov_b32 s70, 311296
    buffer_load_dwordx4 v34, s[20:23], s70 offen lds
    ds_read_b64_tr_b16 v[120:121], v16 offset:12288
    ds_read_b64_tr_b16 v[122:123], v16 offset:13312
    ds_read_b64_tr_b16 v[124:125], v20 offset:12288
    ds_read_b64_tr_b16 v[126:127], v20 offset:13312
    ds_read_b64_tr_b16 v[128:129], v17 offset:12288
    ds_read_b64_tr_b16 v[130:131], v17 offset:13312
    ds_read_b64_tr_b16 v[132:133], v21 offset:12288
    ds_read_b64_tr_b16 v[134:135], v21 offset:13312
    s_waitcnt vmcnt(36) lgkmcnt(0)
    s_barrier
    s_mov_b32 m0, 106496
    s_mov_b32 s70, 786432
    buffer_load_dwordx4 v32, s[20:23], s70 offen lds
    s_mov_b32 m0, 107520
    s_mov_b32 s70, 802816
    buffer_load_dwordx4 v32, s[20:23], s70 offen lds
    s_mov_b32 m0, 108544
    s_mov_b32 s70, 819200
    buffer_load_dwordx4 v34, s[20:23], s70 offen lds
    s_mov_b32 m0, 109568
    s_mov_b32 s70, 835584
    buffer_load_dwordx4 v34, s[20:23], s70 offen lds
    ds_read_b64_tr_b16 v[104:105], v16 offset:16384
    ds_read_b64_tr_b16 v[106:107], v16 offset:17408
    ds_read_b64_tr_b16 v[108:109], v20 offset:16384
    ds_read_b64_tr_b16 v[110:111], v20 offset:17408
    ds_read_b64_tr_b16 v[112:113], v17 offset:16384
    ds_read_b64_tr_b16 v[114:115], v17 offset:17408
    ds_read_b64_tr_b16 v[116:117], v21 offset:16384
    ds_read_b64_tr_b16 v[118:119], v21 offset:17408
    s_cmp_eq_u32 s54, 0
    s_cbranch_scc1 CH2_nosend_82
    s_waitcnt vmcnt(0)
    s_cmp_lg_u32 s96, 0
    s_cbranch_scc1 RDY_ok_83
    s_mov_b32 s68, 0
RDY_lp_84:
    buffer_load_dword v24, off, s[48:51], 0 offset:32 sc1
    s_waitcnt vmcnt(0)
    v_readfirstlane_b32 s70, v24
    s_nop 0
    s_cmp_ge_u32 s70, 256
    s_cbranch_scc1 RDY_all_85
    s_sleep 8
    s_add_u32 s68, s68, 1
    s_cmp_lt_u32 s68, 65536
    s_cbranch_scc1 RDY_lp_84
    s_branch RDY_ok_83
RDY_all_85:
    v_mbcnt_lo_u32_b32 v25, -1, 0
    v_and_b32 v25, 7, v25
    v_min_u32 v26, 1, v25
    v_lshlrev_b32 v25, 2, v25
    v_lshl_add_u32 v25, v26, 7, v25
    buffer_load_dword v24, v25, s[48:51], 0 offen sc1
    s_waitcnt vmcnt(0)
    v_cmp_ne_u32 vcc, 32, v24
    s_nop 0
    s_cbranch_vccnz L_slow
RDY_ok_83:
    v_mov_b32 v24, 1
    s_add_u32 s71, s66, 8
    buffer_store_dword v24, off, s[8:11], s71 sc1
CH2_nosend_82:
    s_waitcnt vmcnt(34) lgkmcnt(0)
    s_barrier
    s_mov_b32 m0, 110592
    s_mov_b32 s70, 1310720
    buffer_load_dwordx4 v32, s[20:23], s70 offen lds
    s_mov_b32 m0, 111616
    s_mov_b32 s70, 1327104
    buffer_load_dwordx4 v32, s[20:23], s70 offen lds
    s_mov_b32 m0, 112640
    s_mov_b32 s70, 1343488
    buffer_load_dwordx4 v34, s[20:23], s70 offen lds
    s_mov_b32 m0, 113664
    s_mov_b32 s70, 1359872
    buffer_load_dwordx4 v34, s[20:23], s70 offen lds
    ds_read_b64_tr_b16 v[136:137], v16 offset:20480
    ds_read_b64_tr_b16 v[138:139], v16 offset:21504
    ds_read_b64_tr_b16 v[140:141], v20 offset:20480
    ds_read_b64_tr_b16 v[142:143], v20 offset:21504
    ds_read_b64_tr_b16 v[144:145], v17 offset:20480
    ds_read_b64_tr_b16 v[146:147], v17 offset:21504
    ds_read_b64_tr_b16 v[148:149], v21 offset:20480
    ds_read_b64_tr_b16 v[150:151], v21 offset:21504
    s_waitcnt vmcnt(34) lgkmcnt(0)
    s_barrier
    s_mov_b32 m0, 114688
    s_mov_b32 s70, 1835008
    buffer_load_dwordx4 v32, s[20:23], s70 offen lds
    s_mov_b32 m0, 115712
    s_mov_b32 s70, 1851392
    buffer_load_dwordx4 v32, s[20:23], s70 offen lds
    s_mov_b32 m0, 116736
    s_mov_b32 s70, 1867776
    buffer_load_dwordx4 v34, s[20:23], s70 offen lds
    s_mov_b32 m0, 117760
    s_mov_b32 s70, 1884160
    buffer_load_dwordx4 v34, s[20:23], s70 offen lds
    ds_read_b64_tr_b16 v[184:185], v16 offset:24576
    ds_read_b64_tr_b16 v[186:187], v16 offset:25600
    ds_read_b64_tr_b16 v[188:189], v20 offset:24576
    ds_read_b64_tr_b16 v[190:191], v20 offset:25600
    ds_read_b64_tr_b16 v[192:193], v17 offset:24576
    ds_read_b64_tr_b16 v[194:195], v17 offset:25600
    ds_read_b64_tr_b16 v[196:197], v21 offset:24576
    ds_read_b64_tr_b16 v[198:199], v21 offset:25600
    s_waitcnt vmcnt(34) lgkmcnt(0)
    s_barrier
    s_mov_b32 m0, 118784
    s_mov_b32 s70, 2359296
    buffer_load_dwordx4 v32, s[20:23], s70 offen lds
    s_mov_b32 m0, 119808
    s_mov_b32 s70, 2375680
    buffer_load_dwordx4 v32, s[20:23], s70 offen lds
    s_mov_b32 m0, 120832
    s_mov_b32 s70, 2392064
    buffer_load_dwordx4 v34, s[20:23], s70 offen lds
    s_mov_b32 m0, 121856
    s_mov_b32 s70, 2408448
    buffer_load_dwordx4 v34, s[20:23], s70 offen lds
    ds_read_b64_tr_b16 v[216:217], v16 offset:28672
    ds_read_b64_tr_b16 v[218:219], v16 offset:29696
    ds_read_b64_tr_b16 v[220:221], v20 offset:28672
    ds_read_b64_tr_b16 v[222:223], v20 offset:29696
    ds_read_b64_tr_b16 v[224:225], v17 offset:28672
    ds_read_b64_tr_b16 v[226:227], v17 offset:29696
    ds_read_b64_tr_b16 v[228:229], v21 offset:28672
    ds_read_b64_tr_b16 v[230:231], v21 offset:29696
    s_waitcnt vmcnt(30) lgkmcnt(0)
    s_barrier
    s_mov_b32 m0, 122880
    s_mov_b32 s70, 2883584
    buffer_load_dwordx4 v32, s[20:23], s70 offen lds
    s_mov_b32 m0, 123904
    s_mov_b32 s70, 2899968
    buffer_load_dwordx4 v32, s[20:23], s70 offen lds
    s_mov_b32 m0, 124928
    s_mov_b32 s70, 2916352
    buffer_load_dwordx4 v34, s[20:23], s70 offen lds
    s_mov_b32 m0, 125952
    s_mov_b32 s70, 2932736
    buffer_load_dwordx4 v34, s[20:23], s70 offen lds
    ds_read_b64_tr_b16 v[88:89], v16 offset:0
    ds_read_b64_tr_b16 v[90:91], v16 offset:1024
    ds_read_b64_tr_b16 v[92:93], v20 offset:0
    ds_read_b64_tr_b16 v[94:95], v20 offset:1024
    ds_read_b64_tr_b16 v[96:97], v17 offset:0
    ds_read_b64_tr_b16 v[98:99], v17 offset:1024
    ds_read_b64_tr_b16 v[100:101], v21 offset:0
    ds_read_b64_tr_b16 v[102:103], v21 offset:1024
    s_waitcnt vmcnt(28) lgkmcnt(0)
    s_barrier
    s_mov_b32 m0, 94208
    s_mov_b32 s70, 3407872
    buffer_load_dwordx4 v32, s[20:23], s70 offen lds
    s_mov_b32 m0, 95232
    s_mov_b32 s70, 3424256
    buffer_load_dwordx4 v32, s[20:23], s70 offen lds
    s_mov_b32 m0, 96256
    s_mov_b32 s70, 3440640
    buffer_load_dwordx4 v34, s[20:23], s70 offen lds
    s_mov_b32 m0, 97280
    s_mov_b32 s70, 3457024
    buffer_load_dwordx4 v34, s[20:23], s70 offen lds
    ds_read_b64_tr_b16 a[8:9], v16 offset:4096
    ds_read_b64_tr_b16 a[10:11], v16 offset:5120
    ds_read_b64_tr_b16 a[12:13], v20 offset:4096
    ds_read_b64_tr_b16 a[14:15], v20 offset:5120
    ds_read_b64_tr_b16 a[16:17], v17 offset:4096
    ds_read_b64_tr_b16 a[18:19], v17 offset:5120
    ds_read_b64_tr_b16 a[20:21], v21 offset:4096
    ds_read_b64_tr_b16 a[22:23], v21 offset:5120
    s_waitcnt vmcnt(24) lgkmcnt(0)
    s_barrier
    s_mov_b32 m0, 98304
    s_mov_b32 s70, 3932160
    buffer_load_dwordx4 v32, s[20:23], s70 offen lds
    s_mov_b32 m0, 99328
    s_mov_b32 s70, 3948544
    buffer_load_dwordx4 v32, s[20:23], s70 offen lds
    s_mov_b32 m0, 100352
    s_mov_b32 s70, 3964928
    buffer_load_dwordx4 v34, s[20:23], s70 offen lds
    s_mov_b32 m0, 101376
    s_mov_b32 s70, 3981312
    buffer_load_dwordx4 v34, s[20:23], s70 offen lds
    ds_read_b64_tr_b16 a[88:89], v16 offset:8192
    ds_read_b64_tr_b16 a[90:91], v16 offset:9216
    ds_read_b64_tr_b16 a[92:93], v20 offset:8192
    ds_read_b64_tr_b16 a[94:95], v20 offset:9216
    ds_read_b64_tr_b16 a[96:97], v17 offset:8192
    ds_read_b64_tr_b16 a[98:99], v17 offset:9216
    ds_read_b64_tr_b16 a[100:101], v21 offset:8192
    ds_read_b64_tr_b16 a[102:103], v21 offset:9216
    s_waitcnt vmcnt(24) lgkmcnt(0)
    s_barrier
    s_mov_b32 m0, 102400
    s_mov_b32 s70, 4456448
    buffer_load_dwordx4 v32, s[20:23], s70 offen lds
    s_mov_b32 m0, 103424
    s_mov_b32 s70, 4472832
    buffer_load_dwordx4 v32, s[20:23], s70 offen lds
    s_mov_b32 m0, 104448
    s_mov_b32 s70, 4489216
    buffer_load_dwordx4 v34, s[20:23], s70 offen lds
    s_mov_b32 m0, 105472
    s_mov_b32 s70, 4505600
    buffer_load_dwordx4 v34, s[20:23], s70 offen lds
    ds_read_b64_tr_b16 a[72:73], v16 offset:12288
    ds_read_b64_tr_b16 a[74:75], v16 offset:13312
    ds_read_b64_tr_b16 a[76:77], v20 offset:12288
    ds_read_b64_tr_b16 a[78:79], v20 offset:13312
    ds_read_b64_tr_b16 a[80:81], v17 offset:12288
    ds_read_b64_tr_b16 a[82:83], v17 offset:13312
    ds_read_b64_tr_b16 a[84:85], v21 offset:12288
    ds_read_b64_tr_b16 a[86:87], v21 offset:13312
    s_waitcnt vmcnt(24) lgkmcnt(0)
    s_barrier
    s_mov_b32 m0, 106496
    s_mov_b32 s70, 4980736
    buffer_load_dwordx4 v32, s[20:23], s70 offen lds
    s_mov_b32 m0, 107520
    s_mov_b32 s70, 4997120
    buffer_load_dwordx4 v32, s[20:23], s70 offen lds
    s_mov_b32 m0, 108544
    s_mov_b32 s70, 5013504
    buffer_load_dwordx4 v34, s[20:23], s70 offen lds
    s_mov_b32 m0, 109568
    s_mov_b32 s70, 5029888
    buffer_load_dwordx4 v34, s[20:23], s70 offen lds
    ds_read_b64_tr_b16 a[56:57], v16 offset:16384
    ds_read_b64_tr_b16 a[58:59], v16 offset:17408
    ds_read_b64_tr_b16 a[60:61], v20 offset:16384
    ds_read_b64_tr_b16 a[62:63], v20 offset:17408
    ds_read_b64_tr_b16 a[64:65], v17 offset:16384
    ds_read_b64_tr_b16 a[66:67], v17 offset:17408
    ds_read_b64_tr_b16 a[68:69], v21 offset:16384
    ds_read_b64_tr_b16 a[70:71], v21 offset:17408
    s_waitcnt vmcnt(24) lgkmcnt(0)
    s_barrier
    s_mov_b32 m0, 110592
    s_mov_b32 s70, 40960
    buffer_load_dwordx4 v33, s[24:27], s70 offen lds
    s_mov_b32 m0, 111616
    s_mov_b32 s70, 43520
    buffer_load_dwordx4 v33, s[24:27], s70 offen lds
    s_mov_b32 m0, 112640
    s_mov_b32 s70, 61440
    buffer_load_dwordx4 v35, s[24:27], s70 offen lds
    s_mov_b32 m0, 113664
    s_mov_b32 s70, 64000
    buffer_load_dwordx4 v35, s[24:27], s70 offen lds
    ds_read_b64_tr_b16 a[120:121], v16 offset:20480
    ds_read_b64_tr_b16 a[122:123], v16 offset:21504
    ds_read_b64_tr_b16 a[124:125], v20 offset:20480
    ds_read_b64_tr_b16 a[126:127], v20 offset:21504
    ds_read_b64_tr_b16 a[128:129], v17 offset:20480
    ds_read_b64_tr_b16 a[130:131], v17 offset:21504
    ds_read_b64_tr_b16 a[132:133], v21 offset:20480
    ds_read_b64_tr_b16 a[134:135], v21 offset:21504
    s_waitcnt vmcnt(24) lgkmcnt(0)
    s_barrier
    s_mov_b32 m0, 114688
    s_mov_b32 s70, 41728
    buffer_load_dwordx4 v33, s[24:27], s70 offen lds
    s_mov_b32 m0, 115712
    s_mov_b32 s70, 44288
    buffer_load_dwordx4 v33, s[24:27], s70 offen lds
    s_mov_b32 m0, 116736
    s_mov_b32 s70, 62208
    buffer_load_dwordx4 v35, s[24:27], s70 offen lds
    s_mov_b32 m0, 117760
    s_mov_b32 s70, 64768
    buffer_load_dwordx4 v35, s[24:27], s70 offen lds
    ds_read_b64_tr_b16 a[104:105], v16 offset:24576
    ds_read_b64_tr_b16 a[106:107], v16 offset:25600
    ds_read_b64_tr_b16 a[108:109], v20 offset:24576
    ds_read_b64_tr_b16 a[110:111], v20 offset:25600
    ds_read_b64_tr_b16 a[112:113], v17 offset:24576
    ds_read_b64_tr_b16 a[114:115], v17 offset:25600
    ds_read_b64_tr_b16 a[116:117], v21 offset:24576
    ds_read_b64_tr_b16 a[118:119], v21 offset:25600
    s_waitcnt vmcnt(24) lgkmcnt(0)
    s_barrier
    s_mov_b32 m0, 118784
    s_mov_b32 s70, 41984
    buffer_load_dwordx4 v33, s[24:27], s70 offen lds
    s_mov_b32 m0, 119808
    s_mov_b32 s70, 44544
    buffer_load_dwordx4 v33, s[24:27], s70 offen lds
    s_mov_b32 m0, 120832
    s_mov_b32 s70, 62464
    buffer_load_dwordx4 v35, s[24:27], s70 offen lds
    s_mov_b32 m0, 121856
    s_mov_b32 s70, 65024
    buffer_load_dwordx4 v35, s[24:27], s70 offen lds
    ds_read_b64_tr_b16 a[136:137], v16 offset:28672
    ds_read_b64_tr_b16 a[138:139], v16 offset:29696
    ds_read_b64_tr_b16 a[140:141], v20 offset:28672
    ds_read_b64_tr_b16 a[142:143], v20 offset:29696
    ds_read_b64_tr_b16 a[144:145], v17 offset:28672
    ds_read_b64_tr_b16 a[146:147], v17 offset:29696
    ds_read_b64_tr_b16 a[148:149], v21 offset:28672
    ds_read_b64_tr_b16 a[150:151], v21 offset:29696
    s_waitcnt vmcnt(24) lgkmcnt(0)
    s_barrier
    s_mov_b32 m0, 122880
    s_mov_b32 s70, 123136
    buffer_load_dwordx4 v33, s[24:27], s70 offen lds
    s_mov_b32 m0, 123904
    s_mov_b32 s70, 125696
    buffer_load_dwordx4 v33, s[24:27], s70 offen lds
    s_mov_b32 m0, 124928
    s_mov_b32 s70, 143616
    buffer_load_dwordx4 v35, s[24:27], s70 offen lds
    s_mov_b32 m0, 125952
    s_mov_b32 s70, 146176
    buffer_load_dwordx4 v35, s[24:27], s70 offen lds
    ds_read_b64_tr_b16 a[24:25], v16 offset:0
    ds_read_b64_tr_b16 a[26:27], v16 offset:1024
    ds_read_b64_tr_b16 a[28:29], v20 offset:0
    ds_read_b64_tr_b16 a[30:31], v20 offset:1024
    ds_read_b64_tr_b16 a[32:33], v17 offset:0
    ds_read_b64_tr_b16 a[34:35], v17 offset:1024
    ds_read_b64_tr_b16 a[36:37], v21 offset:0
    ds_read_b64_tr_b16 a[38:39], v21 offset:1024
    s_waitcnt vmcnt(24) lgkmcnt(0)
    s_barrier
    s_mov_b32 m0, 94208
    s_mov_b32 s70, 262144
    buffer_load_dwordx4 v32, s[16:19], s70 offen lds
    s_mov_b32 m0, 95232
    s_mov_b32 s70, 278528
    buffer_load_dwordx4 v32, s[16:19], s70 offen lds
    s_mov_b32 m0, 96256
    s_mov_b32 s70, 294912
    buffer_load_dwordx4 v34, s[16:19], s70 offen lds
    s_mov_b32 m0, 97280
    s_mov_b32 s70, 311296
    buffer_load_dwordx4 v34, s[16:19], s70 offen lds
    ds_read_b64_tr_b16 a[40:41], v16 offset:4096
    ds_read_b64_tr_b16 a[42:43], v16 offset:5120
    ds_read_b64_tr_b16 a[44:45], v20 offset:4096
    ds_read_b64_tr_b16 a[46:47], v20 offset:5120
    ds_read_b64_tr_b16 a[48:49], v17 offset:4096
    ds_read_b64_tr_b16 a[50:51], v17 offset:5120
    ds_read_b64_tr_b16 a[52:53], v21 offset:4096
    ds_read_b64_tr_b16 a[54:55], v21 offset:5120
    s_waitcnt vmcnt(24) lgkmcnt(0)
    s_barrier
    s_mov_b32 m0, 98304
    s_mov_b32 s70, 1310720
    buffer_load_dwordx4 v32, s[16:19], s70 offen lds
    s_mov_b32 m0, 99328
    s_mov_b32 s70, 1327104
    buffer_load_dwordx4 v32, s[16:19], s70 offen lds
    s_mov_b32 m0, 100352
    s_mov_b32 s70, 1343488
    buffer_load_dwordx4 v34, s[16:19], s70 offen lds
    s_mov_b32 m0, 101376
    s_mov_b32 s70, 1359872
    buffer_load_dwordx4 v34, s[16:19], s70 offen lds
    ds_read_b64_tr_b16 a[152:153], v16 offset:8192
    ds_read_b64_tr_b16 a[154:155], v16 offset:9216
    ds_read_b64_tr_b16 a[156:157], v20 offset:8192
    ds_read_b64_tr_b16 a[158:159], v20 offset:9216
    ds_read_b64_tr_b16 a[160:161], v17 offset:8192
    ds_read_b64_tr_b16 a[162:163], v17 offset:9216
    ds_read_b64_tr_b16 a[164:165], v21 offset:8192
    ds_read_b64_tr_b16 a[166:167], v21 offset:9216
    s_waitcnt vmcnt(24) lgkmcnt(0)
    s_barrier
    s_mov_b32 m0, 102400
    s_mov_b32 s70, 1835008
    buffer_load_dwordx4 v32, s[16:19], s70 offen lds
    s_mov_b32 m0, 103424
    s_mov_b32 s70, 1851392
    buffer_load_dwordx4 v32, s[16:19], s70 offen lds
    s_mov_b32 m0, 104448
    s_mov_b32 s70, 1867776
    buffer_load_dwordx4 v34, s[16:19], s70 offen lds
    s_mov_b32 m0, 105472
    s_mov_b32 s70, 1884160
    buffer_load_dwordx4 v34, s[16:19], s70 offen lds
    ds_read_b64_tr_b16 a[168:169], v16 offset:12288
    ds_read_b64_tr_b16 a[170:171], v16 offset:13312
    ds_read_b64_tr_b16 a[172:173], v20 offset:12288
    ds_read_b64_tr_b16 a[174:175], v20 offset:13312
    ds_read_b64_tr_b16 a[176:177], v17 offset:12288
    ds_read_b64_tr_b16 a[178:179], v17 offset:13312
    ds_read_b64_tr_b16 a[180:181], v21 offset:12288
    ds_read_b64_tr_b16 a[182:183], v21 offset:13312
    s_waitcnt vmcnt(24) lgkmcnt(0)
    s_barrier
    s_mov_b32 m0, 106496
    s_mov_b32 s70, 3407872
    buffer_load_dwordx4 v32, s[16:19], s70 offen lds
    s_mov_b32 m0, 107520
    s_mov_b32 s70, 3424256
    buffer_load_dwordx4 v32, s[16:19], s70 offen lds
    s_mov_b32 m0, 108544
    s_mov_b32 s70, 3440640
    buffer_load_dwordx4 v34, s[16:19], s70 offen lds
    s_mov_b32 m0, 109568
    s_mov_b32 s70, 3457024
    buffer_load_dwordx4 v34, s[16:19], s70 offen lds
    ds_read_b64_tr_b16 a[184:185], v18 offset:16384
    ds_read_b64_tr_b16 a[186:187], v18 offset:17408
    ds_read_b64_tr_b16 a[188:189], v22 offset:16384
    ds_read_b64_tr_b16 a[190:191], v22 offset:17408
    ds_read_b64_tr_b16 a[192:193], v19 offset:16384
    ds_read_b64_tr_b16 a[194:195], v19 offset:17408
    ds_read_b64_tr_b16 a[196:197], v23 offset:16384
    ds_read_b64_tr_b16 a[198:199], v23 offset:17408
    s_waitcnt vmcnt(24) lgkmcnt(0)
    s_barrier
    s_mov_b32 m0, 110592
    s_mov_b32 s70, 4456448
    buffer_load_dwordx4 v32, s[16:19], s70 offen lds
    s_mov_b32 m0, 111616
    s_mov_b32 s70, 4472832
    buffer_load_dwordx4 v32, s[16:19], s70 offen lds
    s_mov_b32 m0, 112640
    s_mov_b32 s70, 4489216
    buffer_load_dwordx4 v34, s[16:19], s70 offen lds
    s_mov_b32 m0, 113664
    s_mov_b32 s70, 4505600
    buffer_load_dwordx4 v34, s[16:19], s70 offen lds
    ds_read_b64_tr_b16 a[224:225], v18 offset:20480
    ds_read_b64_tr_b16 a[226:227], v18 offset:21504
    ds_read_b64_tr_b16 a[228:229], v22 offset:20480
    ds_read_b64_tr_b16 a[230:231], v22 offset:21504
    ds_read_b64_tr_b16 a[232:233], v19 offset:20480
    ds_read_b64_tr_b16 a[234:235], v19 offset:21504
    ds_read_b64_tr_b16 a[236:237], v23 offset:20480
    ds_read_b64_tr_b16 a[238:239], v23 offset:21504
    s_waitcnt vmcnt(24) lgkmcnt(0)
    s_barrier
    s_mov_b32 m0, 114688
    s_mov_b32 s70, 123392
    buffer_load_dwordx4 v33, s[24:27], s70 offen lds
    s_mov_b32 m0, 115712
    s_mov_b32 s70, 125952
    buffer_load_dwordx4 v33, s[24:27], s70 offen lds
    s_mov_b32 m0, 116736
    s_mov_b32 s70, 143872
    buffer_load_dwordx4 v35, s[24:27], s70 offen lds
    s_mov_b32 m0, 117760
    s_mov_b32 s70, 146432
    buffer_load_dwordx4 v35, s[24:27], s70 offen lds
    ds_read_b64_tr_b16 a[240:241], v18 offset:24576
    ds_read_b64_tr_b16 a[242:243], v18 offset:25600
    ds_read_b64_tr_b16 a[244:245], v22 offset:24576
    ds_read_b64_tr_b16 a[246:247], v22 offset:25600
    ds_read_b64_tr_b16 a[248:249], v19 offset:24576
    ds_read_b64_tr_b16 a[250:251], v19 offset:25600
    ds_read_b64_tr_b16 a[252:253], v23 offset:24576
    ds_read_b64_tr_b16 a[254:255], v23 offset:25600
    s_waitcnt vmcnt(24) lgkmcnt(0)
    s_barrier
    s_mov_b32 m0, 118784
    s_mov_b32 s70, 123648
    buffer_load_dwordx4 v33, s[24:27], s70 offen lds
    s_mov_b32 m0, 119808
    s_mov_b32 s70, 126208
    buffer_load_dwordx4 v33, s[24:27], s70 offen lds
    s_mov_b32 m0, 120832
    s_mov_b32 s70, 144128
    buffer_load_dwordx4 v35, s[24:27], s70 offen lds
    s_mov_b32 m0, 121856
    s_mov_b32 s70, 146688
    buffer_load_dwordx4 v35, s[24:27], s70 offen lds
    ds_read_b64_tr_b16 a[200:201], v18 offset:28672
    ds_read_b64_tr_b16 a[202:203], v18 offset:29696
    ds_read_b64_tr_b16 a[204:205], v22 offset:28672
    ds_read_b64_tr_b16 a[206:207], v22 offset:29696
    ds_read_b64_tr_b16 a[208:209], v19 offset:28672
    ds_read_b64_tr_b16 a[210:211], v19 offset:29696
    ds_read_b64_tr_b16 a[212:213], v23 offset:28672
    ds_read_b64_tr_b16 a[214:215], v23 offset:29696
    s_waitcnt vmcnt(24) lgkmcnt(0)
    s_barrier
    s_mov_b32 m0, 122880
    s_mov_b32 s70, 123904
    buffer_load_dwordx4 v33, s[24:27], s70 offen lds
    s_mov_b32 m0, 123904
    s_mov_b32 s70, 126464
    buffer_load_dwordx4 v33, s[24:27], s70 offen lds
    s_mov_b32 m0, 124928
    s_mov_b32 s70, 144384
    buffer_load_dwordx4 v35, s[24:27], s70 offen lds
    s_mov_b32 m0, 125952
    s_mov_b32 s70, 146944
    buffer_load_dwordx4 v35, s[24:27], s70 offen lds
    ds_read_b64_tr_b16 v[40:41], v16 offset:0
    ds_read_b64_tr_b16 v[42:43], v16 offset:1024
    ds_read_b64_tr_b16 v[44:45], v20 offset:0
    ds_read_b64_tr_b16 v[46:47], v20 offset:1024
    ds_read_b64_tr_b16 v[48:49], v17 offset:0
    ds_read_b64_tr_b16 v[50:51], v17 offset:1024
    ds_read_b64_tr_b16 v[52:53], v21 offset:0
    ds_read_b64_tr_b16 v[54:55], v21 offset:1024
    v_lshrrev_b32 v24, 4, v0
    v_bfe_u32 v25, v24, 2, 2
    v_lshlrev_b32 v25, 1, v25
    v_and_b32 v26, 1, v24
    v_add_u32 v25, v25, v26
    v_mul_u32_u24 v25, 1280, v25
    v_lshrrev_b32 v26, 4, v24
    v_lshl_add_u32 v25, v26, 5, v25
    v_bfe_u32 v26, v24, 1, 1
    v_lshl_add_u32 v25, v26, 4, v25
    buffer_load_dwordx4 v[8:11], v25, s[32:35], 0 offen offset:768
    buffer_load_dwordx4 v[12:15], v25, s[32:35], 0 offen offset:896
    v_and_b32 v26, 7, v24
    v_min_u32 v27, 1, v26
    v_lshlrev_b32 v26, 2, v26
    v_lshl_add_u32 v26, v27, 7, v26
    buffer_load_dword v72, off, s[48:51], 0 offset:32 sc1
    buffer_load_dword v73, v26, s[48:51], 0 offen sc1
    v_lshlrev_b32 v24, 3, v0
    buffer_load_dwordx4 v[28:31], v0, s[8:11], s59 offen offset:0 sc1
    buffer_load_dwordx4 v[28:31], v0, s[8:11], s59 offen offset:1024 sc1
    s_add_u32 s70, s56, 10240
    buffer_load_dword v74, v24, s[8:11], s70 offen sc1
    s_waitcnt vmcnt(31) lgkmcnt(0)
    s_barrier
    ds_write_b128 v7, v[40:43] offset:0
    ds_write_b128 v7, v[44:47] offset:1024
    ds_write_b128 v7, v[48:51] offset:2048
    ds_write_b128 v7, v[52:55] offset:3072
    ds_read_b64_tr_b16 v[56:57], v16 offset:4096
    ds_read_b64_tr_b16 v[58:59], v16 offset:5120
    ds_read_b64_tr_b16 v[60:61], v20 offset:4096
    ds_read_b64_tr_b16 v[62:63], v20 offset:5120
    ds_read_b64_tr_b16 v[64:65], v17 offset:4096
    ds_read_b64_tr_b16 v[66:67], v17 offset:5120
    ds_read_b64_tr_b16 v[68:69], v21 offset:4096
    ds_read_b64_tr_b16 v[70:71], v21 offset:5120
    s_waitcnt vmcnt(27) lgkmcnt(0)
    s_barrier
    ds_write_b128 v7, v[56:59] offset:4096
    ds_write_b128 v7, v[60:63] offset:5120
    ds_write_b128 v7, v[64:67] offset:6144
    ds_write_b128 v7, v[68:71] offset:7168
    ds_read_b64_tr_b16 v[40:41], v16 offset:8192
    ds_read_b64_tr_b16 v[42:43], v16 offset:9216
    ds_read_b64_tr_b16 v[44:45], v20 offset:8192
    ds_read_b64_tr_b16 v[46:47], v20 offset:9216
    ds_read_b64_tr_b16 v[48:49], v17 offset:8192
    ds_read_b64_tr_b16 v[50:51], v17 offset:9216
    ds_read_b64_tr_b16 v[52:53], v21 offset:8192
    ds_read_b64_tr_b16 v[54:55], v21 offset:9216
    s_waitcnt vmcnt(23) lgkmcnt(0)
    s_barrier
    ds_write_b128 v7, v[40:43] offset:8192
    ds_write_b128 v7, v[44:47] offset:9216
    ds_write_b128 v7, v[48:51] offset:10240
    ds_write_b128 v7, v[52:55] offset:11264
    ds_read_b64_tr_b16 v[56:57], v16 offset:12288
    ds_read_b64_tr_b16 v[58:59], v16 offset:13312
    ds_read_b64_tr_b16 v[60:61], v20 offset:12288
    ds_read_b64_tr_b16 v[62:63], v20 offset:13312
    ds_read_b64_tr_b16 v[64:65], v17 offset:12288
    ds_read_b64_tr_b16 v[66:67], v17 offset:13312
    ds_read_b64_tr_b16 v[68:69], v21 offset:12288
    ds_read_b64_tr_b16 v[70:71], v21 offset:13312
    s_waitcnt vmcnt(19) lgkmcnt(0)
    s_barrier
    ds_write_b128 v7, v[56:59] offset:12288
    ds_write_b128 v7, v[60:63] offset:13312
    ds_write_b128 v7, v[64:67] offset:14336
    ds_write_b128 v7, v[68:71] offset:15360
    ds_read_b64_tr_b16 v[40:41], v16 offset:16384
    ds_read_b64_tr_b16 v[42:43], v16 offset:17408
    ds_read_b64_tr_b16 v[44:45], v20 offset:16384
    ds_read_b64_tr_b16 v[46:47], v20 offset:17408
    ds_read_b64_tr_b16 v[48:49], v17 offset:16384
    ds_read_b64_tr_b16 v[50:51], v17 offset:17408
    ds_read_b64_tr_b16 v[52:53], v21 offset:16384
    ds_read_b64_tr_b16 v[54:55], v21 offset:17408
    s_waitcnt vmcnt(15) lgkmcnt(0)
    s_barrier
    ds_write_b128 v7, v[40:43] offset:16384
    ds_write_b128 v7, v[44:47] offset:17408
    ds_write_b128 v7, v[48:51] offset:18432
    ds_write_b128 v7, v[52:55] offset:19456
    ds_read_b64_tr_b16 v[56:57], v18 offset:20480
    ds_read_b64_tr_b16 v[58:59], v18 offset:21504
    ds_read_b64_tr_b16 v[60:61], v22 offset:20480
    ds_read_b64_tr_b16 v[62:63], v22 offset:21504
    ds_read_b64_tr_b16 v[64:65], v19 offset:20480
    ds_read_b64_tr_b16 v[66:67], v19 offset:21504
    ds_read_b64_tr_b16 v[68:69], v23 offset:20480
    ds_read_b64_tr_b16 v[70:71], v23 offset:21504
    s_waitcnt vmcnt(11) lgkmcnt(0)
    s_barrier
    ds_write_b128 v7, v[56:59] offset:20480
    ds_write_b128 v7, v[60:63] offset:21504
    ds_write_b128 v7, v[64:67] offset:22528
    ds_write_b128 v7, v[68:71] offset:23552
    ds_read_b64_tr_b16 v[40:41], v18 offset:24576
    ds_read_b64_tr_b16 v[42:43], v18 offset:25600
    ds_read_b64_tr_b16 v[44:45], v22 offset:24576
    ds_read_b64_tr_b16 v[46:47], v22 offset:25600
    ds_read_b64_tr_b16 v[48:49], v19 offset:24576
    ds_read_b64_tr_b16 v[50:51], v19 offset:25600
    ds_read_b64_tr_b16 v[52:53], v23 offset:24576
    ds_read_b64_tr_b16 v[54:55], v23 offset:25600
    s_waitcnt vmcnt(7) lgkmcnt(0)
    s_barrier
    ds_write_b128 v7, v[40:43] offset:24576
    ds_write_b128 v7, v[44:47] offset:25600
    ds_write_b128 v7, v[48:51] offset:26624
    ds_write_b128 v7, v[52:55] offset:27648
    ds_read_b64_tr_b16 v[56:57], v18 offset:28672
    ds_read_b64_tr_b16 v[58:59], v18 offset:29696
    ds_read_b64_tr_b16 v[60:61], v22 offset:28672
    ds_read_b64_tr_b16 v[62:63], v22 offset:29696
    ds_read_b64_tr_b16 v[64:65], v19 offset:28672
    ds_read_b64_tr_b16 v[66:67], v19 offset:29696
    ds_read_b64_tr_b16 v[68:69], v23 offset:28672
    ds_read_b64_tr_b16 v[70:71], v23 offset:29696
    s_waitcnt vmcnt(0)
    s_lshl_b32 s71, s53, 7
    s_add_u32 s71, s71, 24584
    buffer_load_dword v75, off, s[8:11], s71 sc1
    s_waitcnt lgkmcnt(0)
    s_barrier
    ds_write_b128 v7, v[56:59] offset:28672
    ds_write_b128 v7, v[60:63] offset:29696
    ds_write_b128 v7, v[64:67] offset:30720
    ds_write_b128 v7, v[68:71] offset:31744
    s_waitcnt vmcnt(0) lgkmcnt(0)
    v_readfirstlane_b32 s70, v72
    v_cmp_ne_u32 vcc, 32, v73
    s_cmp_ge_u32 s70, 256
    s_cselect_b32 s70, vcc_lo, 1
    s_cmp_eq_u32 s70, 0
    s_cbranch_scc1 CH2_rdy
    s_cmp_lg_u32 s96, 0
    s_cbranch_scc1 RDY_ok_86
    s_mov_b32 s68, 0
RDY_lp_87:
    buffer_load_dword v40, off, s[48:51], 0 offset:32 sc1
    s_waitcnt vmcnt(0)
    v_readfirstlane_b32 s70, v40
    s_nop 0
    s_cmp_ge_u32 s70, 256
    s_cbranch_scc1 RDY_all_88
    s_sleep 8
    s_add_u32 s68, s68, 1
    s_cmp_lt_u32 s68, 65536
    s_cbranch_scc1 RDY_lp_87
    s_branch RDY_ok_86
RDY_all_88:
    v_mbcnt_lo_u32_b32 v41, -1, 0
    v_and_b32 v41, 7, v41
    v_min_u32 v42, 1, v41
    v_lshlrev_b32 v41, 2, v41
    v_lshl_add_u32 v41, v42, 7, v41
    buffer_load_dword v40, v41, s[48:51], 0 offen sc1
    s_waitcnt vmcnt(0)
    v_cmp_ne_u32 vcc, 32, v40
    s_nop 0
    s_cbranch_vccnz L_slow
RDY_ok_86:
    v_mov_b32 v75, 0
CH2_rdy:
    s_mov_b32 s40, 0x3f803f80
    s_mov_b32 s41, 0x3f803f80
    ds_write_b128 v0, v[12:15] offset:7168
    v_mov_b64 v[36:37], v[12:13]
    v_mov_b64 v[38:39], v[14:15]
    ds_write_b128 v0, v[8:11] offset:6144
    v_mov_b64 v[32:33], v[8:9]
    v_mov_b64 v[34:35], v[10:11]
    s_lshl_b32 s71, s53, 7
    s_add_u32 s71, s71, 24584
    s_mov_b32 s68, 0
    v_readfirstlane_b32 s70, v75
    s_nop 0
    s_cmp_lg_u32 s70, 0
    s_cbranch_scc1 CH2_sok
CH2_sw:
    buffer_load_dword v72, off, s[8:11], s71 sc1
    s_waitcnt vmcnt(0)
    v_readfirstlane_b32 s70, v72
    s_nop 0
    s_cmp_lg_u32 s70, 0
    s_cbranch_scc1 CH2_sok
    s_sleep 2
    s_add_u32 s68, s68, 1
    s_cmp_lt_u32 s68, 65536
    s_cbranch_scc1 CH2_sw
CH2_sok:
    buffer_load_dwordx4 v[40:43], v0, s[8:11], s61 offen offset:2048
    buffer_load_dwordx4 v[44:47], v0, s[8:11], s61 offen offset:3072
    buffer_load_dwordx4 v[72:75], v0, s[8:11], s61 offen offset:0
    buffer_load_dwordx4 v[76:79], v0, s[8:11], s61 offen offset:1024
    ds_read_b128 v[56:59], v7 offset:12288
    ds_read_b128 v[60:63], v7 offset:13312
    ds_read_b128 v[64:67], v7 offset:14336
    ds_read_b128 v[68:71], v7 offset:15360
    buffer_load_dwordx4 v[48:51], v0, s[8:11], s3 offen offset:0
    buffer_load_dwordx4 v[52:55], v0, s[8:11], s3 offen offset:1024
    s_waitcnt lgkmcnt(0)
    v_mov_b64 v[8:9], 0
    v_mov_b64 v[10:11], 0
    v_mov_b64 v[12:13], 0
    v_mov_b64 v[14:15], 0
    v_mov_b64 v[16:17], 0
    v_mov_b64 v[18:19], 0
    v_mov_b64 v[20:21], 0
    v_mov_b64 v[22:23], 0
    s_cmp_lg_u32 s96, 0
    s_cbranch_scc1 CHS2_start
CHF2_start:
    s_barrier
    s_mov_b32 m0, 20480
    s_nop 0
    buffer_load_dwordx4 v0, s[8:11], s63 offen offset:0 sc1 lds
    buffer_load_dwordx4 v0, s[8:11], s63 offen offset:1024 sc1 lds
    s_add_u32 s63, s63, 262144
    s_waitcnt vmcnt(0) lgkmcnt(0)
CHF2_loop:
    s_barrier
    ds_read_b128 v[28:31], v0 offset:2048
    v_mov_b32 v23, 0
    v_smfmac_f32_16x16x64_bf16 v[8:11], v[32:35], v[40:47], v1
    buffer_load_dwordx4 v[40:43], v0, s[8:11], s3 offen offset:2048
    v_smfmac_f32_16x16x64_bf16 v[12:15], v[32:35], v[72:79], v1
    buffer_load_dwordx4 v[44:47], v0, s[8:11], s3 offen offset:3072
    v_smfmac_f32_16x16x64_bf16 v[16:19], v[32:35], v[56:63], v1
    buffer_load_dwordx4 v[72:75], v0, s[8:11], s5 offen offset:0
    v_smfmac_f32_16x16x64_bf16 v[20:23], v[32:35], v[64:71], v1
    ds_read_b128 v[32:35], v0 offset:1024
    buffer_load_dwordx4 v[76:79], v0, s[8:11], s5 offen offset:1024
    v_smfmac_f32_16x16x64_bf16 v[8:11], v[36:39], v[48:55], v1
    ds_read_b128 v[56:59], v7 offset:4096
    v_smfmac_f32_16x16x64_bf16 v[12:15], v[36:39], v[80:87], v1
    ds_read_b128 v[60:63], v7 offset:5120
    ds_read_b128 v[64:67], v7 offset:6144
    v_smfmac_f32_16x16x64_bf16 v[16:19], v[36:39], v[88:95], v1
    ds_read_b128 v[68:71], v7 offset:7168
    buffer_load_dwordx4 v[48:51], v0, s[8:11], s62 offen offset:0 sc1
    v_smfmac_f32_16x16x64_bf16 v[20:23], v[36:39], v[96:103], v1
    ds_read_b128 v[36:39], v0 offset:0
    s_waitcnt lgkmcnt(6)
    v_smfmac_f32_16x16x64_bf16 v[8:11], v[28:31], v[104:111], v1
    buffer_load_dwordx4 v[52:55], v0, s[8:11], s62 offen offset:1024 sc1
    v_smfmac_f32_16x16x64_bf16 v[12:15], v[28:31], v[112:119], v1
    buffer_store_dwordx4 v[24:27], v0, s[8:11], s64 offen sc1
    s_waitcnt lgkmcnt(1)
    v_smfmac_f32_16x16x64_bf16 v[16:19], v[28:31], v[56:63], v1
    ds_read_b128 v[24:27], v0 offset:4096
    ds_read_b128 v[56:59], v7 offset:0
    v_smfmac_f32_16x16x64_bf16 v[20:23], v[28:31], v[64:71], v1
    ds_read_b128 v[28:31], v0 offset:3072
    ds_read_b128 v[60:63], v7 offset:1024
    v_smfmac_f32_16x16x64_bf16 v[8:11], v[32:35], v[120:127], v1
    ds_read_b128 v[64:67], v7 offset:2048
    v_smfmac_f32_16x16x64_bf16 v[12:15], v[32:35], v[128:135], v1
    ds_read_b128 v[68:71], v7 offset:3072
    v_smfmac_f32_16x16x64_bf16 v[16:19], v[32:35], v[136:143], v1
    v_smfmac_f32_16x16x64_bf16 v[20:23], v[32:35], v[144:151], v1
    ds_read_b128 v[32:35], v0 offset:8192
    s_waitcnt lgkmcnt(7)
    v_smfmac_f32_16x16x64_bf16 v[8:11], v[36:39], v[152:159], v1
    v_smfmac_f32_16x16x64_bf16 v[12:15], v[36:39], v[160:167], v1
    s_waitcnt lgkmcnt(1)
    v_smfmac_f32_16x16x64_bf16 v[16:19], v[36:39], v[56:63], v1
    ds_read_b128 v[56:59], v7 offset:8192
    v_smfmac_f32_16x16x64_bf16 v[20:23], v[36:39], v[64:71], v1
    ds_read_b128 v[36:39], v0 offset:9216
    ds_read_b128 v[60:63], v7 offset:9216
    v_smfmac_f32_16x16x64_bf16 v[8:11], v[24:27], v[168:175], v1
    ds_read_b128 v[64:67], v7 offset:10240
    v_smfmac_f32_16x16x64_bf16 v[12:15], v[24:27], v[176:183], v1
    ds_read_b128 v[68:71], v7 offset:11264
    v_smfmac_f32_16x16x64_bf16 v[16:19], v[24:27], v[184:191], v1
    v_smfmac_f32_16x16x64_bf16 v[20:23], v[24:27], v[192:199], v1
    ds_read_b128 v[24:27], v0 offset:5120
    s_waitcnt vmcnt(5)
    v_smfmac_f32_16x16x64_bf16 v[8:11], v[28:31], v[40:47], v1
    v_smfmac_f32_16x16x64_bf16 v[12:15], v[28:31], v[200:207], v1
    s_waitcnt lgkmcnt(1)
    v_smfmac_f32_16x16x64_bf16 v[16:19], v[28:31], v[56:63], v1
    ds_read_b128 v[56:59], v7 offset:16384
    v_smfmac_f32_16x16x64_bf16 v[20:23], v[28:31], v[64:71], v1
    ds_read_b128 v[60:63], v7 offset:17408
    s_waitcnt lgkmcnt(2)
    s_waitcnt vmcnt(3)
    v_smfmac_f32_16x16x64_bf16 v[8:11], v[24:27], v[72:79], v1
    ds_read_b128 v[64:67], v7 offset:18432
    v_mov_b64 v[28:29], 0
    v_smfmac_f32_16x16x64_bf16 v[12:15], v[24:27], v[208:215], v1
    ds_read_b128 v[68:71], v7 offset:19456
    v_mov_b64 v[30:31], 0
    v_smfmac_f32_16x16x64_bf16 v[16:19], v[24:27], v[216:223], v1
    ds_read_b128 v[40:43], v0 offset:16384
    v_smfmac_f32_16x16x64_bf16 v[20:23], v[24:27], v[224:231], v1
    ds_read_b128 v[44:47], v0 offset:20480
    v_smfmac_f32_16x16x64_bf16 v[8:11], v[32:35], v[232:239], v1
    v_mov_b64 v[24:25], 0
    v_smfmac_f32_16x16x64_bf16 v[12:15], v[32:35], v[240:247], v1
    v_mov_b64 v[26:27], 0
    s_waitcnt lgkmcnt(2)
    v_smfmac_f32_16x16x64_bf16 v[16:19], v[32:35], v[56:63], v1
    v_smfmac_f32_16x16x64_bf16 v[20:23], v[32:35], v[64:71], v1
    v_smfmac_f32_16x16x64_bf16 v[8:11], v[36:39], v[248:255], v1
    ds_read_b128 v[72:75], v0 offset:17408
    v_smfmac_f32_16x16x64_bf16 v[12:15], v[36:39], a[0:7], v1
    ds_read_b128 v[76:79], v0 offset:21504
    v_smfmac_f32_16x16x64_bf16 v[16:19], v[36:39], a[8:15], v1
    v_smfmac_f32_16x16x64_bf16 v[20:23], v[36:39], a[16:23], v1
    v_smfmac_f32_16x16x64_bf16 v[24:27], v[36:39], a[168:175], v1
    s_nop 1
    v_add_f32 v8, v8, v10
    v_add_f32 v9, v9, v11
    v_add_f32 v12, v12, v14
    v_add_f32 v13, v13, v15
    v_mul_f32 v8, s79, v8
    v_mul_f32 v12, s79, v12
    v_mul_f32 v9, s79, v9
    v_mul_f32 v13, s79, v13
    v_cvt_pk_bf16_f32 v10, v8, v12
    v_cvt_pk_bf16_f32 v11, v9, v13
    ds_write2_b32 v5, v10, v11 offset0:0 offset1:4
    v_add_f32 v16, v16, v18
    v_add_f32 v17, v17, v19
    v_add_f32 v20, v20, v22
    v_add_f32 v21, v21, v23
    v_cvt_pk_bf16_f32 v18, v16, v20
    v_cvt_pk_bf16_f32 v19, v17, v21
    ds_write2_b32 v3, v18, v19 offset0:0 offset1:4
    v_smfmac_f32_16x16x64_bf16 v[28:31], v[36:39], a[176:183], v1
    ds_read_b128 v[36:39], v0 offset:6144
    v_smfmac_f32_16x16x64_bf16 v[24:27], v[32:35], a[152:159], v1
    v_smfmac_f32_16x16x64_bf16 v[28:31], v[32:35], a[160:167], v1
    ds_read_b128 v[32:35], v0 offset:7168
    s_waitcnt lgkmcnt(2)
    s_barrier
    ds_read_b128 v[56:59], v6 offset:10240
    ds_read_b128 v[60:63], v6 offset:10752
    ds_read_b128 v[20:23], v6 offset:12288
    ds_read_b128 v[64:67], v6 offset:11264
    ds_read_b128 v[68:71], v6 offset:11776
    s_waitcnt lgkmcnt(6)
    v_smfmac_f32_16x16x64_bf16 v[24:27], v[36:39], a[24:31], v1
    v_smfmac_f32_16x16x64_bf16 v[28:31], v[36:39], a[32:39], v1
    ds_read_b128 v[36:39], v0 offset:2048
    s_waitcnt lgkmcnt(6)
    v_smfmac_f32_16x16x64_bf16 v[24:27], v[32:35], a[40:47], v1
    v_smfmac_f32_16x16x64_bf16 v[28:31], v[32:35], a[48:55], v1
    ds_read_b128 v[32:35], v0 offset:1024
    s_waitcnt lgkmcnt(6)
    v_mfma_f32_16x16x32_bf16 v[12:15], v[40:43], v[56:59], 0
    ds_read_b128 v[40:43], v6 offset:12800
    v_mfma_f32_16x16x32_bf16 v[16:19], v[44:47], v[56:59], 0
    ds_read_b128 v[44:47], v0 offset:18432
    s_waitcnt lgkmcnt(7)
    v_mfma_f32_16x16x32_bf16 v[12:15], v[72:75], v[60:63], v[12:15]
    ds_read_b128 v[72:75], v0 offset:22528
    v_mfma_f32_16x16x32_bf16 v[16:19], v[76:79], v[60:63], v[16:19]
    ds_read_b128 v[76:79], v6 offset:13312
    s_waitcnt lgkmcnt(8)
    v_mfma_f32_16x16x32_bf16 v[8:11], v[20:23], v[56:59], 0
    ds_read_b128 v[20:23], v6 offset:13824
    s_waitcnt lgkmcnt(4)
    v_mfma_f32_16x16x32_bf16 v[8:11], v[40:43], v[60:63], v[8:11]
    ds_read_b128 v[40:43], v0 offset:19456
    s_waitcnt lgkmcnt(4)
    v_mfma_f32_16x16x32_bf16 v[12:15], v[44:47], v[64:67], v[12:15]
    ds_read_b128 v[44:47], v0 offset:23552
    s_waitcnt lgkmcnt(4)
    v_mfma_f32_16x16x32_bf16 v[16:19], v[72:75], v[64:67], v[16:19]
    s_waitcnt lgkmcnt(3)
    v_mfma_f32_16x16x32_bf16 v[8:11], v[76:79], v[64:67], v[8:11]
    s_waitcnt lgkmcnt(2)
    v_mfma_f32_16x16x32_bf16 v[8:11], v[20:23], v[68:71], v[8:11]
    s_waitcnt lgkmcnt(1)
    v_mfma_f32_16x16x32_bf16 v[12:15], v[40:43], v[68:71], v[12:15]
    s_waitcnt lgkmcnt(0)
    v_mfma_f32_16x16x32_bf16 v[16:19], v[44:47], v[68:71], v[16:19]
    v_smfmac_f32_16x16x64_bf16 v[24:27], v[36:39], a[56:63], v1
    buffer_load_dwordx4 v[72:75], v0, s[8:11], s5 offen offset:2048
    v_smfmac_f32_16x16x64_bf16 v[28:31], v[36:39], a[64:71], v1
    ds_read_b128 v[36:39], v0 offset:0
    buffer_load_dwordx4 v[76:79], v0, s[8:11], s5 offen offset:3072
    s_nop 0
    v_max3_f32 v10, v8, v9, v12
    v_max3_f32 v11, v13, v14, v15
    v_max3_f32 v10, v10, v16, v17
    v_max3_f32 v11, v11, v18, v19
    v_max_f32 v10, v10, v11
    v_max_f32 v11, v10, v11
    v_smfmac_f32_16x16x64_bf16 v[24:27], v[32:35], a[72:79], v1
    buffer_load_dwordx4 v[40:43], v0, s[8:11], s6 offen offset:0
    v_permlane32_swap_b32 v11, v10
    v_max_f32 v10, v10, v11
    v_max_f32 v11, v10, v11
    v_smfmac_f32_16x16x64_bf16 v[28:31], v[32:35], a[80:87], v1
    ds_read_b128 v[32:35], v0 offset:4096
    v_permlane16_swap_b32 v11, v10
    v_max_f32 v10, v10, v11
    v_sub_f32 v12, v12, v10
    s_waitcnt lgkmcnt(1)
    v_smfmac_f32_16x16x64_bf16 v[24:27], v[36:39], a[88:95], v1
    v_sub_f32 v13, v13, v10
    v_exp_f32 v12, v12
    v_smfmac_f32_16x16x64_bf16 v[28:31], v[36:39], a[96:103], v1
    ds_read_b128 v[36:39], v0 offset:3072
    buffer_load_dwordx4 v[44:47], v0, s[8:11], s6 offen offset:1024
    v_sub_f32 v14, v14, v10
    v_exp_f32 v13, v13
    s_waitcnt lgkmcnt(1)
    v_smfmac_f32_16x16x64_bf16 v[24:27], v[32:35], a[104:111], v1
    v_sub_f32 v15, v15, v10
    v_exp_f32 v14, v14
    v_smfmac_f32_16x16x64_bf16 v[28:31], v[32:35], a[112:119], v1
    ds_read_b128 v[32:35], v0 offset:5120
    v_cvt_pk_bf16_f32 v20, v12, v13
    v_sub_f32 v16, v16, v10
    v_exp_f32 v15, v15
    s_waitcnt lgkmcnt(1)
    v_smfmac_f32_16x16x64_bf16 v[24:27], v[36:39], a[120:127], v1
    buffer_load_dwordx4 v[56:59], v0, s[8:11], s6 offen offset:2048
    v_sub_f32 v17, v17, v10
    v_exp_f32 v16, v16
    v_smfmac_f32_16x16x64_bf16 v[28:31], v[36:39], a[128:135], v1
    v_cvt_pk_bf16_f32 v21, v14, v15
    v_sub_f32 v18, v18, v10
    v_exp_f32 v17, v17
    s_waitcnt lgkmcnt(0)
    v_smfmac_f32_16x16x64_bf16 v[24:27], v[32:35], a[136:143], v1
    v_mov_b64 v[12:13], s[40:41]
    v_mov_b64 v[14:15], s[40:41]
    v_sub_f32 v19, v19, v10
    v_exp_f32 v18, v18
    v_smfmac_f32_16x16x64_bf16 v[28:31], v[32:35], a[144:151], v1
    buffer_load_dwordx4 v[60:63], v0, s[8:11], s6 offen offset:3072
    v_cvt_pk_bf16_f32 v22, v16, v17
    v_sub_f32 v8, v8, v10
    v_exp_f32 v19, v19
    v_sub_f32 v9, v9, v10
    v_exp_f32 v8, v8
    v_cvt_pk_bf16_f32 v23, v18, v19
    v_exp_f32 v9, v9
    v_mov_b32 v11, 0
    v_cvt_pk_bf16_f32 v10, v8, v9
    s_waitcnt vmcnt(7)
    v_mfma_f32_16x16x32_bf16 v[16:19], v[12:15], v[20:23], 0
    v_add_f32 v24, v24, v26
    v_add_f32 v25, v25, v27
    v_mfma_f32_16x16x32_bf16 v[32:35], v[48:51], v[20:23], 0
    v_add_f32 v28, v28, v30
    v_add_f32 v29, v29, v31
    v_mfma_f32_16x16x32_bf16 v[36:39], v[52:55], v[20:23], 0
    v_cvt_pk_bf16_f32 v26, v24, v25
    v_cvt_pk_bf16_f32 v27, v28, v29
    v_mfma_f32_16x16x16_bf16 v[16:19], v[12:13], v[10:11], v[16:19]
    v_cvt_pk_bf16_f32 v28, v28, v29
    v_mov_b32 v29, 0
    v_mfma_f32_16x16x16_bf16 v[32:35], v[26:27], v[10:11], v[32:35]
    buffer_load_dwordx4 v[64:67], v0, s[8:11], s7 offen offset:0
    buffer_load_dwordx4 v[68:71], v0, s[8:11], s7 offen offset:1024
    v_mfma_f32_16x16x16_bf16 v[36:39], v[28:29], v[10:11], v[36:39]
    buffer_load_dwordx4 v[48:51], v0, s[8:11], s7 offen offset:2048
    v_lshrrev_b32 v30, 1, v0
    ds_write_b64 v30, v[26:27] offset:15360
    v_rcp_f32 v8, v16
    v_mov_b64 v[12:13], 0
    v_mov_b64 v[14:15], 0
    v_mul_f32 v32, v32, v8
    v_mul_f32 v33, v33, v8
    v_cvt_pk_bf16_f32 v16, v32, v33
    v_mul_f32 v34, v34, v8
    v_mul_f32 v35, v35, v8
    v_cvt_pk_bf16_f32 v17, v34, v35
    v_mul_f32 v36, v36, v8
    v_mul_f32 v37, v37, v8
    v_cvt_pk_bf16_f32 v18, v36, v37
    v_mul_f32 v38, v38, v8
    v_mul_f32 v39, v39, v8
    v_cvt_pk_bf16_f32 v19, v38, v39
    ds_write_b128 v6, v[16:19] offset:17408
    buffer_load_dwordx4 v[52:55], v0, s[8:11], s7 offen offset:3072
    v_mov_b64 v[8:9], 0
    v_mov_b64 v[10:11], 0
    v_mov_b64 v[20:21], 0
    v_mov_b64 v[22:23], 0
    v_mov_b64 v[24:25], 0
    v_mov_b64 v[28:29], 0
    s_waitcnt lgkmcnt(0)
    s_barrier
    ds_read_b128 v[32:35], v0 offset:16384
    ds_read_b128 v[36:39], v0 offset:17408
    s_cmp_eq_u32 s55, 63
    s_cbranch_scc1 CHF2_last
    v_mov_b64 v[16:17], 0
    v_mov_b64 v[18:19], 0
    v_mov_b64 v[26:27], 0
    v_mov_b64 v[30:31], 0
    s_waitcnt lgkmcnt(1)
    v_smfmac_f32_16x16x64_bf16 v[8:11], v[32:35], a[184:191], v1
    v_smfmac_f32_16x16x64_bf16 v[12:15], v[32:35], a[192:199], v1
    s_waitcnt vmcnt(6) lgkmcnt(0)
    v_smfmac_f32_16x16x64_bf16 v[8:11], v[36:39], v[72:79], v1
    buffer_load_dwordx4 v[72:75], v0, s[8:11], s61 offen offset:0
    v_smfmac_f32_16x16x64_bf16 v[12:15], v[36:39], v[40:47], v1
    s_waitcnt vmcnt(3)
    v_smfmac_f32_16x16x64_bf16 v[16:19], v[32:35], v[56:63], v1
    ds_read_b128 v[56:59], v7 offset:20480
    ds_read_b128 v[60:63], v7 offset:21504
    buffer_load_dwordx4 v[76:79], v0, s[8:11], s61 offen offset:1024
    v_smfmac_f32_16x16x64_bf16 v[20:23], v[32:35], v[64:71], v1
    ds_read_b128 v[64:67], v7 offset:22528
    ds_read_b128 v[68:71], v7 offset:23552
    buffer_load_dwordx4 v[40:43], v0, s[8:11], s61 offen offset:2048
    v_add_f32 v8, v8, v10
    v_add_f32 v9, v9, v11
    v_cvt_pk_bf16_f32 v8, v8, v9
    v_smfmac_f32_16x16x64_bf16 v[16:19], v[36:39], a[200:207], v1
    v_and_or_b32 v8, v8, -2, s65
    v_add_f32 v12, v12, v14
    v_add_f32 v13, v13, v15
    v_smfmac_f32_16x16x64_bf16 v[20:23], v[36:39], a[208:215], v1
    buffer_load_dwordx4 v[44:47], v0, s[8:11], s61 offen offset:3072
    v_cvt_pk_bf16_f32 v9, v12, v13
    buffer_store_dwordx2 v[8:9], v4, s[8:11], s58 offen
    v_mov_b64 v[12:13], 0
    s_waitcnt vmcnt(5)
    v_smfmac_f32_16x16x64_bf16 v[24:27], v[32:35], a[216:223], v1
    v_mov_b64 v[14:15], 0
    v_mov_b64 v[10:11], 0
    v_mov_b64 v[8:9], 0
    v_smfmac_f32_16x16x64_bf16 v[28:31], v[32:35], v[48:55], v1
    buffer_load_dwordx4 v[48:51], v0, s[8:11], s3 offen offset:0
    v_add_f32 v16, v16, v18
    v_add_f32 v17, v17, v19
    v_cvt_pk_bf16_f32 v16, v16, v17
    s_waitcnt lgkmcnt(0)
    v_smfmac_f32_16x16x64_bf16 v[24:27], v[36:39], v[56:63], v1
    ds_read_b128 v[56:59], v7 offset:24576
    ds_read_b128 v[60:63], v7 offset:25600
    v_and_or_b32 v16, v16, -2, s65
    v_add_f32 v20, v20, v22
    v_add_f32 v21, v21, v23
    v_smfmac_f32_16x16x64_bf16 v[28:31], v[36:39], v[64:71], v1
    ds_read_b128 v[64:67], v7 offset:26624
    ds_read_b128 v[68:71], v7 offset:27648
    buffer_load_dwordx4 v[52:55], v0, s[8:11], s3 offen offset:1024
    v_cvt_pk_bf16_f32 v17, v20, v21
    buffer_store_dwordx2 v[16:17], v4, s[8:11], s75 offen
    v_mov_b64 v[20:21], 0
    v_smfmac_f32_16x16x64_bf16 v[8:11], v[32:35], a[224:231], v1
    v_mov_b64 v[22:23], 0
    v_mov_b64 v[18:19], 0
    v_mov_b64 v[16:17], 0
    v_smfmac_f32_16x16x64_bf16 v[12:15], v[32:35], a[232:239], v1
    v_add_f32 v24, v24, v26
    v_add_f32 v25, v25, v27
    v_cvt_pk_bf16_f32 v24, v24, v25
    s_waitcnt lgkmcnt(0)
    v_smfmac_f32_16x16x64_bf16 v[8:11], v[36:39], v[56:63], v1
    ds_read_b128 v[56:59], v7 offset:28672
    ds_read_b128 v[60:63], v7 offset:29696
    v_and_or_b32 v24, v24, -2, s65
    v_add_f32 v28, v28, v30
    v_add_f32 v29, v29, v31
    v_smfmac_f32_16x16x64_bf16 v[12:15], v[36:39], v[64:71], v1
    ds_read_b128 v[64:67], v7 offset:30720
    ds_read_b128 v[68:71], v7 offset:31744
    v_cvt_pk_bf16_f32 v25, v28, v29
    buffer_store_dwordx2 v[24:25], v4, s[8:11], s76 offen
    v_smfmac_f32_16x16x64_bf16 v[16:19], v[32:35], a[240:247], v1
    v_smfmac_f32_16x16x64_bf16 v[20:23], v[32:35], a[248:255], v1
    v_add_f32 v8, v8, v10
    v_add_f32 v9, v9, v11
    v_cvt_pk_bf16_f32 v8, v8, v9
    s_waitcnt lgkmcnt(0)
    v_smfmac_f32_16x16x64_bf16 v[16:19], v[36:39], v[56:63], v1
    v_and_or_b32 v8, v8, -2, s65
    v_add_f32 v12, v12, v14
    v_add_f32 v13, v13, v15
    v_smfmac_f32_16x16x64_bf16 v[20:23], v[36:39], v[64:71], v1
    v_cvt_pk_bf16_f32 v9, v12, v13
    buffer_store_dwordx2 v[8:9], v4, s[8:11], s77 offen
    s_nop 1
    v_add_f32 v16, v16, v18
    v_add_f32 v17, v17, v19
    v_cvt_pk_bf16_f32 v16, v16, v17
    v_and_or_b32 v16, v16, -2, s65
    v_add_f32 v20, v20, v22
    v_add_f32 v21, v21, v23
    v_cvt_pk_bf16_f32 v17, v20, v21
    buffer_store_dwordx2 v[16:17], v4, s[8:11], s4 offen
    s_barrier
    s_mov_b32 s68, 0
    v_bfe_u32 v29, v0, 4, 1
    v_lshlrev_b32 v29, 4, v29
    v_mov_b32 v30, 0x3f80
    v_lshlrev_b32 v29, v29, v30
    v_bfe_u32 v30, v0, 5, 3
    v_cmp_eq_u32 vcc, 0, v30
    s_nop 1
    v_cndmask_b32 v32, 0, v29, vcc
    v_cmp_eq_u32 vcc, 1, v30
    s_nop 1
    v_cndmask_b32 v33, 0, v29, vcc
    v_cmp_eq_u32 vcc, 2, v30
    s_nop 1
    v_cndmask_b32 v34, 0, v29, vcc
    v_cmp_eq_u32 vcc, 3, v30
    s_nop 1
    v_cndmask_b32 v35, 0, v29, vcc
    buffer_load_dwordx4 v[8:11], v0, s[8:11], s59 offen offset:0 sc1
    buffer_load_dwordx4 v[12:15], v0, s[8:11], s59 offen offset:1024 sc1
    s_sleep 3
    buffer_load_dwordx4 v[16:19], v0, s[8:11], s59 offen offset:0 sc1
    buffer_load_dwordx4 v[20:23], v0, s[8:11], s59 offen offset:1024 sc1
CHF2_rloop:
    s_waitcnt vmcnt(2)
    v_mfma_f32_16x16x32_bf16 v[24:27], v[8:11], v[32:35], 0
    v_and_b32 v29, v8, v10
    v_or_b32 v30, v8, v10
    v_mfma_f32_16x16x32_bf16 v[24:27], v[12:15], v[32:35], v[24:27]
    v_bitop3_b32 v29, v29, v12, v14 bitop3:0x80
    v_or3_b32 v30, v30, v12, v14
    v_bitop3_b32 v29, v29, v30, s65 bitop3:0x4e
    v_and_b32 v29, 1, v29
    v_cmp_ne_u32 vcc, 0, v29
    s_nop 2
    v_permlane32_swap_b32 v24, v26
    v_permlane32_swap_b32 v25, v27
    v_add_f32 v24, v24, v26
    v_add_f32 v25, v25, v27
    s_cbranch_vccnz CHF2_rbad0
    s_nop 0
    v_permlane16_swap_b32 v24, v25
    v_add_f32 v24, v24, v25
    v_cvt_pk_bf16_f32 v24, v24, v24
    buffer_store_short v24, v2, s[8:11], s56 offen
    s_branch CHF2_rdone
CHF2_rbad0:
    buffer_load_dwordx4 v[8:11], v0, s[8:11], s59 offen offset:0 sc1
    buffer_load_dwordx4 v[12:15], v0, s[8:11], s59 offen offset:1024 sc1
    s_waitcnt vmcnt(2)
    v_mfma_f32_16x16x32_bf16 v[24:27], v[16:19], v[32:35], 0
    v_and_b32 v29, v16, v18
    v_or_b32 v30, v16, v18
    v_mfma_f32_16x16x32_bf16 v[24:27], v[20:23], v[32:35], v[24:27]
    v_bitop3_b32 v29, v29, v20, v22 bitop3:0x80
    v_or3_b32 v30, v30, v20, v22
    v_bitop3_b32 v29, v29, v30, s65 bitop3:0x4e
    v_and_b32 v29, 1, v29
    v_cmp_ne_u32 vcc, 0, v29
    s_nop 2
    v_permlane32_swap_b32 v24, v26
    v_permlane32_swap_b32 v25, v27
    v_add_f32 v24, v24, v26
    v_add_f32 v25, v25, v27
    s_cbranch_vccnz CHF2_rbad1
CHF2_rok:
    s_nop 0
    v_permlane16_swap_b32 v24, v25
    v_add_f32 v24, v24, v25
    v_cvt_pk_bf16_f32 v24, v24, v24
    buffer_store_short v24, v2, s[8:11], s56 offen
    s_branch CHF2_rdone
CHF2_rbad1:
    buffer_load_dwordx4 v[16:19], v0, s[8:11], s59 offen offset:0 sc1
    buffer_load_dwordx4 v[20:23], v0, s[8:11], s59 offen offset:1024 sc1
    s_cmp_lg_u32 s69, 0
    s_cbranch_scc1 CHF2_rok
    s_add_u32 s68, s68, 1
    s_cmp_lt_u32 s68, 65536
    s_cbranch_scc1 CHF2_rloop
    s_mov_b32 s69, 1
    s_branch CHF2_rok
CHF2_rdone:
    v_mov_b32 v25, 0xff81ff81
    buffer_store_short v25, v2, s[8:11], s57 offen
    s_mov_b32 m0, 20480
    s_nop 0
    buffer_load_dwordx4 v0, s[8:11], s63 offen offset:0 sc1 lds
    buffer_load_dwordx4 v0, s[8:11], s63 offen offset:1024 sc1 lds
    s_add_u32 s63, s63, 262144
    v_and_b32 v28, 512, v0
    v_mul_u32_u24 v28, 3, v28
    v_add_u32 v28, v28, v0
    ds_read_b128 v[24:27], v28 offset:13312
    s_add_u32 s72, s56, 6144
    s_xor_b32 s65, s65, 1
    s_add_u32 s64, s64, 131072
    s_xor_b32 s56, s56, s74
    s_xor_b32 s57, s57, s74
    s_add_u32 s62, s62, 262144
    s_add_u32 s55, s55, 1
    s_mov_b32 s68, 0
    s_mov_b32 m0, 6144
    s_sleep 3
    buffer_load_dwordx4 v0, s[8:11], s72 offen offset:0 sc1 lds
    buffer_load_dwordx4 v0, s[8:11], s72 offen offset:1024 sc1 lds
    s_waitcnt vmcnt(6)
    ds_read_b128 v[56:59], v7 offset:12288
    ds_read_b128 v[60:63], v7 offset:13312
    ds_read_b128 v[64:67], v7 offset:14336
    ds_read_b128 v[68:71], v7 offset:15360
    v_mov_b64 v[8:9], 0
    v_mov_b64 v[10:11], 0
    v_mov_b64 v[12:13], 0
    v_mov_b64 v[14:15], 0
    v_mov_b64 v[16:17], 0
    v_mov_b64 v[18:19], 0
    v_mov_b64 v[20:21], 0
    v_mov_b64 v[22:23], 0
    s_sleep 2
CHF2_gloop:
    buffer_load_dwordx4 v0, s[8:11], s72 offen offset:0 sc1 lds
    buffer_load_dwordx4 v0, s[8:11], s72 offen offset:1024 sc1 lds
    s_waitcnt vmcnt(2)
    ds_read_b128 v[32:35], v0 offset:6144
    ds_read_b128 v[36:39], v0 offset:7168
    s_waitcnt lgkmcnt(1)
    v_pk_max_u16 v23, v32, v33
    v_pk_max_u16 v23, v23, v34
    v_pk_max_u16 v23, v23, v35
    s_waitcnt lgkmcnt(0)
    v_pk_max_u16 v23, v23, v36
    v_pk_max_u16 v23, v23, v37
    v_pk_max_u16 v23, v23, v38
    v_pk_max_u16 v23, v23, v39
    v_pk_max_u16 v23, v23, v23 op_sel:[0,1] op_sel_hi:[1,0]
    s_nop 0
    v_cmp_le_u32 vcc, 0xff810000, v23
    s_nop 0
    s_cbranch_vccz CHF2_loop
    s_add_u32 s68, s68, 1
    s_cmp_lt_u32 s68, 64
    s_cbranch_scc1 CHF2_gloop
    s_cmp_lg_u32 s69, 0
    s_cbranch_scc1 CHF2_loop
    v_mov_b32 v23, -1
    v_xor_b32 v22, 0xff81ff81, v32
    v_pk_min_u16 v23, v23, v22
    v_xor_b32 v22, 0xff81ff81, v33
    v_pk_min_u16 v23, v23, v22
    v_xor_b32 v22, 0xff81ff81, v34
    v_pk_min_u16 v23, v23, v22
    v_xor_b32 v22, 0xff81ff81, v35
    v_pk_min_u16 v23, v23, v22
    v_xor_b32 v22, 0xff81ff81, v36
    v_pk_min_u16 v23, v23, v22
    v_xor_b32 v22, 0xff81ff81, v37
    v_pk_min_u16 v23, v23, v22
    v_xor_b32 v22, 0xff81ff81, v38
    v_pk_min_u16 v23, v23, v22
    v_xor_b32 v22, 0xff81ff81, v39
    v_pk_min_u16 v23, v23, v22
    v_pk_min_u16 v23, v23, v23 op_sel:[0,1] op_sel_hi:[1,0]
    v_mov_b32 v22, 0
    v_cmp_eq_u32 vcc, 0, v23
    s_nop 0
    s_cbranch_vccz CHF2_loop
    s_sleep 1
    s_cmp_lt_u32 s68, 65536
    s_cbranch_scc1 CHF2_gloop
    s_mov_b32 s69, 1
    s_branch CHF2_loop
CHF2_last:
    v_and_b32 v28, 512, v0
    v_mul_u32_u24 v28, 3, v28
    v_add_u32 v28, v28, v0
    ds_read_b128 v[24:27], v28 offset:13312
    s_add_u32 s64, s64, 131072
    s_waitcnt lgkmcnt(0)
    buffer_store_dwordx4 v[24:27], v0, s[8:11], s64 offen sc1
    s_waitcnt vmcnt(0)
    s_barrier
    s_waitcnt vmcnt(0) lgkmcnt(0)
    s_endpgm
CHS2_start:
    s_barrier
    s_mov_b32 m0, 20480
    s_nop 0
    buffer_load_dwordx4 v0, s[8:11], s63 offen offset:0 sc1 lds
    buffer_load_dwordx4 v0, s[8:11], s63 offen offset:1024 sc1 lds
    s_add_u32 s63, s63, 262144
    s_waitcnt vmcnt(0) lgkmcnt(0)
CHS2_loop:
    s_barrier
    ds_read_b128 v[28:31], v0 offset:2048
    v_mov_b32 v23, 0
    v_smfmac_f32_16x16x64_bf16 v[8:11], v[32:35], v[40:47], v1
    buffer_load_dwordx4 v[40:43], v0, s[8:11], s3 offen offset:2048
    v_smfmac_f32_16x16x64_bf16 v[12:15], v[32:35], v[72:79], v1
    buffer_load_dwordx4 v[44:47], v0, s[8:11], s3 offen offset:3072
    v_smfmac_f32_16x16x64_bf16 v[16:19], v[32:35], v[56:63], v1
    buffer_load_dwordx4 v[72:75], v0, s[8:11], s5 offen offset:0
    v_smfmac_f32_16x16x64_bf16 v[20:23], v[32:35], v[64:71], v1
    ds_read_b128 v[32:35], v0 offset:1024
    buffer_load_dwordx4 v[76:79], v0, s[8:11], s5 offen offset:1024
    v_smfmac_f32_16x16x64_bf16 v[8:11], v[36:39], v[48:55], v1
    ds_read_b128 v[56:59], v7 offset:4096
    v_smfmac_f32_16x16x64_bf16 v[12:15], v[36:39], v[80:87], v1
    ds_read_b128 v[60:63], v7 offset:5120
    ds_read_b128 v[64:67], v7 offset:6144
    v_smfmac_f32_16x16x64_bf16 v[16:19], v[36:39], v[88:95], v1
    ds_read_b128 v[68:71], v7 offset:7168
    buffer_load_dwordx4 v[48:51], v0, s[8:11], s62 offen offset:0 sc1
    v_smfmac_f32_16x16x64_bf16 v[20:23], v[36:39], v[96:103], v1
    ds_read_b128 v[36:39], v0 offset:0
    s_waitcnt lgkmcnt(6)
    v_smfmac_f32_16x16x64_bf16 v[8:11], v[28:31], v[104:111], v1
    buffer_load_dwordx4 v[52:55], v0, s[8:11], s62 offen offset:1024 sc1
    v_smfmac_f32_16x16x64_bf16 v[12:15], v[28:31], v[112:119], v1
    buffer_store_dwordx4 v[24:27], v0, s[8:11], s64 offen sc1
    s_waitcnt lgkmcnt(1)
    v_smfmac_f32_16x16x64_bf16 v[16:19], v[28:31], v[56:63], v1
    ds_read_b128 v[24:27], v0 offset:4096
    ds_read_b128 v[56:59], v7 offset:0
    v_smfmac_f32_16x16x64_bf16 v[20:23], v[28:31], v[64:71], v1
    ds_read_b128 v[28:31], v0 offset:3072
    ds_read_b128 v[60:63], v7 offset:1024
    v_smfmac_f32_16x16x64_bf16 v[8:11], v[32:35], v[120:127], v1
    ds_read_b128 v[64:67], v7 offset:2048
    v_smfmac_f32_16x16x64_bf16 v[12:15], v[32:35], v[128:135], v1
    ds_read_b128 v[68:71], v7 offset:3072
    v_smfmac_f32_16x16x64_bf16 v[16:19], v[32:35], v[136:143], v1
    v_smfmac_f32_16x16x64_bf16 v[20:23], v[32:35], v[144:151], v1
    ds_read_b128 v[32:35], v0 offset:8192
    s_waitcnt lgkmcnt(7)
    v_smfmac_f32_16x16x64_bf16 v[8:11], v[36:39], v[152:159], v1
    v_smfmac_f32_16x16x64_bf16 v[12:15], v[36:39], v[160:167], v1
    s_waitcnt lgkmcnt(1)
    v_smfmac_f32_16x16x64_bf16 v[16:19], v[36:39], v[56:63], v1
    ds_read_b128 v[56:59], v7 offset:8192
    v_smfmac_f32_16x16x64_bf16 v[20:23], v[36:39], v[64:71], v1
    ds_read_b128 v[36:39], v0 offset:9216
    ds_read_b128 v[60:63], v7 offset:9216
    v_smfmac_f32_16x16x64_bf16 v[8:11], v[24:27], v[168:175], v1
    ds_read_b128 v[64:67], v7 offset:10240
    v_smfmac_f32_16x16x64_bf16 v[12:15], v[24:27], v[176:183], v1
    ds_read_b128 v[68:71], v7 offset:11264
    v_smfmac_f32_16x16x64_bf16 v[16:19], v[24:27], v[184:191], v1
    v_smfmac_f32_16x16x64_bf16 v[20:23], v[24:27], v[192:199], v1
    ds_read_b128 v[24:27], v0 offset:5120
    s_waitcnt vmcnt(5)
    v_smfmac_f32_16x16x64_bf16 v[8:11], v[28:31], v[40:47], v1
    v_smfmac_f32_16x16x64_bf16 v[12:15], v[28:31], v[200:207], v1
    s_waitcnt lgkmcnt(1)
    v_smfmac_f32_16x16x64_bf16 v[16:19], v[28:31], v[56:63], v1
    ds_read_b128 v[56:59], v7 offset:16384
    v_smfmac_f32_16x16x64_bf16 v[20:23], v[28:31], v[64:71], v1
    ds_read_b128 v[60:63], v7 offset:17408
    s_waitcnt lgkmcnt(2)
    s_waitcnt vmcnt(3)
    v_smfmac_f32_16x16x64_bf16 v[8:11], v[24:27], v[72:79], v1
    ds_read_b128 v[64:67], v7 offset:18432
    v_mov_b64 v[28:29], 0
    v_smfmac_f32_16x16x64_bf16 v[12:15], v[24:27], v[208:215], v1
    ds_read_b128 v[68:71], v7 offset:19456
    v_mov_b64 v[30:31], 0
    v_smfmac_f32_16x16x64_bf16 v[16:19], v[24:27], v[216:223], v1
    ds_read_b128 v[40:43], v0 offset:16384
    v_smfmac_f32_16x16x64_bf16 v[20:23], v[24:27], v[224:231], v1
    ds_read_b128 v[44:47], v0 offset:20480
    v_smfmac_f32_16x16x64_bf16 v[8:11], v[32:35], v[232:239], v1
    v_mov_b64 v[24:25], 0
    v_smfmac_f32_16x16x64_bf16 v[12:15], v[32:35], v[240:247], v1
    v_mov_b64 v[26:27], 0
    s_waitcnt lgkmcnt(2)
    v_smfmac_f32_16x16x64_bf16 v[16:19], v[32:35], v[56:63], v1
    v_smfmac_f32_16x16x64_bf16 v[20:23], v[32:35], v[64:71], v1
    v_smfmac_f32_16x16x64_bf16 v[8:11], v[36:39], v[248:255], v1
    ds_read_b128 v[72:75], v0 offset:17408
    v_smfmac_f32_16x16x64_bf16 v[12:15], v[36:39], a[0:7], v1
    ds_read_b128 v[76:79], v0 offset:21504
    v_smfmac_f32_16x16x64_bf16 v[16:19], v[36:39], a[8:15], v1
    v_smfmac_f32_16x16x64_bf16 v[20:23], v[36:39], a[16:23], v1
    v_smfmac_f32_16x16x64_bf16 v[24:27], v[36:39], a[168:175], v1
    s_nop 1
    v_add_f32 v8, v8, v10
    v_add_f32 v9, v9, v11
    v_add_f32 v12, v12, v14
    v_add_f32 v13, v13, v15
    v_mul_f32 v8, s79, v8
    v_mul_f32 v12, s79, v12
    v_mul_f32 v9, s79, v9
    v_mul_f32 v13, s79, v13
    v_cvt_pk_bf16_f32 v10, v8, v12
    v_cvt_pk_bf16_f32 v11, v9, v13
    ds_write2_b32 v5, v10, v11 offset0:0 offset1:4
    v_add_f32 v16, v16, v18
    v_add_f32 v17, v17, v19
    v_add_f32 v20, v20, v22
    v_add_f32 v21, v21, v23
    v_cvt_pk_bf16_f32 v18, v16, v20
    v_cvt_pk_bf16_f32 v19, v17, v21
    ds_write2_b32 v3, v18, v19 offset0:0 offset1:4
    v_smfmac_f32_16x16x64_bf16 v[28:31], v[36:39], a[176:183], v1
    ds_read_b128 v[36:39], v0 offset:6144
    v_smfmac_f32_16x16x64_bf16 v[24:27], v[32:35], a[152:159], v1
    v_smfmac_f32_16x16x64_bf16 v[28:31], v[32:35], a[160:167], v1
    ds_read_b128 v[32:35], v0 offset:7168
    s_waitcnt lgkmcnt(2)
    s_barrier
    ds_read_b128 v[56:59], v6 offset:10240
    ds_read_b128 v[60:63], v6 offset:10752
    ds_read_b128 v[20:23], v6 offset:12288
    ds_read_b128 v[64:67], v6 offset:11264
    ds_read_b128 v[68:71], v6 offset:11776
    s_waitcnt lgkmcnt(6)
    v_smfmac_f32_16x16x64_bf16 v[24:27], v[36:39], a[24:31], v1
    v_smfmac_f32_16x16x64_bf16 v[28:31], v[36:39], a[32:39], v1
    ds_read_b128 v[36:39], v0 offset:2048
    s_waitcnt lgkmcnt(6)
    v_smfmac_f32_16x16x64_bf16 v[24:27], v[32:35], a[40:47], v1
    v_smfmac_f32_16x16x64_bf16 v[28:31], v[32:35], a[48:55], v1
    ds_read_b128 v[32:35], v0 offset:1024
    s_waitcnt lgkmcnt(6)
    v_mfma_f32_16x16x32_bf16 v[12:15], v[40:43], v[56:59], 0
    ds_read_b128 v[40:43], v6 offset:12800
    v_mfma_f32_16x16x32_bf16 v[16:19], v[44:47], v[56:59], 0
    ds_read_b128 v[44:47], v0 offset:18432
    s_waitcnt lgkmcnt(7)
    v_mfma_f32_16x16x32_bf16 v[12:15], v[72:75], v[60:63], v[12:15]
    ds_read_b128 v[72:75], v0 offset:22528
    v_mfma_f32_16x16x32_bf16 v[16:19], v[76:79], v[60:63], v[16:19]
    ds_read_b128 v[76:79], v6 offset:13312
    s_waitcnt lgkmcnt(8)
    v_mfma_f32_16x16x32_bf16 v[8:11], v[20:23], v[56:59], 0
    ds_read_b128 v[20:23], v6 offset:13824
    s_waitcnt lgkmcnt(4)
    v_mfma_f32_16x16x32_bf16 v[8:11], v[40:43], v[60:63], v[8:11]
    ds_read_b128 v[40:43], v0 offset:19456
    s_waitcnt lgkmcnt(4)
    v_mfma_f32_16x16x32_bf16 v[12:15], v[44:47], v[64:67], v[12:15]
    ds_read_b128 v[44:47], v0 offset:23552
    s_waitcnt lgkmcnt(4)
    v_mfma_f32_16x16x32_bf16 v[16:19], v[72:75], v[64:67], v[16:19]
    s_waitcnt lgkmcnt(3)
    v_mfma_f32_16x16x32_bf16 v[8:11], v[76:79], v[64:67], v[8:11]
    s_waitcnt lgkmcnt(2)
    v_mfma_f32_16x16x32_bf16 v[8:11], v[20:23], v[68:71], v[8:11]
    s_waitcnt lgkmcnt(1)
    v_mfma_f32_16x16x32_bf16 v[12:15], v[40:43], v[68:71], v[12:15]
    s_waitcnt lgkmcnt(0)
    v_mfma_f32_16x16x32_bf16 v[16:19], v[44:47], v[68:71], v[16:19]
    v_smfmac_f32_16x16x64_bf16 v[24:27], v[36:39], a[56:63], v1
    buffer_load_dwordx4 v[72:75], v0, s[8:11], s5 offen offset:2048
    v_smfmac_f32_16x16x64_bf16 v[28:31], v[36:39], a[64:71], v1
    ds_read_b128 v[36:39], v0 offset:0
    buffer_load_dwordx4 v[76:79], v0, s[8:11], s5 offen offset:3072
    s_nop 0
    v_max3_f32 v10, v8, v9, v12
    v_max3_f32 v11, v13, v14, v15
    v_max3_f32 v10, v10, v16, v17
    v_max3_f32 v11, v11, v18, v19
    v_max_f32 v10, v10, v11
    v_max_f32 v11, v10, v11
    v_smfmac_f32_16x16x64_bf16 v[24:27], v[32:35], a[72:79], v1
    buffer_load_dwordx4 v[40:43], v0, s[8:11], s6 offen offset:0
    v_permlane32_swap_b32 v11, v10
    v_max_f32 v10, v10, v11
    v_max_f32 v11, v10, v11
    v_smfmac_f32_16x16x64_bf16 v[28:31], v[32:35], a[80:87], v1
    ds_read_b128 v[32:35], v0 offset:4096
    v_permlane16_swap_b32 v11, v10
    v_max_f32 v10, v10, v11
    v_sub_f32 v12, v12, v10
    s_waitcnt lgkmcnt(1)
    v_smfmac_f32_16x16x64_bf16 v[24:27], v[36:39], a[88:95], v1
    v_sub_f32 v13, v13, v10
    v_exp_f32 v12, v12
    v_smfmac_f32_16x16x64_bf16 v[28:31], v[36:39], a[96:103], v1
    ds_read_b128 v[36:39], v0 offset:3072
    buffer_load_dwordx4 v[44:47], v0, s[8:11], s6 offen offset:1024
    v_sub_f32 v14, v14, v10
    v_exp_f32 v13, v13
    s_waitcnt lgkmcnt(1)
    v_smfmac_f32_16x16x64_bf16 v[24:27], v[32:35], a[104:111], v1
    v_sub_f32 v15, v15, v10
    v_exp_f32 v14, v14
    v_smfmac_f32_16x16x64_bf16 v[28:31], v[32:35], a[112:119], v1
    ds_read_b128 v[32:35], v0 offset:5120
    v_cvt_pk_bf16_f32 v20, v12, v13
    v_sub_f32 v16, v16, v10
    v_exp_f32 v15, v15
    s_waitcnt lgkmcnt(1)
    v_smfmac_f32_16x16x64_bf16 v[24:27], v[36:39], a[120:127], v1
    buffer_load_dwordx4 v[56:59], v0, s[8:11], s6 offen offset:2048
    v_sub_f32 v17, v17, v10
    v_exp_f32 v16, v16
    v_smfmac_f32_16x16x64_bf16 v[28:31], v[36:39], a[128:135], v1
    v_cvt_pk_bf16_f32 v21, v14, v15
    v_sub_f32 v18, v18, v10
    v_exp_f32 v17, v17
    s_waitcnt lgkmcnt(0)
    v_smfmac_f32_16x16x64_bf16 v[24:27], v[32:35], a[136:143], v1
    v_mov_b64 v[12:13], s[40:41]
    v_mov_b64 v[14:15], s[40:41]
    v_sub_f32 v19, v19, v10
    v_exp_f32 v18, v18
    v_smfmac_f32_16x16x64_bf16 v[28:31], v[32:35], a[144:151], v1
    buffer_load_dwordx4 v[60:63], v0, s[8:11], s6 offen offset:3072
    v_cvt_pk_bf16_f32 v22, v16, v17
    v_sub_f32 v8, v8, v10
    v_exp_f32 v19, v19
    v_sub_f32 v9, v9, v10
    v_exp_f32 v8, v8
    v_cvt_pk_bf16_f32 v23, v18, v19
    v_exp_f32 v9, v9
    v_mov_b32 v11, 0
    v_cvt_pk_bf16_f32 v10, v8, v9
    s_waitcnt vmcnt(7)
    v_mfma_f32_16x16x32_bf16 v[16:19], v[12:15], v[20:23], 0
    v_add_f32 v24, v24, v26
    v_add_f32 v25, v25, v27
    v_mfma_f32_16x16x32_bf16 v[32:35], v[48:51], v[20:23], 0
    v_add_f32 v28, v28, v30
    v_add_f32 v29, v29, v31
    v_mfma_f32_16x16x32_bf16 v[36:39], v[52:55], v[20:23], 0
    v_cvt_pk_bf16_f32 v26, v24, v25
    v_cvt_pk_bf16_f32 v27, v28, v29
    v_mfma_f32_16x16x16_bf16 v[16:19], v[12:13], v[10:11], v[16:19]
    v_cvt_pk_bf16_f32 v28, v28, v29
    v_mov_b32 v29, 0
    v_mfma_f32_16x16x16_bf16 v[32:35], v[26:27], v[10:11], v[32:35]
    buffer_load_dwordx4 v[64:67], v0, s[8:11], s7 offen offset:0
    buffer_load_dwordx4 v[68:71], v0, s[8:11], s7 offen offset:1024
    v_mfma_f32_16x16x16_bf16 v[36:39], v[28:29], v[10:11], v[36:39]
    buffer_load_dwordx4 v[48:51], v0, s[8:11], s7 offen offset:2048
    v_lshrrev_b32 v30, 1, v0
    ds_write_b64 v30, v[26:27] offset:15360
    v_rcp_f32 v8, v16
    v_mov_b64 v[12:13], 0
    v_mov_b64 v[14:15], 0
    v_mul_f32 v32, v32, v8
    v_mul_f32 v33, v33, v8
    v_cvt_pk_bf16_f32 v16, v32, v33
    v_mul_f32 v34, v34, v8
    v_mul_f32 v35, v35, v8
    v_cvt_pk_bf16_f32 v17, v34, v35
    v_mul_f32 v36, v36, v8
    v_mul_f32 v37, v37, v8
    v_cvt_pk_bf16_f32 v18, v36, v37
    v_mul_f32 v38, v38, v8
    v_mul_f32 v39, v39, v8
    v_cvt_pk_bf16_f32 v19, v38, v39
    ds_write_b128 v6, v[16:19] offset:17408
    buffer_load_dwordx4 v[52:55], v0, s[8:11], s7 offen offset:3072
    v_mov_b64 v[8:9], 0
    v_mov_b64 v[10:11], 0
    v_mov_b64 v[20:21], 0
    v_mov_b64 v[22:23], 0
    v_mov_b64 v[24:25], 0
    v_mov_b64 v[28:29], 0
    s_waitcnt lgkmcnt(0)
    s_barrier
    ds_read_b128 v[32:35], v0 offset:16384
    ds_read_b128 v[36:39], v0 offset:17408
    s_cmp_eq_u32 s55, 63
    s_cbranch_scc1 CHS2_last
    v_mov_b64 v[16:17], 0
    v_mov_b64 v[18:19], 0
    v_mov_b64 v[26:27], 0
    v_mov_b64 v[30:31], 0
    s_waitcnt lgkmcnt(1)
    v_smfmac_f32_16x16x64_bf16 v[8:11], v[32:35], a[184:191], v1
    v_smfmac_f32_16x16x64_bf16 v[12:15], v[32:35], a[192:199], v1
    s_waitcnt vmcnt(6) lgkmcnt(0)
    v_smfmac_f32_16x16x64_bf16 v[8:11], v[36:39], v[72:79], v1
    buffer_load_dwordx4 v[72:75], v0, s[8:11], s61 offen offset:0
    v_smfmac_f32_16x16x64_bf16 v[12:15], v[36:39], v[40:47], v1
    s_waitcnt vmcnt(3)
    v_smfmac_f32_16x16x64_bf16 v[16:19], v[32:35], v[56:63], v1
    ds_read_b128 v[56:59], v7 offset:20480
    ds_read_b128 v[60:63], v7 offset:21504
    buffer_load_dwordx4 v[76:79], v0, s[8:11], s61 offen offset:1024
    v_smfmac_f32_16x16x64_bf16 v[20:23], v[32:35], v[64:71], v1
    ds_read_b128 v[64:67], v7 offset:22528
    ds_read_b128 v[68:71], v7 offset:23552
    buffer_load_dwordx4 v[40:43], v0, s[8:11], s61 offen offset:2048
    v_add_f32 v8, v8, v10
    v_add_f32 v9, v9, v11
    v_cvt_pk_bf16_f32 v8, v8, v9
    v_smfmac_f32_16x16x64_bf16 v[16:19], v[36:39], a[200:207], v1
    v_and_or_b32 v8, v8, -2, s65
    v_add_f32 v12, v12, v14
    v_add_f32 v13, v13, v15
    v_smfmac_f32_16x16x64_bf16 v[20:23], v[36:39], a[208:215], v1
    buffer_load_dwordx4 v[44:47], v0, s[8:11], s61 offen offset:3072
    v_cvt_pk_bf16_f32 v9, v12, v13
    buffer_store_dwordx2 v[8:9], v4, s[8:11], s58 offen sc1
    v_mov_b64 v[12:13], 0
    s_waitcnt vmcnt(5)
    v_smfmac_f32_16x16x64_bf16 v[24:27], v[32:35], a[216:223], v1
    v_mov_b64 v[14:15], 0
    v_mov_b64 v[10:11], 0
    v_mov_b64 v[8:9], 0
    v_smfmac_f32_16x16x64_bf16 v[28:31], v[32:35], v[48:55], v1
    buffer_load_dwordx4 v[48:51], v0, s[8:11], s3 offen offset:0
    v_add_f32 v16, v16, v18
    v_add_f32 v17, v17, v19
    v_cvt_pk_bf16_f32 v16, v16, v17
    s_waitcnt lgkmcnt(0)
    v_smfmac_f32_16x16x64_bf16 v[24:27], v[36:39], v[56:63], v1
    ds_read_b128 v[56:59], v7 offset:24576
    ds_read_b128 v[60:63], v7 offset:25600
    v_and_or_b32 v16, v16, -2, s65
    v_add_f32 v20, v20, v22
    v_add_f32 v21, v21, v23
    v_smfmac_f32_16x16x64_bf16 v[28:31], v[36:39], v[64:71], v1
    ds_read_b128 v[64:67], v7 offset:26624
    ds_read_b128 v[68:71], v7 offset:27648
    buffer_load_dwordx4 v[52:55], v0, s[8:11], s3 offen offset:1024
    v_cvt_pk_bf16_f32 v17, v20, v21
    buffer_store_dwordx2 v[16:17], v4, s[8:11], s75 offen sc1
    v_mov_b64 v[20:21], 0
    v_smfmac_f32_16x16x64_bf16 v[8:11], v[32:35], a[224:231], v1
    v_mov_b64 v[22:23], 0
    v_mov_b64 v[18:19], 0
    v_mov_b64 v[16:17], 0
    v_smfmac_f32_16x16x64_bf16 v[12:15], v[32:35], a[232:239], v1
    v_add_f32 v24, v24, v26
    v_add_f32 v25, v25, v27
    v_cvt_pk_bf16_f32 v24, v24, v25
    s_waitcnt lgkmcnt(0)
    v_smfmac_f32_16x16x64_bf16 v[8:11], v[36:39], v[56:63], v1
    ds_read_b128 v[56:59], v7 offset:28672
    ds_read_b128 v[60:63], v7 offset:29696
    v_and_or_b32 v24, v24, -2, s65
    v_add_f32 v28, v28, v30
    v_add_f32 v29, v29, v31
    v_smfmac_f32_16x16x64_bf16 v[12:15], v[36:39], v[64:71], v1
    ds_read_b128 v[64:67], v7 offset:30720
    ds_read_b128 v[68:71], v7 offset:31744
    v_cvt_pk_bf16_f32 v25, v28, v29
    buffer_store_dwordx2 v[24:25], v4, s[8:11], s76 offen sc1
    v_smfmac_f32_16x16x64_bf16 v[16:19], v[32:35], a[240:247], v1
    v_smfmac_f32_16x16x64_bf16 v[20:23], v[32:35], a[248:255], v1
    v_add_f32 v8, v8, v10
    v_add_f32 v9, v9, v11
    v_cvt_pk_bf16_f32 v8, v8, v9
    s_waitcnt lgkmcnt(0)
    v_smfmac_f32_16x16x64_bf16 v[16:19], v[36:39], v[56:63], v1
    v_and_or_b32 v8, v8, -2, s65
    v_add_f32 v12, v12, v14
    v_add_f32 v13, v13, v15
    v_smfmac_f32_16x16x64_bf16 v[20:23], v[36:39], v[64:71], v1
    v_cvt_pk_bf16_f32 v9, v12, v13
    buffer_store_dwordx2 v[8:9], v4, s[8:11], s77 offen sc1
    s_nop 1
    v_add_f32 v16, v16, v18
    v_add_f32 v17, v17, v19
    v_cvt_pk_bf16_f32 v16, v16, v17
    v_and_or_b32 v16, v16, -2, s65
    v_add_f32 v20, v20, v22
    v_add_f32 v21, v21, v23
    v_cvt_pk_bf16_f32 v17, v20, v21
    buffer_store_dwordx2 v[16:17], v4, s[8:11], s4 offen sc1
    s_barrier
    s_mov_b32 s68, 0
    v_bfe_u32 v29, v0, 4, 1
    v_lshlrev_b32 v29, 4, v29
    v_mov_b32 v30, 0x3f80
    v_lshlrev_b32 v29, v29, v30
    v_bfe_u32 v30, v0, 5, 3
    v_cmp_eq_u32 vcc, 0, v30
    s_nop 1
    v_cndmask_b32 v32, 0, v29, vcc
    v_cmp_eq_u32 vcc, 1, v30
    s_nop 1
    v_cndmask_b32 v33, 0, v29, vcc
    v_cmp_eq_u32 vcc, 2, v30
    s_nop 1
    v_cndmask_b32 v34, 0, v29, vcc
    v_cmp_eq_u32 vcc, 3, v30
    s_nop 1
    v_cndmask_b32 v35, 0, v29, vcc
    buffer_load_dwordx4 v[8:11], v0, s[8:11], s59 offen offset:0 sc1
    buffer_load_dwordx4 v[12:15], v0, s[8:11], s59 offen offset:1024 sc1
    s_sleep 3
    buffer_load_dwordx4 v[16:19], v0, s[8:11], s59 offen offset:0 sc1
    buffer_load_dwordx4 v[20:23], v0, s[8:11], s59 offen offset:1024 sc1
CHS2_rloop:
    s_waitcnt vmcnt(2)
    v_mfma_f32_16x16x32_bf16 v[24:27], v[8:11], v[32:35], 0
    v_and_b32 v29, v8, v10
    v_or_b32 v30, v8, v10
    v_mfma_f32_16x16x32_bf16 v[24:27], v[12:15], v[32:35], v[24:27]
    v_bitop3_b32 v29, v29, v12, v14 bitop3:0x80
    v_or3_b32 v30, v30, v12, v14
    v_bitop3_b32 v29, v29, v30, s65 bitop3:0x4e
    v_and_b32 v29, 1, v29
    v_cmp_ne_u32 vcc, 0, v29
    s_nop 2
    v_permlane32_swap_b32 v24, v26
    v_permlane32_swap_b32 v25, v27
    v_add_f32 v24, v24, v26
    v_add_f32 v25, v25, v27
    s_cbranch_vccnz CHS2_rbad0
    s_nop 0
    v_permlane16_swap_b32 v24, v25
    v_add_f32 v24, v24, v25
    v_cvt_pk_bf16_f32 v24, v24, v24
    buffer_store_short v24, v2, s[8:11], s56 offen sc1
    s_branch CHS2_rdone
CHS2_rbad0:
    buffer_load_dwordx4 v[8:11], v0, s[8:11], s59 offen offset:0 sc1
    buffer_load_dwordx4 v[12:15], v0, s[8:11], s59 offen offset:1024 sc1
    s_waitcnt vmcnt(2)
    v_mfma_f32_16x16x32_bf16 v[24:27], v[16:19], v[32:35], 0
    v_and_b32 v29, v16, v18
    v_or_b32 v30, v16, v18
    v_mfma_f32_16x16x32_bf16 v[24:27], v[20:23], v[32:35], v[24:27]
    v_bitop3_b32 v29, v29, v20, v22 bitop3:0x80
    v_or3_b32 v30, v30, v20, v22
    v_bitop3_b32 v29, v29, v30, s65 bitop3:0x4e
    v_and_b32 v29, 1, v29
    v_cmp_ne_u32 vcc, 0, v29
    s_nop 2
    v_permlane32_swap_b32 v24, v26
    v_permlane32_swap_b32 v25, v27
    v_add_f32 v24, v24, v26
    v_add_f32 v25, v25, v27
    s_cbranch_vccnz CHS2_rbad1
CHS2_rok:
    s_nop 0
    v_permlane16_swap_b32 v24, v25
    v_add_f32 v24, v24, v25
    v_cvt_pk_bf16_f32 v24, v24, v24
    buffer_store_short v24, v2, s[8:11], s56 offen sc1
    s_branch CHS2_rdone
CHS2_rbad1:
    buffer_load_dwordx4 v[16:19], v0, s[8:11], s59 offen offset:0 sc1
    buffer_load_dwordx4 v[20:23], v0, s[8:11], s59 offen offset:1024 sc1
    s_cmp_lg_u32 s69, 0
    s_cbranch_scc1 CHS2_rok
    s_add_u32 s68, s68, 1
    s_cmp_lt_u32 s68, 65536
    s_cbranch_scc1 CHS2_rloop
    s_mov_b32 s69, 1
    s_branch CHS2_rok
CHS2_rdone:
    v_mov_b32 v25, 0xff81ff81
    buffer_store_short v25, v2, s[8:11], s57 offen sc1
    s_mov_b32 m0, 20480
    s_nop 0
    buffer_load_dwordx4 v0, s[8:11], s63 offen offset:0 sc1 lds
    buffer_load_dwordx4 v0, s[8:11], s63 offen offset:1024 sc1 lds
    s_add_u32 s63, s63, 262144
    v_and_b32 v28, 512, v0
    v_mul_u32_u24 v28, 3, v28
    v_add_u32 v28, v28, v0
    ds_read_b128 v[24:27], v28 offset:13312
    s_add_u32 s72, s56, 6144
    s_xor_b32 s65, s65, 1
    s_add_u32 s64, s64, 131072
    s_xor_b32 s56, s56, s74
    s_xor_b32 s57, s57, s74
    s_add_u32 s62, s62, 262144
    s_add_u32 s55, s55, 1
    s_mov_b32 s68, 0
    s_mov_b32 m0, 6144
    s_sleep 3
    buffer_load_dwordx4 v0, s[8:11], s72 offen offset:0 sc1 lds
    buffer_load_dwordx4 v0, s[8:11], s72 offen offset:1024 sc1 lds
    s_waitcnt vmcnt(6)
    ds_read_b128 v[56:59], v7 offset:12288
    ds_read_b128 v[60:63], v7 offset:13312
    ds_read_b128 v[64:67], v7 offset:14336
    ds_read_b128 v[68:71], v7 offset:15360
    v_mov_b64 v[8:9], 0
    v_mov_b64 v[10:11], 0
    v_mov_b64 v[12:13], 0
    v_mov_b64 v[14:15], 0
    v_mov_b64 v[16:17], 0
    v_mov_b64 v[18:19], 0
    v_mov_b64 v[20:21], 0
    v_mov_b64 v[22:23], 0
    s_sleep 2
CHS2_gloop:
    buffer_load_dwordx4 v0, s[8:11], s72 offen offset:0 sc1 lds
    buffer_load_dwordx4 v0, s[8:11], s72 offen offset:1024 sc1 lds
    s_waitcnt vmcnt(2)
    ds_read_b128 v[32:35], v0 offset:6144
    ds_read_b128 v[36:39], v0 offset:7168
    s_waitcnt lgkmcnt(1)
    v_pk_max_u16 v23, v32, v33
    v_pk_max_u16 v23, v23, v34
    v_pk_max_u16 v23, v23, v35
    s_waitcnt lgkmcnt(0)
    v_pk_max_u16 v23, v23, v36
    v_pk_max_u16 v23, v23, v37
    v_pk_max_u16 v23, v23, v38
    v_pk_max_u16 v23, v23, v39
    v_pk_max_u16 v23, v23, v23 op_sel:[0,1] op_sel_hi:[1,0]
    s_nop 0
    v_cmp_le_u32 vcc, 0xff810000, v23
    s_nop 0
    s_cbranch_vccz CHS2_loop
    s_add_u32 s68, s68, 1
    s_cmp_lt_u32 s68, 64
    s_cbranch_scc1 CHS2_gloop
    s_cmp_lg_u32 s69, 0
    s_cbranch_scc1 CHS2_loop
    v_mov_b32 v23, -1
    v_xor_b32 v22, 0xff81ff81, v32
    v_pk_min_u16 v23, v23, v22
    v_xor_b32 v22, 0xff81ff81, v33
    v_pk_min_u16 v23, v23, v22
    v_xor_b32 v22, 0xff81ff81, v34
    v_pk_min_u16 v23, v23, v22
    v_xor_b32 v22, 0xff81ff81, v35
    v_pk_min_u16 v23, v23, v22
    v_xor_b32 v22, 0xff81ff81, v36
    v_pk_min_u16 v23, v23, v22
    v_xor_b32 v22, 0xff81ff81, v37
    v_pk_min_u16 v23, v23, v22
    v_xor_b32 v22, 0xff81ff81, v38
    v_pk_min_u16 v23, v23, v22
    v_xor_b32 v22, 0xff81ff81, v39
    v_pk_min_u16 v23, v23, v22
    v_pk_min_u16 v23, v23, v23 op_sel:[0,1] op_sel_hi:[1,0]
    v_mov_b32 v22, 0
    v_cmp_eq_u32 vcc, 0, v23
    s_nop 0
    s_cbranch_vccz CHS2_loop
    s_sleep 1
    s_cmp_lt_u32 s68, 65536
    s_cbranch_scc1 CHS2_gloop
    s_mov_b32 s69, 1
    s_branch CHS2_loop
CHS2_last:
    v_and_b32 v28, 512, v0
    v_mul_u32_u24 v28, 3, v28
    v_add_u32 v28, v28, v0
    ds_read_b128 v[24:27], v28 offset:13312
    s_add_u32 s64, s64, 131072
    s_waitcnt lgkmcnt(0)
    buffer_store_dwordx4 v[24:27], v0, s[8:11], s64 offen sc1
    s_waitcnt vmcnt(0)
    s_barrier
    s_waitcnt vmcnt(0) lgkmcnt(0)
    s_endpgm
CH3_entry:
    v_and_b32 v40, 63, v0
    v_lshlrev_b32 v0, 4, v40
    v_lshrrev_b32 v41, 4, v40
    v_and_b32 v42, 15, v40
    v_and_b32 v43, 2, v40
    v_cmp_ne_u32 vcc, 0, v43
    v_mov_b32 v44, 0x4444
    v_mov_b32 v45, 0xeeee
    v_cndmask_b32 v1, v44, v45, vcc
    v_and_b32 v43, 13, v42
    v_and_b32 v44, 1, v41
    v_lshl_or_b32 v43, v44, 1, v43
    v_lshlrev_b32 v43, 4, v43
    v_lshrrev_b32 v44, 1, v41
    v_lshl_add_u32 v6, v44, 8, v43
    v_lshrrev_b32 v43, 3, v42
    v_lshlrev_b32 v43, 8, v43
    v_lshl_add_u32 v43, v41, 6, v43
    v_bfe_u32 v44, v42, 2, 1
    v_lshl_add_u32 v43, v44, 5, v43
    v_and_b32 v44, 3, v42
    v_lshl_add_u32 v43, v44, 2, v43
    v_add_u32 v5, 11776, v43
    v_add_u32 v7, 126976, v0
    v_add_u32 v3, 2048, v5
    s_mov_b32 s70, 2176
    v_lshrrev_b32 v43, 3, v42
    v_lshl_add_u32 v43, v43, 2, v41
    v_mul_lo_u32 v43, v43, s70
    v_and_b32 v44, 7, v42
    v_lshl_add_u32 v4, v44, 3, v43
    s_mul_i32 s70, s53, 5
    s_add_u32 s70, s70, 4
    v_lshrrev_b32 v43, 3, v42
    v_add_u32 v43, s70, v43
    v_and_b32 v49, 3, v42
    v_lshlrev_b32 v49, 4, v49
    v_lshl_add_u32 v49, v41, 2, v49
    v_bfe_u32 v48, v42, 2, 1
    v_lshl_add_u32 v49, v48, 1, v49
    v_lshl_add_u32 v2, v43, 6, v49
    v_mov_b32 v46, 0x40000000
    v_cmp_lt_u32 vcc, 7, v42
    s_nop 1
    v_cndmask_b32 v2, v2, v46, vcc
    v_lshlrev_b32 v83, 7, v40
    v_mov_b64 v[86:87], 0
    v_mov_b32 v46, 0x40000000
    v_cmp_gt_u32 vcc, 2, v40
    s_nop 1
    v_cndmask_b32 v85, v46, v83, vcc
    v_cmp_gt_u32 vcc, 1, v40
    s_nop 1
    v_cndmask_b32 v82, v46, v83, vcc
    s_mul_i32 s70, s54, 20480
    s_add_u32 s56, s70, 131072
    s_add_u32 s57, s56, 10240
    s_xor_b32 s74, s56, s57
    s_mul_i32 s70, s54, 348160
    s_add_u32 s70, s70, 196608
    s_lshl_b32 s71, s53, 6
    s_add_u32 s58, s70, s71
    s_add_u32 s58, s58, 52224
    s_add_u32 s75, s58, 69632
    s_add_u32 s76, s58, 139264
    s_add_u32 s77, s58, 208896
    s_add_u32 s4, s58, 278528
    s_mul_i32 s71, s53, 10880
    s_add_u32 s59, s71, s70
    s_add_u32 s59, s59, 8704
    s_add_u32 s60, s59, 2176
    s_mov_b32 s65, 0
    s_mul_i32 s61, s53, 75776
    s_add_u32 s61, s61, 1105920
    s_add_u32 s3, s61, 4096
    s_add_u32 s5, s61, 8192
    s_add_u32 s6, s61, 12288
    s_add_u32 s7, s61, 16384
    s_mul_i32 s70, s54, 16777216
    s_lshl_b32 s71, s53, 13
    s_add_u32 s70, s70, s71
    s_add_u32 s62, s70, 50337792
    s_add_u32 s63, s70, 16783360
    s_mul_i32 s70, s54, 8519680
    s_lshl_b32 s71, s53, 12
    s_add_u32 s70, s70, s71
    s_add_u32 s64, s70, 150998016
    s_mul_i32 s70, s54, 8192
    s_lshr_b32 s71, s53, 1
    s_mul_i32 s71, s71, 384
    s_add_u32 s78, s70, s71
    s_add_u32 s78, s78, 128
    s_and_b32 s71, s53, 1
    s_lshl_b32 s71, s71, 3
    s_add_u32 s78, s78, s71
    s_lshl_b32 s71, s53, 7
    s_add_u32 s66, s70, s71
    s_add_u32 s66, s66, 16384
    s_mov_b32 s55, 0
    s_mov_b32 s67, 0
    s_mov_b32 s69, 0
    s_mov_b32 s79, 0x3e0293ee
    v_and_b32 v44, 3, v40
    v_lshlrev_b32 v46, 1, v41
    v_xor_b32 v46, v46, v42
    v_lshlrev_b32 v46, 4, v46
    v_lshrrev_b32 v45, 1, v41
    v_lshlrev_b32 v45, 3, v45
    v_and_b32 v47, 1, v41
    v_add_u32 v45, v45, v47
    v_lshlrev_b32 v45, 13, v45
    s_lshl_b32 s70, s53, 8
    v_add3_u32 v32, v45, v46, s70
    v_xor_b32 v34, 128, v32
    v_lshrrev_b32 v45, 1, v41
    v_lshlrev_b32 v45, 2, v45
    v_add_u32 v45, v45, v47
    v_mul_u32_u24 v45, 1280, v45
    s_mul_i32 s70, s53, 163840
    v_add3_u32 v33, v45, v46, s70
    v_xor_b32 v35, 128, v33
    v_bfe_u32 v45, v40, 2, 2
    v_lshl_add_u32 v48, v47, 2, v45
    v_lshlrev_b32 v48, 5, v48
    v_lshl_add_u32 v45, v47, 3, v45
    v_lshlrev_b32 v45, 8, v45
    v_lshrrev_b32 v51, 1, v41
    v_mul_u32_u24 v52, 36864, v51
    v_add_u32 v52, 24576, v52
    v_add_u32 v52, v52, v45
    v_mul_u32_u24 v53, 32768, v51
    v_add_u32 v53, 94208, v53
    v_add_u32 v53, v53, v45
    v_lshlrev_b32 v49, 3, v44
    v_add_u32 v49, 192, v49
    v_xor_b32 v49, v49, v48
    v_add_u32 v16, v49, v52
    v_add_u32 v20, v49, v53
    v_lshrrev_b32 v49, 1, v44
    v_lshlrev_b32 v49, 5, v49
    v_and_b32 v50, 1, v44
    v_lshl_add_u32 v49, v50, 3, v49
    v_add_u32 v49, 192, v49
    v_xor_b32 v49, v49, v48
    v_add_u32 v18, v49, v52
    v_add_u32 v22, v49, v53
    v_lshlrev_b32 v49, 3, v44
    v_add_u32 v49, 224, v49
    v_xor_b32 v49, v49, v48
    v_add_u32 v17, v49, v52
    v_add_u32 v21, v49, v53
    v_lshrrev_b32 v49, 1, v44
    v_lshlrev_b32 v49, 5, v49
    v_and_b32 v50, 1, v44
    v_lshl_add_u32 v49, v50, 3, v49
    v_add_u32 v49, 208, v49
    v_xor_b32 v49, v49, v48
    v_add_u32 v19, v49, v52
    v_add_u32 v23, v49, v53
    s_cmp_eq_u32 s54, 0
    s_cselect_b32 s72, 0x20000000, 0
    s_mov_b32 m0, 126976
    s_mov_b32 s70, 393216
    buffer_load_dwordx4 v32, s[12:15], s70 offen lds
    s_mov_b32 m0, 128000
    s_mov_b32 s70, 409600
    buffer_load_dwordx4 v32, s[12:15], s70 offen lds
    s_mov_b32 m0, 129024
    s_mov_b32 s70, 425984
    buffer_load_dwordx4 v34, s[12:15], s70 offen lds
    s_mov_b32 m0, 130048
    s_mov_b32 s70, 442368
    buffer_load_dwordx4 v34, s[12:15], s70 offen lds
    s_mov_b32 m0, 131072
    s_mov_b32 s70, 1966080
    buffer_load_dwordx4 v32, s[12:15], s70 offen lds
    s_mov_b32 m0, 132096
    s_mov_b32 s70, 1982464
    buffer_load_dwordx4 v32, s[12:15], s70 offen lds
    s_mov_b32 m0, 133120
    s_mov_b32 s70, 1998848
    buffer_load_dwordx4 v34, s[12:15], s70 offen lds
    s_mov_b32 m0, 134144
    s_mov_b32 s70, 2015232
    buffer_load_dwordx4 v34, s[12:15], s70 offen lds
    s_mov_b32 m0, 135168
    s_mov_b32 s70, 2490368
    buffer_load_dwordx4 v32, s[12:15], s70 offen lds
    s_mov_b32 m0, 136192
    s_mov_b32 s70, 2506752
    buffer_load_dwordx4 v32, s[12:15], s70 offen lds
    s_mov_b32 m0, 137216
    s_mov_b32 s70, 2523136
    buffer_load_dwordx4 v34, s[12:15], s70 offen lds
    s_mov_b32 m0, 138240
    s_mov_b32 s70, 2539520
    buffer_load_dwordx4 v34, s[12:15], s70 offen lds
    s_mov_b32 m0, 139264
    s_mov_b32 s70, 3014656
    buffer_load_dwordx4 v32, s[12:15], s70 offen lds
    s_mov_b32 m0, 140288
    s_mov_b32 s70, 3031040
    buffer_load_dwordx4 v32, s[12:15], s70 offen lds
    s_mov_b32 m0, 141312
    s_mov_b32 s70, 3047424
    buffer_load_dwordx4 v34, s[12:15], s70 offen lds
    s_mov_b32 m0, 142336
    s_mov_b32 s70, 3063808
    buffer_load_dwordx4 v34, s[12:15], s70 offen lds
    s_mov_b32 m0, 143360
    s_mov_b32 s70, 3538944
    buffer_load_dwordx4 v32, s[12:15], s70 offen lds
    s_mov_b32 m0, 144384
    s_mov_b32 s70, 3555328
    buffer_load_dwordx4 v32, s[12:15], s70 offen lds
    s_mov_b32 m0, 145408
    s_mov_b32 s70, 3571712
    buffer_load_dwordx4 v34, s[12:15], s70 offen lds
    s_mov_b32 m0, 146432
    s_mov_b32 s70, 3588096
    buffer_load_dwordx4 v34, s[12:15], s70 offen lds
    s_mov_b32 m0, 147456
    s_mov_b32 s70, 4063232
    buffer_load_dwordx4 v32, s[12:15], s70 offen lds
    s_mov_b32 m0, 148480
    s_mov_b32 s70, 4079616
    buffer_load_dwordx4 v32, s[12:15], s70 offen lds
    s_mov_b32 m0, 149504
    s_mov_b32 s70, 4096000
    buffer_load_dwordx4 v34, s[12:15], s70 offen lds
    s_mov_b32 m0, 150528
    s_mov_b32 s70, 4112384
    buffer_load_dwordx4 v34, s[12:15], s70 offen lds
    s_mov_b32 m0, 151552
    s_mov_b32 s70, 4587520
    buffer_load_dwordx4 v32, s[12:15], s70 offen lds
    s_mov_b32 m0, 152576
    s_mov_b32 s70, 4603904
    buffer_load_dwordx4 v32, s[12:15], s70 offen lds
    s_mov_b32 m0, 153600
    s_mov_b32 s70, 4620288
    buffer_load_dwordx4 v34, s[12:15], s70 offen lds
    s_mov_b32 m0, 154624
    s_mov_b32 s70, 4636672
    buffer_load_dwordx4 v34, s[12:15], s70 offen lds
    s_mov_b32 m0, 155648
    s_mov_b32 s70, 5111808
    buffer_load_dwordx4 v32, s[12:15], s70 offen lds
    s_mov_b32 m0, 156672
    s_mov_b32 s70, 5128192
    buffer_load_dwordx4 v32, s[12:15], s70 offen lds
    s_mov_b32 m0, 157696
    s_mov_b32 s70, 5144576
    buffer_load_dwordx4 v34, s[12:15], s70 offen lds
    s_mov_b32 m0, 158720
    s_mov_b32 s70, 5160960
    buffer_load_dwordx4 v34, s[12:15], s70 offen lds
    s_waitcnt vmcnt(28) lgkmcnt(0)
    s_barrier
    ds_read_b64_tr_b16 v[160:161], v16 offset:0
    ds_read_b64_tr_b16 v[162:163], v16 offset:1024
    ds_read_b64_tr_b16 v[164:165], v20 offset:0
    ds_read_b64_tr_b16 v[166:167], v20 offset:1024
    ds_read_b64_tr_b16 v[168:169], v17 offset:0
    ds_read_b64_tr_b16 v[170:171], v17 offset:1024
    ds_read_b64_tr_b16 v[172:173], v21 offset:0
    ds_read_b64_tr_b16 v[174:175], v21 offset:1024
    s_waitcnt vmcnt(24) lgkmcnt(0)
    s_barrier
    s_mov_b32 m0, 126976
    s_add_u32 s70, s72, 51456
    buffer_load_dwordx4 v33, s[24:27], s70 offen lds
    s_mov_b32 m0, 128000
    s_add_u32 s70, s72, 54016
    buffer_load_dwordx4 v33, s[24:27], s70 offen lds
    s_mov_b32 m0, 129024
    s_add_u32 s70, s72, 71936
    buffer_load_dwordx4 v35, s[24:27], s70 offen lds
    s_mov_b32 m0, 130048
    s_add_u32 s70, s72, 74496
    buffer_load_dwordx4 v35, s[24:27], s70 offen lds
    ds_read_b64_tr_b16 v[176:177], v16 offset:4096
    ds_read_b64_tr_b16 v[178:179], v16 offset:5120
    ds_read_b64_tr_b16 v[180:181], v20 offset:4096
    ds_read_b64_tr_b16 v[182:183], v20 offset:5120
    ds_read_b64_tr_b16 v[184:185], v17 offset:4096
    ds_read_b64_tr_b16 v[186:187], v17 offset:5120
    ds_read_b64_tr_b16 v[188:189], v21 offset:4096
    ds_read_b64_tr_b16 v[190:191], v21 offset:5120
    s_waitcnt vmcnt(24) lgkmcnt(0)
    s_barrier
    s_mov_b32 m0, 131072
    s_mov_b32 s70, 51712
    buffer_load_dwordx4 v33, s[24:27], s70 offen lds
    s_mov_b32 m0, 132096
    s_mov_b32 s70, 54272
    buffer_load_dwordx4 v33, s[24:27], s70 offen lds
    s_mov_b32 m0, 133120
    s_mov_b32 s70, 72192
    buffer_load_dwordx4 v35, s[24:27], s70 offen lds
    s_mov_b32 m0, 134144
    s_mov_b32 s70, 74752
    buffer_load_dwordx4 v35, s[24:27], s70 offen lds
    ds_read_b64_tr_b16 v[192:193], v16 offset:8192
    ds_read_b64_tr_b16 v[194:195], v16 offset:9216
    ds_read_b64_tr_b16 v[196:197], v20 offset:8192
    ds_read_b64_tr_b16 v[198:199], v20 offset:9216
    ds_read_b64_tr_b16 v[48:49], v17 offset:8192
    ds_read_b64_tr_b16 v[50:51], v17 offset:9216
    ds_read_b64_tr_b16 v[52:53], v21 offset:8192
    ds_read_b64_tr_b16 v[54:55], v21 offset:9216
    s_waitcnt vmcnt(24) lgkmcnt(0)
    s_barrier
    s_add_u32 s71, s3, s72
    buffer_store_dwordx4 v[48:51], v0, s[8:11], s71 offen offset:2048 sc1
    buffer_store_dwordx4 v[52:55], v0, s[8:11], s71 offen offset:3072 sc1
    s_mov_b32 m0, 135168
    s_add_u32 s70, s72, 133120
    buffer_load_dwordx4 v33, s[24:27], s70 offen lds
    s_mov_b32 m0, 136192
    s_add_u32 s70, s72, 135680
    buffer_load_dwordx4 v33, s[24:27], s70 offen lds
    s_mov_b32 m0, 137216
    s_add_u32 s70, s72, 153600
    buffer_load_dwordx4 v35, s[24:27], s70 offen lds
    s_mov_b32 m0, 138240
    s_add_u32 s70, s72, 156160
    buffer_load_dwordx4 v35, s[24:27], s70 offen lds
    ds_read_b64_tr_b16 v[232:233], v16 offset:12288
    ds_read_b64_tr_b16 v[234:235], v16 offset:13312
    ds_read_b64_tr_b16 v[236:237], v20 offset:12288
    ds_read_b64_tr_b16 v[238:239], v20 offset:13312
    ds_read_b64_tr_b16 v[240:241], v17 offset:12288
    ds_read_b64_tr_b16 v[242:243], v17 offset:13312
    ds_read_b64_tr_b16 v[244:245], v21 offset:12288
    ds_read_b64_tr_b16 v[246:247], v21 offset:13312
    s_waitcnt vmcnt(26) lgkmcnt(0)
    s_barrier
    s_mov_b32 m0, 139264
    s_mov_b32 s70, 917504
    buffer_load_dwordx4 v32, s[12:15], s70 offen lds
    s_mov_b32 m0, 140288
    s_mov_b32 s70, 933888
    buffer_load_dwordx4 v32, s[12:15], s70 offen lds
    s_mov_b32 m0, 141312
    s_mov_b32 s70, 950272
    buffer_load_dwordx4 v34, s[12:15], s70 offen lds
    s_mov_b32 m0, 142336
    s_mov_b32 s70, 966656
    buffer_load_dwordx4 v34, s[12:15], s70 offen lds
    ds_read_b64_tr_b16 v[216:217], v16 offset:16384
    ds_read_b64_tr_b16 v[218:219], v16 offset:17408
    ds_read_b64_tr_b16 v[220:221], v20 offset:16384
    ds_read_b64_tr_b16 v[222:223], v20 offset:17408
    ds_read_b64_tr_b16 v[224:225], v17 offset:16384
    ds_read_b64_tr_b16 v[226:227], v17 offset:17408
    ds_read_b64_tr_b16 v[228:229], v21 offset:16384
    ds_read_b64_tr_b16 v[230:231], v21 offset:17408
    s_waitcnt vmcnt(26) lgkmcnt(0)
    s_barrier
    s_mov_b32 m0, 143360
    s_mov_b32 s70, 1441792
    buffer_load_dwordx4 v32, s[12:15], s70 offen lds
    s_mov_b32 m0, 144384
    s_mov_b32 s70, 1458176
    buffer_load_dwordx4 v32, s[12:15], s70 offen lds
    s_mov_b32 m0, 145408
    s_mov_b32 s70, 1474560
    buffer_load_dwordx4 v34, s[12:15], s70 offen lds
    s_mov_b32 m0, 146432
    s_mov_b32 s70, 1490944
    buffer_load_dwordx4 v34, s[12:15], s70 offen lds
    ds_read_b64_tr_b16 v[248:249], v16 offset:20480
    ds_read_b64_tr_b16 v[250:251], v16 offset:21504
    ds_read_b64_tr_b16 v[252:253], v20 offset:20480
    ds_read_b64_tr_b16 v[254:255], v20 offset:21504
    ds_read_b64_tr_b16 a[0:1], v17 offset:20480
    ds_read_b64_tr_b16 a[2:3], v17 offset:21504
    ds_read_b64_tr_b16 a[4:5], v21 offset:20480
    ds_read_b64_tr_b16 a[6:7], v21 offset:21504
    s_waitcnt vmcnt(26) lgkmcnt(0)
    s_barrier
    s_mov_b32 m0, 147456
    s_mov_b32 s70, 917504
    buffer_load_dwordx4 v32, s[16:19], s70 offen lds
    s_mov_b32 m0, 148480
    s_mov_b32 s70, 933888
    buffer_load_dwordx4 v32, s[16:19], s70 offen lds
    s_mov_b32 m0, 149504
    s_mov_b32 s70, 950272
    buffer_load_dwordx4 v34, s[16:19], s70 offen lds
    s_mov_b32 m0, 150528
    s_mov_b32 s70, 966656
    buffer_load_dwordx4 v34, s[16:19], s70 offen lds
    ds_read_b64_tr_b16 v[40:41], v16 offset:24576
    ds_read_b64_tr_b16 v[42:43], v16 offset:25600
    ds_read_b64_tr_b16 v[44:45], v20 offset:24576
    ds_read_b64_tr_b16 v[46:47], v20 offset:25600
    ds_read_b64_tr_b16 v[48:49], v17 offset:24576
    ds_read_b64_tr_b16 v[50:51], v17 offset:25600
    ds_read_b64_tr_b16 v[52:53], v21 offset:24576
    ds_read_b64_tr_b16 v[54:55], v21 offset:25600
    s_waitcnt vmcnt(26) lgkmcnt(0)
    s_barrier
    s_add_u32 s71, s61, s72
    buffer_store_dwordx4 v[40:43], v0, s[8:11], s71 offen offset:2048 sc1
    buffer_store_dwordx4 v[44:47], v0, s[8:11], s71 offen offset:3072 sc1
    s_add_u32 s71, s61, s72
    buffer_store_dwordx4 v[48:51], v0, s[8:11], s71 offen offset:0 sc1
    buffer_store_dwordx4 v[52:55], v0, s[8:11], s71 offen offset:1024 sc1
    s_mov_b32 m0, 151552
    s_mov_b32 s70, 2490368
    buffer_load_dwordx4 v32, s[16:19], s70 offen lds
    s_mov_b32 m0, 152576
    s_mov_b32 s70, 2506752
    buffer_load_dwordx4 v32, s[16:19], s70 offen lds
    s_mov_b32 m0, 153600
    s_mov_b32 s70, 2523136
    buffer_load_dwordx4 v34, s[16:19], s70 offen lds
    s_mov_b32 m0, 154624
    s_mov_b32 s70, 2539520
    buffer_load_dwordx4 v34, s[16:19], s70 offen lds
    ds_read_b64_tr_b16 v[56:57], v16 offset:28672
    ds_read_b64_tr_b16 v[58:59], v16 offset:29696
    ds_read_b64_tr_b16 v[60:61], v20 offset:28672
    ds_read_b64_tr_b16 v[62:63], v20 offset:29696
    ds_read_b64_tr_b16 v[88:89], v17 offset:28672
    ds_read_b64_tr_b16 v[90:91], v17 offset:29696
    ds_read_b64_tr_b16 v[92:93], v21 offset:28672
    ds_read_b64_tr_b16 v[94:95], v21 offset:29696
    s_waitcnt vmcnt(30) lgkmcnt(0)
    s_barrier
    s_add_u32 s71, s3, s72
    buffer_store_dwordx4 v[56:59], v0, s[8:11], s71 offen offset:0 sc1
    buffer_store_dwordx4 v[60:63], v0, s[8:11], s71 offen offset:1024 sc1
    s_mov_b32 m0, 155648
    s_mov_b32 s70, 3014656
    buffer_load_dwordx4 v32, s[16:19], s70 offen lds
    s_mov_b32 m0, 156672
    s_mov_b32 s70, 3031040
    buffer_load_dwordx4 v32, s[16:19], s70 offen lds
    s_mov_b32 m0, 157696
    s_mov_b32 s70, 3047424
    buffer_load_dwordx4 v34, s[16:19], s70 offen lds
    s_mov_b32 m0, 158720
    s_mov_b32 s70, 3063808
    buffer_load_dwordx4 v34, s[16:19], s70 offen lds
    ds_read_b64_tr_b16 v[40:41], v18 offset:0
    ds_read_b64_tr_b16 v[42:43], v18 offset:1024
    ds_read_b64_tr_b16 v[44:45], v22 offset:0
    ds_read_b64_tr_b16 v[46:47], v22 offset:1024
    ds_read_b64_tr_b16 v[48:49], v19 offset:0
    ds_read_b64_tr_b16 v[50:51], v19 offset:1024
    ds_read_b64_tr_b16 v[52:53], v23 offset:0
    ds_read_b64_tr_b16 v[54:55], v23 offset:1024
    s_waitcnt vmcnt(32) lgkmcnt(0)
    s_barrier
    s_add_u32 s71, s6, s72
    buffer_store_dwordx4 v[40:43], v0, s[8:11], s71 offen offset:0 sc1
    buffer_store_dwordx4 v[44:47], v0, s[8:11], s71 offen offset:1024 sc1
    s_add_u32 s71, s6, s72
    buffer_store_dwordx4 v[48:51], v0, s[8:11], s71 offen offset:2048 sc1
    buffer_store_dwordx4 v[52:55], v0, s[8:11], s71 offen offset:3072 sc1
    s_mov_b32 m0, 126976
    s_mov_b32 s70, 4063232
    buffer_load_dwordx4 v32, s[16:19], s70 offen lds
    s_mov_b32 m0, 128000
    s_mov_b32 s70, 4079616
    buffer_load_dwordx4 v32, s[16:19], s70 offen lds
    s_mov_b32 m0, 129024
    s_mov_b32 s70, 4096000
    buffer_load_dwordx4 v34, s[16:19], s70 offen lds
    s_mov_b32 m0, 130048
    s_mov_b32 s70, 4112384
    buffer_load_dwordx4 v34, s[16:19], s70 offen lds
    ds_read_b64_tr_b16 a[216:217], v18 offset:4096
    ds_read_b64_tr_b16 a[218:219], v18 offset:5120
    ds_read_b64_tr_b16 a[220:221], v22 offset:4096
    ds_read_b64_tr_b16 a[222:223], v22 offset:5120
    ds_read_b64_tr_b16 v[64:65], v19 offset:4096
    ds_read_b64_tr_b16 v[66:67], v19 offset:5120
    ds_read_b64_tr_b16 v[68:69], v23 offset:4096
    ds_read_b64_tr_b16 v[70:71], v23 offset:5120
    s_waitcnt vmcnt(34) lgkmcnt(0)
    s_barrier
    s_add_u32 s71, s7, s72
    buffer_store_dwordx4 v[64:67], v0, s[8:11], s71 offen offset:0 sc1
    buffer_store_dwordx4 v[68:71], v0, s[8:11], s71 offen offset:1024 sc1
    s_mov_b32 m0, 131072
    s_mov_b32 s70, 5111808
    buffer_load_dwordx4 v32, s[16:19], s70 offen lds
    s_mov_b32 m0, 132096
    s_mov_b32 s70, 5128192
    buffer_load_dwordx4 v32, s[16:19], s70 offen lds
    s_mov_b32 m0, 133120
    s_mov_b32 s70, 5144576
    buffer_load_dwordx4 v34, s[16:19], s70 offen lds
    s_mov_b32 m0, 134144
    s_mov_b32 s70, 5160960
    buffer_load_dwordx4 v34, s[16:19], s70 offen lds
    ds_read_b64_tr_b16 v[40:41], v18 offset:8192
    ds_read_b64_tr_b16 v[42:43], v18 offset:9216
    ds_read_b64_tr_b16 v[44:45], v22 offset:8192
    ds_read_b64_tr_b16 v[46:47], v22 offset:9216
    ds_read_b64_tr_b16 v[48:49], v19 offset:8192
    ds_read_b64_tr_b16 v[50:51], v19 offset:9216
    ds_read_b64_tr_b16 v[52:53], v23 offset:8192
    ds_read_b64_tr_b16 v[54:55], v23 offset:9216
    s_waitcnt vmcnt(36) lgkmcnt(0)
    s_barrier
    s_add_u32 s71, s5, s72
    buffer_store_dwordx4 v[40:43], v0, s[8:11], s71 offen offset:0 sc1
    buffer_store_dwordx4 v[44:47], v0, s[8:11], s71 offen offset:1024 sc1
    s_add_u32 s71, s5, s72
    buffer_store_dwordx4 v[48:51], v0, s[8:11], s71 offen offset:2048 sc1
    buffer_store_dwordx4 v[52:55], v0, s[8:11], s71 offen offset:3072 sc1
    s_mov_b32 m0, 135168
    s_mov_b32 s70, 393216
    buffer_load_dwordx4 v32, s[20:23], s70 offen lds
    s_mov_b32 m0, 136192
    s_mov_b32 s70, 409600
    buffer_load_dwordx4 v32, s[20:23], s70 offen lds
    s_mov_b32 m0, 137216
    s_mov_b32 s70, 425984
    buffer_load_dwordx4 v34, s[20:23], s70 offen lds
    s_mov_b32 m0, 138240
    s_mov_b32 s70, 442368
    buffer_load_dwordx4 v34, s[20:23], s70 offen lds
    ds_read_b64_tr_b16 v[128:129], v16 offset:12288
    ds_read_b64_tr_b16 v[130:131], v16 offset:13312
    ds_read_b64_tr_b16 v[132:133], v20 offset:12288
    ds_read_b64_tr_b16 v[134:135], v20 offset:13312
    ds_read_b64_tr_b16 v[136:137], v17 offset:12288
    ds_read_b64_tr_b16 v[138:139], v17 offset:13312
    ds_read_b64_tr_b16 v[140:141], v21 offset:12288
    ds_read_b64_tr_b16 v[142:143], v21 offset:13312
    s_waitcnt vmcnt(40) lgkmcnt(0)
    s_barrier
    s_mov_b32 m0, 139264
    s_mov_b32 s70, 917504
    buffer_load_dwordx4 v32, s[20:23], s70 offen lds
    s_mov_b32 m0, 140288
    s_mov_b32 s70, 933888
    buffer_load_dwordx4 v32, s[20:23], s70 offen lds
    s_mov_b32 m0, 141312
    s_mov_b32 s70, 950272
    buffer_load_dwordx4 v34, s[20:23], s70 offen lds
    s_mov_b32 m0, 142336
    s_mov_b32 s70, 966656
    buffer_load_dwordx4 v34, s[20:23], s70 offen lds
    ds_read_b64_tr_b16 v[112:113], v16 offset:16384
    ds_read_b64_tr_b16 v[114:115], v16 offset:17408
    ds_read_b64_tr_b16 v[116:117], v20 offset:16384
    ds_read_b64_tr_b16 v[118:119], v20 offset:17408
    ds_read_b64_tr_b16 v[120:121], v17 offset:16384
    ds_read_b64_tr_b16 v[122:123], v17 offset:17408
    ds_read_b64_tr_b16 v[124:125], v21 offset:16384
    ds_read_b64_tr_b16 v[126:127], v21 offset:17408
    s_cmp_eq_u32 s54, 0
    s_cbranch_scc1 CH3_nosend_89
    s_waitcnt vmcnt(0)
    s_cmp_lg_u32 s96, 0
    s_cbranch_scc1 RDY_ok_90
    s_mov_b32 s68, 0
RDY_lp_91:
    buffer_load_dword v24, off, s[48:51], 0 offset:32 sc1
    s_waitcnt vmcnt(0)
    v_readfirstlane_b32 s70, v24
    s_nop 0
    s_cmp_ge_u32 s70, 256
    s_cbranch_scc1 RDY_all_92
    s_sleep 8
    s_add_u32 s68, s68, 1
    s_cmp_lt_u32 s68, 65536
    s_cbranch_scc1 RDY_lp_91
    s_branch RDY_ok_90
RDY_all_92:
    v_mbcnt_lo_u32_b32 v25, -1, 0
    v_and_b32 v25, 7, v25
    v_min_u32 v26, 1, v25
    v_lshlrev_b32 v25, 2, v25
    v_lshl_add_u32 v25, v26, 7, v25
    buffer_load_dword v24, v25, s[48:51], 0 offen sc1
    s_waitcnt vmcnt(0)
    v_cmp_ne_u32 vcc, 32, v24
    s_nop 0
    s_cbranch_vccnz L_slow
RDY_ok_90:
    v_mov_b32 v24, 1
    s_add_u32 s71, s66, 12
    buffer_store_dword v24, off, s[8:11], s71 sc1
CH3_nosend_89:
    s_waitcnt vmcnt(40) lgkmcnt(0)
    s_barrier
    s_mov_b32 m0, 143360
    s_mov_b32 s70, 1441792
    buffer_load_dwordx4 v32, s[20:23], s70 offen lds
    s_mov_b32 m0, 144384
    s_mov_b32 s70, 1458176
    buffer_load_dwordx4 v32, s[20:23], s70 offen lds
    s_mov_b32 m0, 145408
    s_mov_b32 s70, 1474560
    buffer_load_dwordx4 v34, s[20:23], s70 offen lds
    s_mov_b32 m0, 146432
    s_mov_b32 s70, 1490944
    buffer_load_dwordx4 v34, s[20:23], s70 offen lds
    ds_read_b64_tr_b16 v[144:145], v16 offset:20480
    ds_read_b64_tr_b16 v[146:147], v16 offset:21504
    ds_read_b64_tr_b16 v[148:149], v20 offset:20480
    ds_read_b64_tr_b16 v[150:151], v20 offset:21504
    ds_read_b64_tr_b16 v[152:153], v17 offset:20480
    ds_read_b64_tr_b16 v[154:155], v17 offset:21504
    ds_read_b64_tr_b16 v[156:157], v21 offset:20480
    ds_read_b64_tr_b16 v[158:159], v21 offset:21504
    s_waitcnt vmcnt(36) lgkmcnt(0)
    s_barrier
    s_mov_b32 m0, 147456
    s_mov_b32 s70, 1966080
    buffer_load_dwordx4 v32, s[20:23], s70 offen lds
    s_mov_b32 m0, 148480
    s_mov_b32 s70, 1982464
    buffer_load_dwordx4 v32, s[20:23], s70 offen lds
    s_mov_b32 m0, 149504
    s_mov_b32 s70, 1998848
    buffer_load_dwordx4 v34, s[20:23], s70 offen lds
    s_mov_b32 m0, 150528
    s_mov_b32 s70, 2015232
    buffer_load_dwordx4 v34, s[20:23], s70 offen lds
    ds_read_b64_tr_b16 v[200:201], v16 offset:24576
    ds_read_b64_tr_b16 v[202:203], v16 offset:25600
    ds_read_b64_tr_b16 v[204:205], v20 offset:24576
    ds_read_b64_tr_b16 v[206:207], v20 offset:25600
    ds_read_b64_tr_b16 v[208:209], v17 offset:24576
    ds_read_b64_tr_b16 v[210:211], v17 offset:25600
    ds_read_b64_tr_b16 v[212:213], v21 offset:24576
    ds_read_b64_tr_b16 v[214:215], v21 offset:25600
    s_waitcnt vmcnt(34) lgkmcnt(0)
    s_barrier
    s_mov_b32 m0, 151552
    s_mov_b32 s70, 2490368
    buffer_load_dwordx4 v32, s[20:23], s70 offen lds
    s_mov_b32 m0, 152576
    s_mov_b32 s70, 2506752
    buffer_load_dwordx4 v32, s[20:23], s70 offen lds
    s_mov_b32 m0, 153600
    s_mov_b32 s70, 2523136
    buffer_load_dwordx4 v34, s[20:23], s70 offen lds
    s_mov_b32 m0, 154624
    s_mov_b32 s70, 2539520
    buffer_load_dwordx4 v34, s[20:23], s70 offen lds
    ds_read_b64_tr_b16 v[56:57], v16 offset:28672
    ds_read_b64_tr_b16 v[58:59], v16 offset:29696
    ds_read_b64_tr_b16 v[60:61], v20 offset:28672
    ds_read_b64_tr_b16 v[62:63], v20 offset:29696
    ds_read_b64_tr_b16 v[64:65], v17 offset:28672
    ds_read_b64_tr_b16 v[66:67], v17 offset:29696
    ds_read_b64_tr_b16 v[68:69], v21 offset:28672
    ds_read_b64_tr_b16 v[70:71], v21 offset:29696
    s_waitcnt vmcnt(30) lgkmcnt(0)
    s_barrier
    ds_write_b128 v7, v[56:59] offset:32768
    ds_write_b128 v7, v[60:63] offset:33792
    ds_write_b128 v7, v[64:67] offset:34816
    ds_write_b128 v7, v[68:71] offset:35840
    s_mov_b32 m0, 155648
    s_mov_b32 s70, 3014656
    buffer_load_dwordx4 v32, s[20:23], s70 offen lds
    s_mov_b32 m0, 156672
    s_mov_b32 s70, 3031040
    buffer_load_dwordx4 v32, s[20:23], s70 offen lds
    s_mov_b32 m0, 157696
    s_mov_b32 s70, 3047424
    buffer_load_dwordx4 v34, s[20:23], s70 offen lds
    s_mov_b32 m0, 158720
    s_mov_b32 s70, 3063808
    buffer_load_dwordx4 v34, s[20:23], s70 offen lds
    ds_read_b64_tr_b16 a[8:9], v16 offset:0
    ds_read_b64_tr_b16 a[10:11], v16 offset:1024
    ds_read_b64_tr_b16 a[12:13], v20 offset:0
    ds_read_b64_tr_b16 a[14:15], v20 offset:1024
    ds_read_b64_tr_b16 a[16:17], v17 offset:0
    ds_read_b64_tr_b16 a[18:19], v17 offset:1024
    ds_read_b64_tr_b16 a[20:21], v21 offset:0
    ds_read_b64_tr_b16 a[22:23], v21 offset:1024
    s_waitcnt vmcnt(28) lgkmcnt(0)
    s_barrier
    s_mov_b32 m0, 126976
    s_mov_b32 s70, 3538944
    buffer_load_dwordx4 v32, s[20:23], s70 offen lds
    s_mov_b32 m0, 128000
    s_mov_b32 s70, 3555328
    buffer_load_dwordx4 v32, s[20:23], s70 offen lds
    s_mov_b32 m0, 129024
    s_mov_b32 s70, 3571712
    buffer_load_dwordx4 v34, s[20:23], s70 offen lds
    s_mov_b32 m0, 130048
    s_mov_b32 s70, 3588096
    buffer_load_dwordx4 v34, s[20:23], s70 offen lds
    ds_read_b64_tr_b16 v[96:97], v16 offset:4096
    ds_read_b64_tr_b16 v[98:99], v16 offset:5120
    ds_read_b64_tr_b16 v[100:101], v20 offset:4096
    ds_read_b64_tr_b16 v[102:103], v20 offset:5120
    ds_read_b64_tr_b16 v[104:105], v17 offset:4096
    ds_read_b64_tr_b16 v[106:107], v17 offset:5120
    ds_read_b64_tr_b16 v[108:109], v21 offset:4096
    ds_read_b64_tr_b16 v[110:111], v21 offset:5120
    s_waitcnt vmcnt(24) lgkmcnt(0)
    s_barrier
    s_mov_b32 m0, 131072
    s_mov_b32 s70, 4063232
    buffer_load_dwordx4 v32, s[20:23], s70 offen lds
    s_mov_b32 m0, 132096
    s_mov_b32 s70, 4079616
    buffer_load_dwordx4 v32, s[20:23], s70 offen lds
    s_mov_b32 m0, 133120
    s_mov_b32 s70, 4096000
    buffer_load_dwordx4 v34, s[20:23], s70 offen lds
    s_mov_b32 m0, 134144
    s_mov_b32 s70, 4112384
    buffer_load_dwordx4 v34, s[20:23], s70 offen lds
    ds_read_b64_tr_b16 a[88:89], v16 offset:8192
    ds_read_b64_tr_b16 a[90:91], v16 offset:9216
    ds_read_b64_tr_b16 a[92:93], v20 offset:8192
    ds_read_b64_tr_b16 a[94:95], v20 offset:9216
    ds_read_b64_tr_b16 a[96:97], v17 offset:8192
    ds_read_b64_tr_b16 a[98:99], v17 offset:9216
    ds_read_b64_tr_b16 a[100:101], v21 offset:8192
    ds_read_b64_tr_b16 a[102:103], v21 offset:9216
    s_waitcnt vmcnt(24) lgkmcnt(0)
    s_barrier
    s_mov_b32 m0, 135168
    s_mov_b32 s70, 4587520
    buffer_load_dwordx4 v32, s[20:23], s70 offen lds
    s_mov_b32 m0, 136192
    s_mov_b32 s70, 4603904
    buffer_load_dwordx4 v32, s[20:23], s70 offen lds
    s_mov_b32 m0, 137216
    s_mov_b32 s70, 4620288
    buffer_load_dwordx4 v34, s[20:23], s70 offen lds
    s_mov_b32 m0, 138240
    s_mov_b32 s70, 4636672
    buffer_load_dwordx4 v34, s[20:23], s70 offen lds
    ds_read_b64_tr_b16 a[72:73], v16 offset:12288
    ds_read_b64_tr_b16 a[74:75], v16 offset:13312
    ds_read_b64_tr_b16 a[76:77], v20 offset:12288
    ds_read_b64_tr_b16 a[78:79], v20 offset:13312
    ds_read_b64_tr_b16 a[80:81], v17 offset:12288
    ds_read_b64_tr_b16 a[82:83], v17 offset:13312
    ds_read_b64_tr_b16 a[84:85], v21 offset:12288
    ds_read_b64_tr_b16 a[86:87], v21 offset:13312
    s_waitcnt vmcnt(24) lgkmcnt(0)
    s_barrier
    s_mov_b32 m0, 139264
    s_mov_b32 s70, 5111808
    buffer_load_dwordx4 v32, s[20:23], s70 offen lds
    s_mov_b32 m0, 140288
    s_mov_b32 s70, 5128192
    buffer_load_dwordx4 v32, s[20:23], s70 offen lds
    s_mov_b32 m0, 141312
    s_mov_b32 s70, 5144576
    buffer_load_dwordx4 v34, s[20:23], s70 offen lds
    s_mov_b32 m0, 142336
    s_mov_b32 s70, 5160960
    buffer_load_dwordx4 v34, s[20:23], s70 offen lds
    ds_read_b64_tr_b16 a[56:57], v16 offset:16384
    ds_read_b64_tr_b16 a[58:59], v16 offset:17408
    ds_read_b64_tr_b16 a[60:61], v20 offset:16384
    ds_read_b64_tr_b16 a[62:63], v20 offset:17408
    ds_read_b64_tr_b16 a[64:65], v17 offset:16384
    ds_read_b64_tr_b16 a[66:67], v17 offset:17408
    ds_read_b64_tr_b16 a[68:69], v21 offset:16384
    ds_read_b64_tr_b16 a[70:71], v21 offset:17408
    s_waitcnt vmcnt(24) lgkmcnt(0)
    s_barrier
    s_mov_b32 m0, 143360
    s_mov_b32 s70, 51200
    buffer_load_dwordx4 v33, s[24:27], s70 offen lds
    s_mov_b32 m0, 144384
    s_mov_b32 s70, 53760
    buffer_load_dwordx4 v33, s[24:27], s70 offen lds
    s_mov_b32 m0, 145408
    s_mov_b32 s70, 71680
    buffer_load_dwordx4 v35, s[24:27], s70 offen lds
    s_mov_b32 m0, 146432
    s_mov_b32 s70, 74240
    buffer_load_dwordx4 v35, s[24:27], s70 offen lds
    ds_read_b64_tr_b16 a[104:105], v16 offset:20480
    ds_read_b64_tr_b16 a[106:107], v16 offset:21504
    ds_read_b64_tr_b16 a[108:109], v20 offset:20480
    ds_read_b64_tr_b16 a[110:111], v20 offset:21504
    ds_read_b64_tr_b16 a[112:113], v17 offset:20480
    ds_read_b64_tr_b16 a[114:115], v17 offset:21504
    ds_read_b64_tr_b16 a[116:117], v21 offset:20480
    ds_read_b64_tr_b16 a[118:119], v21 offset:21504
    s_waitcnt vmcnt(24) lgkmcnt(0)
    s_barrier
    s_mov_b32 m0, 147456
    s_mov_b32 s70, 51968
    buffer_load_dwordx4 v33, s[24:27], s70 offen lds
    s_mov_b32 m0, 148480
    s_mov_b32 s70, 54528
    buffer_load_dwordx4 v33, s[24:27], s70 offen lds
    s_mov_b32 m0, 149504
    s_mov_b32 s70, 72448
    buffer_load_dwordx4 v35, s[24:27], s70 offen lds
    s_mov_b32 m0, 150528
    s_mov_b32 s70, 75008
    buffer_load_dwordx4 v35, s[24:27], s70 offen lds
    ds_read_b64_tr_b16 a[120:121], v16 offset:24576
    ds_read_b64_tr_b16 a[122:123], v16 offset:25600
    ds_read_b64_tr_b16 a[124:125], v20 offset:24576
    ds_read_b64_tr_b16 a[126:127], v20 offset:25600
    ds_read_b64_tr_b16 a[128:129], v17 offset:24576
    ds_read_b64_tr_b16 a[130:131], v17 offset:25600
    ds_read_b64_tr_b16 a[132:133], v21 offset:24576
    ds_read_b64_tr_b16 a[134:135], v21 offset:25600
    s_waitcnt vmcnt(24) lgkmcnt(0)
    s_barrier
    s_mov_b32 m0, 151552
    s_mov_b32 s70, 52224
    buffer_load_dwordx4 v33, s[24:27], s70 offen lds
    s_mov_b32 m0, 152576
    s_mov_b32 s70, 54784
    buffer_load_dwordx4 v33, s[24:27], s70 offen lds
    s_mov_b32 m0, 153600
    s_mov_b32 s70, 72704
    buffer_load_dwordx4 v35, s[24:27], s70 offen lds
    s_mov_b32 m0, 154624
    s_mov_b32 s70, 75264
    buffer_load_dwordx4 v35, s[24:27], s70 offen lds
    ds_read_b64_tr_b16 a[152:153], v16 offset:28672
    ds_read_b64_tr_b16 a[154:155], v16 offset:29696
    ds_read_b64_tr_b16 a[156:157], v20 offset:28672
    ds_read_b64_tr_b16 a[158:159], v20 offset:29696
    ds_read_b64_tr_b16 a[160:161], v17 offset:28672
    ds_read_b64_tr_b16 a[162:163], v17 offset:29696
    ds_read_b64_tr_b16 a[164:165], v21 offset:28672
    ds_read_b64_tr_b16 a[166:167], v21 offset:29696
    s_waitcnt vmcnt(24) lgkmcnt(0)
    s_barrier
    s_mov_b32 m0, 155648
    s_mov_b32 s70, 133376
    buffer_load_dwordx4 v33, s[24:27], s70 offen lds
    s_mov_b32 m0, 156672
    s_mov_b32 s70, 135936
    buffer_load_dwordx4 v33, s[24:27], s70 offen lds
    s_mov_b32 m0, 157696
    s_mov_b32 s70, 153856
    buffer_load_dwordx4 v35, s[24:27], s70 offen lds
    s_mov_b32 m0, 158720
    s_mov_b32 s70, 156416
    buffer_load_dwordx4 v35, s[24:27], s70 offen lds
    ds_read_b64_tr_b16 a[136:137], v16 offset:0
    ds_read_b64_tr_b16 a[138:139], v16 offset:1024
    ds_read_b64_tr_b16 a[140:141], v20 offset:0
    ds_read_b64_tr_b16 a[142:143], v20 offset:1024
    ds_read_b64_tr_b16 a[144:145], v17 offset:0
    ds_read_b64_tr_b16 a[146:147], v17 offset:1024
    ds_read_b64_tr_b16 a[148:149], v21 offset:0
    ds_read_b64_tr_b16 a[150:151], v21 offset:1024
    s_waitcnt vmcnt(24) lgkmcnt(0)
    s_barrier
    s_mov_b32 m0, 126976
    s_mov_b32 s70, 393216
    buffer_load_dwordx4 v32, s[16:19], s70 offen lds
    s_mov_b32 m0, 128000
    s_mov_b32 s70, 409600
    buffer_load_dwordx4 v32, s[16:19], s70 offen lds
    s_mov_b32 m0, 129024
    s_mov_b32 s70, 425984
    buffer_load_dwordx4 v34, s[16:19], s70 offen lds
    s_mov_b32 m0, 130048
    s_mov_b32 s70, 442368
    buffer_load_dwordx4 v34, s[16:19], s70 offen lds
    ds_read_b64_tr_b16 a[168:169], v16 offset:4096
    ds_read_b64_tr_b16 a[170:171], v16 offset:5120
    ds_read_b64_tr_b16 a[172:173], v20 offset:4096
    ds_read_b64_tr_b16 a[174:175], v20 offset:5120
    ds_read_b64_tr_b16 a[176:177], v17 offset:4096
    ds_read_b64_tr_b16 a[178:179], v17 offset:5120
    ds_read_b64_tr_b16 a[180:181], v21 offset:4096
    ds_read_b64_tr_b16 a[182:183], v21 offset:5120
    s_waitcnt vmcnt(24) lgkmcnt(0)
    s_barrier
    s_mov_b32 m0, 131072
    s_mov_b32 s70, 1441792
    buffer_load_dwordx4 v32, s[16:19], s70 offen lds
    s_mov_b32 m0, 132096
    s_mov_b32 s70, 1458176
    buffer_load_dwordx4 v32, s[16:19], s70 offen lds
    s_mov_b32 m0, 133120
    s_mov_b32 s70, 1474560
    buffer_load_dwordx4 v34, s[16:19], s70 offen lds
    s_mov_b32 m0, 134144
    s_mov_b32 s70, 1490944
    buffer_load_dwordx4 v34, s[16:19], s70 offen lds
    ds_read_b64_tr_b16 a[24:25], v16 offset:8192
    ds_read_b64_tr_b16 a[26:27], v16 offset:9216
    ds_read_b64_tr_b16 a[28:29], v20 offset:8192
    ds_read_b64_tr_b16 a[30:31], v20 offset:9216
    ds_read_b64_tr_b16 a[32:33], v17 offset:8192
    ds_read_b64_tr_b16 a[34:35], v17 offset:9216
    ds_read_b64_tr_b16 a[36:37], v21 offset:8192
    ds_read_b64_tr_b16 a[38:39], v21 offset:9216
    s_waitcnt vmcnt(24) lgkmcnt(0)
    s_barrier
    s_mov_b32 m0, 135168
    s_mov_b32 s70, 1966080
    buffer_load_dwordx4 v32, s[16:19], s70 offen lds
    s_mov_b32 m0, 136192
    s_mov_b32 s70, 1982464
    buffer_load_dwordx4 v32, s[16:19], s70 offen lds
    s_mov_b32 m0, 137216
    s_mov_b32 s70, 1998848
    buffer_load_dwordx4 v34, s[16:19], s70 offen lds
    s_mov_b32 m0, 138240
    s_mov_b32 s70, 2015232
    buffer_load_dwordx4 v34, s[16:19], s70 offen lds
    ds_read_b64_tr_b16 a[40:41], v16 offset:12288
    ds_read_b64_tr_b16 a[42:43], v16 offset:13312
    ds_read_b64_tr_b16 a[44:45], v20 offset:12288
    ds_read_b64_tr_b16 a[46:47], v20 offset:13312
    ds_read_b64_tr_b16 a[48:49], v17 offset:12288
    ds_read_b64_tr_b16 a[50:51], v17 offset:13312
    ds_read_b64_tr_b16 a[52:53], v21 offset:12288
    ds_read_b64_tr_b16 a[54:55], v21 offset:13312
    s_waitcnt vmcnt(24) lgkmcnt(0)
    s_barrier
    s_mov_b32 m0, 139264
    s_mov_b32 s70, 3538944
    buffer_load_dwordx4 v32, s[16:19], s70 offen lds
    s_mov_b32 m0, 140288
    s_mov_b32 s70, 3555328
    buffer_load_dwordx4 v32, s[16:19], s70 offen lds
    s_mov_b32 m0, 141312
    s_mov_b32 s70, 3571712
    buffer_load_dwordx4 v34, s[16:19], s70 offen lds
    s_mov_b32 m0, 142336
    s_mov_b32 s70, 3588096
    buffer_load_dwordx4 v34, s[16:19], s70 offen lds
    ds_read_b64_tr_b16 a[184:185], v18 offset:16384
    ds_read_b64_tr_b16 a[186:187], v18 offset:17408
    ds_read_b64_tr_b16 a[188:189], v22 offset:16384
    ds_read_b64_tr_b16 a[190:191], v22 offset:17408
    ds_read_b64_tr_b16 a[192:193], v19 offset:16384
    ds_read_b64_tr_b16 a[194:195], v19 offset:17408
    ds_read_b64_tr_b16 a[196:197], v23 offset:16384
    ds_read_b64_tr_b16 a[198:199], v23 offset:17408
    s_waitcnt vmcnt(24) lgkmcnt(0)
    s_barrier
    s_mov_b32 m0, 143360
    s_mov_b32 s70, 4587520
    buffer_load_dwordx4 v32, s[16:19], s70 offen lds
    s_mov_b32 m0, 144384
    s_mov_b32 s70, 4603904
    buffer_load_dwordx4 v32, s[16:19], s70 offen lds
    s_mov_b32 m0, 145408
    s_mov_b32 s70, 4620288
    buffer_load_dwordx4 v34, s[16:19], s70 offen lds
    s_mov_b32 m0, 146432
    s_mov_b32 s70, 4636672
    buffer_load_dwordx4 v34, s[16:19], s70 offen lds
    ds_read_b64_tr_b16 a[224:225], v18 offset:20480
    ds_read_b64_tr_b16 a[226:227], v18 offset:21504
    ds_read_b64_tr_b16 a[228:229], v22 offset:20480
    ds_read_b64_tr_b16 a[230:231], v22 offset:21504
    ds_read_b64_tr_b16 a[232:233], v19 offset:20480
    ds_read_b64_tr_b16 a[234:235], v19 offset:21504
    ds_read_b64_tr_b16 a[236:237], v23 offset:20480
    ds_read_b64_tr_b16 a[238:239], v23 offset:21504
    s_waitcnt vmcnt(24) lgkmcnt(0)
    s_barrier
    s_mov_b32 m0, 147456
    s_mov_b32 s70, 133632
    buffer_load_dwordx4 v33, s[24:27], s70 offen lds
    s_mov_b32 m0, 148480
    s_mov_b32 s70, 136192
    buffer_load_dwordx4 v33, s[24:27], s70 offen lds
    s_mov_b32 m0, 149504
    s_mov_b32 s70, 154112
    buffer_load_dwordx4 v35, s[24:27], s70 offen lds
    s_mov_b32 m0, 150528
    s_mov_b32 s70, 156672
    buffer_load_dwordx4 v35, s[24:27], s70 offen lds
    ds_read_b64_tr_b16 a[240:241], v18 offset:24576
    ds_read_b64_tr_b16 a[242:243], v18 offset:25600
    ds_read_b64_tr_b16 a[244:245], v22 offset:24576
    ds_read_b64_tr_b16 a[246:247], v22 offset:25600
    ds_read_b64_tr_b16 a[248:249], v19 offset:24576
    ds_read_b64_tr_b16 a[250:251], v19 offset:25600
    ds_read_b64_tr_b16 a[252:253], v23 offset:24576
    ds_read_b64_tr_b16 a[254:255], v23 offset:25600
    s_waitcnt vmcnt(24) lgkmcnt(0)
    s_barrier
    s_mov_b32 m0, 151552
    s_mov_b32 s70, 133888
    buffer_load_dwordx4 v33, s[24:27], s70 offen lds
    s_mov_b32 m0, 152576
    s_mov_b32 s70, 136448
    buffer_load_dwordx4 v33, s[24:27], s70 offen lds
    s_mov_b32 m0, 153600
    s_mov_b32 s70, 154368
    buffer_load_dwordx4 v35, s[24:27], s70 offen lds
    s_mov_b32 m0, 154624
    s_mov_b32 s70, 156928
    buffer_load_dwordx4 v35, s[24:27], s70 offen lds
    ds_read_b64_tr_b16 a[200:201], v18 offset:28672
    ds_read_b64_tr_b16 a[202:203], v18 offset:29696
    ds_read_b64_tr_b16 a[204:205], v22 offset:28672
    ds_read_b64_tr_b16 a[206:207], v22 offset:29696
    ds_read_b64_tr_b16 a[208:209], v19 offset:28672
    ds_read_b64_tr_b16 a[210:211], v19 offset:29696
    ds_read_b64_tr_b16 a[212:213], v23 offset:28672
    ds_read_b64_tr_b16 a[214:215], v23 offset:29696
    s_waitcnt vmcnt(24) lgkmcnt(0)
    s_barrier
    s_mov_b32 m0, 155648
    s_mov_b32 s70, 134144
    buffer_load_dwordx4 v33, s[24:27], s70 offen lds
    s_mov_b32 m0, 156672
    s_mov_b32 s70, 136704
    buffer_load_dwordx4 v33, s[24:27], s70 offen lds
    s_mov_b32 m0, 157696
    s_mov_b32 s70, 154624
    buffer_load_dwordx4 v35, s[24:27], s70 offen lds
    s_mov_b32 m0, 158720
    s_mov_b32 s70, 157184
    buffer_load_dwordx4 v35, s[24:27], s70 offen lds
    ds_read_b64_tr_b16 v[40:41], v16 offset:0
    ds_read_b64_tr_b16 v[42:43], v16 offset:1024
    ds_read_b64_tr_b16 v[44:45], v20 offset:0
    ds_read_b64_tr_b16 v[46:47], v20 offset:1024
    ds_read_b64_tr_b16 v[48:49], v17 offset:0
    ds_read_b64_tr_b16 v[50:51], v17 offset:1024
    ds_read_b64_tr_b16 v[52:53], v21 offset:0
    ds_read_b64_tr_b16 v[54:55], v21 offset:1024
    v_lshrrev_b32 v24, 4, v0
    v_bfe_u32 v25, v24, 2, 2
    v_lshlrev_b32 v25, 1, v25
    v_and_b32 v26, 1, v24
    v_add_u32 v25, v25, v26
    v_mul_u32_u24 v25, 1280, v25
    v_lshrrev_b32 v26, 4, v24
    v_lshl_add_u32 v25, v26, 5, v25
    v_bfe_u32 v26, v24, 1, 1
    v_lshl_add_u32 v25, v26, 4, v25
    buffer_load_dwordx4 v[8:11], v25, s[32:35], 0 offen offset:1024
    buffer_load_dwordx4 v[12:15], v25, s[32:35], 0 offen offset:1152
    v_and_b32 v26, 7, v24
    v_min_u32 v27, 1, v26
    v_lshlrev_b32 v26, 2, v26
    v_lshl_add_u32 v26, v27, 7, v26
    buffer_load_dword v72, off, s[48:51], 0 offset:32 sc1
    buffer_load_dword v73, v26, s[48:51], 0 offen sc1
    v_lshlrev_b32 v24, 3, v0
    buffer_load_dwordx4 v[28:31], v0, s[8:11], s59 offen offset:0 sc1
    buffer_load_dwordx4 v[28:31], v0, s[8:11], s59 offen offset:1024 sc1
    s_add_u32 s70, s56, 15360
    buffer_load_dword v74, v24, s[8:11], s70 offen sc1
    s_sub_u32 s70, s63, 6144
    buffer_load_dword v80, v24, s[8:11], s70 offen sc1
    s_waitcnt vmcnt(32) lgkmcnt(0)
    s_barrier
    ds_write_b128 v7, v[40:43] offset:0
    ds_write_b128 v7, v[44:47] offset:1024
    ds_write_b128 v7, v[48:51] offset:2048
    ds_write_b128 v7, v[52:55] offset:3072
    ds_read_b64_tr_b16 v[56:57], v16 offset:4096
    ds_read_b64_tr_b16 v[58:59], v16 offset:5120
    ds_read_b64_tr_b16 v[60:61], v20 offset:4096
    ds_read_b64_tr_b16 v[62:63], v20 offset:5120
    ds_read_b64_tr_b16 v[64:65], v17 offset:4096
    ds_read_b64_tr_b16 v[66:67], v17 offset:5120
    ds_read_b64_tr_b16 v[68:69], v21 offset:4096
    ds_read_b64_tr_b16 v[70:71], v21 offset:5120
    s_waitcnt vmcnt(28) lgkmcnt(0)
    s_barrier
    ds_write_b128 v7, v[56:59] offset:4096
    ds_write_b128 v7, v[60:63] offset:5120
    ds_write_b128 v7, v[64:67] offset:6144
    ds_write_b128 v7, v[68:71] offset:7168
    ds_read_b64_tr_b16 v[40:41], v16 offset:8192
    ds_read_b64_tr_b16 v[42:43], v16 offset:9216
    ds_read_b64_tr_b16 v[44:45], v20 offset:8192
    ds_read_b64_tr_b16 v[46:47], v20 offset:9216
    ds_read_b64_tr_b16 v[48:49], v17 offset:8192
    ds_read_b64_tr_b16 v[50:51], v17 offset:9216
    ds_read_b64_tr_b16 v[52:53], v21 offset:8192
    ds_read_b64_tr_b16 v[54:55], v21 offset:9216
    s_waitcnt vmcnt(24) lgkmcnt(0)
    s_barrier
    ds_write_b128 v7, v[40:43] offset:8192
    ds_write_b128 v7, v[44:47] offset:9216
    ds_write_b128 v7, v[48:51] offset:10240
    ds_write_b128 v7, v[52:55] offset:11264
    ds_read_b64_tr_b16 v[56:57], v16 offset:12288
    ds_read_b64_tr_b16 v[58:59], v16 offset:13312
    ds_read_b64_tr_b16 v[60:61], v20 offset:12288
    ds_read_b64_tr_b16 v[62:63], v20 offset:13312
    ds_read_b64_tr_b16 v[64:65], v17 offset:12288
    ds_read_b64_tr_b16 v[66:67], v17 offset:13312
    ds_read_b64_tr_b16 v[68:69], v21 offset:12288
    ds_read_b64_tr_b16 v[70:71], v21 offset:13312
    s_waitcnt vmcnt(20) lgkmcnt(0)
    s_barrier
    ds_write_b128 v7, v[56:59] offset:12288
    ds_write_b128 v7, v[60:63] offset:13312
    ds_write_b128 v7, v[64:67] offset:14336
    ds_write_b128 v7, v[68:71] offset:15360
    ds_read_b64_tr_b16 v[40:41], v16 offset:16384
    ds_read_b64_tr_b16 v[42:43], v16 offset:17408
    ds_read_b64_tr_b16 v[44:45], v20 offset:16384
    ds_read_b64_tr_b16 v[46:47], v20 offset:17408
    ds_read_b64_tr_b16 v[48:49], v17 offset:16384
    ds_read_b64_tr_b16 v[50:51], v17 offset:17408
    ds_read_b64_tr_b16 v[52:53], v21 offset:16384
    ds_read_b64_tr_b16 v[54:55], v21 offset:17408
    s_waitcnt vmcnt(16) lgkmcnt(0)
    s_barrier
    ds_write_b128 v7, v[40:43] offset:16384
    ds_write_b128 v7, v[44:47] offset:17408
    ds_write_b128 v7, v[48:51] offset:18432
    ds_write_b128 v7, v[52:55] offset:19456
    ds_read_b64_tr_b16 v[56:57], v18 offset:20480
    ds_read_b64_tr_b16 v[58:59], v18 offset:21504
    ds_read_b64_tr_b16 v[60:61], v22 offset:20480
    ds_read_b64_tr_b16 v[62:63], v22 offset:21504
    ds_read_b64_tr_b16 v[64:65], v19 offset:20480
    ds_read_b64_tr_b16 v[66:67], v19 offset:21504
    ds_read_b64_tr_b16 v[68:69], v23 offset:20480
    ds_read_b64_tr_b16 v[70:71], v23 offset:21504
    s_waitcnt vmcnt(12) lgkmcnt(0)
    s_barrier
    ds_write_b128 v7, v[56:59] offset:20480
    ds_write_b128 v7, v[60:63] offset:21504
    ds_write_b128 v7, v[64:67] offset:22528
    ds_write_b128 v7, v[68:71] offset:23552
    ds_read_b64_tr_b16 v[40:41], v18 offset:24576
    ds_read_b64_tr_b16 v[42:43], v18 offset:25600
    ds_read_b64_tr_b16 v[44:45], v22 offset:24576
    ds_read_b64_tr_b16 v[46:47], v22 offset:25600
    ds_read_b64_tr_b16 v[48:49], v19 offset:24576
    ds_read_b64_tr_b16 v[50:51], v19 offset:25600
    ds_read_b64_tr_b16 v[52:53], v23 offset:24576
    ds_read_b64_tr_b16 v[54:55], v23 offset:25600
    s_waitcnt vmcnt(8) lgkmcnt(0)
    s_barrier
    ds_write_b128 v7, v[40:43] offset:24576
    ds_write_b128 v7, v[44:47] offset:25600
    ds_write_b128 v7, v[48:51] offset:26624
    ds_write_b128 v7, v[52:55] offset:27648
    ds_read_b64_tr_b16 v[56:57], v18 offset:28672
    ds_read_b64_tr_b16 v[58:59], v18 offset:29696
    ds_read_b64_tr_b16 v[60:61], v22 offset:28672
    ds_read_b64_tr_b16 v[62:63], v22 offset:29696
    ds_read_b64_tr_b16 v[64:65], v19 offset:28672
    ds_read_b64_tr_b16 v[66:67], v19 offset:29696
    ds_read_b64_tr_b16 v[68:69], v23 offset:28672
    ds_read_b64_tr_b16 v[70:71], v23 offset:29696
    s_waitcnt vmcnt(0)
    s_lshl_b32 s71, s53, 7
    s_add_u32 s71, s71, 24588
    buffer_load_dword v75, off, s[8:11], s71 sc1
    buffer_load_dwordx2 v[86:87], v85, s[8:11], s78 offen sc1
    s_waitcnt lgkmcnt(0)
    s_barrier
    ds_write_b128 v7, v[56:59] offset:28672
    ds_write_b128 v7, v[60:63] offset:29696
    ds_write_b128 v7, v[64:67] offset:30720
    ds_write_b128 v7, v[68:71] offset:31744
    s_waitcnt vmcnt(0) lgkmcnt(0)
    v_readfirstlane_b32 s70, v72
    v_cmp_ne_u32 vcc, 32, v73
    s_cmp_ge_u32 s70, 256
    s_cselect_b32 s70, vcc_lo, 1
    s_cmp_eq_u32 s70, 0
    s_cbranch_scc1 CH3_rdy
    s_cmp_lg_u32 s96, 0
    s_cbranch_scc1 RDY_ok_93
    s_mov_b32 s68, 0
RDY_lp_94:
    buffer_load_dword v40, off, s[48:51], 0 offset:32 sc1
    s_waitcnt vmcnt(0)
    v_readfirstlane_b32 s70, v40
    s_nop 0
    s_cmp_ge_u32 s70, 256
    s_cbranch_scc1 RDY_all_95
    s_sleep 8
    s_add_u32 s68, s68, 1
    s_cmp_lt_u32 s68, 65536
    s_cbranch_scc1 RDY_lp_94
    s_branch RDY_ok_93
RDY_all_95:
    v_mbcnt_lo_u32_b32 v41, -1, 0
    v_and_b32 v41, 7, v41
    v_min_u32 v42, 1, v41
    v_lshlrev_b32 v41, 2, v41
    v_lshl_add_u32 v41, v42, 7, v41
    buffer_load_dword v40, v41, s[48:51], 0 offen sc1
    s_waitcnt vmcnt(0)
    v_cmp_ne_u32 vcc, 32, v40
    s_nop 0
    s_cbranch_vccnz L_slow
RDY_ok_93:
    v_mov_b32 v75, 0
    v_mov_b64 v[86:87], 0
CH3_rdy:
    s_mov_b32 s40, 0x3f803f80
    s_mov_b32 s41, 0x3f803f80
    ds_write_b128 v0, v[12:15] offset:9216
    v_mov_b64 v[36:37], v[12:13]
    v_mov_b64 v[38:39], v[14:15]
    ds_write_b128 v0, v[8:11] offset:8192
    v_mov_b64 v[32:33], v[8:9]
    v_mov_b64 v[34:35], v[10:11]
    s_lshl_b32 s71, s53, 7
    s_add_u32 s71, s71, 24588
    s_mov_b32 s68, 0
    v_readfirstlane_b32 s70, v75
    s_nop 0
    s_cmp_lg_u32 s70, 0
    s_cbranch_scc1 CH3_sok
CH3_sw:
    buffer_load_dword v72, off, s[8:11], s71 sc1
    s_waitcnt vmcnt(0)
    v_readfirstlane_b32 s70, v72
    s_nop 0
    s_cmp_lg_u32 s70, 0
    s_cbranch_scc1 CH3_sok
    s_sleep 2
    s_add_u32 s68, s68, 1
    s_cmp_lt_u32 s68, 65536
    s_cbranch_scc1 CH3_sw
CH3_sok:
    buffer_load_dwordx4 v[40:43], v0, s[8:11], s61 offen offset:2048
    buffer_load_dwordx4 v[44:47], v0, s[8:11], s61 offen offset:3072
    buffer_load_dwordx4 v[72:75], v0, s[8:11], s61 offen offset:0
    buffer_load_dwordx4 v[76:79], v0, s[8:11], s61 offen offset:1024
    ds_read_b128 v[56:59], v7 offset:16384
    ds_read_b128 v[60:63], v7 offset:17408
    ds_read_b128 v[64:67], v7 offset:18432
    ds_read_b128 v[68:71], v7 offset:19456
    buffer_load_dwordx4 v[48:51], v0, s[8:11], s3 offen offset:0
    buffer_load_dwordx4 v[52:55], v0, s[8:11], s3 offen offset:1024
    s_waitcnt lgkmcnt(0)
    v_mov_b64 v[8:9], 0
    v_mov_b64 v[10:11], 0
    v_mov_b64 v[12:13], 0
    v_mov_b64 v[14:15], 0
    v_mov_b64 v[16:17], 0
    v_mov_b64 v[18:19], 0
    v_mov_b64 v[20:21], 0
    v_mov_b64 v[22:23], 0
    s_cmp_lg_u32 s96, 0
    s_cbranch_scc1 CHS3_start
CHF3_start:
    v_min_u32 v80, v86, v87
    s_nop 0
    v_readlane_b32 s70, v80, 0
    v_readlane_b32 s73, v80, 1
    s_nop 0
    s_min_u32 s70, s70, s73
    s_max_u32 s67, s67, s70
    s_cmp_gt_u32 s67, s55
    s_cbranch_scc1 CHF3_inok_96
    s_mov_b32 s68, 0
CHF3_inlp_97:
    buffer_load_dwordx2 v[86:87], v85, s[8:11], s78 offen sc1
    s_waitcnt vmcnt(0)
    v_min_u32 v80, v86, v87
    s_nop 0
    v_readlane_b32 s70, v80, 0
    v_readlane_b32 s73, v80, 1
    s_nop 0
    s_min_u32 s70, s70, s73
    s_max_u32 s67, s67, s70
    s_cmp_gt_u32 s67, s55
    s_cbranch_scc1 CHF3_inok_96
    s_cmp_lg_u32 s69, 0
    s_cbranch_scc1 CHF3_inok_96
    s_sleep 2
    s_add_u32 s68, s68, 1
    s_cmp_lt_u32 s68, 65536
    s_cbranch_scc1 CHF3_inlp_97
    s_mov_b32 s69, 1
CHF3_inok_96:
    s_barrier
    s_mov_b32 m0, 22528
    s_nop 0
    buffer_load_dwordx4 v0, s[8:11], s63 offen offset:0 sc1 lds
    buffer_load_dwordx4 v0, s[8:11], s63 offen offset:1024 sc1 lds
    s_add_u32 s63, s63, 262144
    s_add_u32 s38, s55, 1
    s_cmp_lt_u32 s38, 64
    s_cselect_b32 s70, 0, 262144
    s_sub_u32 s36, s63, s70
    s_sub_u32 s36, s36, 6144
    s_add_u32 s37, s36, 33554432
    s_add_u32 s70, s55, 2
    s_cmp_gt_u32 s67, s70
    s_cselect_b32 s37, 0x20000000, s78
    s_max_u32 s70, s55, 1
    s_sub_u32 s70, s70, 1
    v_mov_b32 v84, s70
    s_waitcnt vmcnt(0) lgkmcnt(0)
CHF3_loop:
    s_barrier
    ds_read_b128 v[28:31], v0 offset:2048
    v_mov_b32 v23, 0
    v_smfmac_f32_16x16x64_bf16 v[8:11], v[32:35], v[40:47], v1
    buffer_load_dwordx4 v[40:43], v0, s[8:11], s3 offen offset:2048
    v_smfmac_f32_16x16x64_bf16 v[12:15], v[32:35], v[72:79], v1
    buffer_load_dwordx4 v[44:47], v0, s[8:11], s3 offen offset:3072
    v_smfmac_f32_16x16x64_bf16 v[16:19], v[32:35], v[56:63], v1
    ds_read_b128 v[56:59], v7 offset:4096
    v_smfmac_f32_16x16x64_bf16 v[20:23], v[32:35], v[64:71], v1
    ds_read_b128 v[32:35], v0 offset:1024
    ds_read_b128 v[60:63], v7 offset:5120
    v_smfmac_f32_16x16x64_bf16 v[8:11], v[36:39], v[48:55], v1
    ds_read_b128 v[64:67], v7 offset:6144
    v_smfmac_f32_16x16x64_bf16 v[12:15], v[36:39], v[88:95], v1
    ds_read_b128 v[68:71], v7 offset:7168
    v_smfmac_f32_16x16x64_bf16 v[16:19], v[36:39], v[96:103], v1
    ds_read_b128 v[72:75], v7 offset:0
    buffer_load_dwordx4 v[48:51], v0, s[8:11], s62 offen offset:0 sc1
    v_smfmac_f32_16x16x64_bf16 v[20:23], v[36:39], v[104:111], v1
    ds_read_b128 v[36:39], v0 offset:0
    s_waitcnt lgkmcnt(7)
    v_smfmac_f32_16x16x64_bf16 v[8:11], v[28:31], v[112:119], v1
    ds_read_b128 v[76:79], v7 offset:1024
    buffer_load_dwordx4 v[52:55], v0, s[8:11], s62 offen offset:1024 sc1
    v_smfmac_f32_16x16x64_bf16 v[12:15], v[28:31], v[120:127], v1
    buffer_store_dwordx4 v[24:27], v0, s[8:11], s64 offen sc1
    s_waitcnt lgkmcnt(3)
    v_smfmac_f32_16x16x64_bf16 v[16:19], v[28:31], v[56:63], v1
    ds_read_b128 v[24:27], v0 offset:3072
    ds_read_b128 v[56:59], v7 offset:2048
    ds_read_b128 v[60:63], v7 offset:3072
    buffer_load_dword v80, v83, s[8:11], s36 offen sc1
    v_smfmac_f32_16x16x64_bf16 v[20:23], v[28:31], v[64:71], v1
    ds_read_b128 v[28:31], v0 offset:4096
    v_smfmac_f32_16x16x64_bf16 v[8:11], v[32:35], v[128:135], v1
    ds_read_b128 v[64:67], v7 offset:8192
    v_smfmac_f32_16x16x64_bf16 v[12:15], v[32:35], v[136:143], v1
    ds_read_b128 v[68:71], v7 offset:9216
    v_smfmac_f32_16x16x64_bf16 v[16:19], v[32:35], v[144:151], v1
    buffer_load_dwordx2 v[86:87], v85, s[8:11], s37 offen sc1
    v_smfmac_f32_16x16x64_bf16 v[20:23], v[32:35], v[152:159], v1
    ds_read_b128 v[32:35], v0 offset:5120
    s_waitcnt lgkmcnt(4)
    v_smfmac_f32_16x16x64_bf16 v[16:19], v[36:39], v[72:79], v1
    ds_read_b128 v[72:75], v7 offset:10240
    ds_read_b128 v[76:79], v7 offset:11264
    v_smfmac_f32_16x16x64_bf16 v[20:23], v[36:39], v[56:63], v1
    v_smfmac_f32_16x16x64_bf16 v[8:11], v[36:39], v[160:167], v1
    ds_read_b128 v[56:59], v7 offset:12288
    v_smfmac_f32_16x16x64_bf16 v[12:15], v[36:39], v[168:175], v1
    ds_read_b128 v[36:39], v0 offset:7168
    v_smfmac_f32_16x16x64_bf16 v[8:11], v[24:27], v[176:183], v1
    ds_read_b128 v[60:63], v7 offset:13312
    v_smfmac_f32_16x16x64_bf16 v[12:15], v[24:27], v[184:191], v1
    s_waitcnt lgkmcnt(3)
    v_smfmac_f32_16x16x64_bf16 v[16:19], v[24:27], v[64:71], v1
    ds_read_b128 v[64:67], v7 offset:14336
    ds_read_b128 v[68:71], v7 offset:15360
    v_smfmac_f32_16x16x64_bf16 v[20:23], v[24:27], v[72:79], v1
    ds_read_b128 v[24:27], v0 offset:6144
    v_smfmac_f32_16x16x64_bf16 v[8:11], v[28:31], v[192:199], v1
    ds_read_b128 v[72:75], v7 offset:32768
    s_waitcnt vmcnt(5)
    v_smfmac_f32_16x16x64_bf16 v[12:15], v[28:31], v[40:47], v1
    ds_read_b128 v[76:79], v7 offset:33792
    v_smfmac_f32_16x16x64_bf16 v[16:19], v[28:31], v[200:207], v1
    v_smfmac_f32_16x16x64_bf16 v[20:23], v[28:31], v[208:215], v1
    s_waitcnt lgkmcnt(2)
    v_smfmac_f32_16x16x64_bf16 v[16:19], v[24:27], v[56:63], v1
    ds_read_b128 v[56:59], v7 offset:34816
    ds_read_b128 v[60:63], v7 offset:35840
    v_mov_b64 v[28:29], 0
    v_smfmac_f32_16x16x64_bf16 v[20:23], v[24:27], v[64:71], v1
    v_mov_b64 v[30:31], 0
    v_smfmac_f32_16x16x64_bf16 v[8:11], v[24:27], v[216:223], v1
    ds_read_b128 v[40:43], v0 offset:16384
    v_smfmac_f32_16x16x64_bf16 v[12:15], v[24:27], v[224:231], v1
    ds_read_b128 v[44:47], v0 offset:20480
    v_smfmac_f32_16x16x64_bf16 v[8:11], v[32:35], v[232:239], v1
    v_mov_b64 v[24:25], 0
    v_smfmac_f32_16x16x64_bf16 v[12:15], v[32:35], v[240:247], v1
    v_mov_b64 v[26:27], 0
    s_waitcnt lgkmcnt(2)
    v_smfmac_f32_16x16x64_bf16 v[16:19], v[32:35], v[72:79], v1
    v_smfmac_f32_16x16x64_bf16 v[20:23], v[32:35], v[56:63], v1
    v_smfmac_f32_16x16x64_bf16 v[8:11], v[36:39], v[248:255], v1
    ds_read_b128 v[64:67], v0 offset:17408
    v_smfmac_f32_16x16x64_bf16 v[12:15], v[36:39], a[0:7], v1
    ds_read_b128 v[68:71], v0 offset:21504
    v_smfmac_f32_16x16x64_bf16 v[16:19], v[36:39], a[8:15], v1
    v_smfmac_f32_16x16x64_bf16 v[20:23], v[36:39], a[16:23], v1
    v_smfmac_f32_16x16x64_bf16 v[24:27], v[36:39], a[168:175], v1
    s_nop 1
    v_add_f32 v8, v8, v10
    v_add_f32 v9, v9, v11
    v_add_f32 v12, v12, v14
    v_add_f32 v13, v13, v15
    v_mul_f32 v8, s79, v8
    v_mul_f32 v12, s79, v12
    v_mul_f32 v9, s79, v9
    v_mul_f32 v13, s79, v13
    v_cvt_pk_bf16_f32 v10, v8, v12
    v_cvt_pk_bf16_f32 v11, v9, v13
    ds_write2_b32 v5, v10, v11 offset0:0 offset1:4
    v_add_f32 v16, v16, v18
    v_add_f32 v17, v17, v19
    v_add_f32 v20, v20, v22
    v_add_f32 v21, v21, v23
    v_cvt_pk_bf16_f32 v18, v16, v20
    v_cvt_pk_bf16_f32 v19, v17, v21
    ds_write2_b32 v3, v18, v19 offset0:0 offset1:4
    v_smfmac_f32_16x16x64_bf16 v[28:31], v[36:39], a[176:183], v1
    ds_read_b128 v[36:39], v0 offset:8192
    v_smfmac_f32_16x16x64_bf16 v[24:27], v[32:35], a[152:159], v1
    v_smfmac_f32_16x16x64_bf16 v[28:31], v[32:35], a[160:167], v1
    ds_read_b128 v[32:35], v0 offset:9216
    s_waitcnt lgkmcnt(2)
    s_barrier
    ds_read_b128 v[56:59], v6 offset:10240
    ds_read_b128 v[60:63], v6 offset:10752
    ds_read_b128 v[20:23], v6 offset:12288
    ds_read_b128 v[72:75], v6 offset:11264
    ds_read_b128 v[76:79], v6 offset:11776
    s_waitcnt lgkmcnt(6)
    v_smfmac_f32_16x16x64_bf16 v[24:27], v[36:39], a[24:31], v1
    v_smfmac_f32_16x16x64_bf16 v[28:31], v[36:39], a[32:39], v1
    ds_read_b128 v[36:39], v0 offset:2048
    s_waitcnt lgkmcnt(6)
    v_smfmac_f32_16x16x64_bf16 v[24:27], v[32:35], a[40:47], v1
    v_smfmac_f32_16x16x64_bf16 v[28:31], v[32:35], a[48:55], v1
    ds_read_b128 v[32:35], v0 offset:1024
    s_waitcnt lgkmcnt(6)
    v_mfma_f32_16x16x32_bf16 v[12:15], v[40:43], v[56:59], 0
    ds_read_b128 v[40:43], v6 offset:12800
    v_mfma_f32_16x16x32_bf16 v[16:19], v[44:47], v[56:59], 0
    ds_read_b128 v[44:47], v0 offset:18432
    s_waitcnt lgkmcnt(7)
    v_mfma_f32_16x16x32_bf16 v[12:15], v[64:67], v[60:63], v[12:15]
    ds_read_b128 v[64:67], v0 offset:22528
    v_mfma_f32_16x16x32_bf16 v[16:19], v[68:71], v[60:63], v[16:19]
    ds_read_b128 v[68:71], v6 offset:13312
    s_waitcnt lgkmcnt(8)
    v_mfma_f32_16x16x32_bf16 v[8:11], v[20:23], v[56:59], 0
    ds_read_b128 v[20:23], v6 offset:13824
    s_waitcnt lgkmcnt(4)
    v_mfma_f32_16x16x32_bf16 v[8:11], v[40:43], v[60:63], v[8:11]
    ds_read_b128 v[40:43], v0 offset:19456
    s_waitcnt lgkmcnt(4)
    v_mfma_f32_16x16x32_bf16 v[12:15], v[44:47], v[72:75], v[12:15]
    ds_read_b128 v[44:47], v0 offset:23552
    s_waitcnt lgkmcnt(4)
    v_mfma_f32_16x16x32_bf16 v[16:19], v[64:67], v[72:75], v[16:19]
    s_waitcnt lgkmcnt(3)
    v_mfma_f32_16x16x32_bf16 v[8:11], v[68:71], v[72:75], v[8:11]
    s_waitcnt lgkmcnt(2)
    v_mfma_f32_16x16x32_bf16 v[8:11], v[20:23], v[76:79], v[8:11]
    s_waitcnt lgkmcnt(1)
    v_mfma_f32_16x16x32_bf16 v[12:15], v[40:43], v[76:79], v[12:15]
    s_waitcnt lgkmcnt(0)
    v_mfma_f32_16x16x32_bf16 v[16:19], v[44:47], v[76:79], v[16:19]
    v_smfmac_f32_16x16x64_bf16 v[24:27], v[36:39], a[56:63], v1
    buffer_load_dwordx4 v[72:75], v0, s[8:11], s5 offen offset:0
    v_smfmac_f32_16x16x64_bf16 v[28:31], v[36:39], a[64:71], v1
    ds_read_b128 v[36:39], v0 offset:0
    buffer_load_dwordx4 v[76:79], v0, s[8:11], s5 offen offset:1024
    s_nop 0
    v_max3_f32 v10, v8, v9, v12
    v_max3_f32 v11, v13, v14, v15
    v_max3_f32 v10, v10, v16, v17
    v_max3_f32 v11, v11, v18, v19
    v_max_f32 v10, v10, v11
    v_max_f32 v11, v10, v11
    v_smfmac_f32_16x16x64_bf16 v[24:27], v[32:35], a[72:79], v1
    buffer_load_dwordx4 v[40:43], v0, s[8:11], s5 offen offset:2048
    v_permlane32_swap_b32 v11, v10
    v_max_f32 v10, v10, v11
    v_max_f32 v11, v10, v11
    v_smfmac_f32_16x16x64_bf16 v[28:31], v[32:35], a[80:87], v1
    ds_read_b128 v[32:35], v0 offset:3072
    v_permlane16_swap_b32 v11, v10
    v_max_f32 v10, v10, v11
    v_sub_f32 v12, v12, v10
    s_waitcnt lgkmcnt(1)
    v_smfmac_f32_16x16x64_bf16 v[24:27], v[36:39], a[88:95], v1
    v_sub_f32 v13, v13, v10
    v_exp_f32 v12, v12
    v_smfmac_f32_16x16x64_bf16 v[28:31], v[36:39], a[96:103], v1
    ds_read_b128 v[36:39], v0 offset:4096
    buffer_load_dwordx4 v[44:47], v0, s[8:11], s5 offen offset:3072
    v_sub_f32 v14, v14, v10
    v_exp_f32 v13, v13
    s_waitcnt lgkmcnt(1)
    v_smfmac_f32_16x16x64_bf16 v[24:27], v[32:35], a[104:111], v1
    v_sub_f32 v15, v15, v10
    v_exp_f32 v14, v14
    v_smfmac_f32_16x16x64_bf16 v[28:31], v[32:35], a[112:119], v1
    ds_read_b128 v[32:35], v0 offset:6144
    v_cvt_pk_bf16_f32 v20, v12, v13
    v_sub_f32 v16, v16, v10
    v_exp_f32 v15, v15
    s_waitcnt lgkmcnt(1)
    v_smfmac_f32_16x16x64_bf16 v[24:27], v[36:39], a[120:127], v1
    buffer_load_dwordx4 v[56:59], v0, s[8:11], s6 offen offset:0
    v_sub_f32 v17, v17, v10
    v_exp_f32 v16, v16
    v_smfmac_f32_16x16x64_bf16 v[28:31], v[36:39], a[128:135], v1
    v_cvt_pk_bf16_f32 v21, v14, v15
    v_sub_f32 v18, v18, v10
    v_exp_f32 v17, v17
    s_waitcnt lgkmcnt(0)
    v_smfmac_f32_16x16x64_bf16 v[24:27], v[32:35], a[136:143], v1
    v_mov_b64 v[12:13], s[40:41]
    v_mov_b64 v[14:15], s[40:41]
    v_sub_f32 v19, v19, v10
    v_exp_f32 v18, v18
    v_smfmac_f32_16x16x64_bf16 v[28:31], v[32:35], a[144:151], v1
    buffer_load_dwordx4 v[60:63], v0, s[8:11], s6 offen offset:1024
    v_cvt_pk_bf16_f32 v22, v16, v17
    v_sub_f32 v8, v8, v10
    v_exp_f32 v19, v19
    v_sub_f32 v9, v9, v10
    v_exp_f32 v8, v8
    v_cvt_pk_bf16_f32 v23, v18, v19
    v_exp_f32 v9, v9
    v_mov_b32 v11, 0
    v_cvt_pk_bf16_f32 v10, v8, v9
    s_waitcnt vmcnt(9)
    v_mfma_f32_16x16x32_bf16 v[16:19], v[12:15], v[20:23], 0
    v_add_f32 v24, v24, v26
    v_add_f32 v25, v25, v27
    v_mfma_f32_16x16x32_bf16 v[32:35], v[48:51], v[20:23], 0
    v_add_f32 v28, v28, v30
    v_add_f32 v29, v29, v31
    v_mfma_f32_16x16x32_bf16 v[36:39], v[52:55], v[20:23], 0
    v_cvt_pk_bf16_f32 v26, v24, v25
    v_cvt_pk_bf16_f32 v27, v28, v29
    v_mfma_f32_16x16x16_bf16 v[16:19], v[12:13], v[10:11], v[16:19]
    v_cvt_pk_bf16_f32 v28, v28, v29
    v_mov_b32 v29, 0
    v_mfma_f32_16x16x16_bf16 v[32:35], v[26:27], v[10:11], v[32:35]
    buffer_load_dwordx4 v[64:67], v0, s[8:11], s6 offen offset:2048
    buffer_load_dwordx4 v[68:71], v0, s[8:11], s6 offen offset:3072
    v_mfma_f32_16x16x16_bf16 v[36:39], v[28:29], v[10:11], v[36:39]
    buffer_load_dwordx4 v[48:51], v0, s[8:11], s7 offen offset:0
    v_lshrrev_b32 v30, 1, v0
    ds_write_b64 v30, v[26:27] offset:15872
    v_rcp_f32 v8, v16
    v_mov_b64 v[12:13], 0
    v_mov_b64 v[14:15], 0
    v_mul_f32 v32, v32, v8
    v_mul_f32 v33, v33, v8
    v_cvt_pk_bf16_f32 v16, v32, v33
    v_mul_f32 v34, v34, v8
    v_mul_f32 v35, v35, v8
    v_cvt_pk_bf16_f32 v17, v34, v35
    v_mul_f32 v36, v36, v8
    v_mul_f32 v37, v37, v8
    v_cvt_pk_bf16_f32 v18, v36, v37
    v_mul_f32 v38, v38, v8
    v_mul_f32 v39, v39, v8
    v_cvt_pk_bf16_f32 v19, v38, v39
    ds_write_b128 v6, v[16:19] offset:17920
    buffer_load_dwordx4 v[52:55], v0, s[8:11], s7 offen offset:1024
    v_mov_b64 v[8:9], 0
    v_mov_b64 v[10:11], 0
    v_mov_b64 v[20:21], 0
    v_mov_b64 v[22:23], 0
    v_mov_b64 v[24:25], 0
    v_mov_b64 v[28:29], 0
    s_waitcnt lgkmcnt(0)
    s_barrier
    ds_read_b128 v[32:35], v0 offset:16384
    ds_read_b128 v[36:39], v0 offset:17408
    s_cmp_eq_u32 s55, 63
    s_cbranch_scc1 CHF3_last
    v_mov_b64 v[16:17], 0
    v_mov_b64 v[18:19], 0
    v_mov_b64 v[26:27], 0
    v_mov_b64 v[30:31], 0
    s_waitcnt lgkmcnt(1)
    v_smfmac_f32_16x16x64_bf16 v[8:11], v[32:35], a[184:191], v1
    v_smfmac_f32_16x16x64_bf16 v[12:15], v[32:35], a[192:199], v1
    s_waitcnt vmcnt(6) lgkmcnt(0)
    v_smfmac_f32_16x16x64_bf16 v[8:11], v[36:39], v[72:79], v1
    buffer_load_dwordx4 v[72:75], v0, s[8:11], s61 offen offset:0
    v_smfmac_f32_16x16x64_bf16 v[12:15], v[36:39], v[40:47], v1
    s_waitcnt vmcnt(3)
    v_smfmac_f32_16x16x64_bf16 v[16:19], v[32:35], v[56:63], v1
    ds_read_b128 v[56:59], v7 offset:20480
    ds_read_b128 v[60:63], v7 offset:21504
    buffer_load_dwordx4 v[76:79], v0, s[8:11], s61 offen offset:1024
    v_smfmac_f32_16x16x64_bf16 v[20:23], v[32:35], v[64:71], v1
    ds_read_b128 v[64:67], v7 offset:22528
    ds_read_b128 v[68:71], v7 offset:23552
    buffer_load_dwordx4 v[40:43], v0, s[8:11], s61 offen offset:2048
    v_add_f32 v8, v8, v10
    v_add_f32 v9, v9, v11
    v_cvt_pk_bf16_f32 v8, v8, v9
    v_smfmac_f32_16x16x64_bf16 v[16:19], v[36:39], a[200:207], v1
    v_and_or_b32 v8, v8, -2, s65
    v_add_f32 v12, v12, v14
    v_add_f32 v13, v13, v15
    v_smfmac_f32_16x16x64_bf16 v[20:23], v[36:39], a[208:215], v1
    buffer_load_dwordx4 v[44:47], v0, s[8:11], s61 offen offset:3072
    v_cvt_pk_bf16_f32 v9, v12, v13
    buffer_store_dwordx2 v[8:9], v4, s[8:11], s58 offen
    v_mov_b64 v[12:13], 0
    s_waitcnt vmcnt(5)
    v_smfmac_f32_16x16x64_bf16 v[24:27], v[32:35], a[216:223], v1
    v_mov_b64 v[14:15], 0
    v_mov_b64 v[10:11], 0
    v_mov_b64 v[8:9], 0
    v_smfmac_f32_16x16x64_bf16 v[28:31], v[32:35], v[48:55], v1
    buffer_load_dwordx4 v[48:51], v0, s[8:11], s3 offen offset:0
    v_add_f32 v16, v16, v18
    v_add_f32 v17, v17, v19
    v_cvt_pk_bf16_f32 v16, v16, v17
    s_waitcnt lgkmcnt(0)
    v_smfmac_f32_16x16x64_bf16 v[24:27], v[36:39], v[56:63], v1
    ds_read_b128 v[56:59], v7 offset:24576
    ds_read_b128 v[60:63], v7 offset:25600
    v_and_or_b32 v16, v16, -2, s65
    v_add_f32 v20, v20, v22
    v_add_f32 v21, v21, v23
    v_smfmac_f32_16x16x64_bf16 v[28:31], v[36:39], v[64:71], v1
    ds_read_b128 v[64:67], v7 offset:26624
    ds_read_b128 v[68:71], v7 offset:27648
    buffer_load_dwordx4 v[52:55], v0, s[8:11], s3 offen offset:1024
    v_cvt_pk_bf16_f32 v17, v20, v21
    buffer_store_dwordx2 v[16:17], v4, s[8:11], s75 offen
    v_mov_b64 v[20:21], 0
    v_smfmac_f32_16x16x64_bf16 v[8:11], v[32:35], a[224:231], v1
    v_mov_b64 v[22:23], 0
    v_mov_b64 v[18:19], 0
    v_mov_b64 v[16:17], 0
    v_smfmac_f32_16x16x64_bf16 v[12:15], v[32:35], a[232:239], v1
    v_add_f32 v24, v24, v26
    v_add_f32 v25, v25, v27
    v_cvt_pk_bf16_f32 v24, v24, v25
    s_waitcnt lgkmcnt(0)
    v_smfmac_f32_16x16x64_bf16 v[8:11], v[36:39], v[56:63], v1
    ds_read_b128 v[56:59], v7 offset:28672
    ds_read_b128 v[60:63], v7 offset:29696
    v_and_or_b32 v24, v24, -2, s65
    v_add_f32 v28, v28, v30
    v_add_f32 v29, v29, v31
    v_smfmac_f32_16x16x64_bf16 v[12:15], v[36:39], v[64:71], v1
    ds_read_b128 v[64:67], v7 offset:30720
    ds_read_b128 v[68:71], v7 offset:31744
    v_cvt_pk_bf16_f32 v25, v28, v29
    buffer_store_dwordx2 v[24:25], v4, s[8:11], s76 offen
    v_smfmac_f32_16x16x64_bf16 v[16:19], v[32:35], a[240:247], v1
    v_smfmac_f32_16x16x64_bf16 v[20:23], v[32:35], a[248:255], v1
    v_add_f32 v8, v8, v10
    v_add_f32 v9, v9, v11
    v_cvt_pk_bf16_f32 v8, v8, v9
    s_waitcnt lgkmcnt(0)
    v_smfmac_f32_16x16x64_bf16 v[16:19], v[36:39], v[56:63], v1
    v_and_or_b32 v8, v8, -2, s65
    v_add_f32 v12, v12, v14
    v_add_f32 v13, v13, v15
    v_smfmac_f32_16x16x64_bf16 v[20:23], v[36:39], v[64:71], v1
    v_cvt_pk_bf16_f32 v9, v12, v13
    buffer_store_dwordx2 v[8:9], v4, s[8:11], s77 offen
    s_nop 1
    v_add_f32 v16, v16, v18
    v_add_f32 v17, v17, v19
    v_cvt_pk_bf16_f32 v16, v16, v17
    v_and_or_b32 v16, v16, -2, s65
    v_add_f32 v20, v20, v22
    v_add_f32 v21, v21, v23
    v_cvt_pk_bf16_f32 v17, v20, v21
    buffer_store_dwordx2 v[16:17], v4, s[8:11], s4 offen
    v_min_u32 v80, v86, v87
    s_nop 0
    v_readlane_b32 s70, v80, 0
    v_readlane_b32 s73, v80, 1
    s_nop 0
    s_min_u32 s70, s70, s73
    s_max_u32 s67, s67, s70
    s_cmp_gt_u32 s67, s38
    s_cbranch_scc1 CHF3_inok_98
    s_mov_b32 s68, 0
CHF3_inlp_99:
    buffer_load_dwordx2 v[86:87], v85, s[8:11], s78 offen sc1
    s_waitcnt vmcnt(0)
    v_min_u32 v80, v86, v87
    s_nop 0
    v_readlane_b32 s70, v80, 0
    v_readlane_b32 s73, v80, 1
    s_nop 0
    s_min_u32 s70, s70, s73
    s_max_u32 s67, s67, s70
    s_cmp_gt_u32 s67, s38
    s_cbranch_scc1 CHF3_inok_98
    s_cmp_lg_u32 s69, 0
    s_cbranch_scc1 CHF3_inok_98
    s_sleep 2
    s_add_u32 s68, s68, 1
    s_cmp_lt_u32 s68, 65536
    s_cbranch_scc1 CHF3_inlp_99
    s_mov_b32 s69, 1
CHF3_inok_98:
    s_mov_b32 s68, 0
    s_barrier
    s_mov_b32 s68, 0
    v_bfe_u32 v29, v0, 4, 1
    v_lshlrev_b32 v29, 4, v29
    v_mov_b32 v30, 0x3f80
    v_lshlrev_b32 v29, v29, v30
    v_bfe_u32 v30, v0, 5, 3
    v_cmp_eq_u32 vcc, 0, v30
    s_nop 1
    v_cndmask_b32 v32, 0, v29, vcc
    v_cmp_eq_u32 vcc, 1, v30
    s_nop 1
    v_cndmask_b32 v33, 0, v29, vcc
    v_cmp_eq_u32 vcc, 2, v30
    s_nop 1
    v_cndmask_b32 v34, 0, v29, vcc
    v_cmp_eq_u32 vcc, 3, v30
    s_nop 1
    v_cndmask_b32 v35, 0, v29, vcc
    buffer_load_dwordx4 v[8:11], v0, s[8:11], s59 offen offset:0 sc1
    buffer_load_dwordx4 v[12:15], v0, s[8:11], s59 offen offset:1024 sc1
    s_sleep 3
    buffer_load_dwordx4 v[16:19], v0, s[8:11], s59 offen offset:0 sc1
    buffer_load_dwordx4 v[20:23], v0, s[8:11], s59 offen offset:1024 sc1
CHF3_rloop:
    s_waitcnt vmcnt(2)
    v_mfma_f32_16x16x32_bf16 v[24:27], v[8:11], v[32:35], 0
    v_and_b32 v29, v8, v10
    v_or_b32 v30, v8, v10
    v_mfma_f32_16x16x32_bf16 v[24:27], v[12:15], v[32:35], v[24:27]
    v_bitop3_b32 v29, v29, v12, v14 bitop3:0x80
    v_or3_b32 v30, v30, v12, v14
    v_bitop3_b32 v29, v29, v30, s65 bitop3:0x4e
    v_and_b32 v29, 1, v29
    v_cmp_ne_u32 vcc, 0, v29
    s_nop 2
    v_permlane32_swap_b32 v24, v26
    v_permlane32_swap_b32 v25, v27
    v_add_f32 v24, v24, v26
    v_add_f32 v25, v25, v27
    s_cbranch_vccnz CHF3_rbad0
    s_nop 0
    v_permlane16_swap_b32 v24, v25
    v_add_f32 v24, v24, v25
    v_cvt_pk_bf16_f32 v24, v24, v24
    buffer_store_short v24, v2, s[8:11], s56 offen
    s_branch CHF3_rdone
CHF3_rbad0:
    buffer_load_dwordx4 v[8:11], v0, s[8:11], s59 offen offset:0 sc1
    buffer_load_dwordx4 v[12:15], v0, s[8:11], s59 offen offset:1024 sc1
    s_waitcnt vmcnt(2)
    v_mfma_f32_16x16x32_bf16 v[24:27], v[16:19], v[32:35], 0
    v_and_b32 v29, v16, v18
    v_or_b32 v30, v16, v18
    v_mfma_f32_16x16x32_bf16 v[24:27], v[20:23], v[32:35], v[24:27]
    v_bitop3_b32 v29, v29, v20, v22 bitop3:0x80
    v_or3_b32 v30, v30, v20, v22
    v_bitop3_b32 v29, v29, v30, s65 bitop3:0x4e
    v_and_b32 v29, 1, v29
    v_cmp_ne_u32 vcc, 0, v29
    s_nop 2
    v_permlane32_swap_b32 v24, v26
    v_permlane32_swap_b32 v25, v27
    v_add_f32 v24, v24, v26
    v_add_f32 v25, v25, v27
    s_cbranch_vccnz CHF3_rbad1
CHF3_rok:
    s_nop 0
    v_permlane16_swap_b32 v24, v25
    v_add_f32 v24, v24, v25
    v_cvt_pk_bf16_f32 v24, v24, v24
    buffer_store_short v24, v2, s[8:11], s56 offen
    s_branch CHF3_rdone
CHF3_rbad1:
    buffer_load_dwordx4 v[16:19], v0, s[8:11], s59 offen offset:0 sc1
    buffer_load_dwordx4 v[20:23], v0, s[8:11], s59 offen offset:1024 sc1
    s_cmp_lg_u32 s69, 0
    s_cbranch_scc1 CHF3_rok
    s_add_u32 s68, s68, 1
    s_cmp_lt_u32 s68, 65536
    s_cbranch_scc1 CHF3_rloop
    s_mov_b32 s69, 1
    s_branch CHF3_rok
CHF3_rdone:
    v_mov_b32 v25, 0xff81ff81
    buffer_store_short v25, v2, s[8:11], s57 offen
    s_mov_b32 m0, 22528
    s_nop 0
    buffer_load_dwordx4 v0, s[8:11], s63 offen offset:0 sc1 lds
    buffer_load_dwordx4 v0, s[8:11], s63 offen offset:1024 sc1 lds
    s_add_u32 s63, s63, 262144
    v_and_b32 v28, 512, v0
    v_mul_u32_u24 v28, 3, v28
    v_add_u32 v28, v28, v0
    ds_read_b128 v[24:27], v28 offset:13824
    s_add_u32 s72, s56, 8192
    s_xor_b32 s65, s65, 1
    s_add_u32 s64, s64, 131072
    s_xor_b32 s56, s56, s74
    s_xor_b32 s57, s57, s74
    s_add_u32 s62, s62, 262144
    s_add_u32 s55, s55, 1
    s_mov_b32 s68, 0
    s_mov_b32 m0, 8192
    s_add_u32 s38, s55, 1
    s_cmp_lt_u32 s38, 64
    s_cselect_b32 s70, 0, 262144
    s_sub_u32 s36, s63, s70
    s_sub_u32 s36, s36, 6144
    s_add_u32 s37, s36, 33554432
    s_add_u32 s70, s55, 2
    s_cmp_gt_u32 s67, s70
    s_cselect_b32 s37, 0x20000000, s78
    s_max_u32 s70, s55, 1
    s_sub_u32 s70, s70, 1
    v_mov_b32 v84, s70
    s_sleep 3
    buffer_load_dwordx4 v0, s[8:11], s72 offen offset:0 sc1 lds
    buffer_load_dwordx4 v0, s[8:11], s72 offen offset:1024 sc1 lds
    s_waitcnt vmcnt(6)
    ds_read_b128 v[56:59], v7 offset:16384
    ds_read_b128 v[60:63], v7 offset:17408
    ds_read_b128 v[64:67], v7 offset:18432
    ds_read_b128 v[68:71], v7 offset:19456
    v_mov_b64 v[8:9], 0
    v_mov_b64 v[10:11], 0
    v_mov_b64 v[12:13], 0
    v_mov_b64 v[14:15], 0
    v_mov_b64 v[16:17], 0
    v_mov_b64 v[18:19], 0
    v_mov_b64 v[20:21], 0
    v_mov_b64 v[22:23], 0
    s_sleep 2
CHF3_gloop:
    buffer_load_dwordx4 v0, s[8:11], s72 offen offset:0 sc1 lds
    buffer_load_dwordx4 v0, s[8:11], s72 offen offset:1024 sc1 lds
    s_waitcnt vmcnt(2)
    ds_read_b128 v[32:35], v0 offset:8192
    ds_read_b128 v[36:39], v0 offset:9216
    s_waitcnt lgkmcnt(1)
    v_pk_max_u16 v23, v32, v33
    v_pk_max_u16 v23, v23, v34
    v_pk_max_u16 v23, v23, v35
    s_waitcnt lgkmcnt(0)
    v_pk_max_u16 v23, v23, v36
    v_pk_max_u16 v23, v23, v37
    v_pk_max_u16 v23, v23, v38
    v_pk_max_u16 v23, v23, v39
    v_pk_max_u16 v23, v23, v23 op_sel:[0,1] op_sel_hi:[1,0]
    s_nop 0
    v_cmp_le_u32 vcc, 0xff810000, v23
    s_nop 0
    s_cbranch_vccz CHF3_loop
    s_add_u32 s68, s68, 1
    s_cmp_lt_u32 s68, 64
    s_cbranch_scc1 CHF3_gloop
    s_cmp_lg_u32 s69, 0
    s_cbranch_scc1 CHF3_loop
    v_mov_b32 v23, -1
    v_xor_b32 v22, 0xff81ff81, v32
    v_pk_min_u16 v23, v23, v22
    v_xor_b32 v22, 0xff81ff81, v33
    v_pk_min_u16 v23, v23, v22
    v_xor_b32 v22, 0xff81ff81, v34
    v_pk_min_u16 v23, v23, v22
    v_xor_b32 v22, 0xff81ff81, v35
    v_pk_min_u16 v23, v23, v22
    v_xor_b32 v22, 0xff81ff81, v36
    v_pk_min_u16 v23, v23, v22
    v_xor_b32 v22, 0xff81ff81, v37
    v_pk_min_u16 v23, v23, v22
    v_xor_b32 v22, 0xff81ff81, v38
    v_pk_min_u16 v23, v23, v22
    v_xor_b32 v22, 0xff81ff81, v39
    v_pk_min_u16 v23, v23, v22
    v_pk_min_u16 v23, v23, v23 op_sel:[0,1] op_sel_hi:[1,0]
    v_mov_b32 v22, 0
    v_cmp_eq_u32 vcc, 0, v23
    s_nop 0
    s_cbranch_vccz CHF3_loop
    s_sleep 1
    s_cmp_lt_u32 s68, 65536
    s_cbranch_scc1 CHF3_gloop
    s_mov_b32 s69, 1
    s_branch CHF3_loop
CHF3_last:
    v_and_b32 v28, 512, v0
    v_mul_u32_u24 v28, 3, v28
    v_add_u32 v28, v28, v0
    ds_read_b128 v[24:27], v28 offset:13824
    s_add_u32 s64, s64, 131072
    s_waitcnt lgkmcnt(0)
    buffer_store_dwordx4 v[24:27], v0, s[8:11], s64 offen sc1
    s_waitcnt vmcnt(0)
    s_barrier
    v_mov_b32 v80, 64
    s_mov_b64 exec, 1
    buffer_store_dword v80, off, s[8:11], s66 sc1
    s_mov_b64 exec, -1
    s_waitcnt vmcnt(0) lgkmcnt(0)
    s_endpgm
CHS3_start:
    v_min_u32 v80, v86, v87
    s_nop 0
    v_readlane_b32 s70, v80, 0
    v_readlane_b32 s73, v80, 1
    s_nop 0
    s_min_u32 s70, s70, s73
    s_max_u32 s67, s67, s70
    s_cmp_gt_u32 s67, s55
    s_cbranch_scc1 CHS3_inok_100
    s_mov_b32 s68, 0
CHS3_inlp_101:
    buffer_load_dwordx2 v[86:87], v85, s[8:11], s78 offen sc1
    s_waitcnt vmcnt(0)
    v_min_u32 v80, v86, v87
    s_nop 0
    v_readlane_b32 s70, v80, 0
    v_readlane_b32 s73, v80, 1
    s_nop 0
    s_min_u32 s70, s70, s73
    s_max_u32 s67, s67, s70
    s_cmp_gt_u32 s67, s55
    s_cbranch_scc1 CHS3_inok_100
    s_cmp_lg_u32 s69, 0
    s_cbranch_scc1 CHS3_inok_100
    s_sleep 2
    s_add_u32 s68, s68, 1
    s_cmp_lt_u32 s68, 65536
    s_cbranch_scc1 CHS3_inlp_101
    s_mov_b32 s69, 1
CHS3_inok_100:
    s_barrier
    s_mov_b32 m0, 22528
    s_nop 0
    buffer_load_dwordx4 v0, s[8:11], s63 offen offset:0 sc1 lds
    buffer_load_dwordx4 v0, s[8:11], s63 offen offset:1024 sc1 lds
    s_add_u32 s63, s63, 262144
    s_add_u32 s38, s55, 1
    s_cmp_lt_u32 s38, 64
    s_cselect_b32 s70, 0, 262144
    s_sub_u32 s36, s63, s70
    s_sub_u32 s36, s36, 6144
    s_add_u32 s37, s36, 33554432
    s_add_u32 s70, s55, 2
    s_cmp_gt_u32 s67, s70
    s_cselect_b32 s37, 0x20000000, s78
    s_max_u32 s70, s55, 1
    s_sub_u32 s70, s70, 1
    v_mov_b32 v84, s70
    s_waitcnt vmcnt(0) lgkmcnt(0)
CHS3_loop:
    s_barrier
    ds_read_b128 v[28:31], v0 offset:2048
    v_mov_b32 v23, 0
    v_smfmac_f32_16x16x64_bf16 v[8:11], v[32:35], v[40:47], v1
    buffer_load_dwordx4 v[40:43], v0, s[8:11], s3 offen offset:2048
    v_smfmac_f32_16x16x64_bf16 v[12:15], v[32:35], v[72:79], v1
    buffer_load_dwordx4 v[44:47], v0, s[8:11], s3 offen offset:3072
    v_smfmac_f32_16x16x64_bf16 v[16:19], v[32:35], v[56:63], v1
    ds_read_b128 v[56:59], v7 offset:4096
    v_smfmac_f32_16x16x64_bf16 v[20:23], v[32:35], v[64:71], v1
    ds_read_b128 v[32:35], v0 offset:1024
    ds_read_b128 v[60:63], v7 offset:5120
    v_smfmac_f32_16x16x64_bf16 v[8:11], v[36:39], v[48:55], v1
    ds_read_b128 v[64:67], v7 offset:6144
    v_smfmac_f32_16x16x64_bf16 v[12:15], v[36:39], v[88:95], v1
    ds_read_b128 v[68:71], v7 offset:7168
    v_smfmac_f32_16x16x64_bf16 v[16:19], v[36:39], v[96:103], v1
    ds_read_b128 v[72:75], v7 offset:0
    buffer_load_dwordx4 v[48:51], v0, s[8:11], s62 offen offset:0 sc1
    v_smfmac_f32_16x16x64_bf16 v[20:23], v[36:39], v[104:111], v1
    ds_read_b128 v[36:39], v0 offset:0
    s_waitcnt lgkmcnt(7)
    v_smfmac_f32_16x16x64_bf16 v[8:11], v[28:31], v[112:119], v1
    ds_read_b128 v[76:79], v7 offset:1024
    buffer_load_dwordx4 v[52:55], v0, s[8:11], s62 offen offset:1024 sc1
    v_smfmac_f32_16x16x64_bf16 v[12:15], v[28:31], v[120:127], v1
    buffer_store_dwordx4 v[24:27], v0, s[8:11], s64 offen sc1
    s_waitcnt lgkmcnt(3)
    v_smfmac_f32_16x16x64_bf16 v[16:19], v[28:31], v[56:63], v1
    ds_read_b128 v[24:27], v0 offset:3072
    ds_read_b128 v[56:59], v7 offset:2048
    ds_read_b128 v[60:63], v7 offset:3072
    buffer_load_dword v80, v83, s[8:11], s36 offen sc1
    v_smfmac_f32_16x16x64_bf16 v[20:23], v[28:31], v[64:71], v1
    ds_read_b128 v[28:31], v0 offset:4096
    v_smfmac_f32_16x16x64_bf16 v[8:11], v[32:35], v[128:135], v1
    ds_read_b128 v[64:67], v7 offset:8192
    v_smfmac_f32_16x16x64_bf16 v[12:15], v[32:35], v[136:143], v1
    ds_read_b128 v[68:71], v7 offset:9216
    v_smfmac_f32_16x16x64_bf16 v[16:19], v[32:35], v[144:151], v1
    buffer_load_dwordx2 v[86:87], v85, s[8:11], s37 offen sc1
    v_smfmac_f32_16x16x64_bf16 v[20:23], v[32:35], v[152:159], v1
    ds_read_b128 v[32:35], v0 offset:5120
    s_waitcnt lgkmcnt(4)
    v_smfmac_f32_16x16x64_bf16 v[16:19], v[36:39], v[72:79], v1
    ds_read_b128 v[72:75], v7 offset:10240
    ds_read_b128 v[76:79], v7 offset:11264
    v_smfmac_f32_16x16x64_bf16 v[20:23], v[36:39], v[56:63], v1
    v_smfmac_f32_16x16x64_bf16 v[8:11], v[36:39], v[160:167], v1
    ds_read_b128 v[56:59], v7 offset:12288
    v_smfmac_f32_16x16x64_bf16 v[12:15], v[36:39], v[168:175], v1
    ds_read_b128 v[36:39], v0 offset:7168
    v_smfmac_f32_16x16x64_bf16 v[8:11], v[24:27], v[176:183], v1
    ds_read_b128 v[60:63], v7 offset:13312
    v_smfmac_f32_16x16x64_bf16 v[12:15], v[24:27], v[184:191], v1
    s_waitcnt lgkmcnt(3)
    v_smfmac_f32_16x16x64_bf16 v[16:19], v[24:27], v[64:71], v1
    ds_read_b128 v[64:67], v7 offset:14336
    ds_read_b128 v[68:71], v7 offset:15360
    v_smfmac_f32_16x16x64_bf16 v[20:23], v[24:27], v[72:79], v1
    ds_read_b128 v[24:27], v0 offset:6144
    v_smfmac_f32_16x16x64_bf16 v[8:11], v[28:31], v[192:199], v1
    ds_read_b128 v[72:75], v7 offset:32768
    s_waitcnt vmcnt(5)
    v_smfmac_f32_16x16x64_bf16 v[12:15], v[28:31], v[40:47], v1
    ds_read_b128 v[76:79], v7 offset:33792
    v_smfmac_f32_16x16x64_bf16 v[16:19], v[28:31], v[200:207], v1
    v_smfmac_f32_16x16x64_bf16 v[20:23], v[28:31], v[208:215], v1
    s_waitcnt lgkmcnt(2)
    v_smfmac_f32_16x16x64_bf16 v[16:19], v[24:27], v[56:63], v1
    ds_read_b128 v[56:59], v7 offset:34816
    ds_read_b128 v[60:63], v7 offset:35840
    v_mov_b64 v[28:29], 0
    v_smfmac_f32_16x16x64_bf16 v[20:23], v[24:27], v[64:71], v1
    v_mov_b64 v[30:31], 0
    v_smfmac_f32_16x16x64_bf16 v[8:11], v[24:27], v[216:223], v1
    ds_read_b128 v[40:43], v0 offset:16384
    v_smfmac_f32_16x16x64_bf16 v[12:15], v[24:27], v[224:231], v1
    ds_read_b128 v[44:47], v0 offset:20480
    v_smfmac_f32_16x16x64_bf16 v[8:11], v[32:35], v[232:239], v1
    v_mov_b64 v[24:25], 0
    v_smfmac_f32_16x16x64_bf16 v[12:15], v[32:35], v[240:247], v1
    v_mov_b64 v[26:27], 0
    s_waitcnt lgkmcnt(2)
    v_smfmac_f32_16x16x64_bf16 v[16:19], v[32:35], v[72:79], v1
    v_smfmac_f32_16x16x64_bf16 v[20:23], v[32:35], v[56:63], v1
    v_smfmac_f32_16x16x64_bf16 v[8:11], v[36:39], v[248:255], v1
    ds_read_b128 v[64:67], v0 offset:17408
    v_smfmac_f32_16x16x64_bf16 v[12:15], v[36:39], a[0:7], v1
    ds_read_b128 v[68:71], v0 offset:21504
    v_smfmac_f32_16x16x64_bf16 v[16:19], v[36:39], a[8:15], v1
    v_smfmac_f32_16x16x64_bf16 v[20:23], v[36:39], a[16:23], v1
    v_smfmac_f32_16x16x64_bf16 v[24:27], v[36:39], a[168:175], v1
    s_nop 1
    v_add_f32 v8, v8, v10
    v_add_f32 v9, v9, v11
    v_add_f32 v12, v12, v14
    v_add_f32 v13, v13, v15
    v_mul_f32 v8, s79, v8
    v_mul_f32 v12, s79, v12
    v_mul_f32 v9, s79, v9
    v_mul_f32 v13, s79, v13
    v_cvt_pk_bf16_f32 v10, v8, v12
    v_cvt_pk_bf16_f32 v11, v9, v13
    ds_write2_b32 v5, v10, v11 offset0:0 offset1:4
    v_add_f32 v16, v16, v18
    v_add_f32 v17, v17, v19
    v_add_f32 v20, v20, v22
    v_add_f32 v21, v21, v23
    v_cvt_pk_bf16_f32 v18, v16, v20
    v_cvt_pk_bf16_f32 v19, v17, v21
    ds_write2_b32 v3, v18, v19 offset0:0 offset1:4
    v_smfmac_f32_16x16x64_bf16 v[28:31], v[36:39], a[176:183], v1
    ds_read_b128 v[36:39], v0 offset:8192
    v_smfmac_f32_16x16x64_bf16 v[24:27], v[32:35], a[152:159], v1
    v_smfmac_f32_16x16x64_bf16 v[28:31], v[32:35], a[160:167], v1
    ds_read_b128 v[32:35], v0 offset:9216
    s_waitcnt lgkmcnt(2)
    s_barrier
    ds_read_b128 v[56:59], v6 offset:10240
    ds_read_b128 v[60:63], v6 offset:10752
    ds_read_b128 v[20:23], v6 offset:12288
    ds_read_b128 v[72:75], v6 offset:11264
    ds_read_b128 v[76:79], v6 offset:11776
    s_waitcnt lgkmcnt(6)
    v_smfmac_f32_16x16x64_bf16 v[24:27], v[36:39], a[24:31], v1
    v_smfmac_f32_16x16x64_bf16 v[28:31], v[36:39], a[32:39], v1
    ds_read_b128 v[36:39], v0 offset:2048
    s_waitcnt lgkmcnt(6)
    v_smfmac_f32_16x16x64_bf16 v[24:27], v[32:35], a[40:47], v1
    v_smfmac_f32_16x16x64_bf16 v[28:31], v[32:35], a[48:55], v1
    ds_read_b128 v[32:35], v0 offset:1024
    s_waitcnt lgkmcnt(6)
    v_mfma_f32_16x16x32_bf16 v[12:15], v[40:43], v[56:59], 0
    ds_read_b128 v[40:43], v6 offset:12800
    v_mfma_f32_16x16x32_bf16 v[16:19], v[44:47], v[56:59], 0
    ds_read_b128 v[44:47], v0 offset:18432
    s_waitcnt lgkmcnt(7)
    v_mfma_f32_16x16x32_bf16 v[12:15], v[64:67], v[60:63], v[12:15]
    ds_read_b128 v[64:67], v0 offset:22528
    v_mfma_f32_16x16x32_bf16 v[16:19], v[68:71], v[60:63], v[16:19]
    ds_read_b128 v[68:71], v6 offset:13312
    s_waitcnt lgkmcnt(8)
    v_mfma_f32_16x16x32_bf16 v[8:11], v[20:23], v[56:59], 0
    ds_read_b128 v[20:23], v6 offset:13824
    s_waitcnt lgkmcnt(4)
    v_mfma_f32_16x16x32_bf16 v[8:11], v[40:43], v[60:63], v[8:11]
    ds_read_b128 v[40:43], v0 offset:19456
    s_waitcnt lgkmcnt(4)
    v_mfma_f32_16x16x32_bf16 v[12:15], v[44:47], v[72:75], v[12:15]
    ds_read_b128 v[44:47], v0 offset:23552
    s_waitcnt lgkmcnt(4)
    v_mfma_f32_16x16x32_bf16 v[16:19], v[64:67], v[72:75], v[16:19]
    s_waitcnt lgkmcnt(3)
    v_mfma_f32_16x16x32_bf16 v[8:11], v[68:71], v[72:75], v[8:11]
    s_waitcnt lgkmcnt(2)
    v_mfma_f32_16x16x32_bf16 v[8:11], v[20:23], v[76:79], v[8:11]
    s_waitcnt lgkmcnt(1)
    v_mfma_f32_16x16x32_bf16 v[12:15], v[40:43], v[76:79], v[12:15]
    s_waitcnt lgkmcnt(0)
    v_mfma_f32_16x16x32_bf16 v[16:19], v[44:47], v[76:79], v[16:19]
    v_smfmac_f32_16x16x64_bf16 v[24:27], v[36:39], a[56:63], v1
    buffer_load_dwordx4 v[72:75], v0, s[8:11], s5 offen offset:0
    v_smfmac_f32_16x16x64_bf16 v[28:31], v[36:39], a[64:71], v1
    ds_read_b128 v[36:39], v0 offset:0
    buffer_load_dwordx4 v[76:79], v0, s[8:11], s5 offen offset:1024
    s_nop 0
    v_max3_f32 v10, v8, v9, v12
    v_max3_f32 v11, v13, v14, v15
    v_max3_f32 v10, v10, v16, v17
    v_max3_f32 v11, v11, v18, v19
    v_max_f32 v10, v10, v11
    v_max_f32 v11, v10, v11
    v_smfmac_f32_16x16x64_bf16 v[24:27], v[32:35], a[72:79], v1
    buffer_load_dwordx4 v[40:43], v0, s[8:11], s5 offen offset:2048
    v_permlane32_swap_b32 v11, v10
    v_max_f32 v10, v10, v11
    v_max_f32 v11, v10, v11
    v_smfmac_f32_16x16x64_bf16 v[28:31], v[32:35], a[80:87], v1
    ds_read_b128 v[32:35], v0 offset:3072
    v_permlane16_swap_b32 v11, v10
    v_max_f32 v10, v10, v11
    v_sub_f32 v12, v12, v10
    s_waitcnt lgkmcnt(1)
    v_smfmac_f32_16x16x64_bf16 v[24:27], v[36:39], a[88:95], v1
    v_sub_f32 v13, v13, v10
    v_exp_f32 v12, v12
    v_smfmac_f32_16x16x64_bf16 v[28:31], v[36:39], a[96:103], v1
    ds_read_b128 v[36:39], v0 offset:4096
    buffer_load_dwordx4 v[44:47], v0, s[8:11], s5 offen offset:3072
    v_sub_f32 v14, v14, v10
    v_exp_f32 v13, v13
    s_waitcnt lgkmcnt(1)
    v_smfmac_f32_16x16x64_bf16 v[24:27], v[32:35], a[104:111], v1
    v_sub_f32 v15, v15, v10
    v_exp_f32 v14, v14
    v_smfmac_f32_16x16x64_bf16 v[28:31], v[32:35], a[112:119], v1
    ds_read_b128 v[32:35], v0 offset:6144
    v_cvt_pk_bf16_f32 v20, v12, v13
    v_sub_f32 v16, v16, v10
    v_exp_f32 v15, v15
    s_waitcnt lgkmcnt(1)
    v_smfmac_f32_16x16x64_bf16 v[24:27], v[36:39], a[120:127], v1
    buffer_load_dwordx4 v[56:59], v0, s[8:11], s6 offen offset:0
    v_sub_f32 v17, v17, v10
    v_exp_f32 v16, v16
    v_smfmac_f32_16x16x64_bf16 v[28:31], v[36:39], a[128:135], v1
    v_cvt_pk_bf16_f32 v21, v14, v15
    v_sub_f32 v18, v18, v10
    v_exp_f32 v17, v17
    s_waitcnt lgkmcnt(0)
    v_smfmac_f32_16x16x64_bf16 v[24:27], v[32:35], a[136:143], v1
    v_mov_b64 v[12:13], s[40:41]
    v_mov_b64 v[14:15], s[40:41]
    v_sub_f32 v19, v19, v10
    v_exp_f32 v18, v18
    v_smfmac_f32_16x16x64_bf16 v[28:31], v[32:35], a[144:151], v1
    buffer_load_dwordx4 v[60:63], v0, s[8:11], s6 offen offset:1024
    v_cvt_pk_bf16_f32 v22, v16, v17
    v_sub_f32 v8, v8, v10
    v_exp_f32 v19, v19
    v_sub_f32 v9, v9, v10
    v_exp_f32 v8, v8
    v_cvt_pk_bf16_f32 v23, v18, v19
    v_exp_f32 v9, v9
    v_mov_b32 v11, 0
    v_cvt_pk_bf16_f32 v10, v8, v9
    s_waitcnt vmcnt(9)
    v_mfma_f32_16x16x32_bf16 v[16:19], v[12:15], v[20:23], 0
    v_add_f32 v24, v24, v26
    v_add_f32 v25, v25, v27
    v_mfma_f32_16x16x32_bf16 v[32:35], v[48:51], v[20:23], 0
    v_add_f32 v28, v28, v30
    v_add_f32 v29, v29, v31
    v_mfma_f32_16x16x32_bf16 v[36:39], v[52:55], v[20:23], 0
    v_cvt_pk_bf16_f32 v26, v24, v25
    v_cvt_pk_bf16_f32 v27, v28, v29
    v_mfma_f32_16x16x16_bf16 v[16:19], v[12:13], v[10:11], v[16:19]
    v_cvt_pk_bf16_f32 v28, v28, v29
    v_mov_b32 v29, 0
    v_mfma_f32_16x16x16_bf16 v[32:35], v[26:27], v[10:11], v[32:35]
    buffer_load_dwordx4 v[64:67], v0, s[8:11], s6 offen offset:2048
    buffer_load_dwordx4 v[68:71], v0, s[8:11], s6 offen offset:3072
    v_mfma_f32_16x16x16_bf16 v[36:39], v[28:29], v[10:11], v[36:39]
    buffer_load_dwordx4 v[48:51], v0, s[8:11], s7 offen offset:0
    v_lshrrev_b32 v30, 1, v0
    ds_write_b64 v30, v[26:27] offset:15872
    v_rcp_f32 v8, v16
    v_mov_b64 v[12:13], 0
    v_mov_b64 v[14:15], 0
    v_mul_f32 v32, v32, v8
    v_mul_f32 v33, v33, v8
    v_cvt_pk_bf16_f32 v16, v32, v33
    v_mul_f32 v34, v34, v8
    v_mul_f32 v35, v35, v8
    v_cvt_pk_bf16_f32 v17, v34, v35
    v_mul_f32 v36, v36, v8
    v_mul_f32 v37, v37, v8
    v_cvt_pk_bf16_f32 v18, v36, v37
    v_mul_f32 v38, v38, v8
    v_mul_f32 v39, v39, v8
    v_cvt_pk_bf16_f32 v19, v38, v39
    ds_write_b128 v6, v[16:19] offset:17920
    buffer_load_dwordx4 v[52:55], v0, s[8:11], s7 offen offset:1024
    v_mov_b64 v[8:9], 0
    v_mov_b64 v[10:11], 0
    v_mov_b64 v[20:21], 0
    v_mov_b64 v[22:23], 0
    v_mov_b64 v[24:25], 0
    v_mov_b64 v[28:29], 0
    s_waitcnt lgkmcnt(0)
    s_barrier
    ds_read_b128 v[32:35], v0 offset:16384
    ds_read_b128 v[36:39], v0 offset:17408
    s_cmp_eq_u32 s55, 63
    s_cbranch_scc1 CHS3_last
    v_mov_b64 v[16:17], 0
    v_mov_b64 v[18:19], 0
    v_mov_b64 v[26:27], 0
    v_mov_b64 v[30:31], 0
    s_waitcnt lgkmcnt(1)
    v_smfmac_f32_16x16x64_bf16 v[8:11], v[32:35], a[184:191], v1
    v_smfmac_f32_16x16x64_bf16 v[12:15], v[32:35], a[192:199], v1
    s_waitcnt vmcnt(6) lgkmcnt(0)
    v_smfmac_f32_16x16x64_bf16 v[8:11], v[36:39], v[72:79], v1
    buffer_load_dwordx4 v[72:75], v0, s[8:11], s61 offen offset:0
    v_smfmac_f32_16x16x64_bf16 v[12:15], v[36:39], v[40:47], v1
    s_waitcnt vmcnt(3)
    v_smfmac_f32_16x16x64_bf16 v[16:19], v[32:35], v[56:63], v1
    ds_read_b128 v[56:59], v7 offset:20480
    ds_read_b128 v[60:63], v7 offset:21504
    buffer_load_dwordx4 v[76:79], v0, s[8:11], s61 offen offset:1024
    v_smfmac_f32_16x16x64_bf16 v[20:23], v[32:35], v[64:71], v1
    ds_read_b128 v[64:67], v7 offset:22528
    ds_read_b128 v[68:71], v7 offset:23552
    buffer_load_dwordx4 v[40:43], v0, s[8:11], s61 offen offset:2048
    v_add_f32 v8, v8, v10
    v_add_f32 v9, v9, v11
    v_cvt_pk_bf16_f32 v8, v8, v9
    v_smfmac_f32_16x16x64_bf16 v[16:19], v[36:39], a[200:207], v1
    v_and_or_b32 v8, v8, -2, s65
    v_add_f32 v12, v12, v14
    v_add_f32 v13, v13, v15
    v_smfmac_f32_16x16x64_bf16 v[20:23], v[36:39], a[208:215], v1
    buffer_load_dwordx4 v[44:47], v0, s[8:11], s61 offen offset:3072
    v_cvt_pk_bf16_f32 v9, v12, v13
    buffer_store_dwordx2 v[8:9], v4, s[8:11], s58 offen sc1
    v_mov_b64 v[12:13], 0
    s_waitcnt vmcnt(5)
    v_smfmac_f32_16x16x64_bf16 v[24:27], v[32:35], a[216:223], v1
    v_mov_b64 v[14:15], 0
    v_mov_b64 v[10:11], 0
    v_mov_b64 v[8:9], 0
    v_smfmac_f32_16x16x64_bf16 v[28:31], v[32:35], v[48:55], v1
    buffer_load_dwordx4 v[48:51], v0, s[8:11], s3 offen offset:0
    v_add_f32 v16, v16, v18
    v_add_f32 v17, v17, v19
    v_cvt_pk_bf16_f32 v16, v16, v17
    s_waitcnt lgkmcnt(0)
    v_smfmac_f32_16x16x64_bf16 v[24:27], v[36:39], v[56:63], v1
    ds_read_b128 v[56:59], v7 offset:24576
    ds_read_b128 v[60:63], v7 offset:25600
    v_and_or_b32 v16, v16, -2, s65
    v_add_f32 v20, v20, v22
    v_add_f32 v21, v21, v23
    v_smfmac_f32_16x16x64_bf16 v[28:31], v[36:39], v[64:71], v1
    ds_read_b128 v[64:67], v7 offset:26624
    ds_read_b128 v[68:71], v7 offset:27648
    buffer_load_dwordx4 v[52:55], v0, s[8:11], s3 offen offset:1024
    v_cvt_pk_bf16_f32 v17, v20, v21
    buffer_store_dwordx2 v[16:17], v4, s[8:11], s75 offen sc1
    v_mov_b64 v[20:21], 0
    v_smfmac_f32_16x16x64_bf16 v[8:11], v[32:35], a[224:231], v1
    v_mov_b64 v[22:23], 0
    v_mov_b64 v[18:19], 0
    v_mov_b64 v[16:17], 0
    v_smfmac_f32_16x16x64_bf16 v[12:15], v[32:35], a[232:239], v1
    v_add_f32 v24, v24, v26
    v_add_f32 v25, v25, v27
    v_cvt_pk_bf16_f32 v24, v24, v25
    s_waitcnt lgkmcnt(0)
    v_smfmac_f32_16x16x64_bf16 v[8:11], v[36:39], v[56:63], v1
    ds_read_b128 v[56:59], v7 offset:28672
    ds_read_b128 v[60:63], v7 offset:29696
    v_and_or_b32 v24, v24, -2, s65
    v_add_f32 v28, v28, v30
    v_add_f32 v29, v29, v31
    v_smfmac_f32_16x16x64_bf16 v[12:15], v[36:39], v[64:71], v1
    ds_read_b128 v[64:67], v7 offset:30720
    ds_read_b128 v[68:71], v7 offset:31744
    v_cvt_pk_bf16_f32 v25, v28, v29
    buffer_store_dwordx2 v[24:25], v4, s[8:11], s76 offen sc1
    v_smfmac_f32_16x16x64_bf16 v[16:19], v[32:35], a[240:247], v1
    v_smfmac_f32_16x16x64_bf16 v[20:23], v[32:35], a[248:255], v1
    v_add_f32 v8, v8, v10
    v_add_f32 v9, v9, v11
    v_cvt_pk_bf16_f32 v8, v8, v9
    s_waitcnt lgkmcnt(0)
    v_smfmac_f32_16x16x64_bf16 v[16:19], v[36:39], v[56:63], v1
    v_and_or_b32 v8, v8, -2, s65
    v_add_f32 v12, v12, v14
    v_add_f32 v13, v13, v15
    v_smfmac_f32_16x16x64_bf16 v[20:23], v[36:39], v[64:71], v1
    v_cvt_pk_bf16_f32 v9, v12, v13
    buffer_store_dwordx2 v[8:9], v4, s[8:11], s77 offen sc1
    s_nop 1
    v_add_f32 v16, v16, v18
    v_add_f32 v17, v17, v19
    v_cvt_pk_bf16_f32 v16, v16, v17
    v_and_or_b32 v16, v16, -2, s65
    v_add_f32 v20, v20, v22
    v_add_f32 v21, v21, v23
    v_cvt_pk_bf16_f32 v17, v20, v21
    buffer_store_dwordx2 v[16:17], v4, s[8:11], s4 offen sc1
    v_min_u32 v80, v86, v87
    s_nop 0
    v_readlane_b32 s70, v80, 0
    v_readlane_b32 s73, v80, 1
    s_nop 0
    s_min_u32 s70, s70, s73
    s_max_u32 s67, s67, s70
    s_cmp_gt_u32 s67, s38
    s_cbranch_scc1 CHS3_inok_102
    s_mov_b32 s68, 0
CHS3_inlp_103:
    buffer_load_dwordx2 v[86:87], v85, s[8:11], s78 offen sc1
    s_waitcnt vmcnt(0)
    v_min_u32 v80, v86, v87
    s_nop 0
    v_readlane_b32 s70, v80, 0
    v_readlane_b32 s73, v80, 1
    s_nop 0
    s_min_u32 s70, s70, s73
    s_max_u32 s67, s67, s70
    s_cmp_gt_u32 s67, s38
    s_cbranch_scc1 CHS3_inok_102
    s_cmp_lg_u32 s69, 0
    s_cbranch_scc1 CHS3_inok_102
    s_sleep 2
    s_add_u32 s68, s68, 1
    s_cmp_lt_u32 s68, 65536
    s_cbranch_scc1 CHS3_inlp_103
    s_mov_b32 s69, 1
CHS3_inok_102:
    s_mov_b32 s68, 0
    s_barrier
    s_mov_b32 s68, 0
    v_bfe_u32 v29, v0, 4, 1
    v_lshlrev_b32 v29, 4, v29
    v_mov_b32 v30, 0x3f80
    v_lshlrev_b32 v29, v29, v30
    v_bfe_u32 v30, v0, 5, 3
    v_cmp_eq_u32 vcc, 0, v30
    s_nop 1
    v_cndmask_b32 v32, 0, v29, vcc
    v_cmp_eq_u32 vcc, 1, v30
    s_nop 1
    v_cndmask_b32 v33, 0, v29, vcc
    v_cmp_eq_u32 vcc, 2, v30
    s_nop 1
    v_cndmask_b32 v34, 0, v29, vcc
    v_cmp_eq_u32 vcc, 3, v30
    s_nop 1
    v_cndmask_b32 v35, 0, v29, vcc
    buffer_load_dwordx4 v[8:11], v0, s[8:11], s59 offen offset:0 sc1
    buffer_load_dwordx4 v[12:15], v0, s[8:11], s59 offen offset:1024 sc1
    s_sleep 3
    buffer_load_dwordx4 v[16:19], v0, s[8:11], s59 offen offset:0 sc1
    buffer_load_dwordx4 v[20:23], v0, s[8:11], s59 offen offset:1024 sc1
CHS3_rloop:
    s_waitcnt vmcnt(2)
    v_mfma_f32_16x16x32_bf16 v[24:27], v[8:11], v[32:35], 0
    v_and_b32 v29, v8, v10
    v_or_b32 v30, v8, v10
    v_mfma_f32_16x16x32_bf16 v[24:27], v[12:15], v[32:35], v[24:27]
    v_bitop3_b32 v29, v29, v12, v14 bitop3:0x80
    v_or3_b32 v30, v30, v12, v14
    v_bitop3_b32 v29, v29, v30, s65 bitop3:0x4e
    v_and_b32 v29, 1, v29
    v_cmp_ne_u32 vcc, 0, v29
    s_nop 2
    v_permlane32_swap_b32 v24, v26
    v_permlane32_swap_b32 v25, v27
    v_add_f32 v24, v24, v26
    v_add_f32 v25, v25, v27
    s_cbranch_vccnz CHS3_rbad0
    s_nop 0
    v_permlane16_swap_b32 v24, v25
    v_add_f32 v24, v24, v25
    v_cvt_pk_bf16_f32 v24, v24, v24
    buffer_store_short v24, v2, s[8:11], s56 offen sc1
    s_branch CHS3_rdone
CHS3_rbad0:
    buffer_load_dwordx4 v[8:11], v0, s[8:11], s59 offen offset:0 sc1
    buffer_load_dwordx4 v[12:15], v0, s[8:11], s59 offen offset:1024 sc1
    s_waitcnt vmcnt(2)
    v_mfma_f32_16x16x32_bf16 v[24:27], v[16:19], v[32:35], 0
    v_and_b32 v29, v16, v18
    v_or_b32 v30, v16, v18
    v_mfma_f32_16x16x32_bf16 v[24:27], v[20:23], v[32:35], v[24:27]
    v_bitop3_b32 v29, v29, v20, v22 bitop3:0x80
    v_or3_b32 v30, v30, v20, v22
    v_bitop3_b32 v29, v29, v30, s65 bitop3:0x4e
    v_and_b32 v29, 1, v29
    v_cmp_ne_u32 vcc, 0, v29
    s_nop 2
    v_permlane32_swap_b32 v24, v26
    v_permlane32_swap_b32 v25, v27
    v_add_f32 v24, v24, v26
    v_add_f32 v25, v25, v27
    s_cbranch_vccnz CHS3_rbad1
CHS3_rok:
    s_nop 0
    v_permlane16_swap_b32 v24, v25
    v_add_f32 v24, v24, v25
    v_cvt_pk_bf16_f32 v24, v24, v24
    buffer_store_short v24, v2, s[8:11], s56 offen sc1
    s_branch CHS3_rdone
CHS3_rbad1:
    buffer_load_dwordx4 v[16:19], v0, s[8:11], s59 offen offset:0 sc1
    buffer_load_dwordx4 v[20:23], v0, s[8:11], s59 offen offset:1024 sc1
    s_cmp_lg_u32 s69, 0
    s_cbranch_scc1 CHS3_rok
    s_add_u32 s68, s68, 1
    s_cmp_lt_u32 s68, 65536
    s_cbranch_scc1 CHS3_rloop
    s_mov_b32 s69, 1
    s_branch CHS3_rok
CHS3_rdone:
    v_mov_b32 v25, 0xff81ff81
    buffer_store_short v25, v2, s[8:11], s57 offen sc1
    s_mov_b32 m0, 22528
    s_nop 0
    buffer_load_dwordx4 v0, s[8:11], s63 offen offset:0 sc1 lds
    buffer_load_dwordx4 v0, s[8:11], s63 offen offset:1024 sc1 lds
    s_add_u32 s63, s63, 262144
    v_and_b32 v28, 512, v0
    v_mul_u32_u24 v28, 3, v28
    v_add_u32 v28, v28, v0
    ds_read_b128 v[24:27], v28 offset:13824
    s_add_u32 s72, s56, 8192
    s_xor_b32 s65, s65, 1
    s_add_u32 s64, s64, 131072
    s_xor_b32 s56, s56, s74
    s_xor_b32 s57, s57, s74
    s_add_u32 s62, s62, 262144
    s_add_u32 s55, s55, 1
    s_mov_b32 s68, 0
    s_mov_b32 m0, 8192
    s_add_u32 s38, s55, 1
    s_cmp_lt_u32 s38, 64
    s_cselect_b32 s70, 0, 262144
    s_sub_u32 s36, s63, s70
    s_sub_u32 s36, s36, 6144
    s_add_u32 s37, s36, 33554432
    s_add_u32 s70, s55, 2
    s_cmp_gt_u32 s67, s70
    s_cselect_b32 s37, 0x20000000, s78
    s_max_u32 s70, s55, 1
    s_sub_u32 s70, s70, 1
    v_mov_b32 v84, s70
    s_sleep 3
    buffer_load_dwordx4 v0, s[8:11], s72 offen offset:0 sc1 lds
    buffer_load_dwordx4 v0, s[8:11], s72 offen offset:1024 sc1 lds
    s_waitcnt vmcnt(6)
    ds_read_b128 v[56:59], v7 offset:16384
    ds_read_b128 v[60:63], v7 offset:17408
    ds_read_b128 v[64:67], v7 offset:18432
    ds_read_b128 v[68:71], v7 offset:19456
    v_mov_b64 v[8:9], 0
    v_mov_b64 v[10:11], 0
    v_mov_b64 v[12:13], 0
    v_mov_b64 v[14:15], 0
    v_mov_b64 v[16:17], 0
    v_mov_b64 v[18:19], 0
    v_mov_b64 v[20:21], 0
    v_mov_b64 v[22:23], 0
    s_sleep 2
CHS3_gloop:
    buffer_load_dwordx4 v0, s[8:11], s72 offen offset:0 sc1 lds
    buffer_load_dwordx4 v0, s[8:11], s72 offen offset:1024 sc1 lds
    s_waitcnt vmcnt(2)
    ds_read_b128 v[32:35], v0 offset:8192
    ds_read_b128 v[36:39], v0 offset:9216
    s_waitcnt lgkmcnt(1)
    v_pk_max_u16 v23, v32, v33
    v_pk_max_u16 v23, v23, v34
    v_pk_max_u16 v23, v23, v35
    s_waitcnt lgkmcnt(0)
    v_pk_max_u16 v23, v23, v36
    v_pk_max_u16 v23, v23, v37
    v_pk_max_u16 v23, v23, v38
    v_pk_max_u16 v23, v23, v39
    v_pk_max_u16 v23, v23, v23 op_sel:[0,1] op_sel_hi:[1,0]
    s_nop 0
    v_cmp_le_u32 vcc, 0xff810000, v23
    s_nop 0
    s_cbranch_vccz CHS3_loop
    s_add_u32 s68, s68, 1
    s_cmp_lt_u32 s68, 64
    s_cbranch_scc1 CHS3_gloop
    s_cmp_lg_u32 s69, 0
    s_cbranch_scc1 CHS3_loop
    v_mov_b32 v23, -1
    v_xor_b32 v22, 0xff81ff81, v32
    v_pk_min_u16 v23, v23, v22
    v_xor_b32 v22, 0xff81ff81, v33
    v_pk_min_u16 v23, v23, v22
    v_xor_b32 v22, 0xff81ff81, v34
    v_pk_min_u16 v23, v23, v22
    v_xor_b32 v22, 0xff81ff81, v35
    v_pk_min_u16 v23, v23, v22
    v_xor_b32 v22, 0xff81ff81, v36
    v_pk_min_u16 v23, v23, v22
    v_xor_b32 v22, 0xff81ff81, v37
    v_pk_min_u16 v23, v23, v22
    v_xor_b32 v22, 0xff81ff81, v38
    v_pk_min_u16 v23, v23, v22
    v_xor_b32 v22, 0xff81ff81, v39
    v_pk_min_u16 v23, v23, v22
    v_pk_min_u16 v23, v23, v23 op_sel:[0,1] op_sel_hi:[1,0]
    v_mov_b32 v22, 0
    v_cmp_eq_u32 vcc, 0, v23
    s_nop 0
    s_cbranch_vccz CHS3_loop
    s_sleep 1
    s_cmp_lt_u32 s68, 65536
    s_cbranch_scc1 CHS3_gloop
    s_mov_b32 s69, 1
    s_branch CHS3_loop
CHS3_last:
    v_and_b32 v28, 512, v0
    v_mul_u32_u24 v28, 3, v28
    v_add_u32 v28, v28, v0
    ds_read_b128 v[24:27], v28 offset:13824
    s_add_u32 s64, s64, 131072
    s_waitcnt lgkmcnt(0)
    buffer_store_dwordx4 v[24:27], v0, s[8:11], s64 offen sc1
    s_waitcnt vmcnt(0)
    s_barrier
    v_mov_b32 v80, 64
    s_mov_b64 exec, 1
    buffer_store_dword v80, off, s[8:11], s66 sc1
    s_mov_b64 exec, -1
    s_waitcnt vmcnt(0) lgkmcnt(0)
    s_endpgm
.section .rodata,"a"
.p2align 6
.amdhsa_kernel interleave_layers__memory_aug_recurrent_mem_tr__dense_activation_relu__prompt_kernel
  .amdhsa_next_free_vgpr 512
  .amdhsa_next_free_sgpr 102
  .amdhsa_accum_offset 256
  .amdhsa_group_segment_fixed_size 0
  .amdhsa_kernarg_size 104
  .amdhsa_user_sgpr_count 2
  .amdhsa_user_sgpr_kernarg_segment_ptr 1
  .amdhsa_system_sgpr_workgroup_id_x 1
.end_amdhsa_kernel
```
